```python
import torch

def _softmax(x, axis=-1):
    return torch.softmax(x, dim=axis)

def _gelu(x):
    return torch.nn.functional.gelu(x, approximate='tanh')

def _silu(x):
    return torch.nn.functional.silu(x)

def _sigmoid(x):
    return torch.sigmoid(x)

def _layernorm(x, axis=-1, eps=1e-05):
    m = x.mean(dim=axis, keepdim=True)
    v = x.var(dim=axis, keepdim=True, unbiased=False)
    return (x - m) / torch.sqrt(v + eps)

def _scatter_add(tgt, idx, src, axis=0):
    return tgt.clone().index_add_(axis, idx, src)

def _segment_sum(src, seg, n):
    out = torch.zeros((n,) + src.shape[1:], dtype=src.dtype)
    return out.index_add_(0, seg, src)

def _pad(x, pw):
    flat = tuple((v for pair in reversed(pw) for v in pair))
    return torch.nn.functional.pad(x, flat)
kernel_name = 'adaLN_cond__memory_aug_recurrent_mem_tr__geglu_ffn__prompt'

def setup_inputs():

    _w = lambda a: (lambda t: t.to(torch.bfloat16) if t.is_floating_point() else t)(torch.as_tensor(a))

    def _A_setup():
        B, S, Dm = (1, 2048, 576)
        H, Dh = (32, 128)
        M, seg = (8, 32)
        seg = min(seg, S)
        S = S // seg * seg
        return {'x': _w((lambda *s: torch.randn(*s, dtype=torch.bfloat16) * 0.05)(B, S, Dm)), 'mem0': _w((lambda *s: torch.randn(*s, dtype=torch.bfloat16) * 0.4)(B, M, Dm)), 'Wq': _w((lambda *s: torch.randn(*s, dtype=torch.bfloat16) * 3.2)(Dm, H, Dh) * Dm ** (-0.5)), 'Wk': _w((lambda *s: torch.randn(*s, dtype=torch.bfloat16) * 3.2)(Dm, H, Dh) * Dm ** (-0.5)), 'Wv': _w((lambda *s: torch.randn(*s, dtype=torch.bfloat16) * 0.4)(Dm, H, Dh) * Dm ** (-0.5)), 'Wo': _w((lambda *s: torch.randn(*s, dtype=torch.bfloat16) * 0.4)(H, Dh, Dm) * (H * Dh) ** (-0.5)), 'seg_len': seg}
    _A_in = _A_setup()

    def _B_setup():
        B, S, D, F = (1, 2048, 576, 4608)
        return {'x': _w((lambda *s: torch.randn(*s, dtype=torch.bfloat16) * 0.05)(B, S, D)), 'w_gate': _w((lambda *s: torch.randn(*s, dtype=torch.bfloat16) * 0.05)(D, F)), 'w_up': _w((lambda *s: torch.randn(*s, dtype=torch.bfloat16) * 0.05)(D, F)), 'w_down': _w((lambda *s: torch.randn(*s, dtype=torch.bfloat16) * 0.05)(F, D))}
    _B_in = _B_setup()
    return {'A_x': _A_in['x'], 'A_mem0': _A_in['mem0'], 'A_Wq': _A_in['Wq'], 'A_Wk': _A_in['Wk'], 'A_Wv': _A_in['Wv'], 'A_Wo': _A_in['Wo'], 'A_seg_len': _A_in['seg_len'], 'B_x': _B_in['x'], 'B_w_gate': _B_in['w_gate'], 'B_w_up': _B_in['w_up'], 'B_w_down': _B_in['w_down'], 'c': _w((lambda *s: torch.randn(*s, dtype=torch.bfloat16) * 0.1)(1, 576) * 8.0), 'w_mod': _w((lambda *s: torch.randn(*s, dtype=torch.bfloat16) * 0.1)(576, 6 * 576) * 576 ** (-0.5) * 8.0)}

def reference(A_x, A_mem0, A_Wq, A_Wk, A_Wv, A_Wo, A_seg_len, B_x, B_w_gate, B_w_up, B_w_down, c, w_mod):

    def _A_ref(x, mem0, Wq, Wk, Wv, Wo, seg_len):
        B, S, Dm = x.shape
        H, Dh = (Wq.shape[1], Wq.shape[2])
        M = mem0.shape[1]
        scale = Dh ** (-0.5)
        n_seg = S // seg_len
        L = M + seg_len
        idx = torch.arange(L)
        mask = (idx[:, None] < M) | (idx[:, None] >= idx[None, :])
        mem = mem0
        outs = []
        for s in range(n_seg):
            xs = x[:, s * seg_len:(s + 1) * seg_len, :].clone()
            h = torch.concatenate([mem, xs], axis=1)
            q = torch.einsum('btd,dhe->bhte', h, Wq)
            k = torch.einsum('btd,dhe->bhte', h, Wk)
            v = torch.einsum('btd,dhe->bhte', h, Wv)
            scores = torch.einsum('bhqe,bhke->bhqk', q, k) * scale
            scores = torch.where(mask[None, None], scores, -1000000000.0)
            p = _softmax(scores, axis=-1)
            o = torch.einsum('bhqk,bhke->bhqe', p, v)
            o = torch.einsum('bhte,hed->btd', o, Wo)
            mem = o[:, :M, :].clone()
            outs.append(o[:, M:, :])
        return torch.concatenate(outs, axis=1)

    def _B_ref(x, w_gate, w_up, w_down):
        return _gelu(x @ w_gate) * (x @ w_up) @ w_down
    x = A_x
    mod = (_silu(c) @ w_mod).reshape(c.shape[0], 6, 1, -1)
    sa, ca, ga, sb, cb, gb = (mod[:, 0].clone(), mod[:, 1].clone(), mod[:, 2].clone(), mod[:, 3].clone(), mod[:, 4].clone(), mod[:, 5].clone())
    h = _layernorm(x, axis=-1) * (1 + ca) + sa
    x = x + ga * _A_ref(h, A_mem0, A_Wq, A_Wk, A_Wv, A_Wo, A_seg_len)
    h = _layernorm(x, axis=-1) * (1 + cb) + sb
    x = x + gb * _B_ref(h, B_w_gate, B_w_up, B_w_down)
    return x
```

```asm
; @launch kernel=mega_kernel grid=(256,1,1) block=(256,1,1) lds=163840
.amdgcn_target "amdgcn-amd-amdhsa--gfx950"
.text
.globl mega_kernel
.p2align 8
.type mega_kernel,@function
mega_kernel:
    s_cmp_ge_u32 s2, 256
    s_cbranch_scc1 L_end_1
    s_load_dwordx2 s[4:5], s[0:1], 120
    s_load_dwordx2 s[6:7], s[0:1], 112
    s_getreg_b32 s72, hwreg(HW_REG_XCC_ID)
    s_and_b32 s72, s72, 7
    v_lshrrev_b32 v1, 6, v0
    s_nop 0
    v_readfirstlane_b32 s73, v1
    s_waitcnt lgkmcnt(0)

    s_add_u32 s68, s4, 135462912
    s_addc_u32 s69, s5, 0
    s_and_b32 s69, s69, 0xffff
    s_mov_b32 s70, 65536
    s_mov_b32 s71, 0x00020000

    s_mov_b32 s84, s6
    s_and_b32 s85, s7, 0xffff
    s_mov_b32 s86, 256
    s_mov_b32 s87, 0x00020000

    s_add_u32 s8, s4, 134217728
    s_addc_u32 s9, s5, 0
    s_and_b32 s9, s9, 0xffff
    s_mov_b32 s10, 1310720
    s_mov_b32 s11, 0x00020000

    s_mul_i32 s22, s2, 5120
    v_lshlrev_b32 v1, 4, v0
    v_mov_b32 v4, 0
    v_mov_b32 v5, 0
    v_mov_b32 v6, 0
    v_mov_b32 v7, 0
    buffer_store_dwordx4 v[4:7], v1, s[8:11], s22 offen sc1
    v_cmp_gt_u32 vcc, 64, v0
    s_and_saveexec_b64 s[24:25], vcc
    s_add_u32 s22, s22, 4096
    buffer_store_dwordx4 v[4:7], v1, s[8:11], s22 offen sc1
    s_mov_b64 exec, s[24:25]
    s_cmp_ge_u32 s2, 27
    s_cbranch_scc1 L_nomod_6
    s_load_dwordx2 s[6:7], s[0:1], 96
    s_load_dwordx2 s[20:21], s[0:1], 88
    s_waitcnt lgkmcnt(0)

    s_mov_b32 s8, s6
    s_and_b32 s9, s7, 0xffff
    s_mov_b32 s10, 3981312
    s_mov_b32 s11, 0x00020000

    s_mov_b32 s12, s20
    s_and_b32 s13, s21, 0xffff
    s_mov_b32 s14, 1152
    s_mov_b32 s15, 0x00020000

    s_add_u32 s16, s4, 0
    s_addc_u32 s17, s5, 0
    s_and_b32 s17, s17, 0xffff
    s_mov_b32 s18, 13824
    s_mov_b32 s19, 0x00020000

    v_and_b32 v1, 63, v0
    v_lshrrev_b32 v2, 6, v0
    s_nop 0
    v_readfirstlane_b32 s22, v2
    s_mul_i32 s23, s22, 288
    v_lshlrev_b32 v3, 1, v1
    buffer_load_ushort v4, v3, s[12:15], s23 offen
    buffer_load_ushort v5, v3, s[12:15], s23 offen offset:128
    buffer_load_ushort v6, v3, s[12:15], s23 offen offset:256
    s_lshl_b32 s23, s2, 8
    s_mul_i32 s24, s22, 995328
    s_add_u32 s24, s24, s23
    v_lshlrev_b32 v7, 2, v1
    s_waitcnt vmcnt(0)

    v_lshlrev_b32 v4, 16, v4
    v_mul_f32 v8, 0xbfb8aa3b, v4
    v_exp_f32 v8, v8
    s_nop 0
    v_add_f32 v8, 1.0, v8
    v_rcp_f32 v8, v8
    s_nop 0
    v_mul_f32 v4, v4, v8

    v_cvt_pk_bf16_f32 v8, v4, v4
    v_lshlrev_b32 v4, 16, v8

    v_lshlrev_b32 v5, 16, v5
    v_mul_f32 v8, 0xbfb8aa3b, v5
    v_exp_f32 v8, v8
    s_nop 0
    v_add_f32 v8, 1.0, v8
    v_rcp_f32 v8, v8
    s_nop 0
    v_mul_f32 v5, v5, v8

    v_cvt_pk_bf16_f32 v8, v5, v5
    v_lshlrev_b32 v5, 16, v8

    v_lshlrev_b32 v6, 16, v6
    v_mul_f32 v8, 0xbfb8aa3b, v6
    v_exp_f32 v8, v8
    s_nop 0
    v_add_f32 v8, 1.0, v8
    v_rcp_f32 v8, v8
    s_nop 0
    v_mul_f32 v6, v6, v8

    v_cvt_pk_bf16_f32 v8, v6, v6
    v_lshlrev_b32 v6, 16, v8

    v_mov_b32 v8, 0
    v_mov_b32 v9, 0
    s_add_u32 s25, s24, 0
    buffer_load_dword v16, v7, s[8:11], s25 offen
    s_add_u32 s25, s24, 6912
    buffer_load_dword v17, v7, s[8:11], s25 offen
    s_add_u32 s25, s24, 13824
    buffer_load_dword v18, v7, s[8:11], s25 offen
    s_add_u32 s25, s24, 20736
    buffer_load_dword v19, v7, s[8:11], s25 offen
    s_add_u32 s25, s24, 27648
    buffer_load_dword v20, v7, s[8:11], s25 offen
    s_add_u32 s25, s24, 34560
    buffer_load_dword v21, v7, s[8:11], s25 offen
    s_add_u32 s25, s24, 41472
    buffer_load_dword v22, v7, s[8:11], s25 offen
    s_add_u32 s25, s24, 48384
    buffer_load_dword v23, v7, s[8:11], s25 offen
    s_add_u32 s25, s24, 55296
    buffer_load_dword v24, v7, s[8:11], s25 offen
    s_add_u32 s25, s24, 62208
    buffer_load_dword v25, v7, s[8:11], s25 offen
    s_add_u32 s25, s24, 69120
    buffer_load_dword v26, v7, s[8:11], s25 offen
    s_add_u32 s25, s24, 76032
    buffer_load_dword v27, v7, s[8:11], s25 offen
    s_add_u32 s25, s24, 82944
    buffer_load_dword v28, v7, s[8:11], s25 offen
    s_add_u32 s25, s24, 89856
    buffer_load_dword v29, v7, s[8:11], s25 offen
    s_add_u32 s25, s24, 96768
    buffer_load_dword v30, v7, s[8:11], s25 offen
    s_add_u32 s25, s24, 103680
    buffer_load_dword v31, v7, s[8:11], s25 offen
    s_add_u32 s25, s24, 110592
    buffer_load_dword v32, v7, s[8:11], s25 offen
    s_add_u32 s25, s24, 117504
    buffer_load_dword v33, v7, s[8:11], s25 offen
    s_add_u32 s25, s24, 124416
    buffer_load_dword v34, v7, s[8:11], s25 offen
    s_add_u32 s25, s24, 131328
    buffer_load_dword v35, v7, s[8:11], s25 offen
    s_add_u32 s25, s24, 138240
    buffer_load_dword v36, v7, s[8:11], s25 offen
    s_add_u32 s25, s24, 145152
    buffer_load_dword v37, v7, s[8:11], s25 offen
    s_add_u32 s25, s24, 152064
    buffer_load_dword v38, v7, s[8:11], s25 offen
    s_add_u32 s25, s24, 158976
    buffer_load_dword v39, v7, s[8:11], s25 offen
    s_add_u32 s25, s24, 165888
    buffer_load_dword v40, v7, s[8:11], s25 offen
    s_add_u32 s25, s24, 172800
    buffer_load_dword v41, v7, s[8:11], s25 offen
    s_add_u32 s25, s24, 179712
    buffer_load_dword v42, v7, s[8:11], s25 offen
    s_add_u32 s25, s24, 186624
    buffer_load_dword v43, v7, s[8:11], s25 offen
    s_add_u32 s25, s24, 193536
    buffer_load_dword v44, v7, s[8:11], s25 offen
    s_add_u32 s25, s24, 200448
    buffer_load_dword v45, v7, s[8:11], s25 offen
    s_add_u32 s25, s24, 207360
    buffer_load_dword v46, v7, s[8:11], s25 offen
    s_add_u32 s25, s24, 214272
    buffer_load_dword v47, v7, s[8:11], s25 offen
    s_add_u32 s25, s24, 221184
    buffer_load_dword v48, v7, s[8:11], s25 offen
    s_add_u32 s25, s24, 228096
    buffer_load_dword v49, v7, s[8:11], s25 offen
    s_add_u32 s25, s24, 235008
    buffer_load_dword v50, v7, s[8:11], s25 offen
    s_add_u32 s25, s24, 241920
    buffer_load_dword v51, v7, s[8:11], s25 offen
    s_add_u32 s25, s24, 248832
    buffer_load_dword v52, v7, s[8:11], s25 offen
    s_add_u32 s25, s24, 255744
    buffer_load_dword v53, v7, s[8:11], s25 offen
    s_add_u32 s25, s24, 262656
    buffer_load_dword v54, v7, s[8:11], s25 offen
    s_add_u32 s25, s24, 269568
    buffer_load_dword v55, v7, s[8:11], s25 offen
    s_add_u32 s25, s24, 276480
    buffer_load_dword v56, v7, s[8:11], s25 offen
    s_add_u32 s25, s24, 283392
    buffer_load_dword v57, v7, s[8:11], s25 offen
    s_add_u32 s25, s24, 290304
    buffer_load_dword v58, v7, s[8:11], s25 offen
    s_add_u32 s25, s24, 297216
    buffer_load_dword v59, v7, s[8:11], s25 offen
    s_add_u32 s25, s24, 304128
    buffer_load_dword v60, v7, s[8:11], s25 offen
    s_add_u32 s25, s24, 311040
    buffer_load_dword v61, v7, s[8:11], s25 offen
    s_add_u32 s25, s24, 317952
    buffer_load_dword v62, v7, s[8:11], s25 offen
    s_add_u32 s25, s24, 324864
    buffer_load_dword v63, v7, s[8:11], s25 offen
    s_add_u32 s25, s24, 331776
    buffer_load_dword v64, v7, s[8:11], s25 offen
    s_add_u32 s25, s24, 338688
    buffer_load_dword v65, v7, s[8:11], s25 offen
    s_add_u32 s25, s24, 345600
    buffer_load_dword v66, v7, s[8:11], s25 offen
    s_add_u32 s25, s24, 352512
    buffer_load_dword v67, v7, s[8:11], s25 offen
    s_add_u32 s25, s24, 359424
    buffer_load_dword v68, v7, s[8:11], s25 offen
    s_add_u32 s25, s24, 366336
    buffer_load_dword v69, v7, s[8:11], s25 offen
    s_add_u32 s25, s24, 373248
    buffer_load_dword v70, v7, s[8:11], s25 offen
    s_add_u32 s25, s24, 380160
    buffer_load_dword v71, v7, s[8:11], s25 offen
    v_readlane_b32 s26, v4, 0
    s_waitcnt vmcnt(55)
    v_lshlrev_b32 v10, 16, v16
    v_and_b32 v11, 0xffff0000, v16
    v_fmac_f32 v8, s26, v10
    v_fmac_f32 v9, s26, v11

    s_add_u32 s25, s24, 387072
    buffer_load_dword v16, v7, s[8:11], s25 offen
    v_readlane_b32 s26, v4, 1
    s_waitcnt vmcnt(55)
    v_lshlrev_b32 v10, 16, v17
    v_and_b32 v11, 0xffff0000, v17
    v_fmac_f32 v8, s26, v10
    v_fmac_f32 v9, s26, v11

    s_add_u32 s25, s24, 393984
    buffer_load_dword v17, v7, s[8:11], s25 offen
    v_readlane_b32 s26, v4, 2
    s_waitcnt vmcnt(55)
    v_lshlrev_b32 v10, 16, v18
    v_and_b32 v11, 0xffff0000, v18
    v_fmac_f32 v8, s26, v10
    v_fmac_f32 v9, s26, v11

    s_add_u32 s25, s24, 400896
    buffer_load_dword v18, v7, s[8:11], s25 offen
    v_readlane_b32 s26, v4, 3
    s_waitcnt vmcnt(55)
    v_lshlrev_b32 v10, 16, v19
    v_and_b32 v11, 0xffff0000, v19
    v_fmac_f32 v8, s26, v10
    v_fmac_f32 v9, s26, v11

    s_add_u32 s25, s24, 407808
    buffer_load_dword v19, v7, s[8:11], s25 offen
    v_readlane_b32 s26, v4, 4
    s_waitcnt vmcnt(55)
    v_lshlrev_b32 v10, 16, v20
    v_and_b32 v11, 0xffff0000, v20
    v_fmac_f32 v8, s26, v10
    v_fmac_f32 v9, s26, v11

    s_add_u32 s25, s24, 414720
    buffer_load_dword v20, v7, s[8:11], s25 offen
    v_readlane_b32 s26, v4, 5
    s_waitcnt vmcnt(55)
    v_lshlrev_b32 v10, 16, v21
    v_and_b32 v11, 0xffff0000, v21
    v_fmac_f32 v8, s26, v10
    v_fmac_f32 v9, s26, v11

    s_add_u32 s25, s24, 421632
    buffer_load_dword v21, v7, s[8:11], s25 offen
    v_readlane_b32 s26, v4, 6
    s_waitcnt vmcnt(55)
    v_lshlrev_b32 v10, 16, v22
    v_and_b32 v11, 0xffff0000, v22
    v_fmac_f32 v8, s26, v10
    v_fmac_f32 v9, s26, v11

    s_add_u32 s25, s24, 428544
    buffer_load_dword v22, v7, s[8:11], s25 offen
    v_readlane_b32 s26, v4, 7
    s_waitcnt vmcnt(55)
    v_lshlrev_b32 v10, 16, v23
    v_and_b32 v11, 0xffff0000, v23
    v_fmac_f32 v8, s26, v10
    v_fmac_f32 v9, s26, v11

    s_add_u32 s25, s24, 435456
    buffer_load_dword v23, v7, s[8:11], s25 offen
    v_readlane_b32 s26, v4, 8
    s_waitcnt vmcnt(55)
    v_lshlrev_b32 v10, 16, v24
    v_and_b32 v11, 0xffff0000, v24
    v_fmac_f32 v8, s26, v10
    v_fmac_f32 v9, s26, v11

    s_add_u32 s25, s24, 442368
    buffer_load_dword v24, v7, s[8:11], s25 offen
    v_readlane_b32 s26, v4, 9
    s_waitcnt vmcnt(55)
    v_lshlrev_b32 v10, 16, v25
    v_and_b32 v11, 0xffff0000, v25
    v_fmac_f32 v8, s26, v10
    v_fmac_f32 v9, s26, v11

    s_add_u32 s25, s24, 449280
    buffer_load_dword v25, v7, s[8:11], s25 offen
    v_readlane_b32 s26, v4, 10
    s_waitcnt vmcnt(55)
    v_lshlrev_b32 v10, 16, v26
    v_and_b32 v11, 0xffff0000, v26
    v_fmac_f32 v8, s26, v10
    v_fmac_f32 v9, s26, v11

    s_add_u32 s25, s24, 456192
    buffer_load_dword v26, v7, s[8:11], s25 offen
    v_readlane_b32 s26, v4, 11
    s_waitcnt vmcnt(55)
    v_lshlrev_b32 v10, 16, v27
    v_and_b32 v11, 0xffff0000, v27
    v_fmac_f32 v8, s26, v10
    v_fmac_f32 v9, s26, v11

    s_add_u32 s25, s24, 463104
    buffer_load_dword v27, v7, s[8:11], s25 offen
    v_readlane_b32 s26, v4, 12
    s_waitcnt vmcnt(55)
    v_lshlrev_b32 v10, 16, v28
    v_and_b32 v11, 0xffff0000, v28
    v_fmac_f32 v8, s26, v10
    v_fmac_f32 v9, s26, v11

    s_add_u32 s25, s24, 470016
    buffer_load_dword v28, v7, s[8:11], s25 offen
    v_readlane_b32 s26, v4, 13
    s_waitcnt vmcnt(55)
    v_lshlrev_b32 v10, 16, v29
    v_and_b32 v11, 0xffff0000, v29
    v_fmac_f32 v8, s26, v10
    v_fmac_f32 v9, s26, v11

    s_add_u32 s25, s24, 476928
    buffer_load_dword v29, v7, s[8:11], s25 offen
    v_readlane_b32 s26, v4, 14
    s_waitcnt vmcnt(55)
    v_lshlrev_b32 v10, 16, v30
    v_and_b32 v11, 0xffff0000, v30
    v_fmac_f32 v8, s26, v10
    v_fmac_f32 v9, s26, v11

    s_add_u32 s25, s24, 483840
    buffer_load_dword v30, v7, s[8:11], s25 offen
    v_readlane_b32 s26, v4, 15
    s_waitcnt vmcnt(55)
    v_lshlrev_b32 v10, 16, v31
    v_and_b32 v11, 0xffff0000, v31
    v_fmac_f32 v8, s26, v10
    v_fmac_f32 v9, s26, v11

    s_add_u32 s25, s24, 490752
    buffer_load_dword v31, v7, s[8:11], s25 offen
    v_readlane_b32 s26, v4, 16
    s_waitcnt vmcnt(55)
    v_lshlrev_b32 v10, 16, v32
    v_and_b32 v11, 0xffff0000, v32
    v_fmac_f32 v8, s26, v10
    v_fmac_f32 v9, s26, v11

    s_add_u32 s25, s24, 497664
    buffer_load_dword v32, v7, s[8:11], s25 offen
    v_readlane_b32 s26, v4, 17
    s_waitcnt vmcnt(55)
    v_lshlrev_b32 v10, 16, v33
    v_and_b32 v11, 0xffff0000, v33
    v_fmac_f32 v8, s26, v10
    v_fmac_f32 v9, s26, v11

    s_add_u32 s25, s24, 504576
    buffer_load_dword v33, v7, s[8:11], s25 offen
    v_readlane_b32 s26, v4, 18
    s_waitcnt vmcnt(55)
    v_lshlrev_b32 v10, 16, v34
    v_and_b32 v11, 0xffff0000, v34
    v_fmac_f32 v8, s26, v10
    v_fmac_f32 v9, s26, v11

    s_add_u32 s25, s24, 511488
    buffer_load_dword v34, v7, s[8:11], s25 offen
    v_readlane_b32 s26, v4, 19
    s_waitcnt vmcnt(55)
    v_lshlrev_b32 v10, 16, v35
    v_and_b32 v11, 0xffff0000, v35
    v_fmac_f32 v8, s26, v10
    v_fmac_f32 v9, s26, v11

    s_add_u32 s25, s24, 518400
    buffer_load_dword v35, v7, s[8:11], s25 offen
    v_readlane_b32 s26, v4, 20
    s_waitcnt vmcnt(55)
    v_lshlrev_b32 v10, 16, v36
    v_and_b32 v11, 0xffff0000, v36
    v_fmac_f32 v8, s26, v10
    v_fmac_f32 v9, s26, v11

    s_add_u32 s25, s24, 525312
    buffer_load_dword v36, v7, s[8:11], s25 offen
    v_readlane_b32 s26, v4, 21
    s_waitcnt vmcnt(55)
    v_lshlrev_b32 v10, 16, v37
    v_and_b32 v11, 0xffff0000, v37
    v_fmac_f32 v8, s26, v10
    v_fmac_f32 v9, s26, v11

    s_add_u32 s25, s24, 532224
    buffer_load_dword v37, v7, s[8:11], s25 offen
    v_readlane_b32 s26, v4, 22
    s_waitcnt vmcnt(55)
    v_lshlrev_b32 v10, 16, v38
    v_and_b32 v11, 0xffff0000, v38
    v_fmac_f32 v8, s26, v10
    v_fmac_f32 v9, s26, v11

    s_add_u32 s25, s24, 539136
    buffer_load_dword v38, v7, s[8:11], s25 offen
    v_readlane_b32 s26, v4, 23
    s_waitcnt vmcnt(55)
    v_lshlrev_b32 v10, 16, v39
    v_and_b32 v11, 0xffff0000, v39
    v_fmac_f32 v8, s26, v10
    v_fmac_f32 v9, s26, v11

    s_add_u32 s25, s24, 546048
    buffer_load_dword v39, v7, s[8:11], s25 offen
    v_readlane_b32 s26, v4, 24
    s_waitcnt vmcnt(55)
    v_lshlrev_b32 v10, 16, v40
    v_and_b32 v11, 0xffff0000, v40
    v_fmac_f32 v8, s26, v10
    v_fmac_f32 v9, s26, v11

    s_add_u32 s25, s24, 552960
    buffer_load_dword v40, v7, s[8:11], s25 offen
    v_readlane_b32 s26, v4, 25
    s_waitcnt vmcnt(55)
    v_lshlrev_b32 v10, 16, v41
    v_and_b32 v11, 0xffff0000, v41
    v_fmac_f32 v8, s26, v10
    v_fmac_f32 v9, s26, v11

    s_add_u32 s25, s24, 559872
    buffer_load_dword v41, v7, s[8:11], s25 offen
    v_readlane_b32 s26, v4, 26
    s_waitcnt vmcnt(55)
    v_lshlrev_b32 v10, 16, v42
    v_and_b32 v11, 0xffff0000, v42
    v_fmac_f32 v8, s26, v10
    v_fmac_f32 v9, s26, v11

    s_add_u32 s25, s24, 566784
    buffer_load_dword v42, v7, s[8:11], s25 offen
    v_readlane_b32 s26, v4, 27
    s_waitcnt vmcnt(55)
    v_lshlrev_b32 v10, 16, v43
    v_and_b32 v11, 0xffff0000, v43
    v_fmac_f32 v8, s26, v10
    v_fmac_f32 v9, s26, v11

    s_add_u32 s25, s24, 573696
    buffer_load_dword v43, v7, s[8:11], s25 offen
    v_readlane_b32 s26, v4, 28
    s_waitcnt vmcnt(55)
    v_lshlrev_b32 v10, 16, v44
    v_and_b32 v11, 0xffff0000, v44
    v_fmac_f32 v8, s26, v10
    v_fmac_f32 v9, s26, v11

    s_add_u32 s25, s24, 580608
    buffer_load_dword v44, v7, s[8:11], s25 offen
    v_readlane_b32 s26, v4, 29
    s_waitcnt vmcnt(55)
    v_lshlrev_b32 v10, 16, v45
    v_and_b32 v11, 0xffff0000, v45
    v_fmac_f32 v8, s26, v10
    v_fmac_f32 v9, s26, v11

    s_add_u32 s25, s24, 587520
    buffer_load_dword v45, v7, s[8:11], s25 offen
    v_readlane_b32 s26, v4, 30
    s_waitcnt vmcnt(55)
    v_lshlrev_b32 v10, 16, v46
    v_and_b32 v11, 0xffff0000, v46
    v_fmac_f32 v8, s26, v10
    v_fmac_f32 v9, s26, v11

    s_add_u32 s25, s24, 594432
    buffer_load_dword v46, v7, s[8:11], s25 offen
    v_readlane_b32 s26, v4, 31
    s_waitcnt vmcnt(55)
    v_lshlrev_b32 v10, 16, v47
    v_and_b32 v11, 0xffff0000, v47
    v_fmac_f32 v8, s26, v10
    v_fmac_f32 v9, s26, v11

    s_add_u32 s25, s24, 601344
    buffer_load_dword v47, v7, s[8:11], s25 offen
    v_readlane_b32 s26, v4, 32
    s_waitcnt vmcnt(55)
    v_lshlrev_b32 v10, 16, v48
    v_and_b32 v11, 0xffff0000, v48
    v_fmac_f32 v8, s26, v10
    v_fmac_f32 v9, s26, v11

    s_add_u32 s25, s24, 608256
    buffer_load_dword v48, v7, s[8:11], s25 offen
    v_readlane_b32 s26, v4, 33
    s_waitcnt vmcnt(55)
    v_lshlrev_b32 v10, 16, v49
    v_and_b32 v11, 0xffff0000, v49
    v_fmac_f32 v8, s26, v10
    v_fmac_f32 v9, s26, v11

    s_add_u32 s25, s24, 615168
    buffer_load_dword v49, v7, s[8:11], s25 offen
    v_readlane_b32 s26, v4, 34
    s_waitcnt vmcnt(55)
    v_lshlrev_b32 v10, 16, v50
    v_and_b32 v11, 0xffff0000, v50
    v_fmac_f32 v8, s26, v10
    v_fmac_f32 v9, s26, v11

    s_add_u32 s25, s24, 622080
    buffer_load_dword v50, v7, s[8:11], s25 offen
    v_readlane_b32 s26, v4, 35
    s_waitcnt vmcnt(55)
    v_lshlrev_b32 v10, 16, v51
    v_and_b32 v11, 0xffff0000, v51
    v_fmac_f32 v8, s26, v10
    v_fmac_f32 v9, s26, v11

    s_add_u32 s25, s24, 628992
    buffer_load_dword v51, v7, s[8:11], s25 offen
    v_readlane_b32 s26, v4, 36
    s_waitcnt vmcnt(55)
    v_lshlrev_b32 v10, 16, v52
    v_and_b32 v11, 0xffff0000, v52
    v_fmac_f32 v8, s26, v10
    v_fmac_f32 v9, s26, v11

    s_add_u32 s25, s24, 635904
    buffer_load_dword v52, v7, s[8:11], s25 offen
    v_readlane_b32 s26, v4, 37
    s_waitcnt vmcnt(55)
    v_lshlrev_b32 v10, 16, v53
    v_and_b32 v11, 0xffff0000, v53
    v_fmac_f32 v8, s26, v10
    v_fmac_f32 v9, s26, v11

    s_add_u32 s25, s24, 642816
    buffer_load_dword v53, v7, s[8:11], s25 offen
    v_readlane_b32 s26, v4, 38
    s_waitcnt vmcnt(55)
    v_lshlrev_b32 v10, 16, v54
    v_and_b32 v11, 0xffff0000, v54
    v_fmac_f32 v8, s26, v10
    v_fmac_f32 v9, s26, v11

    s_add_u32 s25, s24, 649728
    buffer_load_dword v54, v7, s[8:11], s25 offen
    v_readlane_b32 s26, v4, 39
    s_waitcnt vmcnt(55)
    v_lshlrev_b32 v10, 16, v55
    v_and_b32 v11, 0xffff0000, v55
    v_fmac_f32 v8, s26, v10
    v_fmac_f32 v9, s26, v11

    s_add_u32 s25, s24, 656640
    buffer_load_dword v55, v7, s[8:11], s25 offen
    v_readlane_b32 s26, v4, 40
    s_waitcnt vmcnt(55)
    v_lshlrev_b32 v10, 16, v56
    v_and_b32 v11, 0xffff0000, v56
    v_fmac_f32 v8, s26, v10
    v_fmac_f32 v9, s26, v11

    s_add_u32 s25, s24, 663552
    buffer_load_dword v56, v7, s[8:11], s25 offen
    v_readlane_b32 s26, v4, 41
    s_waitcnt vmcnt(55)
    v_lshlrev_b32 v10, 16, v57
    v_and_b32 v11, 0xffff0000, v57
    v_fmac_f32 v8, s26, v10
    v_fmac_f32 v9, s26, v11

    s_add_u32 s25, s24, 670464
    buffer_load_dword v57, v7, s[8:11], s25 offen
    v_readlane_b32 s26, v4, 42
    s_waitcnt vmcnt(55)
    v_lshlrev_b32 v10, 16, v58
    v_and_b32 v11, 0xffff0000, v58
    v_fmac_f32 v8, s26, v10
    v_fmac_f32 v9, s26, v11

    s_add_u32 s25, s24, 677376
    buffer_load_dword v58, v7, s[8:11], s25 offen
    v_readlane_b32 s26, v4, 43
    s_waitcnt vmcnt(55)
    v_lshlrev_b32 v10, 16, v59
    v_and_b32 v11, 0xffff0000, v59
    v_fmac_f32 v8, s26, v10
    v_fmac_f32 v9, s26, v11

    s_add_u32 s25, s24, 684288
    buffer_load_dword v59, v7, s[8:11], s25 offen
    v_readlane_b32 s26, v4, 44
    s_waitcnt vmcnt(55)
    v_lshlrev_b32 v10, 16, v60
    v_and_b32 v11, 0xffff0000, v60
    v_fmac_f32 v8, s26, v10
    v_fmac_f32 v9, s26, v11

    s_add_u32 s25, s24, 691200
    buffer_load_dword v60, v7, s[8:11], s25 offen
    v_readlane_b32 s26, v4, 45
    s_waitcnt vmcnt(55)
    v_lshlrev_b32 v10, 16, v61
    v_and_b32 v11, 0xffff0000, v61
    v_fmac_f32 v8, s26, v10
    v_fmac_f32 v9, s26, v11

    s_add_u32 s25, s24, 698112
    buffer_load_dword v61, v7, s[8:11], s25 offen
    v_readlane_b32 s26, v4, 46
    s_waitcnt vmcnt(55)
    v_lshlrev_b32 v10, 16, v62
    v_and_b32 v11, 0xffff0000, v62
    v_fmac_f32 v8, s26, v10
    v_fmac_f32 v9, s26, v11

    s_add_u32 s25, s24, 705024
    buffer_load_dword v62, v7, s[8:11], s25 offen
    v_readlane_b32 s26, v4, 47
    s_waitcnt vmcnt(55)
    v_lshlrev_b32 v10, 16, v63
    v_and_b32 v11, 0xffff0000, v63
    v_fmac_f32 v8, s26, v10
    v_fmac_f32 v9, s26, v11

    s_add_u32 s25, s24, 711936
    buffer_load_dword v63, v7, s[8:11], s25 offen
    v_readlane_b32 s26, v4, 48
    s_waitcnt vmcnt(55)
    v_lshlrev_b32 v10, 16, v64
    v_and_b32 v11, 0xffff0000, v64
    v_fmac_f32 v8, s26, v10
    v_fmac_f32 v9, s26, v11

    s_add_u32 s25, s24, 718848
    buffer_load_dword v64, v7, s[8:11], s25 offen
    v_readlane_b32 s26, v4, 49
    s_waitcnt vmcnt(55)
    v_lshlrev_b32 v10, 16, v65
    v_and_b32 v11, 0xffff0000, v65
    v_fmac_f32 v8, s26, v10
    v_fmac_f32 v9, s26, v11

    s_add_u32 s25, s24, 725760
    buffer_load_dword v65, v7, s[8:11], s25 offen
    v_readlane_b32 s26, v4, 50
    s_waitcnt vmcnt(55)
    v_lshlrev_b32 v10, 16, v66
    v_and_b32 v11, 0xffff0000, v66
    v_fmac_f32 v8, s26, v10
    v_fmac_f32 v9, s26, v11

    s_add_u32 s25, s24, 732672
    buffer_load_dword v66, v7, s[8:11], s25 offen
    v_readlane_b32 s26, v4, 51
    s_waitcnt vmcnt(55)
    v_lshlrev_b32 v10, 16, v67
    v_and_b32 v11, 0xffff0000, v67
    v_fmac_f32 v8, s26, v10
    v_fmac_f32 v9, s26, v11

    s_add_u32 s25, s24, 739584
    buffer_load_dword v67, v7, s[8:11], s25 offen
    v_readlane_b32 s26, v4, 52
    s_waitcnt vmcnt(55)
    v_lshlrev_b32 v10, 16, v68
    v_and_b32 v11, 0xffff0000, v68
    v_fmac_f32 v8, s26, v10
    v_fmac_f32 v9, s26, v11

    s_add_u32 s25, s24, 746496
    buffer_load_dword v68, v7, s[8:11], s25 offen
    v_readlane_b32 s26, v4, 53
    s_waitcnt vmcnt(55)
    v_lshlrev_b32 v10, 16, v69
    v_and_b32 v11, 0xffff0000, v69
    v_fmac_f32 v8, s26, v10
    v_fmac_f32 v9, s26, v11

    s_add_u32 s25, s24, 753408
    buffer_load_dword v69, v7, s[8:11], s25 offen
    v_readlane_b32 s26, v4, 54
    s_waitcnt vmcnt(55)
    v_lshlrev_b32 v10, 16, v70
    v_and_b32 v11, 0xffff0000, v70
    v_fmac_f32 v8, s26, v10
    v_fmac_f32 v9, s26, v11

    s_add_u32 s25, s24, 760320
    buffer_load_dword v70, v7, s[8:11], s25 offen
    v_readlane_b32 s26, v4, 55
    s_waitcnt vmcnt(55)
    v_lshlrev_b32 v10, 16, v71
    v_and_b32 v11, 0xffff0000, v71
    v_fmac_f32 v8, s26, v10
    v_fmac_f32 v9, s26, v11

    s_add_u32 s25, s24, 767232
    buffer_load_dword v71, v7, s[8:11], s25 offen
    v_readlane_b32 s26, v4, 56
    s_waitcnt vmcnt(55)
    v_lshlrev_b32 v10, 16, v16
    v_and_b32 v11, 0xffff0000, v16
    v_fmac_f32 v8, s26, v10
    v_fmac_f32 v9, s26, v11

    s_add_u32 s25, s24, 774144
    buffer_load_dword v16, v7, s[8:11], s25 offen
    v_readlane_b32 s26, v4, 57
    s_waitcnt vmcnt(55)
    v_lshlrev_b32 v10, 16, v17
    v_and_b32 v11, 0xffff0000, v17
    v_fmac_f32 v8, s26, v10
    v_fmac_f32 v9, s26, v11

    s_add_u32 s25, s24, 781056
    buffer_load_dword v17, v7, s[8:11], s25 offen
    v_readlane_b32 s26, v4, 58
    s_waitcnt vmcnt(55)
    v_lshlrev_b32 v10, 16, v18
    v_and_b32 v11, 0xffff0000, v18
    v_fmac_f32 v8, s26, v10
    v_fmac_f32 v9, s26, v11

    s_add_u32 s25, s24, 787968
    buffer_load_dword v18, v7, s[8:11], s25 offen
    v_readlane_b32 s26, v4, 59
    s_waitcnt vmcnt(55)
    v_lshlrev_b32 v10, 16, v19
    v_and_b32 v11, 0xffff0000, v19
    v_fmac_f32 v8, s26, v10
    v_fmac_f32 v9, s26, v11

    s_add_u32 s25, s24, 794880
    buffer_load_dword v19, v7, s[8:11], s25 offen
    v_readlane_b32 s26, v4, 60
    s_waitcnt vmcnt(55)
    v_lshlrev_b32 v10, 16, v20
    v_and_b32 v11, 0xffff0000, v20
    v_fmac_f32 v8, s26, v10
    v_fmac_f32 v9, s26, v11

    s_add_u32 s25, s24, 801792
    buffer_load_dword v20, v7, s[8:11], s25 offen
    v_readlane_b32 s26, v4, 61
    s_waitcnt vmcnt(55)
    v_lshlrev_b32 v10, 16, v21
    v_and_b32 v11, 0xffff0000, v21
    v_fmac_f32 v8, s26, v10
    v_fmac_f32 v9, s26, v11

    s_add_u32 s25, s24, 808704
    buffer_load_dword v21, v7, s[8:11], s25 offen
    v_readlane_b32 s26, v4, 62
    s_waitcnt vmcnt(55)
    v_lshlrev_b32 v10, 16, v22
    v_and_b32 v11, 0xffff0000, v22
    v_fmac_f32 v8, s26, v10
    v_fmac_f32 v9, s26, v11

    s_add_u32 s25, s24, 815616
    buffer_load_dword v22, v7, s[8:11], s25 offen
    v_readlane_b32 s26, v4, 63
    s_waitcnt vmcnt(55)
    v_lshlrev_b32 v10, 16, v23
    v_and_b32 v11, 0xffff0000, v23
    v_fmac_f32 v8, s26, v10
    v_fmac_f32 v9, s26, v11

    s_add_u32 s25, s24, 822528
    buffer_load_dword v23, v7, s[8:11], s25 offen
    v_readlane_b32 s26, v5, 0
    s_waitcnt vmcnt(55)
    v_lshlrev_b32 v10, 16, v24
    v_and_b32 v11, 0xffff0000, v24
    v_fmac_f32 v8, s26, v10
    v_fmac_f32 v9, s26, v11

    s_add_u32 s25, s24, 829440
    buffer_load_dword v24, v7, s[8:11], s25 offen
    v_readlane_b32 s26, v5, 1
    s_waitcnt vmcnt(55)
    v_lshlrev_b32 v10, 16, v25
    v_and_b32 v11, 0xffff0000, v25
    v_fmac_f32 v8, s26, v10
    v_fmac_f32 v9, s26, v11

    s_add_u32 s25, s24, 836352
    buffer_load_dword v25, v7, s[8:11], s25 offen
    v_readlane_b32 s26, v5, 2
    s_waitcnt vmcnt(55)
    v_lshlrev_b32 v10, 16, v26
    v_and_b32 v11, 0xffff0000, v26
    v_fmac_f32 v8, s26, v10
    v_fmac_f32 v9, s26, v11

    s_add_u32 s25, s24, 843264
    buffer_load_dword v26, v7, s[8:11], s25 offen
    v_readlane_b32 s26, v5, 3
    s_waitcnt vmcnt(55)
    v_lshlrev_b32 v10, 16, v27
    v_and_b32 v11, 0xffff0000, v27
    v_fmac_f32 v8, s26, v10
    v_fmac_f32 v9, s26, v11

    s_add_u32 s25, s24, 850176
    buffer_load_dword v27, v7, s[8:11], s25 offen
    v_readlane_b32 s26, v5, 4
    s_waitcnt vmcnt(55)
    v_lshlrev_b32 v10, 16, v28
    v_and_b32 v11, 0xffff0000, v28
    v_fmac_f32 v8, s26, v10
    v_fmac_f32 v9, s26, v11

    s_add_u32 s25, s24, 857088
    buffer_load_dword v28, v7, s[8:11], s25 offen
    v_readlane_b32 s26, v5, 5
    s_waitcnt vmcnt(55)
    v_lshlrev_b32 v10, 16, v29
    v_and_b32 v11, 0xffff0000, v29
    v_fmac_f32 v8, s26, v10
    v_fmac_f32 v9, s26, v11

    s_add_u32 s25, s24, 864000
    buffer_load_dword v29, v7, s[8:11], s25 offen
    v_readlane_b32 s26, v5, 6
    s_waitcnt vmcnt(55)
    v_lshlrev_b32 v10, 16, v30
    v_and_b32 v11, 0xffff0000, v30
    v_fmac_f32 v8, s26, v10
    v_fmac_f32 v9, s26, v11

    s_add_u32 s25, s24, 870912
    buffer_load_dword v30, v7, s[8:11], s25 offen
    v_readlane_b32 s26, v5, 7
    s_waitcnt vmcnt(55)
    v_lshlrev_b32 v10, 16, v31
    v_and_b32 v11, 0xffff0000, v31
    v_fmac_f32 v8, s26, v10
    v_fmac_f32 v9, s26, v11

    s_add_u32 s25, s24, 877824
    buffer_load_dword v31, v7, s[8:11], s25 offen
    v_readlane_b32 s26, v5, 8
    s_waitcnt vmcnt(55)
    v_lshlrev_b32 v10, 16, v32
    v_and_b32 v11, 0xffff0000, v32
    v_fmac_f32 v8, s26, v10
    v_fmac_f32 v9, s26, v11

    s_add_u32 s25, s24, 884736
    buffer_load_dword v32, v7, s[8:11], s25 offen
    v_readlane_b32 s26, v5, 9
    s_waitcnt vmcnt(55)
    v_lshlrev_b32 v10, 16, v33
    v_and_b32 v11, 0xffff0000, v33
    v_fmac_f32 v8, s26, v10
    v_fmac_f32 v9, s26, v11

    s_add_u32 s25, s24, 891648
    buffer_load_dword v33, v7, s[8:11], s25 offen
    v_readlane_b32 s26, v5, 10
    s_waitcnt vmcnt(55)
    v_lshlrev_b32 v10, 16, v34
    v_and_b32 v11, 0xffff0000, v34
    v_fmac_f32 v8, s26, v10
    v_fmac_f32 v9, s26, v11

    s_add_u32 s25, s24, 898560
    buffer_load_dword v34, v7, s[8:11], s25 offen
    v_readlane_b32 s26, v5, 11
    s_waitcnt vmcnt(55)
    v_lshlrev_b32 v10, 16, v35
    v_and_b32 v11, 0xffff0000, v35
    v_fmac_f32 v8, s26, v10
    v_fmac_f32 v9, s26, v11

    s_add_u32 s25, s24, 905472
    buffer_load_dword v35, v7, s[8:11], s25 offen
    v_readlane_b32 s26, v5, 12
    s_waitcnt vmcnt(55)
    v_lshlrev_b32 v10, 16, v36
    v_and_b32 v11, 0xffff0000, v36
    v_fmac_f32 v8, s26, v10
    v_fmac_f32 v9, s26, v11

    s_add_u32 s25, s24, 912384
    buffer_load_dword v36, v7, s[8:11], s25 offen
    v_readlane_b32 s26, v5, 13
    s_waitcnt vmcnt(55)
    v_lshlrev_b32 v10, 16, v37
    v_and_b32 v11, 0xffff0000, v37
    v_fmac_f32 v8, s26, v10
    v_fmac_f32 v9, s26, v11

    s_add_u32 s25, s24, 919296
    buffer_load_dword v37, v7, s[8:11], s25 offen
    v_readlane_b32 s26, v5, 14
    s_waitcnt vmcnt(55)
    v_lshlrev_b32 v10, 16, v38
    v_and_b32 v11, 0xffff0000, v38
    v_fmac_f32 v8, s26, v10
    v_fmac_f32 v9, s26, v11

    s_add_u32 s25, s24, 926208
    buffer_load_dword v38, v7, s[8:11], s25 offen
    v_readlane_b32 s26, v5, 15
    s_waitcnt vmcnt(55)
    v_lshlrev_b32 v10, 16, v39
    v_and_b32 v11, 0xffff0000, v39
    v_fmac_f32 v8, s26, v10
    v_fmac_f32 v9, s26, v11

    s_add_u32 s25, s24, 933120
    buffer_load_dword v39, v7, s[8:11], s25 offen
    v_readlane_b32 s26, v5, 16
    s_waitcnt vmcnt(55)
    v_lshlrev_b32 v10, 16, v40
    v_and_b32 v11, 0xffff0000, v40
    v_fmac_f32 v8, s26, v10
    v_fmac_f32 v9, s26, v11

    s_add_u32 s25, s24, 940032
    buffer_load_dword v40, v7, s[8:11], s25 offen
    v_readlane_b32 s26, v5, 17
    s_waitcnt vmcnt(55)
    v_lshlrev_b32 v10, 16, v41
    v_and_b32 v11, 0xffff0000, v41
    v_fmac_f32 v8, s26, v10
    v_fmac_f32 v9, s26, v11

    s_add_u32 s25, s24, 946944
    buffer_load_dword v41, v7, s[8:11], s25 offen
    v_readlane_b32 s26, v5, 18
    s_waitcnt vmcnt(55)
    v_lshlrev_b32 v10, 16, v42
    v_and_b32 v11, 0xffff0000, v42
    v_fmac_f32 v8, s26, v10
    v_fmac_f32 v9, s26, v11

    s_add_u32 s25, s24, 953856
    buffer_load_dword v42, v7, s[8:11], s25 offen
    v_readlane_b32 s26, v5, 19
    s_waitcnt vmcnt(55)
    v_lshlrev_b32 v10, 16, v43
    v_and_b32 v11, 0xffff0000, v43
    v_fmac_f32 v8, s26, v10
    v_fmac_f32 v9, s26, v11

    s_add_u32 s25, s24, 960768
    buffer_load_dword v43, v7, s[8:11], s25 offen
    v_readlane_b32 s26, v5, 20
    s_waitcnt vmcnt(55)
    v_lshlrev_b32 v10, 16, v44
    v_and_b32 v11, 0xffff0000, v44
    v_fmac_f32 v8, s26, v10
    v_fmac_f32 v9, s26, v11

    s_add_u32 s25, s24, 967680
    buffer_load_dword v44, v7, s[8:11], s25 offen
    v_readlane_b32 s26, v5, 21
    s_waitcnt vmcnt(55)
    v_lshlrev_b32 v10, 16, v45
    v_and_b32 v11, 0xffff0000, v45
    v_fmac_f32 v8, s26, v10
    v_fmac_f32 v9, s26, v11

    s_add_u32 s25, s24, 974592
    buffer_load_dword v45, v7, s[8:11], s25 offen
    v_readlane_b32 s26, v5, 22
    s_waitcnt vmcnt(55)
    v_lshlrev_b32 v10, 16, v46
    v_and_b32 v11, 0xffff0000, v46
    v_fmac_f32 v8, s26, v10
    v_fmac_f32 v9, s26, v11

    s_add_u32 s25, s24, 981504
    buffer_load_dword v46, v7, s[8:11], s25 offen
    v_readlane_b32 s26, v5, 23
    s_waitcnt vmcnt(55)
    v_lshlrev_b32 v10, 16, v47
    v_and_b32 v11, 0xffff0000, v47
    v_fmac_f32 v8, s26, v10
    v_fmac_f32 v9, s26, v11

    s_add_u32 s25, s24, 988416
    buffer_load_dword v47, v7, s[8:11], s25 offen
    v_readlane_b32 s26, v5, 24
    s_waitcnt vmcnt(55)
    v_lshlrev_b32 v10, 16, v48
    v_and_b32 v11, 0xffff0000, v48
    v_fmac_f32 v8, s26, v10
    v_fmac_f32 v9, s26, v11

    v_readlane_b32 s26, v5, 25
    s_waitcnt vmcnt(54)
    v_lshlrev_b32 v10, 16, v49
    v_and_b32 v11, 0xffff0000, v49
    v_fmac_f32 v8, s26, v10
    v_fmac_f32 v9, s26, v11

    v_readlane_b32 s26, v5, 26
    s_waitcnt vmcnt(53)
    v_lshlrev_b32 v10, 16, v50
    v_and_b32 v11, 0xffff0000, v50
    v_fmac_f32 v8, s26, v10
    v_fmac_f32 v9, s26, v11

    v_readlane_b32 s26, v5, 27
    s_waitcnt vmcnt(52)
    v_lshlrev_b32 v10, 16, v51
    v_and_b32 v11, 0xffff0000, v51
    v_fmac_f32 v8, s26, v10
    v_fmac_f32 v9, s26, v11

    v_readlane_b32 s26, v5, 28
    s_waitcnt vmcnt(51)
    v_lshlrev_b32 v10, 16, v52
    v_and_b32 v11, 0xffff0000, v52
    v_fmac_f32 v8, s26, v10
    v_fmac_f32 v9, s26, v11

    v_readlane_b32 s26, v5, 29
    s_waitcnt vmcnt(50)
    v_lshlrev_b32 v10, 16, v53
    v_and_b32 v11, 0xffff0000, v53
    v_fmac_f32 v8, s26, v10
    v_fmac_f32 v9, s26, v11

    v_readlane_b32 s26, v5, 30
    s_waitcnt vmcnt(49)
    v_lshlrev_b32 v10, 16, v54
    v_and_b32 v11, 0xffff0000, v54
    v_fmac_f32 v8, s26, v10
    v_fmac_f32 v9, s26, v11

    v_readlane_b32 s26, v5, 31
    s_waitcnt vmcnt(48)
    v_lshlrev_b32 v10, 16, v55
    v_and_b32 v11, 0xffff0000, v55
    v_fmac_f32 v8, s26, v10
    v_fmac_f32 v9, s26, v11

    v_readlane_b32 s26, v5, 32
    s_waitcnt vmcnt(47)
    v_lshlrev_b32 v10, 16, v56
    v_and_b32 v11, 0xffff0000, v56
    v_fmac_f32 v8, s26, v10
    v_fmac_f32 v9, s26, v11

    v_readlane_b32 s26, v5, 33
    s_waitcnt vmcnt(46)
    v_lshlrev_b32 v10, 16, v57
    v_and_b32 v11, 0xffff0000, v57
    v_fmac_f32 v8, s26, v10
    v_fmac_f32 v9, s26, v11

    v_readlane_b32 s26, v5, 34
    s_waitcnt vmcnt(45)
    v_lshlrev_b32 v10, 16, v58
    v_and_b32 v11, 0xffff0000, v58
    v_fmac_f32 v8, s26, v10
    v_fmac_f32 v9, s26, v11

    v_readlane_b32 s26, v5, 35
    s_waitcnt vmcnt(44)
    v_lshlrev_b32 v10, 16, v59
    v_and_b32 v11, 0xffff0000, v59
    v_fmac_f32 v8, s26, v10
    v_fmac_f32 v9, s26, v11

    v_readlane_b32 s26, v5, 36
    s_waitcnt vmcnt(43)
    v_lshlrev_b32 v10, 16, v60
    v_and_b32 v11, 0xffff0000, v60
    v_fmac_f32 v8, s26, v10
    v_fmac_f32 v9, s26, v11

    v_readlane_b32 s26, v5, 37
    s_waitcnt vmcnt(42)
    v_lshlrev_b32 v10, 16, v61
    v_and_b32 v11, 0xffff0000, v61
    v_fmac_f32 v8, s26, v10
    v_fmac_f32 v9, s26, v11

    v_readlane_b32 s26, v5, 38
    s_waitcnt vmcnt(41)
    v_lshlrev_b32 v10, 16, v62
    v_and_b32 v11, 0xffff0000, v62
    v_fmac_f32 v8, s26, v10
    v_fmac_f32 v9, s26, v11

    v_readlane_b32 s26, v5, 39
    s_waitcnt vmcnt(40)
    v_lshlrev_b32 v10, 16, v63
    v_and_b32 v11, 0xffff0000, v63
    v_fmac_f32 v8, s26, v10
    v_fmac_f32 v9, s26, v11

    v_readlane_b32 s26, v5, 40
    s_waitcnt vmcnt(39)
    v_lshlrev_b32 v10, 16, v64
    v_and_b32 v11, 0xffff0000, v64
    v_fmac_f32 v8, s26, v10
    v_fmac_f32 v9, s26, v11

    v_readlane_b32 s26, v5, 41
    s_waitcnt vmcnt(38)
    v_lshlrev_b32 v10, 16, v65
    v_and_b32 v11, 0xffff0000, v65
    v_fmac_f32 v8, s26, v10
    v_fmac_f32 v9, s26, v11

    v_readlane_b32 s26, v5, 42
    s_waitcnt vmcnt(37)
    v_lshlrev_b32 v10, 16, v66
    v_and_b32 v11, 0xffff0000, v66
    v_fmac_f32 v8, s26, v10
    v_fmac_f32 v9, s26, v11

    v_readlane_b32 s26, v5, 43
    s_waitcnt vmcnt(36)
    v_lshlrev_b32 v10, 16, v67
    v_and_b32 v11, 0xffff0000, v67
    v_fmac_f32 v8, s26, v10
    v_fmac_f32 v9, s26, v11

    v_readlane_b32 s26, v5, 44
    s_waitcnt vmcnt(35)
    v_lshlrev_b32 v10, 16, v68
    v_and_b32 v11, 0xffff0000, v68
    v_fmac_f32 v8, s26, v10
    v_fmac_f32 v9, s26, v11

    v_readlane_b32 s26, v5, 45
    s_waitcnt vmcnt(34)
    v_lshlrev_b32 v10, 16, v69
    v_and_b32 v11, 0xffff0000, v69
    v_fmac_f32 v8, s26, v10
    v_fmac_f32 v9, s26, v11

    v_readlane_b32 s26, v5, 46
    s_waitcnt vmcnt(33)
    v_lshlrev_b32 v10, 16, v70
    v_and_b32 v11, 0xffff0000, v70
    v_fmac_f32 v8, s26, v10
    v_fmac_f32 v9, s26, v11

    v_readlane_b32 s26, v5, 47
    s_waitcnt vmcnt(32)
    v_lshlrev_b32 v10, 16, v71
    v_and_b32 v11, 0xffff0000, v71
    v_fmac_f32 v8, s26, v10
    v_fmac_f32 v9, s26, v11

    v_readlane_b32 s26, v5, 48
    s_waitcnt vmcnt(31)
    v_lshlrev_b32 v10, 16, v16
    v_and_b32 v11, 0xffff0000, v16
    v_fmac_f32 v8, s26, v10
    v_fmac_f32 v9, s26, v11

    v_readlane_b32 s26, v5, 49
    s_waitcnt vmcnt(30)
    v_lshlrev_b32 v10, 16, v17
    v_and_b32 v11, 0xffff0000, v17
    v_fmac_f32 v8, s26, v10
    v_fmac_f32 v9, s26, v11

    v_readlane_b32 s26, v5, 50
    s_waitcnt vmcnt(29)
    v_lshlrev_b32 v10, 16, v18
    v_and_b32 v11, 0xffff0000, v18
    v_fmac_f32 v8, s26, v10
    v_fmac_f32 v9, s26, v11

    v_readlane_b32 s26, v5, 51
    s_waitcnt vmcnt(28)
    v_lshlrev_b32 v10, 16, v19
    v_and_b32 v11, 0xffff0000, v19
    v_fmac_f32 v8, s26, v10
    v_fmac_f32 v9, s26, v11

    v_readlane_b32 s26, v5, 52
    s_waitcnt vmcnt(27)
    v_lshlrev_b32 v10, 16, v20
    v_and_b32 v11, 0xffff0000, v20
    v_fmac_f32 v8, s26, v10
    v_fmac_f32 v9, s26, v11

    v_readlane_b32 s26, v5, 53
    s_waitcnt vmcnt(26)
    v_lshlrev_b32 v10, 16, v21
    v_and_b32 v11, 0xffff0000, v21
    v_fmac_f32 v8, s26, v10
    v_fmac_f32 v9, s26, v11

    v_readlane_b32 s26, v5, 54
    s_waitcnt vmcnt(25)
    v_lshlrev_b32 v10, 16, v22
    v_and_b32 v11, 0xffff0000, v22
    v_fmac_f32 v8, s26, v10
    v_fmac_f32 v9, s26, v11

    v_readlane_b32 s26, v5, 55
    s_waitcnt vmcnt(24)
    v_lshlrev_b32 v10, 16, v23
    v_and_b32 v11, 0xffff0000, v23
    v_fmac_f32 v8, s26, v10
    v_fmac_f32 v9, s26, v11

    v_readlane_b32 s26, v5, 56
    s_waitcnt vmcnt(23)
    v_lshlrev_b32 v10, 16, v24
    v_and_b32 v11, 0xffff0000, v24
    v_fmac_f32 v8, s26, v10
    v_fmac_f32 v9, s26, v11

    v_readlane_b32 s26, v5, 57
    s_waitcnt vmcnt(22)
    v_lshlrev_b32 v10, 16, v25
    v_and_b32 v11, 0xffff0000, v25
    v_fmac_f32 v8, s26, v10
    v_fmac_f32 v9, s26, v11

    v_readlane_b32 s26, v5, 58
    s_waitcnt vmcnt(21)
    v_lshlrev_b32 v10, 16, v26
    v_and_b32 v11, 0xffff0000, v26
    v_fmac_f32 v8, s26, v10
    v_fmac_f32 v9, s26, v11

    v_readlane_b32 s26, v5, 59
    s_waitcnt vmcnt(20)
    v_lshlrev_b32 v10, 16, v27
    v_and_b32 v11, 0xffff0000, v27
    v_fmac_f32 v8, s26, v10
    v_fmac_f32 v9, s26, v11

    v_readlane_b32 s26, v5, 60
    s_waitcnt vmcnt(19)
    v_lshlrev_b32 v10, 16, v28
    v_and_b32 v11, 0xffff0000, v28
    v_fmac_f32 v8, s26, v10
    v_fmac_f32 v9, s26, v11

    v_readlane_b32 s26, v5, 61
    s_waitcnt vmcnt(18)
    v_lshlrev_b32 v10, 16, v29
    v_and_b32 v11, 0xffff0000, v29
    v_fmac_f32 v8, s26, v10
    v_fmac_f32 v9, s26, v11

    v_readlane_b32 s26, v5, 62
    s_waitcnt vmcnt(17)
    v_lshlrev_b32 v10, 16, v30
    v_and_b32 v11, 0xffff0000, v30
    v_fmac_f32 v8, s26, v10
    v_fmac_f32 v9, s26, v11

    v_readlane_b32 s26, v5, 63
    s_waitcnt vmcnt(16)
    v_lshlrev_b32 v10, 16, v31
    v_and_b32 v11, 0xffff0000, v31
    v_fmac_f32 v8, s26, v10
    v_fmac_f32 v9, s26, v11

    v_readlane_b32 s26, v6, 0
    s_waitcnt vmcnt(15)
    v_lshlrev_b32 v10, 16, v32
    v_and_b32 v11, 0xffff0000, v32
    v_fmac_f32 v8, s26, v10
    v_fmac_f32 v9, s26, v11

    v_readlane_b32 s26, v6, 1
    s_waitcnt vmcnt(14)
    v_lshlrev_b32 v10, 16, v33
    v_and_b32 v11, 0xffff0000, v33
    v_fmac_f32 v8, s26, v10
    v_fmac_f32 v9, s26, v11

    v_readlane_b32 s26, v6, 2
    s_waitcnt vmcnt(13)
    v_lshlrev_b32 v10, 16, v34
    v_and_b32 v11, 0xffff0000, v34
    v_fmac_f32 v8, s26, v10
    v_fmac_f32 v9, s26, v11

    v_readlane_b32 s26, v6, 3
    s_waitcnt vmcnt(12)
    v_lshlrev_b32 v10, 16, v35
    v_and_b32 v11, 0xffff0000, v35
    v_fmac_f32 v8, s26, v10
    v_fmac_f32 v9, s26, v11

    v_readlane_b32 s26, v6, 4
    s_waitcnt vmcnt(11)
    v_lshlrev_b32 v10, 16, v36
    v_and_b32 v11, 0xffff0000, v36
    v_fmac_f32 v8, s26, v10
    v_fmac_f32 v9, s26, v11

    v_readlane_b32 s26, v6, 5
    s_waitcnt vmcnt(10)
    v_lshlrev_b32 v10, 16, v37
    v_and_b32 v11, 0xffff0000, v37
    v_fmac_f32 v8, s26, v10
    v_fmac_f32 v9, s26, v11

    v_readlane_b32 s26, v6, 6
    s_waitcnt vmcnt(9)
    v_lshlrev_b32 v10, 16, v38
    v_and_b32 v11, 0xffff0000, v38
    v_fmac_f32 v8, s26, v10
    v_fmac_f32 v9, s26, v11

    v_readlane_b32 s26, v6, 7
    s_waitcnt vmcnt(8)
    v_lshlrev_b32 v10, 16, v39
    v_and_b32 v11, 0xffff0000, v39
    v_fmac_f32 v8, s26, v10
    v_fmac_f32 v9, s26, v11

    v_readlane_b32 s26, v6, 8
    s_waitcnt vmcnt(7)
    v_lshlrev_b32 v10, 16, v40
    v_and_b32 v11, 0xffff0000, v40
    v_fmac_f32 v8, s26, v10
    v_fmac_f32 v9, s26, v11

    v_readlane_b32 s26, v6, 9
    s_waitcnt vmcnt(6)
    v_lshlrev_b32 v10, 16, v41
    v_and_b32 v11, 0xffff0000, v41
    v_fmac_f32 v8, s26, v10
    v_fmac_f32 v9, s26, v11

    v_readlane_b32 s26, v6, 10
    s_waitcnt vmcnt(5)
    v_lshlrev_b32 v10, 16, v42
    v_and_b32 v11, 0xffff0000, v42
    v_fmac_f32 v8, s26, v10
    v_fmac_f32 v9, s26, v11

    v_readlane_b32 s26, v6, 11
    s_waitcnt vmcnt(4)
    v_lshlrev_b32 v10, 16, v43
    v_and_b32 v11, 0xffff0000, v43
    v_fmac_f32 v8, s26, v10
    v_fmac_f32 v9, s26, v11

    v_readlane_b32 s26, v6, 12
    s_waitcnt vmcnt(3)
    v_lshlrev_b32 v10, 16, v44
    v_and_b32 v11, 0xffff0000, v44
    v_fmac_f32 v8, s26, v10
    v_fmac_f32 v9, s26, v11

    v_readlane_b32 s26, v6, 13
    s_waitcnt vmcnt(2)
    v_lshlrev_b32 v10, 16, v45
    v_and_b32 v11, 0xffff0000, v45
    v_fmac_f32 v8, s26, v10
    v_fmac_f32 v9, s26, v11

    v_readlane_b32 s26, v6, 14
    s_waitcnt vmcnt(1)
    v_lshlrev_b32 v10, 16, v46
    v_and_b32 v11, 0xffff0000, v46
    v_fmac_f32 v8, s26, v10
    v_fmac_f32 v9, s26, v11

    v_readlane_b32 s26, v6, 15
    s_waitcnt vmcnt(0)
    v_lshlrev_b32 v10, 16, v47
    v_and_b32 v11, 0xffff0000, v47
    v_fmac_f32 v8, s26, v10
    v_fmac_f32 v9, s26, v11

    v_lshlrev_b32 v10, 3, v0
    ds_write_b64 v10, v[8:9]
    s_waitcnt lgkmcnt(0)
    s_barrier
    s_cmp_lg_u32 s22, 0
    s_cbranch_scc1 L_nomod_6
    v_lshlrev_b32 v10, 3, v1

    ds_read_b64 v[12:13], v10 offset:512
    ds_read_b64 v[14:15], v10 offset:1024
    ds_read_b64 v[16:17], v10 offset:1536
    s_waitcnt lgkmcnt(0)
    v_add_f32 v8, v8, v12
    v_add_f32 v9, v9, v13
    v_add_f32 v8, v8, v14
    v_add_f32 v9, v9, v15
    v_add_f32 v8, v8, v16
    v_add_f32 v9, v9, v17
    v_cvt_pk_bf16_f32 v6, v8, v9
    v_lshlrev_b32 v8, 16, v6
    v_and_b32 v9, 0xffff0000, v6

    s_lshl_b32 s23, s2, 9
    v_add_u32 v10, s23, v10
    buffer_store_dwordx2 v[8:9], v10, s[16:19], 0 offen sc1

L_nomod_6:
    s_waitcnt vmcnt(0)
    s_barrier
    s_cmp_lg_u32 s73, 0
    s_cbranch_scc1 L_regdone_3
    s_mul_i32 s74, s72, 16
    v_mov_b32 v1, 0
    v_mov_b32 v2, 1
    v_mov_b32 v3, 1
    s_mov_b64 exec, 1
    buffer_atomic_add v2, v1, s[84:87], s74 offen sc0
    s_waitcnt vmcnt(0)
    s_mov_b32 s75, 128
    buffer_atomic_add v3, v1, s[84:87], s75 offen
    s_mov_b64 exec, -1
    v_readfirstlane_b32 s76, v2
    v_mov_b32 v1, 163716
    s_nop 1
    v_mov_b32 v2, s76
    ds_write_b32 v1, v2
    s_waitcnt lgkmcnt(0)

L_regdone_3:
    s_barrier
    v_mov_b32 v1, 163716
    ds_read_b32 v2, v1
    s_waitcnt lgkmcnt(0)
    v_readfirstlane_b32 s76, v2
    s_barrier
    s_cmp_lg_u32 s72, 0
    s_cbranch_scc1 L_notcand_5
    s_cmp_ge_u32 s76, 32
    s_cbranch_scc1 L_notcand_5
    s_mov_b32 s3, s76

    s_load_dwordx2 s[4:5], s[0:1], 120
    s_load_dwordx4 s[8:11], s[0:1], 16
    s_load_dwordx4 s[12:15], s[0:1], 32
    s_load_dwordx2 s[16:17], s[0:1], 8
    s_mov_b32 s20, s3
    v_lshrrev_b32 v44, 6, v0
    s_nop 0
    v_readfirstlane_b32 s21, v44
    s_mov_b32 s26, 0x00ff00ff
    s_mov_b32 s27, 0x00ff00ff
    s_mov_b32 s28, -1
    s_mov_b32 s29, 0
    s_mov_b32 s30, -1
    s_mov_b32 s31, 15
    s_mov_b32 s33, 0x07060302
    s_waitcnt lgkmcnt(0)

    s_add_u32 s48, s4, 20971520
    s_addc_u32 s49, s5, 0
    s_and_b32 s49, s49, 0xffff
    s_mov_b32 s50, 16777216
    s_mov_b32 s51, 0x00020000

    s_add_u32 s52, s4, 37748736
    s_addc_u32 s53, s5, 0
    s_and_b32 s53, s53, 0xffff
    s_mov_b32 s54, 16777216
    s_mov_b32 s55, 0x00020000

    s_add_u32 s56, s4, 54525952
    s_addc_u32 s57, s5, 0
    s_and_b32 s57, s57, 0xffff
    s_mov_b32 s58, 4194304
    s_mov_b32 s59, 0x00020000

    s_add_u32 s60, s4, 58720256
    s_addc_u32 s61, s5, 0
    s_and_b32 s61, s61, 0xffff
    s_mov_b32 s62, 4194304
    s_mov_b32 s63, 0x00020000

    s_add_u32 s64, s4, 134217728
    s_addc_u32 s65, s5, 0
    s_and_b32 s65, s65, 0xffff
    s_mov_b32 s66, 1179648
    s_mov_b32 s67, 0x00020000

    s_add_u32 s68, s4, 135397376
    s_addc_u32 s69, s5, 0
    s_and_b32 s69, s69, 0xffff
    s_mov_b32 s70, 36864
    s_mov_b32 s71, 0x00020000

    s_add_u32 s96, s4, 135462912
    s_addc_u32 s97, s5, 0
    s_and_b32 s97, s97, 0xffff
    s_mov_b32 s98, 65536
    s_mov_b32 s99, 0x00020000

    v_and_b32 v74, 63, v0
    v_lshrrev_b32 v44, 4, v0
    v_and_b32 v45, 15, v0
    v_lshlrev_b32 v46, 13, v44
    v_lshl_add_u32 v46, v45, 4, v46
    v_and_b32 v47, 3, v44
    v_lshrrev_b32 v48, 7, v0
    v_lshl_add_u32 v47, v48, 2, v47
    v_lshrrev_b32 v48, 1, v45
    v_xor_b32 v47, v47, v48
    v_lshlrev_b32 v47, 5, v47
    v_and_b32 v48, 1, v45
    v_lshl_add_u32 v47, v48, 4, v47
    v_lshl_add_u32 v47, v44, 8, v47
    v_add_u32 v48, 65536, v47
    v_add_u32 v49, 131072, v47
    v_lshrrev_b32 v50, 4, v74
    v_and_b32 v51, 15, v74
    v_lshrrev_b32 v52, 2, v51
    v_lshl_add_u32 v53, v50, 3, v52
    v_and_b32 v50, 1, v50
    v_lshl_add_u32 v52, v50, 2, v52
    v_and_b32 v51, 3, v51
    v_lshlrev_b32 v51, 3, v51
    v_lshl_add_u32 v51, v53, 8, v51
    s_lshl_b32 s34, s21, 1

    s_add_u32 s35, s34, 0
    v_xor_b32 v53, s35, v52
    v_lshl_add_u32 v54, v53, 5, v51
    v_add_u32 v55, 65536, v54
    v_add_u32 v56, 131072, v54

    s_add_u32 s35, s34, 1
    v_xor_b32 v53, s35, v52
    v_lshl_add_u32 v57, v53, 5, v51
    v_add_u32 v58, 65536, v57
    v_add_u32 v59, 131072, v57

    s_mov_b32 s72, s8
    s_and_b32 s73, s9, 0xffff
    s_mov_b32 s74, 4718592
    s_mov_b32 s75, 0x00020000

    s_lshl_b32 s36, s20, 8
    s_add_u32 s37, s36, 0
    buffer_load_dwordx4 v[80:83], v46, s[72:75], s37 offen

    s_add_u32 s37, s36, 131072
    buffer_load_dwordx4 v[84:87], v46, s[72:75], s37 offen

    s_add_u32 s37, s36, 262144
    buffer_load_dwordx4 v[88:91], v46, s[72:75], s37 offen

    s_add_u32 s37, s36, 393216
    buffer_load_dwordx4 v[92:95], v46, s[72:75], s37 offen

    s_add_u32 s37, s36, 524288
    buffer_load_dwordx4 v[96:99], v46, s[72:75], s37 offen

    s_add_u32 s37, s36, 655360
    buffer_load_dwordx4 v[100:103], v46, s[72:75], s37 offen

    s_add_u32 s37, s36, 786432
    buffer_load_dwordx4 v[104:107], v46, s[72:75], s37 offen

    s_add_u32 s37, s36, 917504
    buffer_load_dwordx4 v[108:111], v46, s[72:75], s37 offen

    s_add_u32 s37, s36, 1048576
    buffer_load_dwordx4 v[112:115], v46, s[72:75], s37 offen

    s_add_u32 s37, s36, 1179648
    buffer_load_dwordx4 v[116:119], v46, s[72:75], s37 offen

    s_add_u32 s37, s36, 1310720
    buffer_load_dwordx4 v[120:123], v46, s[72:75], s37 offen

    s_add_u32 s37, s36, 1441792
    buffer_load_dwordx4 v[124:127], v46, s[72:75], s37 offen

    s_add_u32 s37, s36, 1572864
    buffer_load_dwordx4 v[128:131], v46, s[72:75], s37 offen

    s_add_u32 s37, s36, 1703936
    buffer_load_dwordx4 v[132:135], v46, s[72:75], s37 offen

    s_add_u32 s37, s36, 1835008
    buffer_load_dwordx4 v[136:139], v46, s[72:75], s37 offen

    s_add_u32 s37, s36, 1966080
    buffer_load_dwordx4 v[140:143], v46, s[72:75], s37 offen

    s_add_u32 s37, s36, 2097152
    buffer_load_dwordx4 v[144:147], v46, s[72:75], s37 offen

    s_add_u32 s37, s36, 2228224
    buffer_load_dwordx4 v[148:151], v46, s[72:75], s37 offen

    s_add_u32 s37, s36, 2359296
    buffer_load_dwordx4 v[152:155], v46, s[72:75], s37 offen

    s_add_u32 s37, s36, 2490368
    buffer_load_dwordx4 v[156:159], v46, s[72:75], s37 offen

    s_add_u32 s37, s36, 2621440
    buffer_load_dwordx4 v[160:163], v46, s[72:75], s37 offen

    s_add_u32 s37, s36, 2752512
    buffer_load_dwordx4 v[164:167], v46, s[72:75], s37 offen

    s_add_u32 s37, s36, 2883584
    buffer_load_dwordx4 v[168:171], v46, s[72:75], s37 offen

    s_add_u32 s37, s36, 3014656
    buffer_load_dwordx4 v[172:175], v46, s[72:75], s37 offen

    s_add_u32 s37, s36, 3145728
    buffer_load_dwordx4 v[176:179], v46, s[72:75], s37 offen

    s_add_u32 s37, s36, 3276800
    buffer_load_dwordx4 v[180:183], v46, s[72:75], s37 offen

    s_add_u32 s37, s36, 3407872
    buffer_load_dwordx4 v[184:187], v46, s[72:75], s37 offen

    s_add_u32 s37, s36, 3538944
    buffer_load_dwordx4 v[188:191], v46, s[72:75], s37 offen

    s_add_u32 s37, s36, 3670016
    buffer_load_dwordx4 v[192:195], v46, s[72:75], s37 offen

    s_add_u32 s37, s36, 3801088
    buffer_load_dwordx4 v[196:199], v46, s[72:75], s37 offen

    s_add_u32 s37, s36, 3932160
    buffer_load_dwordx4 v[200:203], v46, s[72:75], s37 offen

    s_add_u32 s37, s36, 4063232
    buffer_load_dwordx4 v[204:207], v46, s[72:75], s37 offen

    s_add_u32 s37, s36, 4194304
    buffer_load_dwordx4 v[208:211], v46, s[72:75], s37 offen

    s_add_u32 s37, s36, 4325376
    buffer_load_dwordx4 v[212:215], v46, s[72:75], s37 offen

    s_add_u32 s37, s36, 4456448
    buffer_load_dwordx4 v[216:219], v46, s[72:75], s37 offen

    s_add_u32 s37, s36, 4587520
    buffer_load_dwordx4 v[220:223], v46, s[72:75], s37 offen

    s_waitcnt vmcnt(35)
    ds_write_b128 v47, v[80:83] offset:0

    s_waitcnt vmcnt(34)
    ds_write_b128 v47, v[84:87] offset:4096

    s_waitcnt vmcnt(33)
    ds_write_b128 v47, v[88:91] offset:8192

    s_waitcnt vmcnt(32)
    ds_write_b128 v47, v[92:95] offset:12288

    s_waitcnt vmcnt(31)
    ds_write_b128 v47, v[96:99] offset:16384

    s_waitcnt vmcnt(30)
    ds_write_b128 v47, v[100:103] offset:20480

    s_waitcnt vmcnt(29)
    ds_write_b128 v47, v[104:107] offset:24576

    s_waitcnt vmcnt(28)
    ds_write_b128 v47, v[108:111] offset:28672

    s_waitcnt vmcnt(27)
    ds_write_b128 v47, v[112:115] offset:32768

    s_waitcnt vmcnt(26)
    ds_write_b128 v47, v[116:119] offset:36864

    s_waitcnt vmcnt(25)
    ds_write_b128 v47, v[120:123] offset:40960

    s_waitcnt vmcnt(24)
    ds_write_b128 v47, v[124:127] offset:45056

    s_waitcnt vmcnt(23)
    ds_write_b128 v47, v[128:131] offset:49152

    s_waitcnt vmcnt(22)
    ds_write_b128 v47, v[132:135] offset:53248

    s_waitcnt vmcnt(21)
    ds_write_b128 v47, v[136:139] offset:57344

    s_waitcnt vmcnt(20)
    ds_write_b128 v47, v[140:143] offset:61440

    s_waitcnt vmcnt(19)
    ds_write_b128 v48, v[144:147] offset:0

    s_waitcnt vmcnt(18)
    ds_write_b128 v48, v[148:151] offset:4096

    s_waitcnt vmcnt(17)
    ds_write_b128 v48, v[152:155] offset:8192

    s_waitcnt vmcnt(16)
    ds_write_b128 v48, v[156:159] offset:12288

    s_waitcnt vmcnt(15)
    ds_write_b128 v48, v[160:163] offset:16384

    s_waitcnt vmcnt(14)
    ds_write_b128 v48, v[164:167] offset:20480

    s_waitcnt vmcnt(13)
    ds_write_b128 v48, v[168:171] offset:24576

    s_waitcnt vmcnt(12)
    ds_write_b128 v48, v[172:175] offset:28672

    s_waitcnt vmcnt(11)
    ds_write_b128 v48, v[176:179] offset:32768

    s_waitcnt vmcnt(10)
    ds_write_b128 v48, v[180:183] offset:36864

    s_waitcnt vmcnt(9)
    ds_write_b128 v48, v[184:187] offset:40960

    s_waitcnt vmcnt(8)
    ds_write_b128 v48, v[188:191] offset:45056

    s_waitcnt vmcnt(7)
    ds_write_b128 v48, v[192:195] offset:49152

    s_waitcnt vmcnt(6)
    ds_write_b128 v48, v[196:199] offset:53248

    s_waitcnt vmcnt(5)
    ds_write_b128 v48, v[200:203] offset:57344

    s_waitcnt vmcnt(4)
    ds_write_b128 v48, v[204:207] offset:61440

    s_waitcnt vmcnt(3)
    ds_write_b128 v49, v[208:211] offset:0

    s_waitcnt vmcnt(2)
    ds_write_b128 v49, v[212:215] offset:4096

    s_waitcnt vmcnt(1)
    ds_write_b128 v49, v[216:219] offset:8192

    s_waitcnt vmcnt(0)
    ds_write_b128 v49, v[220:223] offset:12288

    s_waitcnt lgkmcnt(0)
    s_barrier
    s_mov_b32 s72, s10
    s_and_b32 s73, s11, 0xffff
    s_mov_b32 s74, 4718592
    s_mov_b32 s75, 0x00020000

    s_lshl_b32 s36, s20, 8
    s_add_u32 s37, s36, 0
    buffer_load_dwordx4 v[80:83], v46, s[72:75], s37 offen

    s_add_u32 s37, s36, 131072
    buffer_load_dwordx4 v[84:87], v46, s[72:75], s37 offen

    s_add_u32 s37, s36, 262144
    buffer_load_dwordx4 v[88:91], v46, s[72:75], s37 offen

    s_add_u32 s37, s36, 393216
    buffer_load_dwordx4 v[92:95], v46, s[72:75], s37 offen

    s_add_u32 s37, s36, 524288
    buffer_load_dwordx4 v[96:99], v46, s[72:75], s37 offen

    s_add_u32 s37, s36, 655360
    buffer_load_dwordx4 v[100:103], v46, s[72:75], s37 offen

    s_add_u32 s37, s36, 786432
    buffer_load_dwordx4 v[104:107], v46, s[72:75], s37 offen

    s_add_u32 s37, s36, 917504
    buffer_load_dwordx4 v[108:111], v46, s[72:75], s37 offen

    s_add_u32 s37, s36, 1048576
    buffer_load_dwordx4 v[112:115], v46, s[72:75], s37 offen

    s_add_u32 s37, s36, 1179648
    buffer_load_dwordx4 v[116:119], v46, s[72:75], s37 offen

    s_add_u32 s37, s36, 1310720
    buffer_load_dwordx4 v[120:123], v46, s[72:75], s37 offen

    s_add_u32 s37, s36, 1441792
    buffer_load_dwordx4 v[124:127], v46, s[72:75], s37 offen

    s_add_u32 s37, s36, 1572864
    buffer_load_dwordx4 v[128:131], v46, s[72:75], s37 offen

    s_add_u32 s37, s36, 1703936
    buffer_load_dwordx4 v[132:135], v46, s[72:75], s37 offen

    s_add_u32 s37, s36, 1835008
    buffer_load_dwordx4 v[136:139], v46, s[72:75], s37 offen

    s_add_u32 s37, s36, 1966080
    buffer_load_dwordx4 v[140:143], v46, s[72:75], s37 offen

    s_add_u32 s37, s36, 2097152
    buffer_load_dwordx4 v[144:147], v46, s[72:75], s37 offen

    s_add_u32 s37, s36, 2228224
    buffer_load_dwordx4 v[148:151], v46, s[72:75], s37 offen

    s_add_u32 s37, s36, 2359296
    buffer_load_dwordx4 v[152:155], v46, s[72:75], s37 offen

    s_add_u32 s37, s36, 2490368
    buffer_load_dwordx4 v[156:159], v46, s[72:75], s37 offen

    s_add_u32 s37, s36, 2621440
    buffer_load_dwordx4 v[160:163], v46, s[72:75], s37 offen

    s_add_u32 s37, s36, 2752512
    buffer_load_dwordx4 v[164:167], v46, s[72:75], s37 offen

    s_add_u32 s37, s36, 2883584
    buffer_load_dwordx4 v[168:171], v46, s[72:75], s37 offen

    s_add_u32 s37, s36, 3014656
    buffer_load_dwordx4 v[172:175], v46, s[72:75], s37 offen

    s_add_u32 s37, s36, 3145728
    buffer_load_dwordx4 v[176:179], v46, s[72:75], s37 offen

    s_add_u32 s37, s36, 3276800
    buffer_load_dwordx4 v[180:183], v46, s[72:75], s37 offen

    s_add_u32 s37, s36, 3407872
    buffer_load_dwordx4 v[184:187], v46, s[72:75], s37 offen

    s_add_u32 s37, s36, 3538944
    buffer_load_dwordx4 v[188:191], v46, s[72:75], s37 offen

    s_add_u32 s37, s36, 3670016
    buffer_load_dwordx4 v[192:195], v46, s[72:75], s37 offen

    s_add_u32 s37, s36, 3801088
    buffer_load_dwordx4 v[196:199], v46, s[72:75], s37 offen

    s_add_u32 s37, s36, 3932160
    buffer_load_dwordx4 v[200:203], v46, s[72:75], s37 offen

    s_add_u32 s37, s36, 4063232
    buffer_load_dwordx4 v[204:207], v46, s[72:75], s37 offen

    s_add_u32 s37, s36, 4194304
    buffer_load_dwordx4 v[208:211], v46, s[72:75], s37 offen

    s_add_u32 s37, s36, 4325376
    buffer_load_dwordx4 v[212:215], v46, s[72:75], s37 offen

    s_add_u32 s37, s36, 4456448
    buffer_load_dwordx4 v[216:219], v46, s[72:75], s37 offen

    s_add_u32 s37, s36, 4587520
    buffer_load_dwordx4 v[220:223], v46, s[72:75], s37 offen

    ds_read_b64_tr_b16 a[0:1], v54 offset:0
    ds_read_b64_tr_b16 a[2:3], v54 offset:1024
    ds_read_b64_tr_b16 a[4:5], v54 offset:8192
    ds_read_b64_tr_b16 a[6:7], v54 offset:9216
    ds_read_b64_tr_b16 a[8:9], v54 offset:16384
    ds_read_b64_tr_b16 a[10:11], v54 offset:17408
    ds_read_b64_tr_b16 a[12:13], v54 offset:24576
    ds_read_b64_tr_b16 a[14:15], v54 offset:25600
    ds_read_b64_tr_b16 a[16:17], v54 offset:32768
    ds_read_b64_tr_b16 a[18:19], v54 offset:33792
    ds_read_b64_tr_b16 a[20:21], v54 offset:40960
    ds_read_b64_tr_b16 a[22:23], v54 offset:41984
    s_waitcnt lgkmcnt(0)
    ds_read_b64_tr_b16 a[24:25], v54 offset:49152
    ds_read_b64_tr_b16 a[26:27], v54 offset:50176
    ds_read_b64_tr_b16 a[28:29], v54 offset:57344
    ds_read_b64_tr_b16 a[30:31], v54 offset:58368
    ds_read_b64_tr_b16 a[32:33], v55 offset:0
    ds_read_b64_tr_b16 a[34:35], v55 offset:1024
    ds_read_b64_tr_b16 a[36:37], v55 offset:8192
    ds_read_b64_tr_b16 a[38:39], v55 offset:9216
    ds_read_b64_tr_b16 a[40:41], v55 offset:16384
    ds_read_b64_tr_b16 a[42:43], v55 offset:17408
    ds_read_b64_tr_b16 a[44:45], v55 offset:24576
    ds_read_b64_tr_b16 a[46:47], v55 offset:25600
    s_waitcnt lgkmcnt(0)
    ds_read_b64_tr_b16 a[48:49], v55 offset:32768
    ds_read_b64_tr_b16 a[50:51], v55 offset:33792
    ds_read_b64_tr_b16 a[52:53], v55 offset:40960
    ds_read_b64_tr_b16 a[54:55], v55 offset:41984
    ds_read_b64_tr_b16 a[56:57], v55 offset:49152
    ds_read_b64_tr_b16 a[58:59], v55 offset:50176
    ds_read_b64_tr_b16 a[60:61], v55 offset:57344
    ds_read_b64_tr_b16 a[62:63], v55 offset:58368
    ds_read_b64_tr_b16 a[64:65], v56 offset:0
    ds_read_b64_tr_b16 a[66:67], v56 offset:1024
    ds_read_b64_tr_b16 a[68:69], v56 offset:8192
    ds_read_b64_tr_b16 a[70:71], v56 offset:9216
    s_waitcnt lgkmcnt(0)
    ds_read_b64_tr_b16 a[72:73], v57 offset:0
    ds_read_b64_tr_b16 a[74:75], v57 offset:1024
    ds_read_b64_tr_b16 a[76:77], v57 offset:8192
    ds_read_b64_tr_b16 a[78:79], v57 offset:9216
    ds_read_b64_tr_b16 a[80:81], v57 offset:16384
    ds_read_b64_tr_b16 a[82:83], v57 offset:17408
    ds_read_b64_tr_b16 a[84:85], v57 offset:24576
    ds_read_b64_tr_b16 a[86:87], v57 offset:25600
    ds_read_b64_tr_b16 a[88:89], v57 offset:32768
    ds_read_b64_tr_b16 a[90:91], v57 offset:33792
    ds_read_b64_tr_b16 a[92:93], v57 offset:40960
    ds_read_b64_tr_b16 a[94:95], v57 offset:41984
    s_waitcnt lgkmcnt(0)
    ds_read_b64_tr_b16 a[96:97], v57 offset:49152
    ds_read_b64_tr_b16 a[98:99], v57 offset:50176
    ds_read_b64_tr_b16 a[100:101], v57 offset:57344
    ds_read_b64_tr_b16 a[102:103], v57 offset:58368
    ds_read_b64_tr_b16 a[104:105], v58 offset:0
    ds_read_b64_tr_b16 a[106:107], v58 offset:1024
    ds_read_b64_tr_b16 a[108:109], v58 offset:8192
    ds_read_b64_tr_b16 a[110:111], v58 offset:9216
    ds_read_b64_tr_b16 a[112:113], v58 offset:16384
    ds_read_b64_tr_b16 a[114:115], v58 offset:17408
    ds_read_b64_tr_b16 a[116:117], v58 offset:24576
    ds_read_b64_tr_b16 a[118:119], v58 offset:25600
    s_waitcnt lgkmcnt(0)
    ds_read_b64_tr_b16 a[120:121], v58 offset:32768
    ds_read_b64_tr_b16 a[122:123], v58 offset:33792
    ds_read_b64_tr_b16 a[124:125], v58 offset:40960
    ds_read_b64_tr_b16 a[126:127], v58 offset:41984
    ds_read_b64_tr_b16 a[128:129], v58 offset:49152
    ds_read_b64_tr_b16 a[130:131], v58 offset:50176
    ds_read_b64_tr_b16 a[132:133], v58 offset:57344
    ds_read_b64_tr_b16 a[134:135], v58 offset:58368
    ds_read_b64_tr_b16 a[136:137], v59 offset:0
    ds_read_b64_tr_b16 a[138:139], v59 offset:1024
    ds_read_b64_tr_b16 a[140:141], v59 offset:8192
    ds_read_b64_tr_b16 a[142:143], v59 offset:9216
    s_waitcnt lgkmcnt(0)
    s_waitcnt lgkmcnt(0)
    s_barrier
    s_waitcnt vmcnt(35)
    ds_write_b128 v47, v[80:83] offset:0

    s_waitcnt vmcnt(34)
    ds_write_b128 v47, v[84:87] offset:4096

    s_waitcnt vmcnt(33)
    ds_write_b128 v47, v[88:91] offset:8192

    s_waitcnt vmcnt(32)
    ds_write_b128 v47, v[92:95] offset:12288

    s_waitcnt vmcnt(31)
    ds_write_b128 v47, v[96:99] offset:16384

    s_waitcnt vmcnt(30)
    ds_write_b128 v47, v[100:103] offset:20480

    s_waitcnt vmcnt(29)
    ds_write_b128 v47, v[104:107] offset:24576

    s_waitcnt vmcnt(28)
    ds_write_b128 v47, v[108:111] offset:28672

    s_waitcnt vmcnt(27)
    ds_write_b128 v47, v[112:115] offset:32768

    s_waitcnt vmcnt(26)
    ds_write_b128 v47, v[116:119] offset:36864

    s_waitcnt vmcnt(25)
    ds_write_b128 v47, v[120:123] offset:40960

    s_waitcnt vmcnt(24)
    ds_write_b128 v47, v[124:127] offset:45056

    s_waitcnt vmcnt(23)
    ds_write_b128 v47, v[128:131] offset:49152

    s_waitcnt vmcnt(22)
    ds_write_b128 v47, v[132:135] offset:53248

    s_waitcnt vmcnt(21)
    ds_write_b128 v47, v[136:139] offset:57344

    s_waitcnt vmcnt(20)
    ds_write_b128 v47, v[140:143] offset:61440

    s_waitcnt vmcnt(19)
    ds_write_b128 v48, v[144:147] offset:0

    s_waitcnt vmcnt(18)
    ds_write_b128 v48, v[148:151] offset:4096

    s_waitcnt vmcnt(17)
    ds_write_b128 v48, v[152:155] offset:8192

    s_waitcnt vmcnt(16)
    ds_write_b128 v48, v[156:159] offset:12288

    s_waitcnt vmcnt(15)
    ds_write_b128 v48, v[160:163] offset:16384

    s_waitcnt vmcnt(14)
    ds_write_b128 v48, v[164:167] offset:20480

    s_waitcnt vmcnt(13)
    ds_write_b128 v48, v[168:171] offset:24576

    s_waitcnt vmcnt(12)
    ds_write_b128 v48, v[172:175] offset:28672

    s_waitcnt vmcnt(11)
    ds_write_b128 v48, v[176:179] offset:32768

    s_waitcnt vmcnt(10)
    ds_write_b128 v48, v[180:183] offset:36864

    s_waitcnt vmcnt(9)
    ds_write_b128 v48, v[184:187] offset:40960

    s_waitcnt vmcnt(8)
    ds_write_b128 v48, v[188:191] offset:45056

    s_waitcnt vmcnt(7)
    ds_write_b128 v48, v[192:195] offset:49152

    s_waitcnt vmcnt(6)
    ds_write_b128 v48, v[196:199] offset:53248

    s_waitcnt vmcnt(5)
    ds_write_b128 v48, v[200:203] offset:57344

    s_waitcnt vmcnt(4)
    ds_write_b128 v48, v[204:207] offset:61440

    s_waitcnt vmcnt(3)
    ds_write_b128 v49, v[208:211] offset:0

    s_waitcnt vmcnt(2)
    ds_write_b128 v49, v[212:215] offset:4096

    s_waitcnt vmcnt(1)
    ds_write_b128 v49, v[216:219] offset:8192

    s_waitcnt vmcnt(0)
    ds_write_b128 v49, v[220:223] offset:12288

    s_waitcnt lgkmcnt(0)
    s_barrier
    s_mov_b32 s72, s12
    s_and_b32 s73, s13, 0xffff
    s_mov_b32 s74, 4718592
    s_mov_b32 s75, 0x00020000

    s_lshl_b32 s36, s20, 8
    s_add_u32 s37, s36, 0
    buffer_load_dwordx4 v[112:115], v46, s[72:75], s37 offen

    s_add_u32 s37, s36, 131072
    buffer_load_dwordx4 v[116:119], v46, s[72:75], s37 offen

    s_add_u32 s37, s36, 262144
    buffer_load_dwordx4 v[120:123], v46, s[72:75], s37 offen

    s_add_u32 s37, s36, 393216
    buffer_load_dwordx4 v[124:127], v46, s[72:75], s37 offen

    s_add_u32 s37, s36, 524288
    buffer_load_dwordx4 v[128:131], v46, s[72:75], s37 offen

    s_add_u32 s37, s36, 655360
    buffer_load_dwordx4 v[132:135], v46, s[72:75], s37 offen

    s_add_u32 s37, s36, 786432
    buffer_load_dwordx4 v[136:139], v46, s[72:75], s37 offen

    s_add_u32 s37, s36, 917504
    buffer_load_dwordx4 v[140:143], v46, s[72:75], s37 offen

    s_add_u32 s37, s36, 1048576
    buffer_load_dwordx4 v[144:147], v46, s[72:75], s37 offen

    s_add_u32 s37, s36, 1179648
    buffer_load_dwordx4 v[148:151], v46, s[72:75], s37 offen

    s_add_u32 s37, s36, 1310720
    buffer_load_dwordx4 v[152:155], v46, s[72:75], s37 offen

    s_add_u32 s37, s36, 1441792
    buffer_load_dwordx4 v[156:159], v46, s[72:75], s37 offen

    s_add_u32 s37, s36, 1572864
    buffer_load_dwordx4 v[160:163], v46, s[72:75], s37 offen

    s_add_u32 s37, s36, 1703936
    buffer_load_dwordx4 v[164:167], v46, s[72:75], s37 offen

    s_add_u32 s37, s36, 1835008
    buffer_load_dwordx4 v[168:171], v46, s[72:75], s37 offen

    s_add_u32 s37, s36, 1966080
    buffer_load_dwordx4 v[172:175], v46, s[72:75], s37 offen

    s_add_u32 s37, s36, 2097152
    buffer_load_dwordx4 v[176:179], v46, s[72:75], s37 offen

    s_add_u32 s37, s36, 2228224
    buffer_load_dwordx4 v[180:183], v46, s[72:75], s37 offen

    s_add_u32 s37, s36, 2359296
    buffer_load_dwordx4 v[184:187], v46, s[72:75], s37 offen

    s_add_u32 s37, s36, 2490368
    buffer_load_dwordx4 v[188:191], v46, s[72:75], s37 offen

    s_add_u32 s37, s36, 2621440
    buffer_load_dwordx4 v[192:195], v46, s[72:75], s37 offen

    s_add_u32 s37, s36, 2752512
    buffer_load_dwordx4 v[196:199], v46, s[72:75], s37 offen

    s_add_u32 s37, s36, 2883584
    buffer_load_dwordx4 v[200:203], v46, s[72:75], s37 offen

    s_add_u32 s37, s36, 3014656
    buffer_load_dwordx4 v[204:207], v46, s[72:75], s37 offen

    s_add_u32 s37, s36, 3145728
    buffer_load_dwordx4 v[208:211], v46, s[72:75], s37 offen

    s_add_u32 s37, s36, 3276800
    buffer_load_dwordx4 v[212:215], v46, s[72:75], s37 offen

    s_add_u32 s37, s36, 3407872
    buffer_load_dwordx4 v[216:219], v46, s[72:75], s37 offen

    s_add_u32 s37, s36, 3538944
    buffer_load_dwordx4 v[220:223], v46, s[72:75], s37 offen

    s_add_u32 s37, s36, 3670016
    buffer_load_dwordx4 v[224:227], v46, s[72:75], s37 offen

    s_add_u32 s37, s36, 3801088
    buffer_load_dwordx4 v[228:231], v46, s[72:75], s37 offen

    s_add_u32 s37, s36, 3932160
    buffer_load_dwordx4 v[232:235], v46, s[72:75], s37 offen

    s_add_u32 s37, s36, 4063232
    buffer_load_dwordx4 v[236:239], v46, s[72:75], s37 offen

    s_add_u32 s37, s36, 4194304
    buffer_load_dwordx4 v[240:243], v46, s[72:75], s37 offen

    s_add_u32 s37, s36, 4325376
    buffer_load_dwordx4 v[244:247], v46, s[72:75], s37 offen

    s_add_u32 s37, s36, 4456448
    buffer_load_dwordx4 v[248:251], v46, s[72:75], s37 offen

    s_add_u32 s37, s36, 4587520
    buffer_load_dwordx4 v[252:255], v46, s[72:75], s37 offen

    ds_read_b64_tr_b16 a[144:145], v54 offset:0
    ds_read_b64_tr_b16 a[146:147], v54 offset:1024
    ds_read_b64_tr_b16 a[148:149], v54 offset:8192
    ds_read_b64_tr_b16 a[150:151], v54 offset:9216
    ds_read_b64_tr_b16 a[152:153], v54 offset:16384
    ds_read_b64_tr_b16 a[154:155], v54 offset:17408
    ds_read_b64_tr_b16 a[156:157], v54 offset:24576
    ds_read_b64_tr_b16 a[158:159], v54 offset:25600
    ds_read_b64_tr_b16 a[160:161], v54 offset:32768
    ds_read_b64_tr_b16 a[162:163], v54 offset:33792
    ds_read_b64_tr_b16 a[164:165], v54 offset:40960
    ds_read_b64_tr_b16 a[166:167], v54 offset:41984
    s_waitcnt lgkmcnt(0)
    ds_read_b64_tr_b16 a[168:169], v54 offset:49152
    ds_read_b64_tr_b16 a[170:171], v54 offset:50176
    ds_read_b64_tr_b16 a[172:173], v54 offset:57344
    ds_read_b64_tr_b16 a[174:175], v54 offset:58368
    ds_read_b64_tr_b16 a[176:177], v55 offset:0
    ds_read_b64_tr_b16 a[178:179], v55 offset:1024
    ds_read_b64_tr_b16 a[180:181], v55 offset:8192
    ds_read_b64_tr_b16 a[182:183], v55 offset:9216
    ds_read_b64_tr_b16 a[184:185], v55 offset:16384
    ds_read_b64_tr_b16 a[186:187], v55 offset:17408
    ds_read_b64_tr_b16 a[188:189], v55 offset:24576
    ds_read_b64_tr_b16 a[190:191], v55 offset:25600
    s_waitcnt lgkmcnt(0)
    ds_read_b64_tr_b16 a[192:193], v55 offset:32768
    ds_read_b64_tr_b16 a[194:195], v55 offset:33792
    ds_read_b64_tr_b16 a[196:197], v55 offset:40960
    ds_read_b64_tr_b16 a[198:199], v55 offset:41984
    ds_read_b64_tr_b16 a[200:201], v55 offset:49152
    ds_read_b64_tr_b16 a[202:203], v55 offset:50176
    ds_read_b64_tr_b16 a[204:205], v55 offset:57344
    ds_read_b64_tr_b16 a[206:207], v55 offset:58368
    ds_read_b64_tr_b16 a[208:209], v56 offset:0
    ds_read_b64_tr_b16 a[210:211], v56 offset:1024
    ds_read_b64_tr_b16 a[212:213], v56 offset:8192
    ds_read_b64_tr_b16 a[214:215], v56 offset:9216
    s_waitcnt lgkmcnt(0)
    ds_read_b64_tr_b16 a[216:217], v57 offset:0
    ds_read_b64_tr_b16 a[218:219], v57 offset:1024
    ds_read_b64_tr_b16 a[220:221], v57 offset:8192
    ds_read_b64_tr_b16 a[222:223], v57 offset:9216
    ds_read_b64_tr_b16 a[224:225], v57 offset:16384
    ds_read_b64_tr_b16 a[226:227], v57 offset:17408
    ds_read_b64_tr_b16 a[228:229], v57 offset:24576
    ds_read_b64_tr_b16 a[230:231], v57 offset:25600
    ds_read_b64_tr_b16 a[232:233], v57 offset:32768
    ds_read_b64_tr_b16 a[234:235], v57 offset:33792
    ds_read_b64_tr_b16 a[236:237], v57 offset:40960
    ds_read_b64_tr_b16 a[238:239], v57 offset:41984
    s_waitcnt lgkmcnt(0)
    ds_read_b64_tr_b16 a[240:241], v57 offset:49152
    ds_read_b64_tr_b16 a[242:243], v57 offset:50176
    ds_read_b64_tr_b16 a[244:245], v57 offset:57344
    ds_read_b64_tr_b16 a[246:247], v57 offset:58368
    ds_read_b64_tr_b16 a[248:249], v58 offset:0
    ds_read_b64_tr_b16 a[250:251], v58 offset:1024
    ds_read_b64_tr_b16 a[252:253], v58 offset:8192
    ds_read_b64_tr_b16 a[254:255], v58 offset:9216
    ds_read_b64_tr_b16 v[80:81], v58 offset:16384
    ds_read_b64_tr_b16 v[82:83], v58 offset:17408
    ds_read_b64_tr_b16 v[84:85], v58 offset:24576
    ds_read_b64_tr_b16 v[86:87], v58 offset:25600
    s_waitcnt lgkmcnt(0)
    ds_read_b64_tr_b16 v[88:89], v58 offset:32768
    ds_read_b64_tr_b16 v[90:91], v58 offset:33792
    ds_read_b64_tr_b16 v[92:93], v58 offset:40960
    ds_read_b64_tr_b16 v[94:95], v58 offset:41984
    ds_read_b64_tr_b16 v[96:97], v58 offset:49152
    ds_read_b64_tr_b16 v[98:99], v58 offset:50176
    ds_read_b64_tr_b16 v[100:101], v58 offset:57344
    ds_read_b64_tr_b16 v[102:103], v58 offset:58368
    ds_read_b64_tr_b16 v[104:105], v59 offset:0
    ds_read_b64_tr_b16 v[106:107], v59 offset:1024
    ds_read_b64_tr_b16 v[108:109], v59 offset:8192
    ds_read_b64_tr_b16 v[110:111], v59 offset:9216
    s_waitcnt lgkmcnt(0)
    s_waitcnt lgkmcnt(0)
    s_barrier
    s_waitcnt vmcnt(35)
    ds_write_b128 v47, v[112:115] offset:0

    s_waitcnt vmcnt(34)
    ds_write_b128 v47, v[116:119] offset:4096

    s_waitcnt vmcnt(33)
    ds_write_b128 v47, v[120:123] offset:8192

    s_waitcnt vmcnt(32)
    ds_write_b128 v47, v[124:127] offset:12288

    s_waitcnt vmcnt(31)
    ds_write_b128 v47, v[128:131] offset:16384

    s_waitcnt vmcnt(30)
    ds_write_b128 v47, v[132:135] offset:20480

    s_waitcnt vmcnt(29)
    ds_write_b128 v47, v[136:139] offset:24576

    s_waitcnt vmcnt(28)
    ds_write_b128 v47, v[140:143] offset:28672

    s_waitcnt vmcnt(27)
    ds_write_b128 v47, v[144:147] offset:32768

    s_waitcnt vmcnt(26)
    ds_write_b128 v47, v[148:151] offset:36864

    s_waitcnt vmcnt(25)
    ds_write_b128 v47, v[152:155] offset:40960

    s_waitcnt vmcnt(24)
    ds_write_b128 v47, v[156:159] offset:45056

    s_waitcnt vmcnt(23)
    ds_write_b128 v47, v[160:163] offset:49152

    s_waitcnt vmcnt(22)
    ds_write_b128 v47, v[164:167] offset:53248

    s_waitcnt vmcnt(21)
    ds_write_b128 v47, v[168:171] offset:57344

    s_waitcnt vmcnt(20)
    ds_write_b128 v47, v[172:175] offset:61440

    s_waitcnt vmcnt(19)
    ds_write_b128 v48, v[176:179] offset:0

    s_waitcnt vmcnt(18)
    ds_write_b128 v48, v[180:183] offset:4096

    s_waitcnt vmcnt(17)
    ds_write_b128 v48, v[184:187] offset:8192

    s_waitcnt vmcnt(16)
    ds_write_b128 v48, v[188:191] offset:12288

    s_waitcnt vmcnt(15)
    ds_write_b128 v48, v[192:195] offset:16384

    s_waitcnt vmcnt(14)
    ds_write_b128 v48, v[196:199] offset:20480

    s_waitcnt vmcnt(13)
    ds_write_b128 v48, v[200:203] offset:24576

    s_waitcnt vmcnt(12)
    ds_write_b128 v48, v[204:207] offset:28672

    s_waitcnt vmcnt(11)
    ds_write_b128 v48, v[208:211] offset:32768

    s_waitcnt vmcnt(10)
    ds_write_b128 v48, v[212:215] offset:36864

    s_waitcnt vmcnt(9)
    ds_write_b128 v48, v[216:219] offset:40960

    s_waitcnt vmcnt(8)
    ds_write_b128 v48, v[220:223] offset:45056

    s_waitcnt vmcnt(7)
    ds_write_b128 v48, v[224:227] offset:49152

    s_waitcnt vmcnt(6)
    ds_write_b128 v48, v[228:231] offset:53248

    s_waitcnt vmcnt(5)
    ds_write_b128 v48, v[232:235] offset:57344

    s_waitcnt vmcnt(4)
    ds_write_b128 v48, v[236:239] offset:61440

    s_waitcnt vmcnt(3)
    ds_write_b128 v49, v[240:243] offset:0

    s_waitcnt vmcnt(2)
    ds_write_b128 v49, v[244:247] offset:4096

    s_waitcnt vmcnt(1)
    ds_write_b128 v49, v[248:251] offset:8192

    s_waitcnt vmcnt(0)
    ds_write_b128 v49, v[252:255] offset:12288

    s_waitcnt lgkmcnt(0)
    s_barrier
    ds_read_b64_tr_b16 v[112:113], v54 offset:0
    ds_read_b64_tr_b16 v[114:115], v54 offset:1024
    ds_read_b64_tr_b16 v[116:117], v54 offset:8192
    ds_read_b64_tr_b16 v[118:119], v54 offset:9216
    ds_read_b64_tr_b16 v[120:121], v54 offset:16384
    ds_read_b64_tr_b16 v[122:123], v54 offset:17408
    ds_read_b64_tr_b16 v[124:125], v54 offset:24576
    ds_read_b64_tr_b16 v[126:127], v54 offset:25600
    ds_read_b64_tr_b16 v[128:129], v54 offset:32768
    ds_read_b64_tr_b16 v[130:131], v54 offset:33792
    ds_read_b64_tr_b16 v[132:133], v54 offset:40960
    ds_read_b64_tr_b16 v[134:135], v54 offset:41984
    s_waitcnt lgkmcnt(0)
    ds_read_b64_tr_b16 v[136:137], v54 offset:49152
    ds_read_b64_tr_b16 v[138:139], v54 offset:50176
    ds_read_b64_tr_b16 v[140:141], v54 offset:57344
    ds_read_b64_tr_b16 v[142:143], v54 offset:58368
    ds_read_b64_tr_b16 v[144:145], v55 offset:0
    ds_read_b64_tr_b16 v[146:147], v55 offset:1024
    ds_read_b64_tr_b16 v[148:149], v55 offset:8192
    ds_read_b64_tr_b16 v[150:151], v55 offset:9216
    ds_read_b64_tr_b16 v[152:153], v55 offset:16384
    ds_read_b64_tr_b16 v[154:155], v55 offset:17408
    ds_read_b64_tr_b16 v[156:157], v55 offset:24576
    ds_read_b64_tr_b16 v[158:159], v55 offset:25600
    s_waitcnt lgkmcnt(0)
    ds_read_b64_tr_b16 v[160:161], v55 offset:32768
    ds_read_b64_tr_b16 v[162:163], v55 offset:33792
    ds_read_b64_tr_b16 v[164:165], v55 offset:40960
    ds_read_b64_tr_b16 v[166:167], v55 offset:41984
    ds_read_b64_tr_b16 v[168:169], v55 offset:49152
    ds_read_b64_tr_b16 v[170:171], v55 offset:50176
    ds_read_b64_tr_b16 v[172:173], v55 offset:57344
    ds_read_b64_tr_b16 v[174:175], v55 offset:58368
    ds_read_b64_tr_b16 v[176:177], v56 offset:0
    ds_read_b64_tr_b16 v[178:179], v56 offset:1024
    ds_read_b64_tr_b16 v[180:181], v56 offset:8192
    ds_read_b64_tr_b16 v[182:183], v56 offset:9216
    s_waitcnt lgkmcnt(0)
    ds_read_b64_tr_b16 v[184:185], v57 offset:0
    ds_read_b64_tr_b16 v[186:187], v57 offset:1024
    ds_read_b64_tr_b16 v[188:189], v57 offset:8192
    ds_read_b64_tr_b16 v[190:191], v57 offset:9216
    ds_read_b64_tr_b16 v[192:193], v57 offset:16384
    ds_read_b64_tr_b16 v[194:195], v57 offset:17408
    ds_read_b64_tr_b16 v[196:197], v57 offset:24576
    ds_read_b64_tr_b16 v[198:199], v57 offset:25600
    ds_read_b64_tr_b16 v[200:201], v57 offset:32768
    ds_read_b64_tr_b16 v[202:203], v57 offset:33792
    ds_read_b64_tr_b16 v[204:205], v57 offset:40960
    ds_read_b64_tr_b16 v[206:207], v57 offset:41984
    s_waitcnt lgkmcnt(0)
    ds_read_b64_tr_b16 v[208:209], v57 offset:49152
    ds_read_b64_tr_b16 v[210:211], v57 offset:50176
    ds_read_b64_tr_b16 v[212:213], v57 offset:57344
    ds_read_b64_tr_b16 v[214:215], v57 offset:58368
    ds_read_b64_tr_b16 v[216:217], v58 offset:0
    ds_read_b64_tr_b16 v[218:219], v58 offset:1024
    ds_read_b64_tr_b16 v[220:221], v58 offset:8192
    ds_read_b64_tr_b16 v[222:223], v58 offset:9216
    ds_read_b64_tr_b16 v[224:225], v58 offset:16384
    ds_read_b64_tr_b16 v[226:227], v58 offset:17408
    ds_read_b64_tr_b16 v[228:229], v58 offset:24576
    ds_read_b64_tr_b16 v[230:231], v58 offset:25600
    s_waitcnt lgkmcnt(0)
    ds_read_b64_tr_b16 v[232:233], v58 offset:32768
    ds_read_b64_tr_b16 v[234:235], v58 offset:33792
    ds_read_b64_tr_b16 v[236:237], v58 offset:40960
    ds_read_b64_tr_b16 v[238:239], v58 offset:41984
    ds_read_b64_tr_b16 v[240:241], v58 offset:49152
    ds_read_b64_tr_b16 v[242:243], v58 offset:50176
    ds_read_b64_tr_b16 v[244:245], v58 offset:57344
    ds_read_b64_tr_b16 v[246:247], v58 offset:58368
    ds_read_b64_tr_b16 v[248:249], v59 offset:0
    ds_read_b64_tr_b16 v[250:251], v59 offset:1024
    ds_read_b64_tr_b16 v[252:253], v59 offset:8192
    ds_read_b64_tr_b16 v[254:255], v59 offset:9216
    s_waitcnt lgkmcnt(0)
    s_waitcnt lgkmcnt(0)
    s_barrier
    s_mov_b32 s72, s14
    s_and_b32 s73, s15, 0xffff
    s_mov_b32 s74, 4718592
    s_mov_b32 s75, 0x00020000

    s_mul_i32 s36, s20, 147456
    v_lshlrev_b32 v46, 4, v0
    s_mov_b32 s38, 58255

    s_add_u32 s37, s36, 0
    buffer_load_dwordx4 v[4:7], v46, s[72:75], s37 offen

    s_add_u32 s37, s36, 4096
    buffer_load_dwordx4 v[8:11], v46, s[72:75], s37 offen

    s_add_u32 s37, s36, 8192
    buffer_load_dwordx4 v[12:15], v46, s[72:75], s37 offen

    s_add_u32 s37, s36, 12288
    buffer_load_dwordx4 v[16:19], v46, s[72:75], s37 offen

    s_add_u32 s37, s36, 16384
    buffer_load_dwordx4 v[20:23], v46, s[72:75], s37 offen

    s_add_u32 s37, s36, 20480
    buffer_load_dwordx4 v[24:27], v46, s[72:75], s37 offen

    s_add_u32 s37, s36, 24576
    buffer_load_dwordx4 v[28:31], v46, s[72:75], s37 offen

    s_add_u32 s37, s36, 28672
    buffer_load_dwordx4 v[32:35], v46, s[72:75], s37 offen

    s_add_u32 s37, s36, 32768
    buffer_load_dwordx4 v[36:39], v46, s[72:75], s37 offen

    v_add_u32 v47, 0, v0
    v_mul_lo_u32 v48, v47, s38
    v_lshrrev_b32 v48, 22, v48
    v_mul_u32_u24 v49, 72, v48
    v_sub_u32 v47, v47, v49
    v_bfe_u32 v49, v48, 1, 1
    v_bfe_u32 v50, v48, 3, 1
    v_lshl_add_u32 v49, v50, 1, v49
    v_lshrrev_b32 v50, 1, v47
    v_xor_b32 v49, v49, v50
    v_lshlrev_b32 v49, 5, v49
    v_and_b32 v47, 1, v47
    v_lshl_add_u32 v49, v47, 4, v49
    v_mul_u32_u24 v48, 1152, v48
    v_add_u32 v49, v49, v48
    s_waitcnt vmcnt(8)
    ds_write_b128 v49, v[4:7]

    v_add_u32 v47, 256, v0
    v_mul_lo_u32 v48, v47, s38
    v_lshrrev_b32 v48, 22, v48
    v_mul_u32_u24 v49, 72, v48
    v_sub_u32 v47, v47, v49
    v_bfe_u32 v49, v48, 1, 1
    v_bfe_u32 v50, v48, 3, 1
    v_lshl_add_u32 v49, v50, 1, v49
    v_lshrrev_b32 v50, 1, v47
    v_xor_b32 v49, v49, v50
    v_lshlrev_b32 v49, 5, v49
    v_and_b32 v47, 1, v47
    v_lshl_add_u32 v49, v47, 4, v49
    v_mul_u32_u24 v48, 1152, v48
    v_add_u32 v49, v49, v48
    s_waitcnt vmcnt(7)
    ds_write_b128 v49, v[8:11]

    v_add_u32 v47, 512, v0
    v_mul_lo_u32 v48, v47, s38
    v_lshrrev_b32 v48, 22, v48
    v_mul_u32_u24 v49, 72, v48
    v_sub_u32 v47, v47, v49
    v_bfe_u32 v49, v48, 1, 1
    v_bfe_u32 v50, v48, 3, 1
    v_lshl_add_u32 v49, v50, 1, v49
    v_lshrrev_b32 v50, 1, v47
    v_xor_b32 v49, v49, v50
    v_lshlrev_b32 v49, 5, v49
    v_and_b32 v47, 1, v47
    v_lshl_add_u32 v49, v47, 4, v49
    v_mul_u32_u24 v48, 1152, v48
    v_add_u32 v49, v49, v48
    s_waitcnt vmcnt(6)
    ds_write_b128 v49, v[12:15]

    v_add_u32 v47, 768, v0
    v_mul_lo_u32 v48, v47, s38
    v_lshrrev_b32 v48, 22, v48
    v_mul_u32_u24 v49, 72, v48
    v_sub_u32 v47, v47, v49
    v_bfe_u32 v49, v48, 1, 1
    v_bfe_u32 v50, v48, 3, 1
    v_lshl_add_u32 v49, v50, 1, v49
    v_lshrrev_b32 v50, 1, v47
    v_xor_b32 v49, v49, v50
    v_lshlrev_b32 v49, 5, v49
    v_and_b32 v47, 1, v47
    v_lshl_add_u32 v49, v47, 4, v49
    v_mul_u32_u24 v48, 1152, v48
    v_add_u32 v49, v49, v48
    s_waitcnt vmcnt(5)
    ds_write_b128 v49, v[16:19]

    v_add_u32 v47, 1024, v0
    v_mul_lo_u32 v48, v47, s38
    v_lshrrev_b32 v48, 22, v48
    v_mul_u32_u24 v49, 72, v48
    v_sub_u32 v47, v47, v49
    v_bfe_u32 v49, v48, 1, 1
    v_bfe_u32 v50, v48, 3, 1
    v_lshl_add_u32 v49, v50, 1, v49
    v_lshrrev_b32 v50, 1, v47
    v_xor_b32 v49, v49, v50
    v_lshlrev_b32 v49, 5, v49
    v_and_b32 v47, 1, v47
    v_lshl_add_u32 v49, v47, 4, v49
    v_mul_u32_u24 v48, 1152, v48
    v_add_u32 v49, v49, v48
    s_waitcnt vmcnt(4)
    ds_write_b128 v49, v[20:23]

    v_add_u32 v47, 1280, v0
    v_mul_lo_u32 v48, v47, s38
    v_lshrrev_b32 v48, 22, v48
    v_mul_u32_u24 v49, 72, v48
    v_sub_u32 v47, v47, v49
    v_bfe_u32 v49, v48, 1, 1
    v_bfe_u32 v50, v48, 3, 1
    v_lshl_add_u32 v49, v50, 1, v49
    v_lshrrev_b32 v50, 1, v47
    v_xor_b32 v49, v49, v50
    v_lshlrev_b32 v49, 5, v49
    v_and_b32 v47, 1, v47
    v_lshl_add_u32 v49, v47, 4, v49
    v_mul_u32_u24 v48, 1152, v48
    v_add_u32 v49, v49, v48
    s_waitcnt vmcnt(3)
    ds_write_b128 v49, v[24:27]

    v_add_u32 v47, 1536, v0
    v_mul_lo_u32 v48, v47, s38
    v_lshrrev_b32 v48, 22, v48
    v_mul_u32_u24 v49, 72, v48
    v_sub_u32 v47, v47, v49
    v_bfe_u32 v49, v48, 1, 1
    v_bfe_u32 v50, v48, 3, 1
    v_lshl_add_u32 v49, v50, 1, v49
    v_lshrrev_b32 v50, 1, v47
    v_xor_b32 v49, v49, v50
    v_lshlrev_b32 v49, 5, v49
    v_and_b32 v47, 1, v47
    v_lshl_add_u32 v49, v47, 4, v49
    v_mul_u32_u24 v48, 1152, v48
    v_add_u32 v49, v49, v48
    s_waitcnt vmcnt(2)
    ds_write_b128 v49, v[28:31]

    v_add_u32 v47, 1792, v0
    v_mul_lo_u32 v48, v47, s38
    v_lshrrev_b32 v48, 22, v48
    v_mul_u32_u24 v49, 72, v48
    v_sub_u32 v47, v47, v49
    v_bfe_u32 v49, v48, 1, 1
    v_bfe_u32 v50, v48, 3, 1
    v_lshl_add_u32 v49, v50, 1, v49
    v_lshrrev_b32 v50, 1, v47
    v_xor_b32 v49, v49, v50
    v_lshlrev_b32 v49, 5, v49
    v_and_b32 v47, 1, v47
    v_lshl_add_u32 v49, v47, 4, v49
    v_mul_u32_u24 v48, 1152, v48
    v_add_u32 v49, v49, v48
    s_waitcnt vmcnt(1)
    ds_write_b128 v49, v[32:35]

    v_add_u32 v47, 2048, v0
    v_mul_lo_u32 v48, v47, s38
    v_lshrrev_b32 v48, 22, v48
    v_mul_u32_u24 v49, 72, v48
    v_sub_u32 v47, v47, v49
    v_bfe_u32 v49, v48, 1, 1
    v_bfe_u32 v50, v48, 3, 1
    v_lshl_add_u32 v49, v50, 1, v49
    v_lshrrev_b32 v50, 1, v47
    v_xor_b32 v49, v49, v50
    v_lshlrev_b32 v49, 5, v49
    v_and_b32 v47, 1, v47
    v_lshl_add_u32 v49, v47, 4, v49
    v_mul_u32_u24 v48, 1152, v48
    v_add_u32 v49, v49, v48
    s_waitcnt vmcnt(0)
    ds_write_b128 v49, v[36:39]

    s_add_u32 s37, s36, 36864
    buffer_load_dwordx4 v[4:7], v46, s[72:75], s37 offen

    s_add_u32 s37, s36, 40960
    buffer_load_dwordx4 v[8:11], v46, s[72:75], s37 offen

    s_add_u32 s37, s36, 45056
    buffer_load_dwordx4 v[12:15], v46, s[72:75], s37 offen

    s_add_u32 s37, s36, 49152
    buffer_load_dwordx4 v[16:19], v46, s[72:75], s37 offen

    s_add_u32 s37, s36, 53248
    buffer_load_dwordx4 v[20:23], v46, s[72:75], s37 offen

    s_add_u32 s37, s36, 57344
    buffer_load_dwordx4 v[24:27], v46, s[72:75], s37 offen

    s_add_u32 s37, s36, 61440
    buffer_load_dwordx4 v[28:31], v46, s[72:75], s37 offen

    s_add_u32 s37, s36, 65536
    buffer_load_dwordx4 v[32:35], v46, s[72:75], s37 offen

    s_add_u32 s37, s36, 69632
    buffer_load_dwordx4 v[36:39], v46, s[72:75], s37 offen

    v_add_u32 v47, 2304, v0
    v_mul_lo_u32 v48, v47, s38
    v_lshrrev_b32 v48, 22, v48
    v_mul_u32_u24 v49, 72, v48
    v_sub_u32 v47, v47, v49
    v_bfe_u32 v49, v48, 1, 1
    v_bfe_u32 v50, v48, 3, 1
    v_lshl_add_u32 v49, v50, 1, v49
    v_lshrrev_b32 v50, 1, v47
    v_xor_b32 v49, v49, v50
    v_lshlrev_b32 v49, 5, v49
    v_and_b32 v47, 1, v47
    v_lshl_add_u32 v49, v47, 4, v49
    v_mul_u32_u24 v48, 1152, v48
    v_add_u32 v49, v49, v48
    s_waitcnt vmcnt(8)
    ds_write_b128 v49, v[4:7]

    v_add_u32 v47, 2560, v0
    v_mul_lo_u32 v48, v47, s38
    v_lshrrev_b32 v48, 22, v48
    v_mul_u32_u24 v49, 72, v48
    v_sub_u32 v47, v47, v49
    v_bfe_u32 v49, v48, 1, 1
    v_bfe_u32 v50, v48, 3, 1
    v_lshl_add_u32 v49, v50, 1, v49
    v_lshrrev_b32 v50, 1, v47
    v_xor_b32 v49, v49, v50
    v_lshlrev_b32 v49, 5, v49
    v_and_b32 v47, 1, v47
    v_lshl_add_u32 v49, v47, 4, v49
    v_mul_u32_u24 v48, 1152, v48
    v_add_u32 v49, v49, v48
    s_waitcnt vmcnt(7)
    ds_write_b128 v49, v[8:11]

    v_add_u32 v47, 2816, v0
    v_mul_lo_u32 v48, v47, s38
    v_lshrrev_b32 v48, 22, v48
    v_mul_u32_u24 v49, 72, v48
    v_sub_u32 v47, v47, v49
    v_bfe_u32 v49, v48, 1, 1
    v_bfe_u32 v50, v48, 3, 1
    v_lshl_add_u32 v49, v50, 1, v49
    v_lshrrev_b32 v50, 1, v47
    v_xor_b32 v49, v49, v50
    v_lshlrev_b32 v49, 5, v49
    v_and_b32 v47, 1, v47
    v_lshl_add_u32 v49, v47, 4, v49
    v_mul_u32_u24 v48, 1152, v48
    v_add_u32 v49, v49, v48
    s_waitcnt vmcnt(6)
    ds_write_b128 v49, v[12:15]

    v_add_u32 v47, 3072, v0
    v_mul_lo_u32 v48, v47, s38
    v_lshrrev_b32 v48, 22, v48
    v_mul_u32_u24 v49, 72, v48
    v_sub_u32 v47, v47, v49
    v_bfe_u32 v49, v48, 1, 1
    v_bfe_u32 v50, v48, 3, 1
    v_lshl_add_u32 v49, v50, 1, v49
    v_lshrrev_b32 v50, 1, v47
    v_xor_b32 v49, v49, v50
    v_lshlrev_b32 v49, 5, v49
    v_and_b32 v47, 1, v47
    v_lshl_add_u32 v49, v47, 4, v49
    v_mul_u32_u24 v48, 1152, v48
    v_add_u32 v49, v49, v48
    s_waitcnt vmcnt(5)
    ds_write_b128 v49, v[16:19]

    v_add_u32 v47, 3328, v0
    v_mul_lo_u32 v48, v47, s38
    v_lshrrev_b32 v48, 22, v48
    v_mul_u32_u24 v49, 72, v48
    v_sub_u32 v47, v47, v49
    v_bfe_u32 v49, v48, 1, 1
    v_bfe_u32 v50, v48, 3, 1
    v_lshl_add_u32 v49, v50, 1, v49
    v_lshrrev_b32 v50, 1, v47
    v_xor_b32 v49, v49, v50
    v_lshlrev_b32 v49, 5, v49
    v_and_b32 v47, 1, v47
    v_lshl_add_u32 v49, v47, 4, v49
    v_mul_u32_u24 v48, 1152, v48
    v_add_u32 v49, v49, v48
    s_waitcnt vmcnt(4)
    ds_write_b128 v49, v[20:23]

    v_add_u32 v47, 3584, v0
    v_mul_lo_u32 v48, v47, s38
    v_lshrrev_b32 v48, 22, v48
    v_mul_u32_u24 v49, 72, v48
    v_sub_u32 v47, v47, v49
    v_bfe_u32 v49, v48, 1, 1
    v_bfe_u32 v50, v48, 3, 1
    v_lshl_add_u32 v49, v50, 1, v49
    v_lshrrev_b32 v50, 1, v47
    v_xor_b32 v49, v49, v50
    v_lshlrev_b32 v49, 5, v49
    v_and_b32 v47, 1, v47
    v_lshl_add_u32 v49, v47, 4, v49
    v_mul_u32_u24 v48, 1152, v48
    v_add_u32 v49, v49, v48
    s_waitcnt vmcnt(3)
    ds_write_b128 v49, v[24:27]

    v_add_u32 v47, 3840, v0
    v_mul_lo_u32 v48, v47, s38
    v_lshrrev_b32 v48, 22, v48
    v_mul_u32_u24 v49, 72, v48
    v_sub_u32 v47, v47, v49
    v_bfe_u32 v49, v48, 1, 1
    v_bfe_u32 v50, v48, 3, 1
    v_lshl_add_u32 v49, v50, 1, v49
    v_lshrrev_b32 v50, 1, v47
    v_xor_b32 v49, v49, v50
    v_lshlrev_b32 v49, 5, v49
    v_and_b32 v47, 1, v47
    v_lshl_add_u32 v49, v47, 4, v49
    v_mul_u32_u24 v48, 1152, v48
    v_add_u32 v49, v49, v48
    s_waitcnt vmcnt(2)
    ds_write_b128 v49, v[28:31]

    v_add_u32 v47, 4096, v0
    v_mul_lo_u32 v48, v47, s38
    v_lshrrev_b32 v48, 22, v48
    v_mul_u32_u24 v49, 72, v48
    v_sub_u32 v47, v47, v49
    v_bfe_u32 v49, v48, 1, 1
    v_bfe_u32 v50, v48, 3, 1
    v_lshl_add_u32 v49, v50, 1, v49
    v_lshrrev_b32 v50, 1, v47
    v_xor_b32 v49, v49, v50
    v_lshlrev_b32 v49, 5, v49
    v_and_b32 v47, 1, v47
    v_lshl_add_u32 v49, v47, 4, v49
    v_mul_u32_u24 v48, 1152, v48
    v_add_u32 v49, v49, v48
    s_waitcnt vmcnt(1)
    ds_write_b128 v49, v[32:35]

    v_add_u32 v47, 4352, v0
    v_mul_lo_u32 v48, v47, s38
    v_lshrrev_b32 v48, 22, v48
    v_mul_u32_u24 v49, 72, v48
    v_sub_u32 v47, v47, v49
    v_bfe_u32 v49, v48, 1, 1
    v_bfe_u32 v50, v48, 3, 1
    v_lshl_add_u32 v49, v50, 1, v49
    v_lshrrev_b32 v50, 1, v47
    v_xor_b32 v49, v49, v50
    v_lshlrev_b32 v49, 5, v49
    v_and_b32 v47, 1, v47
    v_lshl_add_u32 v49, v47, 4, v49
    v_mul_u32_u24 v48, 1152, v48
    v_add_u32 v49, v49, v48
    s_waitcnt vmcnt(0)
    ds_write_b128 v49, v[36:39]

    s_add_u32 s37, s36, 73728
    buffer_load_dwordx4 v[4:7], v46, s[72:75], s37 offen

    s_add_u32 s37, s36, 77824
    buffer_load_dwordx4 v[8:11], v46, s[72:75], s37 offen

    s_add_u32 s37, s36, 81920
    buffer_load_dwordx4 v[12:15], v46, s[72:75], s37 offen

    s_add_u32 s37, s36, 86016
    buffer_load_dwordx4 v[16:19], v46, s[72:75], s37 offen

    s_add_u32 s37, s36, 90112
    buffer_load_dwordx4 v[20:23], v46, s[72:75], s37 offen

    s_add_u32 s37, s36, 94208
    buffer_load_dwordx4 v[24:27], v46, s[72:75], s37 offen

    s_add_u32 s37, s36, 98304
    buffer_load_dwordx4 v[28:31], v46, s[72:75], s37 offen

    s_add_u32 s37, s36, 102400
    buffer_load_dwordx4 v[32:35], v46, s[72:75], s37 offen

    s_add_u32 s37, s36, 106496
    buffer_load_dwordx4 v[36:39], v46, s[72:75], s37 offen

    v_add_u32 v47, 4608, v0
    v_mul_lo_u32 v48, v47, s38
    v_lshrrev_b32 v48, 22, v48
    v_mul_u32_u24 v49, 72, v48
    v_sub_u32 v47, v47, v49
    v_bfe_u32 v49, v48, 1, 1
    v_bfe_u32 v50, v48, 3, 1
    v_lshl_add_u32 v49, v50, 1, v49
    v_lshrrev_b32 v50, 1, v47
    v_xor_b32 v49, v49, v50
    v_lshlrev_b32 v49, 5, v49
    v_and_b32 v47, 1, v47
    v_lshl_add_u32 v49, v47, 4, v49
    v_mul_u32_u24 v48, 1152, v48
    v_add_u32 v49, v49, v48
    s_waitcnt vmcnt(8)
    ds_write_b128 v49, v[4:7]

    v_add_u32 v47, 4864, v0
    v_mul_lo_u32 v48, v47, s38
    v_lshrrev_b32 v48, 22, v48
    v_mul_u32_u24 v49, 72, v48
    v_sub_u32 v47, v47, v49
    v_bfe_u32 v49, v48, 1, 1
    v_bfe_u32 v50, v48, 3, 1
    v_lshl_add_u32 v49, v50, 1, v49
    v_lshrrev_b32 v50, 1, v47
    v_xor_b32 v49, v49, v50
    v_lshlrev_b32 v49, 5, v49
    v_and_b32 v47, 1, v47
    v_lshl_add_u32 v49, v47, 4, v49
    v_mul_u32_u24 v48, 1152, v48
    v_add_u32 v49, v49, v48
    s_waitcnt vmcnt(7)
    ds_write_b128 v49, v[8:11]

    v_add_u32 v47, 5120, v0
    v_mul_lo_u32 v48, v47, s38
    v_lshrrev_b32 v48, 22, v48
    v_mul_u32_u24 v49, 72, v48
    v_sub_u32 v47, v47, v49
    v_bfe_u32 v49, v48, 1, 1
    v_bfe_u32 v50, v48, 3, 1
    v_lshl_add_u32 v49, v50, 1, v49
    v_lshrrev_b32 v50, 1, v47
    v_xor_b32 v49, v49, v50
    v_lshlrev_b32 v49, 5, v49
    v_and_b32 v47, 1, v47
    v_lshl_add_u32 v49, v47, 4, v49
    v_mul_u32_u24 v48, 1152, v48
    v_add_u32 v49, v49, v48
    s_waitcnt vmcnt(6)
    ds_write_b128 v49, v[12:15]

    v_add_u32 v47, 5376, v0
    v_mul_lo_u32 v48, v47, s38
    v_lshrrev_b32 v48, 22, v48
    v_mul_u32_u24 v49, 72, v48
    v_sub_u32 v47, v47, v49
    v_bfe_u32 v49, v48, 1, 1
    v_bfe_u32 v50, v48, 3, 1
    v_lshl_add_u32 v49, v50, 1, v49
    v_lshrrev_b32 v50, 1, v47
    v_xor_b32 v49, v49, v50
    v_lshlrev_b32 v49, 5, v49
    v_and_b32 v47, 1, v47
    v_lshl_add_u32 v49, v47, 4, v49
    v_mul_u32_u24 v48, 1152, v48
    v_add_u32 v49, v49, v48
    s_waitcnt vmcnt(5)
    ds_write_b128 v49, v[16:19]

    v_add_u32 v47, 5632, v0
    v_mul_lo_u32 v48, v47, s38
    v_lshrrev_b32 v48, 22, v48
    v_mul_u32_u24 v49, 72, v48
    v_sub_u32 v47, v47, v49
    v_bfe_u32 v49, v48, 1, 1
    v_bfe_u32 v50, v48, 3, 1
    v_lshl_add_u32 v49, v50, 1, v49
    v_lshrrev_b32 v50, 1, v47
    v_xor_b32 v49, v49, v50
    v_lshlrev_b32 v49, 5, v49
    v_and_b32 v47, 1, v47
    v_lshl_add_u32 v49, v47, 4, v49
    v_mul_u32_u24 v48, 1152, v48
    v_add_u32 v49, v49, v48
    s_waitcnt vmcnt(4)
    ds_write_b128 v49, v[20:23]

    v_add_u32 v47, 5888, v0
    v_mul_lo_u32 v48, v47, s38
    v_lshrrev_b32 v48, 22, v48
    v_mul_u32_u24 v49, 72, v48
    v_sub_u32 v47, v47, v49
    v_bfe_u32 v49, v48, 1, 1
    v_bfe_u32 v50, v48, 3, 1
    v_lshl_add_u32 v49, v50, 1, v49
    v_lshrrev_b32 v50, 1, v47
    v_xor_b32 v49, v49, v50
    v_lshlrev_b32 v49, 5, v49
    v_and_b32 v47, 1, v47
    v_lshl_add_u32 v49, v47, 4, v49
    v_mul_u32_u24 v48, 1152, v48
    v_add_u32 v49, v49, v48
    s_waitcnt vmcnt(3)
    ds_write_b128 v49, v[24:27]

    v_add_u32 v47, 6144, v0
    v_mul_lo_u32 v48, v47, s38
    v_lshrrev_b32 v48, 22, v48
    v_mul_u32_u24 v49, 72, v48
    v_sub_u32 v47, v47, v49
    v_bfe_u32 v49, v48, 1, 1
    v_bfe_u32 v50, v48, 3, 1
    v_lshl_add_u32 v49, v50, 1, v49
    v_lshrrev_b32 v50, 1, v47
    v_xor_b32 v49, v49, v50
    v_lshlrev_b32 v49, 5, v49
    v_and_b32 v47, 1, v47
    v_lshl_add_u32 v49, v47, 4, v49
    v_mul_u32_u24 v48, 1152, v48
    v_add_u32 v49, v49, v48
    s_waitcnt vmcnt(2)
    ds_write_b128 v49, v[28:31]

    v_add_u32 v47, 6400, v0
    v_mul_lo_u32 v48, v47, s38
    v_lshrrev_b32 v48, 22, v48
    v_mul_u32_u24 v49, 72, v48
    v_sub_u32 v47, v47, v49
    v_bfe_u32 v49, v48, 1, 1
    v_bfe_u32 v50, v48, 3, 1
    v_lshl_add_u32 v49, v50, 1, v49
    v_lshrrev_b32 v50, 1, v47
    v_xor_b32 v49, v49, v50
    v_lshlrev_b32 v49, 5, v49
    v_and_b32 v47, 1, v47
    v_lshl_add_u32 v49, v47, 4, v49
    v_mul_u32_u24 v48, 1152, v48
    v_add_u32 v49, v49, v48
    s_waitcnt vmcnt(1)
    ds_write_b128 v49, v[32:35]

    v_add_u32 v47, 6656, v0
    v_mul_lo_u32 v48, v47, s38
    v_lshrrev_b32 v48, 22, v48
    v_mul_u32_u24 v49, 72, v48
    v_sub_u32 v47, v47, v49
    v_bfe_u32 v49, v48, 1, 1
    v_bfe_u32 v50, v48, 3, 1
    v_lshl_add_u32 v49, v50, 1, v49
    v_lshrrev_b32 v50, 1, v47
    v_xor_b32 v49, v49, v50
    v_lshlrev_b32 v49, 5, v49
    v_and_b32 v47, 1, v47
    v_lshl_add_u32 v49, v47, 4, v49
    v_mul_u32_u24 v48, 1152, v48
    v_add_u32 v49, v49, v48
    s_waitcnt vmcnt(0)
    ds_write_b128 v49, v[36:39]

    s_add_u32 s37, s36, 110592
    buffer_load_dwordx4 v[4:7], v46, s[72:75], s37 offen

    s_add_u32 s37, s36, 114688
    buffer_load_dwordx4 v[8:11], v46, s[72:75], s37 offen

    s_add_u32 s37, s36, 118784
    buffer_load_dwordx4 v[12:15], v46, s[72:75], s37 offen

    s_add_u32 s37, s36, 122880
    buffer_load_dwordx4 v[16:19], v46, s[72:75], s37 offen

    s_add_u32 s37, s36, 126976
    buffer_load_dwordx4 v[20:23], v46, s[72:75], s37 offen

    s_add_u32 s37, s36, 131072
    buffer_load_dwordx4 v[24:27], v46, s[72:75], s37 offen

    s_add_u32 s37, s36, 135168
    buffer_load_dwordx4 v[28:31], v46, s[72:75], s37 offen

    s_add_u32 s37, s36, 139264
    buffer_load_dwordx4 v[32:35], v46, s[72:75], s37 offen

    s_add_u32 s37, s36, 143360
    buffer_load_dwordx4 v[36:39], v46, s[72:75], s37 offen

    v_add_u32 v47, 6912, v0
    v_mul_lo_u32 v48, v47, s38
    v_lshrrev_b32 v48, 22, v48
    v_mul_u32_u24 v49, 72, v48
    v_sub_u32 v47, v47, v49
    v_bfe_u32 v49, v48, 1, 1
    v_bfe_u32 v50, v48, 3, 1
    v_lshl_add_u32 v49, v50, 1, v49
    v_lshrrev_b32 v50, 1, v47
    v_xor_b32 v49, v49, v50
    v_lshlrev_b32 v49, 5, v49
    v_and_b32 v47, 1, v47
    v_lshl_add_u32 v49, v47, 4, v49
    v_mul_u32_u24 v48, 1152, v48
    v_add_u32 v49, v49, v48
    s_waitcnt vmcnt(8)
    ds_write_b128 v49, v[4:7]

    v_add_u32 v47, 7168, v0
    v_mul_lo_u32 v48, v47, s38
    v_lshrrev_b32 v48, 22, v48
    v_mul_u32_u24 v49, 72, v48
    v_sub_u32 v47, v47, v49
    v_bfe_u32 v49, v48, 1, 1
    v_bfe_u32 v50, v48, 3, 1
    v_lshl_add_u32 v49, v50, 1, v49
    v_lshrrev_b32 v50, 1, v47
    v_xor_b32 v49, v49, v50
    v_lshlrev_b32 v49, 5, v49
    v_and_b32 v47, 1, v47
    v_lshl_add_u32 v49, v47, 4, v49
    v_mul_u32_u24 v48, 1152, v48
    v_add_u32 v49, v49, v48
    s_waitcnt vmcnt(7)
    ds_write_b128 v49, v[8:11]

    v_add_u32 v47, 7424, v0
    v_mul_lo_u32 v48, v47, s38
    v_lshrrev_b32 v48, 22, v48
    v_mul_u32_u24 v49, 72, v48
    v_sub_u32 v47, v47, v49
    v_bfe_u32 v49, v48, 1, 1
    v_bfe_u32 v50, v48, 3, 1
    v_lshl_add_u32 v49, v50, 1, v49
    v_lshrrev_b32 v50, 1, v47
    v_xor_b32 v49, v49, v50
    v_lshlrev_b32 v49, 5, v49
    v_and_b32 v47, 1, v47
    v_lshl_add_u32 v49, v47, 4, v49
    v_mul_u32_u24 v48, 1152, v48
    v_add_u32 v49, v49, v48
    s_waitcnt vmcnt(6)
    ds_write_b128 v49, v[12:15]

    v_add_u32 v47, 7680, v0
    v_mul_lo_u32 v48, v47, s38
    v_lshrrev_b32 v48, 22, v48
    v_mul_u32_u24 v49, 72, v48
    v_sub_u32 v47, v47, v49
    v_bfe_u32 v49, v48, 1, 1
    v_bfe_u32 v50, v48, 3, 1
    v_lshl_add_u32 v49, v50, 1, v49
    v_lshrrev_b32 v50, 1, v47
    v_xor_b32 v49, v49, v50
    v_lshlrev_b32 v49, 5, v49
    v_and_b32 v47, 1, v47
    v_lshl_add_u32 v49, v47, 4, v49
    v_mul_u32_u24 v48, 1152, v48
    v_add_u32 v49, v49, v48
    s_waitcnt vmcnt(5)
    ds_write_b128 v49, v[16:19]

    v_add_u32 v47, 7936, v0
    v_mul_lo_u32 v48, v47, s38
    v_lshrrev_b32 v48, 22, v48
    v_mul_u32_u24 v49, 72, v48
    v_sub_u32 v47, v47, v49
    v_bfe_u32 v49, v48, 1, 1
    v_bfe_u32 v50, v48, 3, 1
    v_lshl_add_u32 v49, v50, 1, v49
    v_lshrrev_b32 v50, 1, v47
    v_xor_b32 v49, v49, v50
    v_lshlrev_b32 v49, 5, v49
    v_and_b32 v47, 1, v47
    v_lshl_add_u32 v49, v47, 4, v49
    v_mul_u32_u24 v48, 1152, v48
    v_add_u32 v49, v49, v48
    s_waitcnt vmcnt(4)
    ds_write_b128 v49, v[20:23]

    v_add_u32 v47, 8192, v0
    v_mul_lo_u32 v48, v47, s38
    v_lshrrev_b32 v48, 22, v48
    v_mul_u32_u24 v49, 72, v48
    v_sub_u32 v47, v47, v49
    v_bfe_u32 v49, v48, 1, 1
    v_bfe_u32 v50, v48, 3, 1
    v_lshl_add_u32 v49, v50, 1, v49
    v_lshrrev_b32 v50, 1, v47
    v_xor_b32 v49, v49, v50
    v_lshlrev_b32 v49, 5, v49
    v_and_b32 v47, 1, v47
    v_lshl_add_u32 v49, v47, 4, v49
    v_mul_u32_u24 v48, 1152, v48
    v_add_u32 v49, v49, v48
    s_waitcnt vmcnt(3)
    ds_write_b128 v49, v[24:27]

    v_add_u32 v47, 8448, v0
    v_mul_lo_u32 v48, v47, s38
    v_lshrrev_b32 v48, 22, v48
    v_mul_u32_u24 v49, 72, v48
    v_sub_u32 v47, v47, v49
    v_bfe_u32 v49, v48, 1, 1
    v_bfe_u32 v50, v48, 3, 1
    v_lshl_add_u32 v49, v50, 1, v49
    v_lshrrev_b32 v50, 1, v47
    v_xor_b32 v49, v49, v50
    v_lshlrev_b32 v49, 5, v49
    v_and_b32 v47, 1, v47
    v_lshl_add_u32 v49, v47, 4, v49
    v_mul_u32_u24 v48, 1152, v48
    v_add_u32 v49, v49, v48
    s_waitcnt vmcnt(2)
    ds_write_b128 v49, v[28:31]

    v_add_u32 v47, 8704, v0
    v_mul_lo_u32 v48, v47, s38
    v_lshrrev_b32 v48, 22, v48
    v_mul_u32_u24 v49, 72, v48
    v_sub_u32 v47, v47, v49
    v_bfe_u32 v49, v48, 1, 1
    v_bfe_u32 v50, v48, 3, 1
    v_lshl_add_u32 v49, v50, 1, v49
    v_lshrrev_b32 v50, 1, v47
    v_xor_b32 v49, v49, v50
    v_lshlrev_b32 v49, 5, v49
    v_and_b32 v47, 1, v47
    v_lshl_add_u32 v49, v47, 4, v49
    v_mul_u32_u24 v48, 1152, v48
    v_add_u32 v49, v49, v48
    s_waitcnt vmcnt(1)
    ds_write_b128 v49, v[32:35]

    v_add_u32 v47, 8960, v0
    v_mul_lo_u32 v48, v47, s38
    v_lshrrev_b32 v48, 22, v48
    v_mul_u32_u24 v49, 72, v48
    v_sub_u32 v47, v47, v49
    v_bfe_u32 v49, v48, 1, 1
    v_bfe_u32 v50, v48, 3, 1
    v_lshl_add_u32 v49, v50, 1, v49
    v_lshrrev_b32 v50, 1, v47
    v_xor_b32 v49, v49, v50
    v_lshlrev_b32 v49, 5, v49
    v_and_b32 v47, 1, v47
    v_lshl_add_u32 v49, v47, 4, v49
    v_mul_u32_u24 v48, 1152, v48
    v_add_u32 v49, v49, v48
    s_waitcnt vmcnt(0)
    ds_write_b128 v49, v[36:39]

    s_waitcnt lgkmcnt(0)
    s_barrier
    v_lshrrev_b32 v45, 4, v74
    v_and_b32 v46, 15, v74
    v_lshrrev_b32 v47, 2, v46
    v_lshl_add_u32 v47, v45, 3, v47
    v_mul_u32_u24 v48, 1152, v47
    v_and_b32 v47, 3, v46
    v_lshl_add_u32 v48, v47, 3, v48
    v_lshrrev_b32 v47, 3, v46
    v_and_b32 v49, 1, v45
    v_lshl_add_u32 v49, v49, 1, v47
    s_mul_i32 s36, s21, 9
    s_mul_i32 s38, s21, 9216
    v_lshlrev_b32 v50, 4, v74
    v_add_u32 v50, s38, v50

    s_add_u32 s37, s36, 0
    v_xor_b32 v51, s37, v49
    v_lshl_add_u32 v51, v51, 5, v48
    v_add_u32 v51, 0, v51
    ds_read_b64_tr_b16 v[4:5], v51
    ds_read_b64_tr_b16 v[6:7], v51 offset:4608

    s_add_u32 s37, s36, 1
    v_xor_b32 v51, s37, v49
    v_lshl_add_u32 v51, v51, 5, v48
    v_add_u32 v51, 0, v51
    ds_read_b64_tr_b16 v[8:9], v51
    ds_read_b64_tr_b16 v[10:11], v51 offset:4608

    s_add_u32 s37, s36, 2
    v_xor_b32 v51, s37, v49
    v_lshl_add_u32 v51, v51, 5, v48
    v_add_u32 v51, 0, v51
    ds_read_b64_tr_b16 v[12:13], v51
    ds_read_b64_tr_b16 v[14:15], v51 offset:4608

    s_add_u32 s37, s36, 3
    v_xor_b32 v51, s37, v49
    v_lshl_add_u32 v51, v51, 5, v48
    v_add_u32 v51, 0, v51
    ds_read_b64_tr_b16 v[16:17], v51
    ds_read_b64_tr_b16 v[18:19], v51 offset:4608

    s_add_u32 s37, s36, 4
    v_xor_b32 v51, s37, v49
    v_lshl_add_u32 v51, v51, 5, v48
    v_add_u32 v51, 0, v51
    ds_read_b64_tr_b16 v[20:21], v51
    ds_read_b64_tr_b16 v[22:23], v51 offset:4608

    s_add_u32 s37, s36, 5
    v_xor_b32 v51, s37, v49
    v_lshl_add_u32 v51, v51, 5, v48
    v_add_u32 v51, 0, v51
    ds_read_b64_tr_b16 v[24:25], v51
    ds_read_b64_tr_b16 v[26:27], v51 offset:4608

    s_add_u32 s37, s36, 6
    v_xor_b32 v51, s37, v49
    v_lshl_add_u32 v51, v51, 5, v48
    v_add_u32 v51, 0, v51
    ds_read_b64_tr_b16 v[28:29], v51
    ds_read_b64_tr_b16 v[30:31], v51 offset:4608

    s_add_u32 s37, s36, 7
    v_xor_b32 v51, s37, v49
    v_lshl_add_u32 v51, v51, 5, v48
    v_add_u32 v51, 0, v51
    ds_read_b64_tr_b16 v[32:33], v51
    ds_read_b64_tr_b16 v[34:35], v51 offset:4608

    s_add_u32 s37, s36, 8
    v_xor_b32 v51, s37, v49
    v_lshl_add_u32 v51, v51, 5, v48
    v_add_u32 v51, 0, v51
    ds_read_b64_tr_b16 v[36:37], v51
    ds_read_b64_tr_b16 v[38:39], v51 offset:4608

    s_waitcnt lgkmcnt(0)
    s_barrier
    v_add_u32 v51, 0, v50

    ds_write_b128 v51, v[4:7] offset:0
    ds_write_b128 v51, v[8:11] offset:1024
    ds_write_b128 v51, v[12:15] offset:2048
    ds_write_b128 v51, v[16:19] offset:3072
    ds_write_b128 v51, v[20:23] offset:4096
    ds_write_b128 v51, v[24:27] offset:5120
    ds_write_b128 v51, v[28:31] offset:6144
    ds_write_b128 v51, v[32:35] offset:7168
    ds_write_b128 v51, v[36:39] offset:8192
    s_waitcnt lgkmcnt(0)
    s_barrier
    s_add_u32 s37, s36, 0
    v_xor_b32 v51, s37, v49
    v_lshl_add_u32 v51, v51, 5, v48
    v_add_u32 v51, 36864, v51
    ds_read_b64_tr_b16 v[4:5], v51
    ds_read_b64_tr_b16 v[6:7], v51 offset:4608

    s_add_u32 s37, s36, 1
    v_xor_b32 v51, s37, v49
    v_lshl_add_u32 v51, v51, 5, v48
    v_add_u32 v51, 36864, v51
    ds_read_b64_tr_b16 v[8:9], v51
    ds_read_b64_tr_b16 v[10:11], v51 offset:4608

    s_add_u32 s37, s36, 2
    v_xor_b32 v51, s37, v49
    v_lshl_add_u32 v51, v51, 5, v48
    v_add_u32 v51, 36864, v51
    ds_read_b64_tr_b16 v[12:13], v51
    ds_read_b64_tr_b16 v[14:15], v51 offset:4608

    s_add_u32 s37, s36, 3
    v_xor_b32 v51, s37, v49
    v_lshl_add_u32 v51, v51, 5, v48
    v_add_u32 v51, 36864, v51
    ds_read_b64_tr_b16 v[16:17], v51
    ds_read_b64_tr_b16 v[18:19], v51 offset:4608

    s_add_u32 s37, s36, 4
    v_xor_b32 v51, s37, v49
    v_lshl_add_u32 v51, v51, 5, v48
    v_add_u32 v51, 36864, v51
    ds_read_b64_tr_b16 v[20:21], v51
    ds_read_b64_tr_b16 v[22:23], v51 offset:4608

    s_add_u32 s37, s36, 5
    v_xor_b32 v51, s37, v49
    v_lshl_add_u32 v51, v51, 5, v48
    v_add_u32 v51, 36864, v51
    ds_read_b64_tr_b16 v[24:25], v51
    ds_read_b64_tr_b16 v[26:27], v51 offset:4608

    s_add_u32 s37, s36, 6
    v_xor_b32 v51, s37, v49
    v_lshl_add_u32 v51, v51, 5, v48
    v_add_u32 v51, 36864, v51
    ds_read_b64_tr_b16 v[28:29], v51
    ds_read_b64_tr_b16 v[30:31], v51 offset:4608

    s_add_u32 s37, s36, 7
    v_xor_b32 v51, s37, v49
    v_lshl_add_u32 v51, v51, 5, v48
    v_add_u32 v51, 36864, v51
    ds_read_b64_tr_b16 v[32:33], v51
    ds_read_b64_tr_b16 v[34:35], v51 offset:4608

    s_add_u32 s37, s36, 8
    v_xor_b32 v51, s37, v49
    v_lshl_add_u32 v51, v51, 5, v48
    v_add_u32 v51, 36864, v51
    ds_read_b64_tr_b16 v[36:37], v51
    ds_read_b64_tr_b16 v[38:39], v51 offset:4608

    s_waitcnt lgkmcnt(0)
    s_barrier
    v_add_u32 v51, 36864, v50

    ds_write_b128 v51, v[4:7] offset:0
    ds_write_b128 v51, v[8:11] offset:1024
    ds_write_b128 v51, v[12:15] offset:2048
    ds_write_b128 v51, v[16:19] offset:3072
    ds_write_b128 v51, v[20:23] offset:4096
    ds_write_b128 v51, v[24:27] offset:5120
    ds_write_b128 v51, v[28:31] offset:6144
    ds_write_b128 v51, v[32:35] offset:7168
    ds_write_b128 v51, v[36:39] offset:8192
    s_waitcnt lgkmcnt(0)
    s_barrier
    s_add_u32 s37, s36, 0
    v_xor_b32 v51, s37, v49
    v_lshl_add_u32 v51, v51, 5, v48
    v_add_u32 v51, 73728, v51
    ds_read_b64_tr_b16 v[4:5], v51
    ds_read_b64_tr_b16 v[6:7], v51 offset:4608

    s_add_u32 s37, s36, 1
    v_xor_b32 v51, s37, v49
    v_lshl_add_u32 v51, v51, 5, v48
    v_add_u32 v51, 73728, v51
    ds_read_b64_tr_b16 v[8:9], v51
    ds_read_b64_tr_b16 v[10:11], v51 offset:4608

    s_add_u32 s37, s36, 2
    v_xor_b32 v51, s37, v49
    v_lshl_add_u32 v51, v51, 5, v48
    v_add_u32 v51, 73728, v51
    ds_read_b64_tr_b16 v[12:13], v51
    ds_read_b64_tr_b16 v[14:15], v51 offset:4608

    s_add_u32 s37, s36, 3
    v_xor_b32 v51, s37, v49
    v_lshl_add_u32 v51, v51, 5, v48
    v_add_u32 v51, 73728, v51
    ds_read_b64_tr_b16 v[16:17], v51
    ds_read_b64_tr_b16 v[18:19], v51 offset:4608

    s_add_u32 s37, s36, 4
    v_xor_b32 v51, s37, v49
    v_lshl_add_u32 v51, v51, 5, v48
    v_add_u32 v51, 73728, v51
    ds_read_b64_tr_b16 v[20:21], v51
    ds_read_b64_tr_b16 v[22:23], v51 offset:4608

    s_add_u32 s37, s36, 5
    v_xor_b32 v51, s37, v49
    v_lshl_add_u32 v51, v51, 5, v48
    v_add_u32 v51, 73728, v51
    ds_read_b64_tr_b16 v[24:25], v51
    ds_read_b64_tr_b16 v[26:27], v51 offset:4608

    s_add_u32 s37, s36, 6
    v_xor_b32 v51, s37, v49
    v_lshl_add_u32 v51, v51, 5, v48
    v_add_u32 v51, 73728, v51
    ds_read_b64_tr_b16 v[28:29], v51
    ds_read_b64_tr_b16 v[30:31], v51 offset:4608

    s_add_u32 s37, s36, 7
    v_xor_b32 v51, s37, v49
    v_lshl_add_u32 v51, v51, 5, v48
    v_add_u32 v51, 73728, v51
    ds_read_b64_tr_b16 v[32:33], v51
    ds_read_b64_tr_b16 v[34:35], v51 offset:4608

    s_add_u32 s37, s36, 8
    v_xor_b32 v51, s37, v49
    v_lshl_add_u32 v51, v51, 5, v48
    v_add_u32 v51, 73728, v51
    ds_read_b64_tr_b16 v[36:37], v51
    ds_read_b64_tr_b16 v[38:39], v51 offset:4608

    s_waitcnt lgkmcnt(0)
    s_barrier
    v_add_u32 v51, 73728, v50

    ds_write_b128 v51, v[4:7] offset:0
    ds_write_b128 v51, v[8:11] offset:1024
    ds_write_b128 v51, v[12:15] offset:2048
    ds_write_b128 v51, v[16:19] offset:3072
    ds_write_b128 v51, v[20:23] offset:4096
    ds_write_b128 v51, v[24:27] offset:5120
    ds_write_b128 v51, v[28:31] offset:6144
    ds_write_b128 v51, v[32:35] offset:7168
    ds_write_b128 v51, v[36:39] offset:8192
    s_waitcnt lgkmcnt(0)
    s_barrier
    s_add_u32 s37, s36, 0
    v_xor_b32 v51, s37, v49
    v_lshl_add_u32 v51, v51, 5, v48
    v_add_u32 v51, 110592, v51
    ds_read_b64_tr_b16 v[4:5], v51
    ds_read_b64_tr_b16 v[6:7], v51 offset:4608

    s_add_u32 s37, s36, 1
    v_xor_b32 v51, s37, v49
    v_lshl_add_u32 v51, v51, 5, v48
    v_add_u32 v51, 110592, v51
    ds_read_b64_tr_b16 v[8:9], v51
    ds_read_b64_tr_b16 v[10:11], v51 offset:4608

    s_add_u32 s37, s36, 2
    v_xor_b32 v51, s37, v49
    v_lshl_add_u32 v51, v51, 5, v48
    v_add_u32 v51, 110592, v51
    ds_read_b64_tr_b16 v[12:13], v51
    ds_read_b64_tr_b16 v[14:15], v51 offset:4608

    s_add_u32 s37, s36, 3
    v_xor_b32 v51, s37, v49
    v_lshl_add_u32 v51, v51, 5, v48
    v_add_u32 v51, 110592, v51
    ds_read_b64_tr_b16 v[16:17], v51
    ds_read_b64_tr_b16 v[18:19], v51 offset:4608

    s_add_u32 s37, s36, 4
    v_xor_b32 v51, s37, v49
    v_lshl_add_u32 v51, v51, 5, v48
    v_add_u32 v51, 110592, v51
    ds_read_b64_tr_b16 v[20:21], v51
    ds_read_b64_tr_b16 v[22:23], v51 offset:4608

    s_add_u32 s37, s36, 5
    v_xor_b32 v51, s37, v49
    v_lshl_add_u32 v51, v51, 5, v48
    v_add_u32 v51, 110592, v51
    ds_read_b64_tr_b16 v[24:25], v51
    ds_read_b64_tr_b16 v[26:27], v51 offset:4608

    s_add_u32 s37, s36, 6
    v_xor_b32 v51, s37, v49
    v_lshl_add_u32 v51, v51, 5, v48
    v_add_u32 v51, 110592, v51
    ds_read_b64_tr_b16 v[28:29], v51
    ds_read_b64_tr_b16 v[30:31], v51 offset:4608

    s_add_u32 s37, s36, 7
    v_xor_b32 v51, s37, v49
    v_lshl_add_u32 v51, v51, 5, v48
    v_add_u32 v51, 110592, v51
    ds_read_b64_tr_b16 v[32:33], v51
    ds_read_b64_tr_b16 v[34:35], v51 offset:4608

    s_add_u32 s37, s36, 8
    v_xor_b32 v51, s37, v49
    v_lshl_add_u32 v51, v51, 5, v48
    v_add_u32 v51, 110592, v51
    ds_read_b64_tr_b16 v[36:37], v51
    ds_read_b64_tr_b16 v[38:39], v51 offset:4608

    s_waitcnt lgkmcnt(0)
    s_barrier
    v_add_u32 v51, 110592, v50

    ds_write_b128 v51, v[4:7] offset:0
    ds_write_b128 v51, v[8:11] offset:1024
    ds_write_b128 v51, v[12:15] offset:2048
    ds_write_b128 v51, v[16:19] offset:3072
    ds_write_b128 v51, v[20:23] offset:4096
    ds_write_b128 v51, v[24:27] offset:5120
    ds_write_b128 v51, v[28:31] offset:6144
    ds_write_b128 v51, v[32:35] offset:7168
    ds_write_b128 v51, v[36:39] offset:8192
    s_waitcnt lgkmcnt(0)
    s_barrier
    s_mov_b32 s73, s21
    s_cmp_lg_u32 s73, 0
    s_cbranch_scc1 L_regother_11
    v_mov_b32 v44, 0
    s_mov_b32 s75, 128
    s_mov_b32 s79, 0
    s_mov_b64 exec, 1

L_regpoll_8:
    buffer_load_dword v45, v44, s[84:87], s75 offen sc1
    s_add_u32 s79, s79, 1
    s_waitcnt vmcnt(0)
    v_readfirstlane_b32 s77, v45
    s_cmp_gt_u32 s79, 200000
    s_cbranch_scc1 L_regbad_9
    s_cmp_ge_u32 s77, 256
    s_cbranch_scc1 L_regpoll_8_ok
    s_sleep 4
    s_branch L_regpoll_8

L_regpoll_8_ok:
    s_mov_b64 exec, 0xff
    v_mul_u32_u24 v44, 16, v0
    s_mov_b32 s75, 0
    buffer_load_dword v45, v44, s[84:87], s75 offen sc1
    s_waitcnt vmcnt(0)
    v_cmp_ne_u32 vcc, 32, v45
    s_mov_b32 s77, 1
    s_cbranch_vccz L_regw_10

L_regbad_9:
    s_mov_b32 s77, 0
L_regw_10:
    s_mov_b64 exec, -1
    v_mov_b32 v44, 163712
    v_mov_b32 v45, s77
    ds_write_b32 v44, v45
    s_waitcnt lgkmcnt(0)

L_regother_11:
    s_barrier
    v_mov_b32 v44, 163712
    ds_read_b32 v45, v44
    s_waitcnt lgkmcnt(0)
    v_readfirstlane_b32 s77, v45
    s_barrier
    s_cmp_eq_u32 s77, 0
    s_cbranch_scc1 L_fallback_4

    v_and_b32 v44, 7, v0
    v_bfe_u32 v45, v0, 4, 2
    v_and_b32 v46, 15, v0
    v_mul_u32_u24 v1, 1184, v44
    v_lshl_add_u32 v1, v45, 4, v1
    v_add_u32 v1, 147456, v1
    v_mul_u32_u24 v3, 272, v44
    v_lshl_add_u32 v3, v45, 4, v3
    v_add_u32 v3, 156928, v3
    v_mul_u32_u24 v2, 272, v46
    v_lshl_add_u32 v2, v45, 3, v2
    s_lshl_b32 s34, s21, 6
    s_add_u32 s34, s34, 156928
    v_add_u32 v2, s34, v2
    s_mov_b32 s22, 0

    s_mov_b32 s72, s16
    s_and_b32 s73, s17, 0xffff
    s_mov_b32 s74, 9216
    s_mov_b32 s75, 0x00020000

    v_add_u32 v44, 0, v0
    s_mov_b32 s34, 58255
    v_mul_lo_u32 v45, v44, s34
    v_lshrrev_b32 v45, 22, v45
    v_mul_u32_u24 v46, 72, v45
    v_sub_u32 v46, v44, v46
    v_mul_u32_u24 v45, 1184, v45
    v_lshl_add_u32 v45, v46, 4, v45
    v_add_u32 v45, 147456, v45
    v_lshlrev_b32 v46, 4, v44
    v_cmp_gt_u32 vcc, 576, v44
    s_and_saveexec_b64 s[76:77], vcc
    buffer_load_dwordx4 v[48:51], v46, s[72:75], 0 offen
    s_waitcnt vmcnt(0)
    ds_write_b128 v45, v[48:51]
    s_mov_b64 exec, s[76:77]

    v_add_u32 v44, 256, v0
    s_mov_b32 s34, 58255
    v_mul_lo_u32 v45, v44, s34
    v_lshrrev_b32 v45, 22, v45
    v_mul_u32_u24 v46, 72, v45
    v_sub_u32 v46, v44, v46
    v_mul_u32_u24 v45, 1184, v45
    v_lshl_add_u32 v45, v46, 4, v45
    v_add_u32 v45, 147456, v45
    v_lshlrev_b32 v46, 4, v44
    v_cmp_gt_u32 vcc, 576, v44
    s_and_saveexec_b64 s[76:77], vcc
    buffer_load_dwordx4 v[48:51], v46, s[72:75], 0 offen
    s_waitcnt vmcnt(0)
    ds_write_b128 v45, v[48:51]
    s_mov_b64 exec, s[76:77]

    v_add_u32 v44, 512, v0
    s_mov_b32 s34, 58255
    v_mul_lo_u32 v45, v44, s34
    v_lshrrev_b32 v45, 22, v45
    v_mul_u32_u24 v46, 72, v45
    v_sub_u32 v46, v44, v46
    v_mul_u32_u24 v45, 1184, v45
    v_lshl_add_u32 v45, v46, 4, v45
    v_add_u32 v45, 147456, v45
    v_lshlrev_b32 v46, 4, v44
    v_cmp_gt_u32 vcc, 576, v44
    s_and_saveexec_b64 s[76:77], vcc
    buffer_load_dwordx4 v[48:51], v46, s[72:75], 0 offen
    s_waitcnt vmcnt(0)
    ds_write_b128 v45, v[48:51]
    s_mov_b64 exec, s[76:77]

    s_and_b32 s34, s22, 3
    s_cmp_lg_u32 s34, 0
    s_cbranch_scc1 L_nokvwait_14
    s_lshr_b32 s34, s22, 2
    s_add_u32 s34, s34, 16
    s_lshl_b32 s34, s34, 5
    s_add_u32 s34, s34, s20
    s_lshl_b32 s34, s34, 2
    v_and_b32 v76, 1, v0
    v_lshlrev_b32 v76, 11, v76
    s_mov_b32 s32, 0

L_kvwait_15:
    buffer_load_dword v77, v76, s[96:99], s34 offen sc1
    s_add_u32 s32, s32, 1
    s_waitcnt vmcnt(0)
    v_cmp_eq_u32 vcc, 0, v77
    s_cmp_gt_u32 s32, 100000
    s_cbranch_scc1 L_nokvwait_14
    s_cbranch_vccnz L_kvwait_15

L_nokvwait_14:
    v_and_b32 v76, 15, v0
    v_bfe_u32 v77, v0, 4, 2
    v_lshlrev_b32 v78, 13, v76
    v_lshl_add_u32 v78, v77, 4, v78
    s_lshl_b32 s17, s22, 18
    s_lshl_b32 s18, s20, 8
    s_add_u32 s17, s17, s18
    s_add_u32 s18, s17, 131072
    v_lshlrev_b32 v79, 6, v76
    v_lshl_add_u32 v79, v77, 3, v79
    s_lshl_b32 s19, s21, 11
    v_add_u32 v79, s19, v79
    s_lshl_b32 s19, s22, 5
    s_add_u32 s19, s19, s20
    s_lshl_b32 s19, s19, 13

    buffer_load_dwordx4 v[4:7], v78, s[48:51], s17 offen offset:0
    buffer_load_dwordx4 v[20:23], v78, s[48:51], s18 offen offset:0
    buffer_load_dwordx4 v[8:11], v78, s[48:51], s17 offen offset:64
    buffer_load_dwordx4 v[24:27], v78, s[48:51], s18 offen offset:64
    buffer_load_dwordx4 v[12:15], v78, s[48:51], s17 offen offset:128
    buffer_load_dwordx4 v[28:31], v78, s[48:51], s18 offen offset:128
    buffer_load_dwordx4 v[16:19], v78, s[48:51], s17 offen offset:192
    buffer_load_dwordx4 v[32:35], v78, s[48:51], s18 offen offset:192
    buffer_load_dwordx2 v[36:37], v79, s[52:55], s19 offen offset:0
    buffer_load_dwordx2 v[38:39], v79, s[52:55], s19 offen offset:32
    buffer_load_dwordx2 v[40:41], v79, s[52:55], s19 offen offset:1024
    buffer_load_dwordx2 v[42:43], v79, s[52:55], s19 offen offset:1056
    s_waitcnt lgkmcnt(0)
    s_barrier
L_step_12:
    ds_read_b128 v[60:63], v1 offset:0
    ds_read_b128 v[64:67], v1 offset:64
    ds_read_b128 v[68:71], v1 offset:128
    ds_read_b128 v[72:75], v1 offset:192
    s_waitcnt lgkmcnt(3)
    v_mfma_f32_16x16x32_bf16 v[44:47], a[0:3], v[60:63], 0
    v_mfma_f32_16x16x32_bf16 v[48:51], a[72:75], v[60:63], 0
    v_mfma_f32_16x16x32_bf16 v[52:55], a[144:147], v[60:63], 0
    v_mfma_f32_16x16x32_bf16 v[56:59], a[216:219], v[60:63], 0
    ds_read_b128 v[60:63], v1 offset:256
    s_waitcnt lgkmcnt(3)
    v_mfma_f32_16x16x32_bf16 v[44:47], a[4:7], v[64:67], v[44:47]
    v_mfma_f32_16x16x32_bf16 v[48:51], a[76:79], v[64:67], v[48:51]
    v_mfma_f32_16x16x32_bf16 v[52:55], a[148:151], v[64:67], v[52:55]
    v_mfma_f32_16x16x32_bf16 v[56:59], a[220:223], v[64:67], v[56:59]
    ds_read_b128 v[64:67], v1 offset:320
    s_waitcnt lgkmcnt(3)
    v_mfma_f32_16x16x32_bf16 v[44:47], a[8:11], v[68:71], v[44:47]
    v_mfma_f32_16x16x32_bf16 v[48:51], a[80:83], v[68:71], v[48:51]
    v_mfma_f32_16x16x32_bf16 v[52:55], a[152:155], v[68:71], v[52:55]
    v_mfma_f32_16x16x32_bf16 v[56:59], a[224:227], v[68:71], v[56:59]
    ds_read_b128 v[68:71], v1 offset:384
    s_waitcnt lgkmcnt(3)
    v_mfma_f32_16x16x32_bf16 v[44:47], a[12:15], v[72:75], v[44:47]
    v_mfma_f32_16x16x32_bf16 v[48:51], a[84:87], v[72:75], v[48:51]
    v_mfma_f32_16x16x32_bf16 v[52:55], a[156:159], v[72:75], v[52:55]
    v_mfma_f32_16x16x32_bf16 v[56:59], a[228:231], v[72:75], v[56:59]
    ds_read_b128 v[72:75], v1 offset:448
    s_waitcnt lgkmcnt(3)
    v_mfma_f32_16x16x32_bf16 v[44:47], a[16:19], v[60:63], v[44:47]
    v_mfma_f32_16x16x32_bf16 v[48:51], a[88:91], v[60:63], v[48:51]
    v_mfma_f32_16x16x32_bf16 v[52:55], a[160:163], v[60:63], v[52:55]
    v_mfma_f32_16x16x32_bf16 v[56:59], a[232:235], v[60:63], v[56:59]
    ds_read_b128 v[60:63], v1 offset:512
    s_waitcnt lgkmcnt(3)
    v_mfma_f32_16x16x32_bf16 v[44:47], a[20:23], v[64:67], v[44:47]
    v_mfma_f32_16x16x32_bf16 v[48:51], a[92:95], v[64:67], v[48:51]
    v_mfma_f32_16x16x32_bf16 v[52:55], a[164:167], v[64:67], v[52:55]
    v_mfma_f32_16x16x32_bf16 v[56:59], a[236:239], v[64:67], v[56:59]
    ds_read_b128 v[64:67], v1 offset:576
    s_waitcnt lgkmcnt(3)
    v_mfma_f32_16x16x32_bf16 v[44:47], a[24:27], v[68:71], v[44:47]
    v_mfma_f32_16x16x32_bf16 v[48:51], a[96:99], v[68:71], v[48:51]
    v_mfma_f32_16x16x32_bf16 v[52:55], a[168:171], v[68:71], v[52:55]
    v_mfma_f32_16x16x32_bf16 v[56:59], a[240:243], v[68:71], v[56:59]
    ds_read_b128 v[68:71], v1 offset:640
    s_waitcnt lgkmcnt(3)
    v_mfma_f32_16x16x32_bf16 v[44:47], a[28:31], v[72:75], v[44:47]
    v_mfma_f32_16x16x32_bf16 v[48:51], a[100:103], v[72:75], v[48:51]
    v_mfma_f32_16x16x32_bf16 v[52:55], a[172:175], v[72:75], v[52:55]
    v_mfma_f32_16x16x32_bf16 v[56:59], a[244:247], v[72:75], v[56:59]
    ds_read_b128 v[72:75], v1 offset:704
    s_waitcnt lgkmcnt(3)
    v_mfma_f32_16x16x32_bf16 v[44:47], a[32:35], v[60:63], v[44:47]
    v_mfma_f32_16x16x32_bf16 v[48:51], a[104:107], v[60:63], v[48:51]
    v_mfma_f32_16x16x32_bf16 v[52:55], a[176:179], v[60:63], v[52:55]
    v_mfma_f32_16x16x32_bf16 v[56:59], a[248:251], v[60:63], v[56:59]
    ds_read_b128 v[60:63], v1 offset:768
    s_waitcnt lgkmcnt(3)
    v_mfma_f32_16x16x32_bf16 v[44:47], a[36:39], v[64:67], v[44:47]
    v_mfma_f32_16x16x32_bf16 v[48:51], a[108:111], v[64:67], v[48:51]
    v_mfma_f32_16x16x32_bf16 v[52:55], a[180:183], v[64:67], v[52:55]
    v_mfma_f32_16x16x32_bf16 v[56:59], a[252:255], v[64:67], v[56:59]
    ds_read_b128 v[64:67], v1 offset:832
    s_waitcnt lgkmcnt(3)
    v_mfma_f32_16x16x32_bf16 v[44:47], a[40:43], v[68:71], v[44:47]
    v_mfma_f32_16x16x32_bf16 v[48:51], a[112:115], v[68:71], v[48:51]
    v_mfma_f32_16x16x32_bf16 v[52:55], a[184:187], v[68:71], v[52:55]
    v_mfma_f32_16x16x32_bf16 v[56:59], v[80:83], v[68:71], v[56:59]
    ds_read_b128 v[68:71], v1 offset:896
    s_waitcnt lgkmcnt(3)
    v_mfma_f32_16x16x32_bf16 v[44:47], a[44:47], v[72:75], v[44:47]
    v_mfma_f32_16x16x32_bf16 v[48:51], a[116:119], v[72:75], v[48:51]
    v_mfma_f32_16x16x32_bf16 v[52:55], a[188:191], v[72:75], v[52:55]
    v_mfma_f32_16x16x32_bf16 v[56:59], v[84:87], v[72:75], v[56:59]
    ds_read_b128 v[72:75], v1 offset:960
    s_waitcnt lgkmcnt(3)
    v_mfma_f32_16x16x32_bf16 v[44:47], a[48:51], v[60:63], v[44:47]
    v_mfma_f32_16x16x32_bf16 v[48:51], a[120:123], v[60:63], v[48:51]
    v_mfma_f32_16x16x32_bf16 v[52:55], a[192:195], v[60:63], v[52:55]
    v_mfma_f32_16x16x32_bf16 v[56:59], v[88:91], v[60:63], v[56:59]
    ds_read_b128 v[60:63], v1 offset:1024
    s_waitcnt lgkmcnt(3)
    v_mfma_f32_16x16x32_bf16 v[44:47], a[52:55], v[64:67], v[44:47]
    v_mfma_f32_16x16x32_bf16 v[48:51], a[124:127], v[64:67], v[48:51]
    v_mfma_f32_16x16x32_bf16 v[52:55], a[196:199], v[64:67], v[52:55]
    v_mfma_f32_16x16x32_bf16 v[56:59], v[92:95], v[64:67], v[56:59]
    ds_read_b128 v[64:67], v1 offset:1088
    s_waitcnt lgkmcnt(3)
    v_mfma_f32_16x16x32_bf16 v[44:47], a[56:59], v[68:71], v[44:47]
    v_mfma_f32_16x16x32_bf16 v[48:51], a[128:131], v[68:71], v[48:51]
    v_mfma_f32_16x16x32_bf16 v[52:55], a[200:203], v[68:71], v[52:55]
    v_mfma_f32_16x16x32_bf16 v[56:59], v[96:99], v[68:71], v[56:59]
    s_waitcnt lgkmcnt(2)
    v_mfma_f32_16x16x32_bf16 v[44:47], a[60:63], v[72:75], v[44:47]
    v_mfma_f32_16x16x32_bf16 v[48:51], a[132:135], v[72:75], v[48:51]
    v_mfma_f32_16x16x32_bf16 v[52:55], a[204:207], v[72:75], v[52:55]
    v_mfma_f32_16x16x32_bf16 v[56:59], v[100:103], v[72:75], v[56:59]
    s_waitcnt lgkmcnt(1)
    v_mfma_f32_16x16x32_bf16 v[44:47], a[64:67], v[60:63], v[44:47]
    v_mfma_f32_16x16x32_bf16 v[48:51], a[136:139], v[60:63], v[48:51]
    v_mfma_f32_16x16x32_bf16 v[52:55], a[208:211], v[60:63], v[52:55]
    v_mfma_f32_16x16x32_bf16 v[56:59], v[104:107], v[60:63], v[56:59]
    s_waitcnt lgkmcnt(0)
    v_mfma_f32_16x16x32_bf16 v[44:47], a[68:71], v[64:67], v[44:47]
    v_mfma_f32_16x16x32_bf16 v[48:51], a[140:143], v[64:67], v[48:51]
    v_mfma_f32_16x16x32_bf16 v[52:55], a[212:215], v[64:67], v[52:55]
    v_mfma_f32_16x16x32_bf16 v[56:59], v[108:111], v[64:67], v[56:59]
    v_and_b32 v60, 15, v0
    v_bfe_u32 v61, v0, 4, 2
    v_lshlrev_b32 v62, 8, v60
    v_lshl_add_u32 v62, v61, 3, v62
    s_lshl_b32 s34, s21, 6
    v_add_u32 v62, s34, v62
    s_lshl_b32 s37, s22, 5
    s_add_u32 s37, s37, s20
    s_lshl_b32 s37, s37, 11
    s_mov_b64 exec, s[26:27]

    v_cvt_pk_bf16_f32 v44, v44, v45
    v_cvt_pk_bf16_f32 v45, v46, v47
    ds_write_b64 v2, v[44:45] offset:0

    v_cvt_pk_bf16_f32 v48, v48, v49
    v_cvt_pk_bf16_f32 v49, v50, v51
    ds_write_b64 v2, v[48:49] offset:32

    v_cvt_pk_bf16_f32 v52, v52, v53
    v_cvt_pk_bf16_f32 v53, v54, v55
    ds_write_b64 v2, v[52:53] offset:2176

    v_cvt_pk_bf16_f32 v56, v56, v57
    v_cvt_pk_bf16_f32 v57, v58, v59
    ds_write_b64 v2, v[56:57] offset:2208

    buffer_store_dwordx2 v[52:53], v62, s[56:59], s37 offen offset:0 sc1
    buffer_store_dwordx2 v[56:57], v62, s[56:59], s37 offen offset:32 sc1
    s_mov_b64 exec, -1
    s_waitcnt lgkmcnt(0)
    s_barrier

    ds_read_b128 v[72:75], v3 offset:0
    ds_read_b128 v[76:79], v3 offset:2176
    ds_read_b128 v[52:55], v1 offset:0
    ds_read_b128 v[56:59], v1 offset:64
    s_waitcnt lgkmcnt(1)
    v_mfma_f32_16x16x32_bf16 v[44:47], v[52:55], v[112:115], 0
    v_mfma_f32_16x16x32_bf16 v[48:51], v[52:55], v[184:187], 0
    s_waitcnt vmcnt(2)
    v_mfma_f32_16x16x32_bf16 v[60:63], v[76:79], v[72:75], 0
    v_mfma_f32_16x16x32_bf16 v[64:67], v[4:7], v[72:75], 0
    v_mfma_f32_16x16x32_bf16 v[68:71], v[20:23], v[72:75], 0
    ds_read_b128 v[52:55], v1 offset:128
    s_waitcnt lgkmcnt(1)
    v_mfma_f32_16x16x32_bf16 v[44:47], v[56:59], v[116:119], v[44:47]
    v_mfma_f32_16x16x32_bf16 v[48:51], v[56:59], v[188:191], v[48:51]
    ds_read_b128 v[72:75], v3 offset:64
    ds_read_b128 v[76:79], v3 offset:2240
    ds_read_b128 v[56:59], v1 offset:192
    s_waitcnt lgkmcnt(3)
    v_mfma_f32_16x16x32_bf16 v[44:47], v[52:55], v[120:123], v[44:47]
    v_mfma_f32_16x16x32_bf16 v[48:51], v[52:55], v[192:195], v[48:51]
    ds_read_b128 v[52:55], v1 offset:256
    s_waitcnt lgkmcnt(1)
    v_mfma_f32_16x16x32_bf16 v[44:47], v[56:59], v[124:127], v[44:47]
    v_mfma_f32_16x16x32_bf16 v[48:51], v[56:59], v[196:199], v[48:51]
    v_mfma_f32_16x16x32_bf16 v[60:63], v[76:79], v[72:75], v[60:63]
    v_mfma_f32_16x16x32_bf16 v[64:67], v[8:11], v[72:75], v[64:67]
    v_mfma_f32_16x16x32_bf16 v[68:71], v[24:27], v[72:75], v[68:71]
    ds_read_b128 v[56:59], v1 offset:320
    s_waitcnt lgkmcnt(1)
    v_mfma_f32_16x16x32_bf16 v[44:47], v[52:55], v[128:131], v[44:47]
    v_mfma_f32_16x16x32_bf16 v[48:51], v[52:55], v[200:203], v[48:51]
    ds_read_b128 v[72:75], v3 offset:128
    ds_read_b128 v[76:79], v3 offset:2304
    ds_read_b128 v[52:55], v1 offset:384
    s_waitcnt lgkmcnt(3)
    v_mfma_f32_16x16x32_bf16 v[44:47], v[56:59], v[132:135], v[44:47]
    v_mfma_f32_16x16x32_bf16 v[48:51], v[56:59], v[204:207], v[48:51]
    ds_read_b128 v[56:59], v1 offset:448
    s_waitcnt lgkmcnt(1)
    v_mfma_f32_16x16x32_bf16 v[44:47], v[52:55], v[136:139], v[44:47]
    v_mfma_f32_16x16x32_bf16 v[48:51], v[52:55], v[208:211], v[48:51]
    v_mfma_f32_16x16x32_bf16 v[60:63], v[76:79], v[72:75], v[60:63]
    v_mfma_f32_16x16x32_bf16 v[64:67], v[12:15], v[72:75], v[64:67]
    v_mfma_f32_16x16x32_bf16 v[68:71], v[28:31], v[72:75], v[68:71]
    ds_read_b128 v[52:55], v1 offset:512
    s_waitcnt lgkmcnt(1)
    v_mfma_f32_16x16x32_bf16 v[44:47], v[56:59], v[140:143], v[44:47]
    v_mfma_f32_16x16x32_bf16 v[48:51], v[56:59], v[212:215], v[48:51]
    ds_read_b128 v[72:75], v3 offset:192
    ds_read_b128 v[76:79], v3 offset:2368
    ds_read_b128 v[56:59], v1 offset:576
    s_waitcnt lgkmcnt(3)
    v_mfma_f32_16x16x32_bf16 v[44:47], v[52:55], v[144:147], v[44:47]
    v_mfma_f32_16x16x32_bf16 v[48:51], v[52:55], v[216:219], v[48:51]
    ds_read_b128 v[52:55], v1 offset:640
    s_waitcnt lgkmcnt(1)
    v_mfma_f32_16x16x32_bf16 v[44:47], v[56:59], v[148:151], v[44:47]
    v_mfma_f32_16x16x32_bf16 v[48:51], v[56:59], v[220:223], v[48:51]
    v_mfma_f32_16x16x32_bf16 v[60:63], v[76:79], v[72:75], v[60:63]
    v_mfma_f32_16x16x32_bf16 v[64:67], v[16:19], v[72:75], v[64:67]
    v_mfma_f32_16x16x32_bf16 v[68:71], v[32:35], v[72:75], v[68:71]
    ds_read_b128 v[56:59], v1 offset:704
    s_waitcnt lgkmcnt(1)
    v_mfma_f32_16x16x32_bf16 v[44:47], v[52:55], v[152:155], v[44:47]
    v_mfma_f32_16x16x32_bf16 v[48:51], v[52:55], v[224:227], v[48:51]
    ds_read_b128 v[52:55], v1 offset:768
    s_waitcnt lgkmcnt(1)
    v_mfma_f32_16x16x32_bf16 v[44:47], v[56:59], v[156:159], v[44:47]
    v_mfma_f32_16x16x32_bf16 v[48:51], v[56:59], v[228:231], v[48:51]
    s_cmp_ge_u32 s21, 2
    s_cbranch_scc1 L_nowarm_16
    s_cmp_eq_u32 s22, 63
    s_cbranch_scc1 L_nowarm_16
    s_add_u32 s38, s22, 1

    s_cmp_eq_u32 s21, 1
    s_cbranch_scc1 L_warmv_17
    v_bfe_u32 v78, v0, 1, 5
    v_lshlrev_b32 v78, 13, v78
    v_and_b32 v79, 1, v0
    v_lshl_add_u32 v78, v79, 7, v78
    s_lshl_b32 s39, s38, 18
    s_lshl_b32 s40, s20, 8
    s_add_u32 s39, s39, s40
    s_mov_b32 m0, 163456
    s_nop 0
    buffer_load_dword v78, s[48:51], s39 offen lds
    s_branch L_nowarm_16

L_warmv_17:
    v_and_b32 v78, 63, v0
    v_lshlrev_b32 v78, 7, v78
    s_lshl_b32 s39, s38, 5
    s_add_u32 s39, s39, s20
    s_lshl_b32 s39, s39, 13
    s_mov_b32 m0, 163456
    s_nop 0
    buffer_load_dword v78, s[52:55], s39 offen lds

L_nowarm_16:
    s_mov_b32 s34, 1035273459
    v_cvt_pk_bf16_f32 v72, v60, v61
    v_lshlrev_b32 v60, 16, v72
    v_and_b32 v61, 0xffff0000, v72

    v_mul_f32 v60, s34, v60
    v_mul_f32 v61, s34, v61

    v_cvt_pk_bf16_f32 v72, v60, v61
    v_lshlrev_b32 v60, 16, v72
    v_and_b32 v61, 0xffff0000, v72

    v_cvt_pk_bf16_f32 v72, v62, v63
    v_lshlrev_b32 v62, 16, v72
    v_and_b32 v63, 0xffff0000, v72

    v_mul_f32 v62, s34, v62
    v_mul_f32 v63, s34, v63

    v_cvt_pk_bf16_f32 v72, v62, v63
    v_lshlrev_b32 v62, 16, v72
    v_and_b32 v63, 0xffff0000, v72

    ds_read_b128 v[56:59], v1 offset:832
    s_waitcnt lgkmcnt(1)
    v_mfma_f32_16x16x32_bf16 v[44:47], v[52:55], v[160:163], v[44:47]
    v_mfma_f32_16x16x32_bf16 v[48:51], v[52:55], v[232:235], v[48:51]
    v_cvt_pk_bf16_f32 v72, v64, v65
    v_lshlrev_b32 v64, 16, v72
    v_and_b32 v65, 0xffff0000, v72

    v_mul_f32 v64, s34, v64
    v_mul_f32 v65, s34, v65

    v_cvt_pk_bf16_f32 v72, v64, v65
    v_lshlrev_b32 v64, 16, v72
    v_and_b32 v65, 0xffff0000, v72

    v_cvt_pk_bf16_f32 v72, v66, v67
    v_lshlrev_b32 v66, 16, v72
    v_and_b32 v67, 0xffff0000, v72

    v_mul_f32 v66, s34, v66
    v_mul_f32 v67, s34, v67

    v_cvt_pk_bf16_f32 v72, v66, v67
    v_lshlrev_b32 v66, 16, v72
    v_and_b32 v67, 0xffff0000, v72

    ds_read_b128 v[52:55], v1 offset:896
    s_waitcnt lgkmcnt(1)
    v_mfma_f32_16x16x32_bf16 v[44:47], v[56:59], v[164:167], v[44:47]
    v_mfma_f32_16x16x32_bf16 v[48:51], v[56:59], v[236:239], v[48:51]
    v_cvt_pk_bf16_f32 v72, v68, v69
    v_lshlrev_b32 v68, 16, v72
    v_and_b32 v69, 0xffff0000, v72

    v_mul_f32 v68, s34, v68
    v_mul_f32 v69, s34, v69

    v_cvt_pk_bf16_f32 v72, v68, v69
    v_lshlrev_b32 v68, 16, v72
    v_and_b32 v69, 0xffff0000, v72

    v_cvt_pk_bf16_f32 v72, v70, v71
    v_lshlrev_b32 v70, 16, v72
    v_and_b32 v71, 0xffff0000, v72

    v_mul_f32 v70, s34, v70
    v_mul_f32 v71, s34, v71

    v_cvt_pk_bf16_f32 v72, v70, v71
    v_lshlrev_b32 v70, 16, v72
    v_and_b32 v71, 0xffff0000, v72

    ds_read_b128 v[56:59], v1 offset:960
    s_waitcnt lgkmcnt(1)
    v_mfma_f32_16x16x32_bf16 v[44:47], v[52:55], v[168:171], v[44:47]
    v_mfma_f32_16x16x32_bf16 v[48:51], v[52:55], v[240:243], v[48:51]
    s_mov_b64 exec, s[28:29]
    s_not_b64 exec, exec

    v_mov_b32 v60, 0xce6e6b28
    v_mov_b32 v61, 0xce6e6b28
    v_mov_b32 v62, 0xce6e6b28
    v_mov_b32 v63, 0xce6e6b28
    s_mov_b64 exec, -1
    v_max3_f32 v72, v60, v61, v62
    v_max3_f32 v72, v72, v63, v64
    v_max3_f32 v72, v72, v65, v66
    v_max3_f32 v72, v72, v67, v68
    v_max3_f32 v72, v72, v69, v70
    v_max_f32 v72, v72, v71
    v_mov_b32 v73, v72
    s_nop 1
    v_permlane16_swap_b32 v72, v73
    s_nop 1
    v_max_f32 v72, v72, v73
    v_mov_b32 v73, v72
    s_nop 1
    v_permlane32_swap_b32 v72, v73
    s_nop 1
    v_max_f32 v72, v72, v73

    ds_read_b128 v[52:55], v1 offset:1024
    s_waitcnt lgkmcnt(1)
    v_mfma_f32_16x16x32_bf16 v[44:47], v[56:59], v[172:175], v[44:47]
    v_mfma_f32_16x16x32_bf16 v[48:51], v[56:59], v[244:247], v[48:51]
    s_mov_b32 s34, 0x3fb8aa3b
    v_mul_f32 v72, s34, v72

    v_fma_f32 v60, v60, s34, -v72
    v_fma_f32 v61, v61, s34, -v72
    v_fma_f32 v62, v62, s34, -v72
    v_fma_f32 v63, v63, s34, -v72
    v_fma_f32 v64, v64, s34, -v72
    v_fma_f32 v65, v65, s34, -v72
    v_fma_f32 v66, v66, s34, -v72
    v_fma_f32 v67, v67, s34, -v72
    v_fma_f32 v68, v68, s34, -v72
    v_fma_f32 v69, v69, s34, -v72
    v_fma_f32 v70, v70, s34, -v72
    v_fma_f32 v71, v71, s34, -v72
    v_exp_f32 v60, v60
    v_exp_f32 v61, v61
    v_exp_f32 v62, v62
    v_exp_f32 v63, v63
    v_exp_f32 v64, v64
    v_exp_f32 v65, v65
    ds_read_b128 v[56:59], v1 offset:1088
    s_waitcnt lgkmcnt(1)
    v_mfma_f32_16x16x32_bf16 v[44:47], v[52:55], v[176:179], v[44:47]
    v_mfma_f32_16x16x32_bf16 v[48:51], v[52:55], v[248:251], v[48:51]
    v_exp_f32 v66, v66
    v_exp_f32 v67, v67
    v_exp_f32 v68, v68
    v_exp_f32 v69, v69
    v_exp_f32 v70, v70
    v_exp_f32 v71, v71
    s_waitcnt lgkmcnt(0)
    v_mfma_f32_16x16x32_bf16 v[44:47], v[56:59], v[180:183], v[44:47]
    v_mfma_f32_16x16x32_bf16 v[48:51], v[56:59], v[252:255], v[48:51]
    v_add_f32 v74, v60, v61
    v_add_f32 v76, v62, v63

    v_add_f32 v74, v74, v64
    v_add_f32 v76, v76, v65

    v_add_f32 v74, v74, v66
    v_add_f32 v76, v76, v67

    v_add_f32 v74, v74, v68
    v_add_f32 v76, v76, v69

    v_add_f32 v74, v74, v70
    v_add_f32 v76, v76, v71

    v_add_f32 v74, v74, v76
    v_mov_b32 v75, v74
    s_nop 1
    v_permlane16_swap_b32 v74, v75
    s_nop 1
    v_add_f32 v74, v74, v75
    v_mov_b32 v75, v74
    s_nop 1
    v_permlane32_swap_b32 v74, v75
    s_nop 1
    v_add_f32 v74, v74, v75

    v_rcp_f32 v74, v74
    s_nop 0

    v_mul_f32 v60, v60, v74
    v_mul_f32 v61, v61, v74
    v_cvt_pk_bf16_f32 v60, v60, v61

    v_mul_f32 v62, v62, v74
    v_mul_f32 v63, v63, v74
    v_cvt_pk_bf16_f32 v61, v62, v63

    v_mul_f32 v64, v64, v74
    v_mul_f32 v65, v65, v74
    v_cvt_pk_bf16_f32 v62, v64, v65

    v_mul_f32 v66, v66, v74
    v_mul_f32 v67, v67, v74
    v_cvt_pk_bf16_f32 v63, v66, v67

    v_mul_f32 v68, v68, v74
    v_mul_f32 v69, v69, v74
    v_cvt_pk_bf16_f32 v64, v68, v69

    v_mul_f32 v70, v70, v74
    v_mul_f32 v71, v71, v74
    v_cvt_pk_bf16_f32 v65, v70, v71

    v_and_b32 v52, 15, v0
    v_bfe_u32 v53, v0, 4, 2
    v_lshlrev_b32 v54, 4, v52
    v_lshl_add_u32 v54, v53, 3, v54
    s_lshl_b32 s34, s21, 9
    v_add_u32 v54, s34, v54
    s_nop 3

    v_cvt_pk_bf16_f32 v76, v44, v45
    v_cvt_pk_bf16_f32 v77, v46, v47

    v_cvt_pk_bf16_f32 v78, v48, v49
    v_cvt_pk_bf16_f32 v79, v50, v51

    s_nop 1
    v_mfma_f32_16x16x16_bf16 v[44:47], v[76:77], v[60:61], 0
    v_mfma_f32_16x16x16_bf16 v[44:47], v[36:37], v[62:63], v[44:47]
    v_mfma_f32_16x16x16_bf16 v[44:47], v[38:39], v[64:65], v[44:47]
    v_mfma_f32_16x16x16_bf16 v[48:51], v[78:79], v[60:61], 0
    v_mfma_f32_16x16x16_bf16 v[48:51], v[40:41], v[62:63], v[48:51]
    v_mfma_f32_16x16x16_bf16 v[48:51], v[42:43], v[64:65], v[48:51]
    s_mov_b64 exec, s[28:29]
    buffer_store_dwordx2 v[76:77], v54, s[60:63], s37 offen offset:0 sc1
    buffer_store_dwordx2 v[78:79], v54, s[60:63], s37 offen offset:256 sc1
    s_mov_b64 exec, -1
    s_cmp_eq_u32 s22, 63
    s_cbranch_scc1 L_chain_done_13
    s_and_b32 s34, s22, 1
    s_mul_i32 s24, s34, 0x90000
    s_mul_i32 s25, s34, 18432
    s_lshr_b32 s23, s22, 1
    s_and_b32 s23, s23, 1
    s_add_u32 s23, s23, 1
    s_mul_i32 s35, s20, 576
    s_add_u32 s35, s35, s24
    s_mov_b64 exec, s[26:27]

    v_cvt_pk_bf16_f32 v44, v44, v45
    v_cvt_pk_bf16_f32 v45, v46, v47
    ds_write_b64 v2, v[44:45] offset:4352

    v_cvt_pk_bf16_f32 v48, v48, v49
    v_cvt_pk_bf16_f32 v49, v50, v51
    ds_write_b64 v2, v[48:49] offset:4384

    s_mov_b64 exec, -1
    v_and_b32 v76, 63, v0
    v_lshlrev_b32 v76, 4, v76
    s_mul_i32 s36, s21, 9216
    v_add_u32 v76, s36, v76
    v_add_u32 v77, 73728, v76
    v_and_b32 v78, 7, v0
    v_lshl_add_u32 v78, v78, 2, s21
    v_mul_u32_u24 v78, 18432, v78
    v_bfe_u32 v79, v0, 4, 2
    v_lshl_add_u32 v78, v79, 4, v78
    v_bfe_u32 v79, v0, 3, 1
    v_lshl_add_u32 v78, v79, 6, v78

    s_lshl_b32 s35, s20, 9
    s_add_u32 s35, s35, s24
    s_lshl_b32 s45, s20, 6
    s_add_u32 s45, s45, s24
    s_add_u32 s45, s45, 16384

    ds_read_b128 v[4:7], v76 offset:0
    ds_read_b128 v[8:11], v76 offset:36864
    ds_read_b128 v[12:15], v77 offset:0
    ds_read_b128 v[16:19], v77 offset:36864
    ds_read_b128 v[20:23], v76 offset:1024
    ds_read_b128 v[24:27], v76 offset:37888
    ds_read_b128 v[28:31], v77 offset:1024
    ds_read_b128 v[32:35], v77 offset:37888
    s_waitcnt lgkmcnt(8)
    s_barrier
    ds_read_b128 v[44:47], v3 offset:4352
    ds_read_b128 v[48:51], v3 offset:4416
    ds_read_b128 v[52:55], v3 offset:4480
    ds_read_b128 v[56:59], v3 offset:4544
    ds_read_b128 v[36:39], v76 offset:2048
    ds_read_b128 v[40:43], v76 offset:38912
    ds_read_b128 v[68:71], v77 offset:2048
    ds_read_b128 v[72:75], v77 offset:38912
    s_waitcnt lgkmcnt(4)
    v_mfma_f32_16x16x32_bf16 v[60:63], v[4:7], v[44:47], 0
    v_mfma_f32_16x16x32_bf16 v[60:63], v[8:11], v[48:51], v[60:63]
    v_mfma_f32_16x16x32_bf16 v[60:63], v[12:15], v[52:55], v[60:63]
    v_mfma_f32_16x16x32_bf16 v[60:63], v[16:19], v[56:59], v[60:63]
    ds_read_b128 v[4:7], v76 offset:3072
    ds_read_b128 v[8:11], v76 offset:39936
    ds_read_b128 v[12:15], v77 offset:3072
    ds_read_b128 v[16:19], v77 offset:39936
    v_mfma_f32_16x16x32_bf16 v[64:67], v[20:23], v[44:47], 0
    v_mfma_f32_16x16x32_bf16 v[64:67], v[24:27], v[48:51], v[64:67]
    v_mfma_f32_16x16x32_bf16 v[64:67], v[28:31], v[52:55], v[64:67]
    v_mfma_f32_16x16x32_bf16 v[64:67], v[32:35], v[56:59], v[64:67]
    ds_read_b128 v[20:23], v76 offset:4096
    ds_read_b128 v[24:27], v76 offset:40960
    ds_read_b128 v[28:31], v77 offset:4096
    ds_read_b128 v[32:35], v77 offset:40960
    s_nop 3
    v_mov_b32_dpp v60, v64 row_shr:8 row_mask:0xf bank_mask:0xc
    v_mov_b32_dpp v61, v65 row_shr:8 row_mask:0xf bank_mask:0xc
    v_mov_b32_dpp v62, v66 row_shr:8 row_mask:0xf bank_mask:0xc
    v_mov_b32_dpp v63, v67 row_shr:8 row_mask:0xf bank_mask:0xc
    v_bfi_b32 v60, 3, s23, v60
    v_bfi_b32 v61, 3, s23, v61
    v_bfi_b32 v62, 3, s23, v62
    v_bfi_b32 v63, 3, s23, v63
    buffer_store_dwordx4 v[60:63], v78, s[64:67], s35 offen offset:0
    s_nop 1
    s_waitcnt lgkmcnt(8)
    v_mfma_f32_16x16x32_bf16 v[60:63], v[36:39], v[44:47], 0
    v_mfma_f32_16x16x32_bf16 v[60:63], v[40:43], v[48:51], v[60:63]
    v_mfma_f32_16x16x32_bf16 v[60:63], v[68:71], v[52:55], v[60:63]
    v_mfma_f32_16x16x32_bf16 v[60:63], v[72:75], v[56:59], v[60:63]
    ds_read_b128 v[36:39], v76 offset:5120
    ds_read_b128 v[40:43], v76 offset:41984
    ds_read_b128 v[68:71], v77 offset:5120
    ds_read_b128 v[72:75], v77 offset:41984
    s_waitcnt lgkmcnt(8)
    v_mfma_f32_16x16x32_bf16 v[64:67], v[4:7], v[44:47], 0
    v_mfma_f32_16x16x32_bf16 v[64:67], v[8:11], v[48:51], v[64:67]
    v_mfma_f32_16x16x32_bf16 v[64:67], v[12:15], v[52:55], v[64:67]
    v_mfma_f32_16x16x32_bf16 v[64:67], v[16:19], v[56:59], v[64:67]
    ds_read_b128 v[4:7], v76 offset:6144
    ds_read_b128 v[8:11], v76 offset:43008
    ds_read_b128 v[12:15], v77 offset:6144
    ds_read_b128 v[16:19], v77 offset:43008
    s_nop 3
    v_mov_b32_dpp v60, v64 row_shr:8 row_mask:0xf bank_mask:0xc
    v_mov_b32_dpp v61, v65 row_shr:8 row_mask:0xf bank_mask:0xc
    v_mov_b32_dpp v62, v66 row_shr:8 row_mask:0xf bank_mask:0xc
    v_mov_b32_dpp v63, v67 row_shr:8 row_mask:0xf bank_mask:0xc
    v_bfi_b32 v60, 3, s23, v60
    v_bfi_b32 v61, 3, s23, v61
    v_bfi_b32 v62, 3, s23, v62
    v_bfi_b32 v63, 3, s23, v63
    buffer_store_dwordx4 v[60:63], v78, s[64:67], s35 offen offset:128
    s_nop 1
    s_waitcnt lgkmcnt(8)
    v_mfma_f32_16x16x32_bf16 v[60:63], v[20:23], v[44:47], 0
    v_mfma_f32_16x16x32_bf16 v[60:63], v[24:27], v[48:51], v[60:63]
    v_mfma_f32_16x16x32_bf16 v[60:63], v[28:31], v[52:55], v[60:63]
    v_mfma_f32_16x16x32_bf16 v[60:63], v[32:35], v[56:59], v[60:63]
    ds_read_b128 v[20:23], v76 offset:7168
    ds_read_b128 v[24:27], v76 offset:44032
    ds_read_b128 v[28:31], v77 offset:7168
    ds_read_b128 v[32:35], v77 offset:44032
    s_waitcnt lgkmcnt(8)
    v_mfma_f32_16x16x32_bf16 v[64:67], v[36:39], v[44:47], 0
    v_mfma_f32_16x16x32_bf16 v[64:67], v[40:43], v[48:51], v[64:67]
    v_mfma_f32_16x16x32_bf16 v[64:67], v[68:71], v[52:55], v[64:67]
    v_mfma_f32_16x16x32_bf16 v[64:67], v[72:75], v[56:59], v[64:67]
    ds_read_b128 v[36:39], v76 offset:8192
    ds_read_b128 v[40:43], v76 offset:45056
    ds_read_b128 v[68:71], v77 offset:8192
    ds_read_b128 v[72:75], v77 offset:45056
    s_nop 3
    v_mov_b32_dpp v60, v64 row_shr:8 row_mask:0xf bank_mask:0xc
    v_mov_b32_dpp v61, v65 row_shr:8 row_mask:0xf bank_mask:0xc
    v_mov_b32_dpp v62, v66 row_shr:8 row_mask:0xf bank_mask:0xc
    v_mov_b32_dpp v63, v67 row_shr:8 row_mask:0xf bank_mask:0xc
    v_bfi_b32 v60, 3, s23, v60
    v_bfi_b32 v61, 3, s23, v61
    v_bfi_b32 v62, 3, s23, v62
    v_bfi_b32 v63, 3, s23, v63
    buffer_store_dwordx4 v[60:63], v78, s[64:67], s35 offen offset:256
    s_nop 1
    s_waitcnt lgkmcnt(8)
    v_mfma_f32_16x16x32_bf16 v[60:63], v[4:7], v[44:47], 0
    v_mfma_f32_16x16x32_bf16 v[60:63], v[8:11], v[48:51], v[60:63]
    v_mfma_f32_16x16x32_bf16 v[60:63], v[12:15], v[52:55], v[60:63]
    v_mfma_f32_16x16x32_bf16 v[60:63], v[16:19], v[56:59], v[60:63]
    s_waitcnt lgkmcnt(4)
    v_mfma_f32_16x16x32_bf16 v[64:67], v[20:23], v[44:47], 0
    v_mfma_f32_16x16x32_bf16 v[64:67], v[24:27], v[48:51], v[64:67]
    v_mfma_f32_16x16x32_bf16 v[64:67], v[28:31], v[52:55], v[64:67]
    v_mfma_f32_16x16x32_bf16 v[64:67], v[32:35], v[56:59], v[64:67]
    s_nop 7
    v_mov_b32_dpp v60, v64 row_shr:8 row_mask:0xf bank_mask:0xc
    v_mov_b32_dpp v61, v65 row_shr:8 row_mask:0xf bank_mask:0xc
    v_mov_b32_dpp v62, v66 row_shr:8 row_mask:0xf bank_mask:0xc
    v_mov_b32_dpp v63, v67 row_shr:8 row_mask:0xf bank_mask:0xc
    v_bfi_b32 v60, 3, s23, v60
    v_bfi_b32 v61, 3, s23, v61
    v_bfi_b32 v62, 3, s23, v62
    v_bfi_b32 v63, 3, s23, v63
    buffer_store_dwordx4 v[60:63], v78, s[64:67], s35 offen offset:384
    s_nop 1
    s_waitcnt lgkmcnt(0)
    v_mfma_f32_16x16x32_bf16 v[60:63], v[36:39], v[44:47], 0
    v_mfma_f32_16x16x32_bf16 v[60:63], v[40:43], v[48:51], v[60:63]
    v_mfma_f32_16x16x32_bf16 v[60:63], v[68:71], v[52:55], v[60:63]
    v_mfma_f32_16x16x32_bf16 v[60:63], v[72:75], v[56:59], v[60:63]
    s_nop 7
    v_bfi_b32 v60, 3, s23, v60
    v_bfi_b32 v61, 3, s23, v61
    v_bfi_b32 v62, 3, s23, v62
    v_bfi_b32 v63, 3, s23, v63
    s_mov_b64 exec, s[26:27]
    buffer_store_dwordx4 v[60:63], v78, s[64:67], s45 offen
    s_mov_b64 exec, -1

    v_bfe_u32 v44, v0, 3, 3
    v_lshlrev_b32 v44, 9, v44
    v_and_b32 v47, 7, v0
    v_lshl_add_u32 v44, v47, 4, v44
    v_and_b32 v47, 31, v0
    v_lshlrev_b32 v47, 6, v47
    s_mul_i32 s35, s20, 18432
    s_add_u32 s35, s35, s24
    s_lshl_b32 s36, s21, 4
    s_add_u32 s36, s36, s35
    s_add_u32 s36, s36, 16384
    s_lshl_b32 s37, s21, 7
    s_add_u32 s35, s35, s37
    s_add_u32 s37, s35, 4096
    s_add_u32 s38, s35, 8192
    s_add_u32 s39, s35, 12288
    s_mov_b32 s32, 0
    s_mov_b32 s42, 3641

    v_add_u32 v56, 0, v0
    v_mul_lo_u32 v57, v56, s42
    v_lshrrev_b32 v57, 19, v57
    v_mul_u32_u24 v58, 144, v57
    v_sub_u32 v56, v56, v58
    v_mul_u32_u24 v57, 1184, v57
    v_lshl_add_u32 v48, v56, 3, v57
    v_add_u32 v48, 147456, v48

    v_add_u32 v56, 256, v0
    v_mul_lo_u32 v57, v56, s42
    v_lshrrev_b32 v57, 19, v57
    v_mul_u32_u24 v58, 144, v57
    v_sub_u32 v56, v56, v58
    v_mul_u32_u24 v57, 1184, v57
    v_lshl_add_u32 v49, v56, 3, v57
    v_add_u32 v49, 147456, v49

    v_add_u32 v56, 512, v0
    v_mul_lo_u32 v57, v56, s42
    v_lshrrev_b32 v57, 19, v57
    v_mul_u32_u24 v58, 144, v57
    v_sub_u32 v56, v56, v58
    v_mul_u32_u24 v57, 1184, v57
    v_lshl_add_u32 v50, v56, 3, v57
    v_add_u32 v50, 147456, v50

    v_add_u32 v56, 768, v0
    v_mul_lo_u32 v57, v56, s42
    v_lshrrev_b32 v57, 19, v57
    v_mul_u32_u24 v58, 144, v57
    v_sub_u32 v56, v56, v58
    v_mul_u32_u24 v57, 1184, v57
    v_lshl_add_u32 v51, v56, 3, v57
    v_add_u32 v51, 147456, v51

    v_add_u32 v56, 1024, v0
    v_mul_lo_u32 v57, v56, s42
    v_lshrrev_b32 v57, 19, v57
    v_mul_u32_u24 v58, 144, v57
    v_sub_u32 v56, v56, v58
    v_mul_u32_u24 v57, 1184, v57
    v_lshl_add_u32 v52, v56, 3, v57
    v_add_u32 v52, 147456, v52

    buffer_load_dwordx4 v[4:7], v44, s[64:67], s35 offen sc1
    buffer_load_dwordx4 v[8:11], v44, s[64:67], s37 offen sc1
    buffer_load_dwordx4 v[12:15], v44, s[64:67], s38 offen sc1
    buffer_load_dwordx4 v[16:19], v44, s[64:67], s39 offen sc1
    buffer_load_dwordx4 v[20:23], v47, s[64:67], s36 offen sc1
    s_sleep 3
    buffer_load_dwordx4 v[24:27], v44, s[64:67], s35 offen sc1
    buffer_load_dwordx4 v[28:31], v44, s[64:67], s37 offen sc1
    buffer_load_dwordx4 v[32:35], v44, s[64:67], s38 offen sc1
    buffer_load_dwordx4 v[36:39], v44, s[64:67], s39 offen sc1
    buffer_load_dwordx4 v[40:43], v47, s[64:67], s36 offen sc1
L_poll1_18:
    s_waitcnt vmcnt(5)
    v_and_b32 v45, v4, v5
    v_or_b32 v46, v4, v5
    v_and_b32 v45, v45, v6
    v_and_b32 v45, v45, v7
    v_or3_b32 v46, v46, v6, v7
    v_and_b32 v45, v45, v8
    v_and_b32 v45, v45, v9
    v_or3_b32 v46, v46, v8, v9
    v_and_b32 v45, v45, v10
    v_and_b32 v45, v45, v11
    v_or3_b32 v46, v46, v10, v11
    v_and_b32 v45, v45, v12
    v_and_b32 v45, v45, v13
    v_or3_b32 v46, v46, v12, v13
    v_and_b32 v45, v45, v14
    v_and_b32 v45, v45, v15
    v_or3_b32 v46, v46, v14, v15
    v_and_b32 v45, v45, v16
    v_and_b32 v45, v45, v17
    v_or3_b32 v46, v46, v16, v17
    v_and_b32 v45, v45, v18
    v_and_b32 v45, v45, v19
    v_or3_b32 v46, v46, v18, v19
    v_and_b32 v45, v45, v20
    v_and_b32 v45, v45, v21
    v_or3_b32 v46, v46, v20, v21
    v_and_b32 v45, v45, v22
    v_and_b32 v45, v45, v23
    v_or3_b32 v46, v46, v22, v23
    v_xor_b32 v45, s23, v45
    v_xor_b32 v46, s23, v46
    v_or_b32 v45, v45, v46
    v_and_b32 v45, 3, v45
    v_cmp_ne_u32 vcc, 0, v45
    s_nop 1
    s_cbranch_vccnz L_p1retA_20

L_poll1x_19:
    v_add_f32 v72, v4, v8
    v_add_f32_dpp v68, v20, v20 row_shr:1 row_mask:0xf bank_mask:0xf bound_ctrl:0
    v_add_f32 v73, v5, v9
    v_add_f32_dpp v69, v21, v21 row_shr:1 row_mask:0xf bank_mask:0xf bound_ctrl:0
    v_add_f32 v74, v6, v10
    v_add_f32_dpp v70, v22, v22 row_shr:1 row_mask:0xf bank_mask:0xf bound_ctrl:0
    v_add_f32 v75, v7, v11
    v_add_f32_dpp v71, v23, v23 row_shr:1 row_mask:0xf bank_mask:0xf bound_ctrl:0
    v_add_f32 v72, v72, v12
    v_add_f32_dpp v68, v68, v68 row_shr:2 row_mask:0xf bank_mask:0xf bound_ctrl:0
    v_add_f32 v73, v73, v13
    v_add_f32_dpp v69, v69, v69 row_shr:2 row_mask:0xf bank_mask:0xf bound_ctrl:0
    v_add_f32 v74, v74, v14
    v_add_f32_dpp v70, v70, v70 row_shr:2 row_mask:0xf bank_mask:0xf bound_ctrl:0
    v_add_f32 v75, v75, v15
    v_add_f32_dpp v71, v71, v71 row_shr:2 row_mask:0xf bank_mask:0xf bound_ctrl:0
    v_add_f32 v72, v72, v16
    v_add_f32_dpp v68, v68, v68 row_shr:4 row_mask:0xf bank_mask:0xf bound_ctrl:0
    v_add_f32 v73, v73, v17
    v_add_f32_dpp v69, v69, v69 row_shr:4 row_mask:0xf bank_mask:0xf bound_ctrl:0
    v_add_f32 v74, v74, v18
    v_add_f32_dpp v70, v70, v70 row_shr:4 row_mask:0xf bank_mask:0xf bound_ctrl:0
    v_add_f32 v75, v75, v19
    v_add_f32_dpp v71, v71, v71 row_shr:4 row_mask:0xf bank_mask:0xf bound_ctrl:0
    s_branch L_p1join_22
L_p1retA_20:
    buffer_load_dwordx4 v[4:7], v44, s[64:67], s35 offen sc1
    buffer_load_dwordx4 v[8:11], v44, s[64:67], s37 offen sc1
    buffer_load_dwordx4 v[12:15], v44, s[64:67], s38 offen sc1
    buffer_load_dwordx4 v[16:19], v44, s[64:67], s39 offen sc1
    buffer_load_dwordx4 v[20:23], v47, s[64:67], s36 offen sc1
    s_waitcnt vmcnt(5)
    v_and_b32 v45, v24, v25
    v_or_b32 v46, v24, v25
    v_and_b32 v45, v45, v26
    v_and_b32 v45, v45, v27
    v_or3_b32 v46, v46, v26, v27
    v_and_b32 v45, v45, v28
    v_and_b32 v45, v45, v29
    v_or3_b32 v46, v46, v28, v29
    v_and_b32 v45, v45, v30
    v_and_b32 v45, v45, v31
    v_or3_b32 v46, v46, v30, v31
    v_and_b32 v45, v45, v32
    v_and_b32 v45, v45, v33
    v_or3_b32 v46, v46, v32, v33
    v_and_b32 v45, v45, v34
    v_and_b32 v45, v45, v35
    v_or3_b32 v46, v46, v34, v35
    v_and_b32 v45, v45, v36
    v_and_b32 v45, v45, v37
    v_or3_b32 v46, v46, v36, v37
    v_and_b32 v45, v45, v38
    v_and_b32 v45, v45, v39
    v_or3_b32 v46, v46, v38, v39
    v_and_b32 v45, v45, v40
    v_and_b32 v45, v45, v41
    v_or3_b32 v46, v46, v40, v41
    v_and_b32 v45, v45, v42
    v_and_b32 v45, v45, v43
    v_or3_b32 v46, v46, v42, v43
    v_xor_b32 v45, s23, v45
    v_xor_b32 v46, s23, v46
    v_or_b32 v45, v45, v46
    v_and_b32 v45, 3, v45
    v_cmp_ne_u32 vcc, 0, v45
    s_nop 1
    s_cbranch_vccnz L_p1retB_21

    v_add_f32 v72, v24, v28
    v_add_f32_dpp v68, v40, v40 row_shr:1 row_mask:0xf bank_mask:0xf bound_ctrl:0
    v_add_f32 v73, v25, v29
    v_add_f32_dpp v69, v41, v41 row_shr:1 row_mask:0xf bank_mask:0xf bound_ctrl:0
    v_add_f32 v74, v26, v30
    v_add_f32_dpp v70, v42, v42 row_shr:1 row_mask:0xf bank_mask:0xf bound_ctrl:0
    v_add_f32 v75, v27, v31
    v_add_f32_dpp v71, v43, v43 row_shr:1 row_mask:0xf bank_mask:0xf bound_ctrl:0
    v_add_f32 v72, v72, v32
    v_add_f32_dpp v68, v68, v68 row_shr:2 row_mask:0xf bank_mask:0xf bound_ctrl:0
    v_add_f32 v73, v73, v33
    v_add_f32_dpp v69, v69, v69 row_shr:2 row_mask:0xf bank_mask:0xf bound_ctrl:0
    v_add_f32 v74, v74, v34
    v_add_f32_dpp v70, v70, v70 row_shr:2 row_mask:0xf bank_mask:0xf bound_ctrl:0
    v_add_f32 v75, v75, v35
    v_add_f32_dpp v71, v71, v71 row_shr:2 row_mask:0xf bank_mask:0xf bound_ctrl:0
    v_add_f32 v72, v72, v36
    v_add_f32_dpp v68, v68, v68 row_shr:4 row_mask:0xf bank_mask:0xf bound_ctrl:0
    v_add_f32 v73, v73, v37
    v_add_f32_dpp v69, v69, v69 row_shr:4 row_mask:0xf bank_mask:0xf bound_ctrl:0
    v_add_f32 v74, v74, v38
    v_add_f32_dpp v70, v70, v70 row_shr:4 row_mask:0xf bank_mask:0xf bound_ctrl:0
    v_add_f32 v75, v75, v39
    v_add_f32_dpp v71, v71, v71 row_shr:4 row_mask:0xf bank_mask:0xf bound_ctrl:0
    s_branch L_p1join_22
L_p1retB_21:
    buffer_load_dwordx4 v[24:27], v44, s[64:67], s35 offen sc1
    buffer_load_dwordx4 v[28:31], v44, s[64:67], s37 offen sc1
    buffer_load_dwordx4 v[32:35], v44, s[64:67], s38 offen sc1
    buffer_load_dwordx4 v[36:39], v44, s[64:67], s39 offen sc1
    buffer_load_dwordx4 v[40:43], v47, s[64:67], s36 offen sc1
    s_add_u32 s32, s32, 1
    s_cmp_gt_u32 s32, 100000
    s_cbranch_scc1 L_poll1x_19
    s_branch L_poll1_18

L_p1join_22:
    v_add_f32_dpp v72, v72, v72 row_shr:8 row_mask:0xf bank_mask:0xf bound_ctrl:0
    v_add_f32_dpp v68, v68, v68 row_shr:8 row_mask:0xf bank_mask:0xf bound_ctrl:0
    v_add_f32_dpp v73, v73, v73 row_shr:8 row_mask:0xf bank_mask:0xf bound_ctrl:0
    v_add_f32_dpp v69, v69, v69 row_shr:8 row_mask:0xf bank_mask:0xf bound_ctrl:0
    v_add_f32_dpp v74, v74, v74 row_shr:8 row_mask:0xf bank_mask:0xf bound_ctrl:0
    v_add_f32_dpp v70, v70, v70 row_shr:8 row_mask:0xf bank_mask:0xf bound_ctrl:0
    v_add_f32_dpp v75, v75, v75 row_shr:8 row_mask:0xf bank_mask:0xf bound_ctrl:0
    v_add_f32_dpp v71, v71, v71 row_shr:8 row_mask:0xf bank_mask:0xf bound_ctrl:0
    v_mov_b32 v56, v72
    v_mov_b32 v60, v68
    v_mov_b32 v57, v73
    v_mov_b32 v61, v69
    v_mov_b32 v58, v74
    v_mov_b32 v62, v70
    v_mov_b32 v59, v75
    v_mov_b32 v63, v71
    s_nop 0
    v_permlane16_swap_b32 v72, v56
    v_permlane16_swap_b32 v68, v60
    v_permlane16_swap_b32 v73, v57
    v_permlane16_swap_b32 v69, v61
    v_permlane16_swap_b32 v74, v58
    v_permlane16_swap_b32 v70, v62
    v_permlane16_swap_b32 v75, v59
    v_permlane16_swap_b32 v71, v63
    s_nop 0
    v_add_f32 v72, v72, v56
    v_add_f32 v68, v68, v60
    v_add_f32 v73, v73, v57
    v_add_f32 v69, v69, v61
    v_add_f32 v74, v74, v58
    v_add_f32 v70, v70, v62
    v_add_f32 v75, v75, v59
    v_add_f32 v71, v71, v63
    v_mov_b32 v56, v72
    v_mov_b32 v57, v73
    v_mov_b32 v58, v74
    v_mov_b32 v59, v75
    s_nop 1
    v_permlane32_swap_b32 v72, v56
    v_permlane32_swap_b32 v73, v57
    v_permlane32_swap_b32 v74, v58
    v_permlane32_swap_b32 v75, v59
    s_nop 0
    v_add_f32 v72, v72, v56
    v_add_f32 v73, v73, v57
    v_add_f32 v74, v74, v58
    v_add_f32 v75, v75, v59
    s_mov_b64 exec, 0x80000000
    v_mov_b32 v72, v68
    v_mov_b32 v73, v69
    v_mov_b32 v74, v70
    v_mov_b32 v75, v71
    s_mov_b64 exec, -1
    v_and_b32 v47, 7, v0
    v_lshlrev_b32 v47, 4, v47
    s_lshl_b32 s36, s21, 7
    v_add_u32 v47, s36, v47
    s_lshl_b32 s36, s21, 4
    s_add_u32 s36, s36, 512
    s_mov_b64 exec, 0x80000000
    v_mov_b32 v47, s36
    s_mov_b64 exec, -1

    v_cvt_pk_bf16_f32 v46, v72, v73
    v_lshlrev_b32 v72, 16, v46
    v_and_b32 v73, 0xffff0000, v46
    v_or_b32 v72, s23, v72
    v_or_b32 v73, s23, v73

    v_cvt_pk_bf16_f32 v46, v74, v75
    v_lshlrev_b32 v74, 16, v46
    v_and_b32 v75, 0xffff0000, v46
    v_or_b32 v74, s23, v74
    v_or_b32 v75, s23, v75

    s_mul_i32 s35, s20, 576
    s_add_u32 s35, s35, s25
    s_mov_b64 exec, 0x8000ff00
    buffer_store_dwordx4 v[72:75], v47, s[68:71], s35 offen
    s_mov_b64 exec, -1

    s_add_u32 s22, s22, 1
    v_lshlrev_b32 v44, 4, v0

    s_cmp_lg_u32 s21, 3
    s_cbranch_scc1 L_nowflag_23
    s_add_u32 s38, s22, 1
    s_and_b32 s39, s38, 3
    s_cmp_lg_u32 s39, 0
    s_cbranch_scc1 L_nowflag_23
    s_cmp_ge_u32 s38, 64
    s_cbranch_scc1 L_nowflag_23
    s_lshr_b32 s39, s38, 2
    s_add_u32 s39, s39, 16
    s_lshl_b32 s39, s39, 5
    s_add_u32 s39, s39, s20
    s_lshl_b32 s39, s39, 2
    v_and_b32 v45, 1, v0
    v_lshlrev_b32 v45, 11, v45
    s_mov_b32 s32, 0

L_wflag_24:
    buffer_load_dword v46, v45, s[96:99], s39 offen sc1
    s_add_u32 s32, s32, 1
    s_waitcnt vmcnt(0)
    v_cmp_eq_u32 vcc, 0, v46
    s_cmp_gt_u32 s32, 100000
    s_cbranch_scc1 L_nowflag_23
    s_cbranch_vccnz L_wflag_24

L_nowflag_23:
    s_add_u32 s34, s25, 0
    s_add_u32 s35, s25, 4096
    s_add_u32 s36, s25, 8192
    s_add_u32 s37, s25, 12288
    s_add_u32 s38, s25, 16384
    s_cmp_ge_u32 s21, 2
    s_cselect_b32 s38, s34, s38
    s_mov_b32 s32, 0

L_poll2_25:
    s_add_u32 s32, s32, 1
    s_cmp_gt_u32 s32, 100000
    s_cbranch_scc1 L_poll2x_26

    buffer_load_dwordx4 v[56:59], v44, s[68:71], s34 offen sc1
    buffer_load_dwordx4 v[60:63], v44, s[68:71], s35 offen sc1
    buffer_load_dwordx4 v[64:67], v44, s[68:71], s36 offen sc1
    buffer_load_dwordx4 v[68:71], v44, s[68:71], s37 offen sc1
    buffer_load_dwordx4 v[72:75], v44, s[68:71], s38 offen sc1
    s_waitcnt vmcnt(0)
    v_and_b32 v45, v56, v57
    v_or_b32 v46, v56, v57
    v_and_b32 v45, v45, v58
    v_and_b32 v45, v45, v59
    v_or3_b32 v46, v46, v58, v59
    v_and_b32 v45, v45, v60
    v_and_b32 v45, v45, v61
    v_or3_b32 v46, v46, v60, v61
    v_and_b32 v45, v45, v62
    v_and_b32 v45, v45, v63
    v_or3_b32 v46, v46, v62, v63
    v_and_b32 v45, v45, v64
    v_and_b32 v45, v45, v65
    v_or3_b32 v46, v46, v64, v65
    v_and_b32 v45, v45, v66
    v_and_b32 v45, v45, v67
    v_or3_b32 v46, v46, v66, v67
    v_and_b32 v45, v45, v68
    v_and_b32 v45, v45, v69
    v_or3_b32 v46, v46, v68, v69
    v_and_b32 v45, v45, v70
    v_and_b32 v45, v45, v71
    v_or3_b32 v46, v46, v70, v71
    v_and_b32 v45, v45, v72
    v_and_b32 v45, v45, v73
    v_or3_b32 v46, v46, v72, v73
    v_and_b32 v45, v45, v74
    v_and_b32 v45, v45, v75
    v_or3_b32 v46, v46, v74, v75
    v_xor_b32 v45, s23, v45
    v_xor_b32 v46, s23, v46
    v_or_b32 v45, v45, v46
    v_and_b32 v45, 3, v45
    v_cmp_ne_u32 vcc, 0, v45
    s_nop 1
    s_cbranch_vccnz L_poll2_25

L_poll2x_26:
    v_perm_b32 v56, v57, v56, s33
    v_perm_b32 v57, v59, v58, s33
    ds_write_b64 v48, v[56:57]

    v_perm_b32 v60, v61, v60, s33
    v_perm_b32 v61, v63, v62, s33
    ds_write_b64 v49, v[60:61]

    v_perm_b32 v64, v65, v64, s33
    v_perm_b32 v65, v67, v66, s33
    ds_write_b64 v50, v[64:65]

    v_perm_b32 v68, v69, v68, s33
    v_perm_b32 v69, v71, v70, s33
    ds_write_b64 v51, v[68:69]

    s_cmp_ge_u32 s21, 2
    s_cbranch_scc1 L_skip4_27

    v_perm_b32 v72, v73, v72, s33
    v_perm_b32 v73, v75, v74, s33
    ds_write_b64 v52, v[72:73]

L_skip4_27:
    v_and_b32 v76, 15, v0
    v_bfe_u32 v77, v0, 4, 2
    v_lshlrev_b32 v78, 13, v76
    v_lshl_add_u32 v78, v77, 4, v78
    s_lshl_b32 s17, s22, 18
    s_lshl_b32 s18, s20, 8
    s_add_u32 s17, s17, s18
    s_add_u32 s18, s17, 131072
    v_lshlrev_b32 v79, 6, v76
    v_lshl_add_u32 v79, v77, 3, v79
    s_lshl_b32 s19, s21, 11
    v_add_u32 v79, s19, v79
    s_lshl_b32 s19, s22, 5
    s_add_u32 s19, s19, s20
    s_lshl_b32 s19, s19, 13

    buffer_load_dwordx4 v[4:7], v78, s[48:51], s17 offen offset:0
    buffer_load_dwordx4 v[20:23], v78, s[48:51], s18 offen offset:0
    buffer_load_dwordx4 v[8:11], v78, s[48:51], s17 offen offset:64
    buffer_load_dwordx4 v[24:27], v78, s[48:51], s18 offen offset:64
    buffer_load_dwordx4 v[12:15], v78, s[48:51], s17 offen offset:128
    buffer_load_dwordx4 v[28:31], v78, s[48:51], s18 offen offset:128
    buffer_load_dwordx4 v[16:19], v78, s[48:51], s17 offen offset:192
    buffer_load_dwordx4 v[32:35], v78, s[48:51], s18 offen offset:192
    buffer_load_dwordx2 v[36:37], v79, s[52:55], s19 offen offset:0
    buffer_load_dwordx2 v[38:39], v79, s[52:55], s19 offen offset:32
    buffer_load_dwordx2 v[40:41], v79, s[52:55], s19 offen offset:1024
    buffer_load_dwordx2 v[42:43], v79, s[52:55], s19 offen offset:1056
    s_waitcnt lgkmcnt(0)
    s_barrier

    s_cmp_lg_u32 s21, 1
    s_cbranch_scc1 L_noprog_28
    s_lshl_b32 s36, s20, 6
    v_mov_b32 v45, 8192
    v_mov_b32 v46, s22
    s_mov_b64 exec, 1
    buffer_store_dword v46, v45, s[96:99], s36 offen sc1
    s_mov_b64 exec, -1

L_noprog_28:
    s_branch L_step_12
L_chain_done_13:
    s_waitcnt vmcnt(0)
    s_barrier
    s_lshl_b32 s36, s20, 6
    v_mov_b32 v45, 8192
    v_mov_b32 v46, 64
    v_cmp_eq_u32 vcc, 0, v0
    s_and_saveexec_b64 s[76:77], vcc
    buffer_store_dword v46, v45, s[96:99], s36 offen sc1
    s_mov_b64 exec, s[76:77]

    s_branch L_end_1
L_notcand_5:
    s_cmp_lg_u32 s73, 0
    s_cbranch_scc1 L_regother_32
    v_mov_b32 v1, 0
    s_mov_b32 s75, 128
    s_mov_b32 s79, 0
    s_mov_b64 exec, 1

L_regpoll_29:
    buffer_load_dword v2, v1, s[84:87], s75 offen sc1
    s_add_u32 s79, s79, 1
    s_waitcnt vmcnt(0)
    v_readfirstlane_b32 s77, v2
    s_cmp_gt_u32 s79, 200000
    s_cbranch_scc1 L_regbad_30
    s_cmp_ge_u32 s77, 256
    s_cbranch_scc1 L_regpoll_29_ok
    s_sleep 4
    s_branch L_regpoll_29

L_regpoll_29_ok:
    s_mov_b64 exec, 0xff
    v_mul_u32_u24 v1, 16, v0
    s_mov_b32 s75, 0
    buffer_load_dword v2, v1, s[84:87], s75 offen sc1
    s_waitcnt vmcnt(0)
    v_cmp_ne_u32 vcc, 32, v2
    s_mov_b32 s77, 1
    s_cbranch_vccz L_regw_31

L_regbad_30:
    s_mov_b32 s77, 0
L_regw_31:
    s_mov_b64 exec, -1
    v_mov_b32 v1, 163712
    v_mov_b32 v2, s77
    ds_write_b32 v1, v2
    s_waitcnt lgkmcnt(0)

L_regother_32:
    s_barrier
    v_mov_b32 v1, 163712
    ds_read_b32 v2, v1
    s_waitcnt lgkmcnt(0)
    v_readfirstlane_b32 s77, v2
    s_barrier
    s_cmp_eq_u32 s77, 0
    s_cbranch_scc1 L_fallback_4

    s_lshl_b32 s3, s72, 5
    s_add_u32 s3, s3, s76
    s_branch L_worker_2

L_fallback_4:
    s_mov_b32 s3, s2
    s_cmp_ge_u32 s3, 32
    s_cbranch_scc1 L_worker_2

    s_load_dwordx2 s[4:5], s[0:1], 120
    s_load_dwordx4 s[8:11], s[0:1], 16
    s_load_dwordx4 s[12:15], s[0:1], 32
    s_load_dwordx2 s[16:17], s[0:1], 8
    s_mov_b32 s20, s3
    v_lshrrev_b32 v44, 6, v0
    s_nop 0
    v_readfirstlane_b32 s21, v44
    s_mov_b32 s26, 0x00ff00ff
    s_mov_b32 s27, 0x00ff00ff
    s_mov_b32 s28, -1
    s_mov_b32 s29, 0
    s_mov_b32 s30, -1
    s_mov_b32 s31, 15
    s_mov_b32 s33, 0x07060302
    s_waitcnt lgkmcnt(0)

    s_add_u32 s48, s4, 20971520
    s_addc_u32 s49, s5, 0
    s_and_b32 s49, s49, 0xffff
    s_mov_b32 s50, 16777216
    s_mov_b32 s51, 0x00020000

    s_add_u32 s52, s4, 37748736
    s_addc_u32 s53, s5, 0
    s_and_b32 s53, s53, 0xffff
    s_mov_b32 s54, 16777216
    s_mov_b32 s55, 0x00020000

    s_add_u32 s56, s4, 54525952
    s_addc_u32 s57, s5, 0
    s_and_b32 s57, s57, 0xffff
    s_mov_b32 s58, 4194304
    s_mov_b32 s59, 0x00020000

    s_add_u32 s60, s4, 58720256
    s_addc_u32 s61, s5, 0
    s_and_b32 s61, s61, 0xffff
    s_mov_b32 s62, 4194304
    s_mov_b32 s63, 0x00020000

    s_add_u32 s64, s4, 134217728
    s_addc_u32 s65, s5, 0
    s_and_b32 s65, s65, 0xffff
    s_mov_b32 s66, 1179648
    s_mov_b32 s67, 0x00020000

    s_add_u32 s68, s4, 135397376
    s_addc_u32 s69, s5, 0
    s_and_b32 s69, s69, 0xffff
    s_mov_b32 s70, 36864
    s_mov_b32 s71, 0x00020000

    s_add_u32 s96, s4, 135462912
    s_addc_u32 s97, s5, 0
    s_and_b32 s97, s97, 0xffff
    s_mov_b32 s98, 65536
    s_mov_b32 s99, 0x00020000

    v_and_b32 v74, 63, v0
    v_lshrrev_b32 v44, 4, v0
    v_and_b32 v45, 15, v0
    v_lshlrev_b32 v46, 13, v44
    v_lshl_add_u32 v46, v45, 4, v46
    v_and_b32 v47, 3, v44
    v_lshrrev_b32 v48, 7, v0
    v_lshl_add_u32 v47, v48, 2, v47
    v_lshrrev_b32 v48, 1, v45
    v_xor_b32 v47, v47, v48
    v_lshlrev_b32 v47, 5, v47
    v_and_b32 v48, 1, v45
    v_lshl_add_u32 v47, v48, 4, v47
    v_lshl_add_u32 v47, v44, 8, v47
    v_add_u32 v48, 65536, v47
    v_add_u32 v49, 131072, v47
    v_lshrrev_b32 v50, 4, v74
    v_and_b32 v51, 15, v74
    v_lshrrev_b32 v52, 2, v51
    v_lshl_add_u32 v53, v50, 3, v52
    v_and_b32 v50, 1, v50
    v_lshl_add_u32 v52, v50, 2, v52
    v_and_b32 v51, 3, v51
    v_lshlrev_b32 v51, 3, v51
    v_lshl_add_u32 v51, v53, 8, v51
    s_lshl_b32 s34, s21, 1

    s_add_u32 s35, s34, 0
    v_xor_b32 v53, s35, v52
    v_lshl_add_u32 v54, v53, 5, v51
    v_add_u32 v55, 65536, v54
    v_add_u32 v56, 131072, v54

    s_add_u32 s35, s34, 1
    v_xor_b32 v53, s35, v52
    v_lshl_add_u32 v57, v53, 5, v51
    v_add_u32 v58, 65536, v57
    v_add_u32 v59, 131072, v57

    s_mov_b32 s72, s8
    s_and_b32 s73, s9, 0xffff
    s_mov_b32 s74, 4718592
    s_mov_b32 s75, 0x00020000

    s_lshl_b32 s36, s20, 8
    s_add_u32 s37, s36, 0
    buffer_load_dwordx4 v[80:83], v46, s[72:75], s37 offen

    s_add_u32 s37, s36, 131072
    buffer_load_dwordx4 v[84:87], v46, s[72:75], s37 offen

    s_add_u32 s37, s36, 262144
    buffer_load_dwordx4 v[88:91], v46, s[72:75], s37 offen

    s_add_u32 s37, s36, 393216
    buffer_load_dwordx4 v[92:95], v46, s[72:75], s37 offen

    s_add_u32 s37, s36, 524288
    buffer_load_dwordx4 v[96:99], v46, s[72:75], s37 offen

    s_add_u32 s37, s36, 655360
    buffer_load_dwordx4 v[100:103], v46, s[72:75], s37 offen

    s_add_u32 s37, s36, 786432
    buffer_load_dwordx4 v[104:107], v46, s[72:75], s37 offen

    s_add_u32 s37, s36, 917504
    buffer_load_dwordx4 v[108:111], v46, s[72:75], s37 offen

    s_add_u32 s37, s36, 1048576
    buffer_load_dwordx4 v[112:115], v46, s[72:75], s37 offen

    s_add_u32 s37, s36, 1179648
    buffer_load_dwordx4 v[116:119], v46, s[72:75], s37 offen

    s_add_u32 s37, s36, 1310720
    buffer_load_dwordx4 v[120:123], v46, s[72:75], s37 offen

    s_add_u32 s37, s36, 1441792
    buffer_load_dwordx4 v[124:127], v46, s[72:75], s37 offen

    s_add_u32 s37, s36, 1572864
    buffer_load_dwordx4 v[128:131], v46, s[72:75], s37 offen

    s_add_u32 s37, s36, 1703936
    buffer_load_dwordx4 v[132:135], v46, s[72:75], s37 offen

    s_add_u32 s37, s36, 1835008
    buffer_load_dwordx4 v[136:139], v46, s[72:75], s37 offen

    s_add_u32 s37, s36, 1966080
    buffer_load_dwordx4 v[140:143], v46, s[72:75], s37 offen

    s_add_u32 s37, s36, 2097152
    buffer_load_dwordx4 v[144:147], v46, s[72:75], s37 offen

    s_add_u32 s37, s36, 2228224
    buffer_load_dwordx4 v[148:151], v46, s[72:75], s37 offen

    s_add_u32 s37, s36, 2359296
    buffer_load_dwordx4 v[152:155], v46, s[72:75], s37 offen

    s_add_u32 s37, s36, 2490368
    buffer_load_dwordx4 v[156:159], v46, s[72:75], s37 offen

    s_add_u32 s37, s36, 2621440
    buffer_load_dwordx4 v[160:163], v46, s[72:75], s37 offen

    s_add_u32 s37, s36, 2752512
    buffer_load_dwordx4 v[164:167], v46, s[72:75], s37 offen

    s_add_u32 s37, s36, 2883584
    buffer_load_dwordx4 v[168:171], v46, s[72:75], s37 offen

    s_add_u32 s37, s36, 3014656
    buffer_load_dwordx4 v[172:175], v46, s[72:75], s37 offen

    s_add_u32 s37, s36, 3145728
    buffer_load_dwordx4 v[176:179], v46, s[72:75], s37 offen

    s_add_u32 s37, s36, 3276800
    buffer_load_dwordx4 v[180:183], v46, s[72:75], s37 offen

    s_add_u32 s37, s36, 3407872
    buffer_load_dwordx4 v[184:187], v46, s[72:75], s37 offen

    s_add_u32 s37, s36, 3538944
    buffer_load_dwordx4 v[188:191], v46, s[72:75], s37 offen

    s_add_u32 s37, s36, 3670016
    buffer_load_dwordx4 v[192:195], v46, s[72:75], s37 offen

    s_add_u32 s37, s36, 3801088
    buffer_load_dwordx4 v[196:199], v46, s[72:75], s37 offen

    s_add_u32 s37, s36, 3932160
    buffer_load_dwordx4 v[200:203], v46, s[72:75], s37 offen

    s_add_u32 s37, s36, 4063232
    buffer_load_dwordx4 v[204:207], v46, s[72:75], s37 offen

    s_add_u32 s37, s36, 4194304
    buffer_load_dwordx4 v[208:211], v46, s[72:75], s37 offen

    s_add_u32 s37, s36, 4325376
    buffer_load_dwordx4 v[212:215], v46, s[72:75], s37 offen

    s_add_u32 s37, s36, 4456448
    buffer_load_dwordx4 v[216:219], v46, s[72:75], s37 offen

    s_add_u32 s37, s36, 4587520
    buffer_load_dwordx4 v[220:223], v46, s[72:75], s37 offen

    s_waitcnt vmcnt(35)
    ds_write_b128 v47, v[80:83] offset:0

    s_waitcnt vmcnt(34)
    ds_write_b128 v47, v[84:87] offset:4096

    s_waitcnt vmcnt(33)
    ds_write_b128 v47, v[88:91] offset:8192

    s_waitcnt vmcnt(32)
    ds_write_b128 v47, v[92:95] offset:12288

    s_waitcnt vmcnt(31)
    ds_write_b128 v47, v[96:99] offset:16384

    s_waitcnt vmcnt(30)
    ds_write_b128 v47, v[100:103] offset:20480

    s_waitcnt vmcnt(29)
    ds_write_b128 v47, v[104:107] offset:24576

    s_waitcnt vmcnt(28)
    ds_write_b128 v47, v[108:111] offset:28672

    s_waitcnt vmcnt(27)
    ds_write_b128 v47, v[112:115] offset:32768

    s_waitcnt vmcnt(26)
    ds_write_b128 v47, v[116:119] offset:36864

    s_waitcnt vmcnt(25)
    ds_write_b128 v47, v[120:123] offset:40960

    s_waitcnt vmcnt(24)
    ds_write_b128 v47, v[124:127] offset:45056

    s_waitcnt vmcnt(23)
    ds_write_b128 v47, v[128:131] offset:49152

    s_waitcnt vmcnt(22)
    ds_write_b128 v47, v[132:135] offset:53248

    s_waitcnt vmcnt(21)
    ds_write_b128 v47, v[136:139] offset:57344

    s_waitcnt vmcnt(20)
    ds_write_b128 v47, v[140:143] offset:61440

    s_waitcnt vmcnt(19)
    ds_write_b128 v48, v[144:147] offset:0

    s_waitcnt vmcnt(18)
    ds_write_b128 v48, v[148:151] offset:4096

    s_waitcnt vmcnt(17)
    ds_write_b128 v48, v[152:155] offset:8192

    s_waitcnt vmcnt(16)
    ds_write_b128 v48, v[156:159] offset:12288

    s_waitcnt vmcnt(15)
    ds_write_b128 v48, v[160:163] offset:16384

    s_waitcnt vmcnt(14)
    ds_write_b128 v48, v[164:167] offset:20480

    s_waitcnt vmcnt(13)
    ds_write_b128 v48, v[168:171] offset:24576

    s_waitcnt vmcnt(12)
    ds_write_b128 v48, v[172:175] offset:28672

    s_waitcnt vmcnt(11)
    ds_write_b128 v48, v[176:179] offset:32768

    s_waitcnt vmcnt(10)
    ds_write_b128 v48, v[180:183] offset:36864

    s_waitcnt vmcnt(9)
    ds_write_b128 v48, v[184:187] offset:40960

    s_waitcnt vmcnt(8)
    ds_write_b128 v48, v[188:191] offset:45056

    s_waitcnt vmcnt(7)
    ds_write_b128 v48, v[192:195] offset:49152

    s_waitcnt vmcnt(6)
    ds_write_b128 v48, v[196:199] offset:53248

    s_waitcnt vmcnt(5)
    ds_write_b128 v48, v[200:203] offset:57344

    s_waitcnt vmcnt(4)
    ds_write_b128 v48, v[204:207] offset:61440

    s_waitcnt vmcnt(3)
    ds_write_b128 v49, v[208:211] offset:0

    s_waitcnt vmcnt(2)
    ds_write_b128 v49, v[212:215] offset:4096

    s_waitcnt vmcnt(1)
    ds_write_b128 v49, v[216:219] offset:8192

    s_waitcnt vmcnt(0)
    ds_write_b128 v49, v[220:223] offset:12288

    s_waitcnt lgkmcnt(0)
    s_barrier
    s_mov_b32 s72, s10
    s_and_b32 s73, s11, 0xffff
    s_mov_b32 s74, 4718592
    s_mov_b32 s75, 0x00020000

    s_lshl_b32 s36, s20, 8
    s_add_u32 s37, s36, 0
    buffer_load_dwordx4 v[80:83], v46, s[72:75], s37 offen

    s_add_u32 s37, s36, 131072
    buffer_load_dwordx4 v[84:87], v46, s[72:75], s37 offen

    s_add_u32 s37, s36, 262144
    buffer_load_dwordx4 v[88:91], v46, s[72:75], s37 offen

    s_add_u32 s37, s36, 393216
    buffer_load_dwordx4 v[92:95], v46, s[72:75], s37 offen

    s_add_u32 s37, s36, 524288
    buffer_load_dwordx4 v[96:99], v46, s[72:75], s37 offen

    s_add_u32 s37, s36, 655360
    buffer_load_dwordx4 v[100:103], v46, s[72:75], s37 offen

    s_add_u32 s37, s36, 786432
    buffer_load_dwordx4 v[104:107], v46, s[72:75], s37 offen

    s_add_u32 s37, s36, 917504
    buffer_load_dwordx4 v[108:111], v46, s[72:75], s37 offen

    s_add_u32 s37, s36, 1048576
    buffer_load_dwordx4 v[112:115], v46, s[72:75], s37 offen

    s_add_u32 s37, s36, 1179648
    buffer_load_dwordx4 v[116:119], v46, s[72:75], s37 offen

    s_add_u32 s37, s36, 1310720
    buffer_load_dwordx4 v[120:123], v46, s[72:75], s37 offen

    s_add_u32 s37, s36, 1441792
    buffer_load_dwordx4 v[124:127], v46, s[72:75], s37 offen

    s_add_u32 s37, s36, 1572864
    buffer_load_dwordx4 v[128:131], v46, s[72:75], s37 offen

    s_add_u32 s37, s36, 1703936
    buffer_load_dwordx4 v[132:135], v46, s[72:75], s37 offen

    s_add_u32 s37, s36, 1835008
    buffer_load_dwordx4 v[136:139], v46, s[72:75], s37 offen

    s_add_u32 s37, s36, 1966080
    buffer_load_dwordx4 v[140:143], v46, s[72:75], s37 offen

    s_add_u32 s37, s36, 2097152
    buffer_load_dwordx4 v[144:147], v46, s[72:75], s37 offen

    s_add_u32 s37, s36, 2228224
    buffer_load_dwordx4 v[148:151], v46, s[72:75], s37 offen

    s_add_u32 s37, s36, 2359296
    buffer_load_dwordx4 v[152:155], v46, s[72:75], s37 offen

    s_add_u32 s37, s36, 2490368
    buffer_load_dwordx4 v[156:159], v46, s[72:75], s37 offen

    s_add_u32 s37, s36, 2621440
    buffer_load_dwordx4 v[160:163], v46, s[72:75], s37 offen

    s_add_u32 s37, s36, 2752512
    buffer_load_dwordx4 v[164:167], v46, s[72:75], s37 offen

    s_add_u32 s37, s36, 2883584
    buffer_load_dwordx4 v[168:171], v46, s[72:75], s37 offen

    s_add_u32 s37, s36, 3014656
    buffer_load_dwordx4 v[172:175], v46, s[72:75], s37 offen

    s_add_u32 s37, s36, 3145728
    buffer_load_dwordx4 v[176:179], v46, s[72:75], s37 offen

    s_add_u32 s37, s36, 3276800
    buffer_load_dwordx4 v[180:183], v46, s[72:75], s37 offen

    s_add_u32 s37, s36, 3407872
    buffer_load_dwordx4 v[184:187], v46, s[72:75], s37 offen

    s_add_u32 s37, s36, 3538944
    buffer_load_dwordx4 v[188:191], v46, s[72:75], s37 offen

    s_add_u32 s37, s36, 3670016
    buffer_load_dwordx4 v[192:195], v46, s[72:75], s37 offen

    s_add_u32 s37, s36, 3801088
    buffer_load_dwordx4 v[196:199], v46, s[72:75], s37 offen

    s_add_u32 s37, s36, 3932160
    buffer_load_dwordx4 v[200:203], v46, s[72:75], s37 offen

    s_add_u32 s37, s36, 4063232
    buffer_load_dwordx4 v[204:207], v46, s[72:75], s37 offen

    s_add_u32 s37, s36, 4194304
    buffer_load_dwordx4 v[208:211], v46, s[72:75], s37 offen

    s_add_u32 s37, s36, 4325376
    buffer_load_dwordx4 v[212:215], v46, s[72:75], s37 offen

    s_add_u32 s37, s36, 4456448
    buffer_load_dwordx4 v[216:219], v46, s[72:75], s37 offen

    s_add_u32 s37, s36, 4587520
    buffer_load_dwordx4 v[220:223], v46, s[72:75], s37 offen

    ds_read_b64_tr_b16 a[0:1], v54 offset:0
    ds_read_b64_tr_b16 a[2:3], v54 offset:1024
    ds_read_b64_tr_b16 a[4:5], v54 offset:8192
    ds_read_b64_tr_b16 a[6:7], v54 offset:9216
    ds_read_b64_tr_b16 a[8:9], v54 offset:16384
    ds_read_b64_tr_b16 a[10:11], v54 offset:17408
    ds_read_b64_tr_b16 a[12:13], v54 offset:24576
    ds_read_b64_tr_b16 a[14:15], v54 offset:25600
    ds_read_b64_tr_b16 a[16:17], v54 offset:32768
    ds_read_b64_tr_b16 a[18:19], v54 offset:33792
    ds_read_b64_tr_b16 a[20:21], v54 offset:40960
    ds_read_b64_tr_b16 a[22:23], v54 offset:41984
    s_waitcnt lgkmcnt(0)
    ds_read_b64_tr_b16 a[24:25], v54 offset:49152
    ds_read_b64_tr_b16 a[26:27], v54 offset:50176
    ds_read_b64_tr_b16 a[28:29], v54 offset:57344
    ds_read_b64_tr_b16 a[30:31], v54 offset:58368
    ds_read_b64_tr_b16 a[32:33], v55 offset:0
    ds_read_b64_tr_b16 a[34:35], v55 offset:1024
    ds_read_b64_tr_b16 a[36:37], v55 offset:8192
    ds_read_b64_tr_b16 a[38:39], v55 offset:9216
    ds_read_b64_tr_b16 a[40:41], v55 offset:16384
    ds_read_b64_tr_b16 a[42:43], v55 offset:17408
    ds_read_b64_tr_b16 a[44:45], v55 offset:24576
    ds_read_b64_tr_b16 a[46:47], v55 offset:25600
    s_waitcnt lgkmcnt(0)
    ds_read_b64_tr_b16 a[48:49], v55 offset:32768
    ds_read_b64_tr_b16 a[50:51], v55 offset:33792
    ds_read_b64_tr_b16 a[52:53], v55 offset:40960
    ds_read_b64_tr_b16 a[54:55], v55 offset:41984
    ds_read_b64_tr_b16 a[56:57], v55 offset:49152
    ds_read_b64_tr_b16 a[58:59], v55 offset:50176
    ds_read_b64_tr_b16 a[60:61], v55 offset:57344
    ds_read_b64_tr_b16 a[62:63], v55 offset:58368
    ds_read_b64_tr_b16 a[64:65], v56 offset:0
    ds_read_b64_tr_b16 a[66:67], v56 offset:1024
    ds_read_b64_tr_b16 a[68:69], v56 offset:8192
    ds_read_b64_tr_b16 a[70:71], v56 offset:9216
    s_waitcnt lgkmcnt(0)
    ds_read_b64_tr_b16 a[72:73], v57 offset:0
    ds_read_b64_tr_b16 a[74:75], v57 offset:1024
    ds_read_b64_tr_b16 a[76:77], v57 offset:8192
    ds_read_b64_tr_b16 a[78:79], v57 offset:9216
    ds_read_b64_tr_b16 a[80:81], v57 offset:16384
    ds_read_b64_tr_b16 a[82:83], v57 offset:17408
    ds_read_b64_tr_b16 a[84:85], v57 offset:24576
    ds_read_b64_tr_b16 a[86:87], v57 offset:25600
    ds_read_b64_tr_b16 a[88:89], v57 offset:32768
    ds_read_b64_tr_b16 a[90:91], v57 offset:33792
    ds_read_b64_tr_b16 a[92:93], v57 offset:40960
    ds_read_b64_tr_b16 a[94:95], v57 offset:41984
    s_waitcnt lgkmcnt(0)
    ds_read_b64_tr_b16 a[96:97], v57 offset:49152
    ds_read_b64_tr_b16 a[98:99], v57 offset:50176
    ds_read_b64_tr_b16 a[100:101], v57 offset:57344
    ds_read_b64_tr_b16 a[102:103], v57 offset:58368
    ds_read_b64_tr_b16 a[104:105], v58 offset:0
    ds_read_b64_tr_b16 a[106:107], v58 offset:1024
    ds_read_b64_tr_b16 a[108:109], v58 offset:8192
    ds_read_b64_tr_b16 a[110:111], v58 offset:9216
    ds_read_b64_tr_b16 a[112:113], v58 offset:16384
    ds_read_b64_tr_b16 a[114:115], v58 offset:17408
    ds_read_b64_tr_b16 a[116:117], v58 offset:24576
    ds_read_b64_tr_b16 a[118:119], v58 offset:25600
    s_waitcnt lgkmcnt(0)
    ds_read_b64_tr_b16 a[120:121], v58 offset:32768
    ds_read_b64_tr_b16 a[122:123], v58 offset:33792
    ds_read_b64_tr_b16 a[124:125], v58 offset:40960
    ds_read_b64_tr_b16 a[126:127], v58 offset:41984
    ds_read_b64_tr_b16 a[128:129], v58 offset:49152
    ds_read_b64_tr_b16 a[130:131], v58 offset:50176
    ds_read_b64_tr_b16 a[132:133], v58 offset:57344
    ds_read_b64_tr_b16 a[134:135], v58 offset:58368
    ds_read_b64_tr_b16 a[136:137], v59 offset:0
    ds_read_b64_tr_b16 a[138:139], v59 offset:1024
    ds_read_b64_tr_b16 a[140:141], v59 offset:8192
    ds_read_b64_tr_b16 a[142:143], v59 offset:9216
    s_waitcnt lgkmcnt(0)
    s_waitcnt lgkmcnt(0)
    s_barrier
    s_waitcnt vmcnt(35)
    ds_write_b128 v47, v[80:83] offset:0

    s_waitcnt vmcnt(34)
    ds_write_b128 v47, v[84:87] offset:4096

    s_waitcnt vmcnt(33)
    ds_write_b128 v47, v[88:91] offset:8192

    s_waitcnt vmcnt(32)
    ds_write_b128 v47, v[92:95] offset:12288

    s_waitcnt vmcnt(31)
    ds_write_b128 v47, v[96:99] offset:16384

    s_waitcnt vmcnt(30)
    ds_write_b128 v47, v[100:103] offset:20480

    s_waitcnt vmcnt(29)
    ds_write_b128 v47, v[104:107] offset:24576

    s_waitcnt vmcnt(28)
    ds_write_b128 v47, v[108:111] offset:28672

    s_waitcnt vmcnt(27)
    ds_write_b128 v47, v[112:115] offset:32768

    s_waitcnt vmcnt(26)
    ds_write_b128 v47, v[116:119] offset:36864

    s_waitcnt vmcnt(25)
    ds_write_b128 v47, v[120:123] offset:40960

    s_waitcnt vmcnt(24)
    ds_write_b128 v47, v[124:127] offset:45056

    s_waitcnt vmcnt(23)
    ds_write_b128 v47, v[128:131] offset:49152

    s_waitcnt vmcnt(22)
    ds_write_b128 v47, v[132:135] offset:53248

    s_waitcnt vmcnt(21)
    ds_write_b128 v47, v[136:139] offset:57344

    s_waitcnt vmcnt(20)
    ds_write_b128 v47, v[140:143] offset:61440

    s_waitcnt vmcnt(19)
    ds_write_b128 v48, v[144:147] offset:0

    s_waitcnt vmcnt(18)
    ds_write_b128 v48, v[148:151] offset:4096

    s_waitcnt vmcnt(17)
    ds_write_b128 v48, v[152:155] offset:8192

    s_waitcnt vmcnt(16)
    ds_write_b128 v48, v[156:159] offset:12288

    s_waitcnt vmcnt(15)
    ds_write_b128 v48, v[160:163] offset:16384

    s_waitcnt vmcnt(14)
    ds_write_b128 v48, v[164:167] offset:20480

    s_waitcnt vmcnt(13)
    ds_write_b128 v48, v[168:171] offset:24576

    s_waitcnt vmcnt(12)
    ds_write_b128 v48, v[172:175] offset:28672

    s_waitcnt vmcnt(11)
    ds_write_b128 v48, v[176:179] offset:32768

    s_waitcnt vmcnt(10)
    ds_write_b128 v48, v[180:183] offset:36864

    s_waitcnt vmcnt(9)
    ds_write_b128 v48, v[184:187] offset:40960

    s_waitcnt vmcnt(8)
    ds_write_b128 v48, v[188:191] offset:45056

    s_waitcnt vmcnt(7)
    ds_write_b128 v48, v[192:195] offset:49152

    s_waitcnt vmcnt(6)
    ds_write_b128 v48, v[196:199] offset:53248

    s_waitcnt vmcnt(5)
    ds_write_b128 v48, v[200:203] offset:57344

    s_waitcnt vmcnt(4)
    ds_write_b128 v48, v[204:207] offset:61440

    s_waitcnt vmcnt(3)
    ds_write_b128 v49, v[208:211] offset:0

    s_waitcnt vmcnt(2)
    ds_write_b128 v49, v[212:215] offset:4096

    s_waitcnt vmcnt(1)
    ds_write_b128 v49, v[216:219] offset:8192

    s_waitcnt vmcnt(0)
    ds_write_b128 v49, v[220:223] offset:12288

    s_waitcnt lgkmcnt(0)
    s_barrier
    s_mov_b32 s72, s12
    s_and_b32 s73, s13, 0xffff
    s_mov_b32 s74, 4718592
    s_mov_b32 s75, 0x00020000

    s_lshl_b32 s36, s20, 8
    s_add_u32 s37, s36, 0
    buffer_load_dwordx4 v[112:115], v46, s[72:75], s37 offen

    s_add_u32 s37, s36, 131072
    buffer_load_dwordx4 v[116:119], v46, s[72:75], s37 offen

    s_add_u32 s37, s36, 262144
    buffer_load_dwordx4 v[120:123], v46, s[72:75], s37 offen

    s_add_u32 s37, s36, 393216
    buffer_load_dwordx4 v[124:127], v46, s[72:75], s37 offen

    s_add_u32 s37, s36, 524288
    buffer_load_dwordx4 v[128:131], v46, s[72:75], s37 offen

    s_add_u32 s37, s36, 655360
    buffer_load_dwordx4 v[132:135], v46, s[72:75], s37 offen

    s_add_u32 s37, s36, 786432
    buffer_load_dwordx4 v[136:139], v46, s[72:75], s37 offen

    s_add_u32 s37, s36, 917504
    buffer_load_dwordx4 v[140:143], v46, s[72:75], s37 offen

    s_add_u32 s37, s36, 1048576
    buffer_load_dwordx4 v[144:147], v46, s[72:75], s37 offen

    s_add_u32 s37, s36, 1179648
    buffer_load_dwordx4 v[148:151], v46, s[72:75], s37 offen

    s_add_u32 s37, s36, 1310720
    buffer_load_dwordx4 v[152:155], v46, s[72:75], s37 offen

    s_add_u32 s37, s36, 1441792
    buffer_load_dwordx4 v[156:159], v46, s[72:75], s37 offen

    s_add_u32 s37, s36, 1572864
    buffer_load_dwordx4 v[160:163], v46, s[72:75], s37 offen

    s_add_u32 s37, s36, 1703936
    buffer_load_dwordx4 v[164:167], v46, s[72:75], s37 offen

    s_add_u32 s37, s36, 1835008
    buffer_load_dwordx4 v[168:171], v46, s[72:75], s37 offen

    s_add_u32 s37, s36, 1966080
    buffer_load_dwordx4 v[172:175], v46, s[72:75], s37 offen

    s_add_u32 s37, s36, 2097152
    buffer_load_dwordx4 v[176:179], v46, s[72:75], s37 offen

    s_add_u32 s37, s36, 2228224
    buffer_load_dwordx4 v[180:183], v46, s[72:75], s37 offen

    s_add_u32 s37, s36, 2359296
    buffer_load_dwordx4 v[184:187], v46, s[72:75], s37 offen

    s_add_u32 s37, s36, 2490368
    buffer_load_dwordx4 v[188:191], v46, s[72:75], s37 offen

    s_add_u32 s37, s36, 2621440
    buffer_load_dwordx4 v[192:195], v46, s[72:75], s37 offen

    s_add_u32 s37, s36, 2752512
    buffer_load_dwordx4 v[196:199], v46, s[72:75], s37 offen

    s_add_u32 s37, s36, 2883584
    buffer_load_dwordx4 v[200:203], v46, s[72:75], s37 offen

    s_add_u32 s37, s36, 3014656
    buffer_load_dwordx4 v[204:207], v46, s[72:75], s37 offen

    s_add_u32 s37, s36, 3145728
    buffer_load_dwordx4 v[208:211], v46, s[72:75], s37 offen

    s_add_u32 s37, s36, 3276800
    buffer_load_dwordx4 v[212:215], v46, s[72:75], s37 offen

    s_add_u32 s37, s36, 3407872
    buffer_load_dwordx4 v[216:219], v46, s[72:75], s37 offen

    s_add_u32 s37, s36, 3538944
    buffer_load_dwordx4 v[220:223], v46, s[72:75], s37 offen

    s_add_u32 s37, s36, 3670016
    buffer_load_dwordx4 v[224:227], v46, s[72:75], s37 offen

    s_add_u32 s37, s36, 3801088
    buffer_load_dwordx4 v[228:231], v46, s[72:75], s37 offen

    s_add_u32 s37, s36, 3932160
    buffer_load_dwordx4 v[232:235], v46, s[72:75], s37 offen

    s_add_u32 s37, s36, 4063232
    buffer_load_dwordx4 v[236:239], v46, s[72:75], s37 offen

    s_add_u32 s37, s36, 4194304
    buffer_load_dwordx4 v[240:243], v46, s[72:75], s37 offen

    s_add_u32 s37, s36, 4325376
    buffer_load_dwordx4 v[244:247], v46, s[72:75], s37 offen

    s_add_u32 s37, s36, 4456448
    buffer_load_dwordx4 v[248:251], v46, s[72:75], s37 offen

    s_add_u32 s37, s36, 4587520
    buffer_load_dwordx4 v[252:255], v46, s[72:75], s37 offen

    ds_read_b64_tr_b16 a[144:145], v54 offset:0
    ds_read_b64_tr_b16 a[146:147], v54 offset:1024
    ds_read_b64_tr_b16 a[148:149], v54 offset:8192
    ds_read_b64_tr_b16 a[150:151], v54 offset:9216
    ds_read_b64_tr_b16 a[152:153], v54 offset:16384
    ds_read_b64_tr_b16 a[154:155], v54 offset:17408
    ds_read_b64_tr_b16 a[156:157], v54 offset:24576
    ds_read_b64_tr_b16 a[158:159], v54 offset:25600
    ds_read_b64_tr_b16 a[160:161], v54 offset:32768
    ds_read_b64_tr_b16 a[162:163], v54 offset:33792
    ds_read_b64_tr_b16 a[164:165], v54 offset:40960
    ds_read_b64_tr_b16 a[166:167], v54 offset:41984
    s_waitcnt lgkmcnt(0)
    ds_read_b64_tr_b16 a[168:169], v54 offset:49152
    ds_read_b64_tr_b16 a[170:171], v54 offset:50176
    ds_read_b64_tr_b16 a[172:173], v54 offset:57344
    ds_read_b64_tr_b16 a[174:175], v54 offset:58368
    ds_read_b64_tr_b16 a[176:177], v55 offset:0
    ds_read_b64_tr_b16 a[178:179], v55 offset:1024
    ds_read_b64_tr_b16 a[180:181], v55 offset:8192
    ds_read_b64_tr_b16 a[182:183], v55 offset:9216
    ds_read_b64_tr_b16 a[184:185], v55 offset:16384
    ds_read_b64_tr_b16 a[186:187], v55 offset:17408
    ds_read_b64_tr_b16 a[188:189], v55 offset:24576
    ds_read_b64_tr_b16 a[190:191], v55 offset:25600
    s_waitcnt lgkmcnt(0)
    ds_read_b64_tr_b16 a[192:193], v55 offset:32768
    ds_read_b64_tr_b16 a[194:195], v55 offset:33792
    ds_read_b64_tr_b16 a[196:197], v55 offset:40960
    ds_read_b64_tr_b16 a[198:199], v55 offset:41984
    ds_read_b64_tr_b16 a[200:201], v55 offset:49152
    ds_read_b64_tr_b16 a[202:203], v55 offset:50176
    ds_read_b64_tr_b16 a[204:205], v55 offset:57344
    ds_read_b64_tr_b16 a[206:207], v55 offset:58368
    ds_read_b64_tr_b16 a[208:209], v56 offset:0
    ds_read_b64_tr_b16 a[210:211], v56 offset:1024
    ds_read_b64_tr_b16 a[212:213], v56 offset:8192
    ds_read_b64_tr_b16 a[214:215], v56 offset:9216
    s_waitcnt lgkmcnt(0)
    ds_read_b64_tr_b16 a[216:217], v57 offset:0
    ds_read_b64_tr_b16 a[218:219], v57 offset:1024
    ds_read_b64_tr_b16 a[220:221], v57 offset:8192
    ds_read_b64_tr_b16 a[222:223], v57 offset:9216
    ds_read_b64_tr_b16 a[224:225], v57 offset:16384
    ds_read_b64_tr_b16 a[226:227], v57 offset:17408
    ds_read_b64_tr_b16 a[228:229], v57 offset:24576
    ds_read_b64_tr_b16 a[230:231], v57 offset:25600
    ds_read_b64_tr_b16 a[232:233], v57 offset:32768
    ds_read_b64_tr_b16 a[234:235], v57 offset:33792
    ds_read_b64_tr_b16 a[236:237], v57 offset:40960
    ds_read_b64_tr_b16 a[238:239], v57 offset:41984
    s_waitcnt lgkmcnt(0)
    ds_read_b64_tr_b16 a[240:241], v57 offset:49152
    ds_read_b64_tr_b16 a[242:243], v57 offset:50176
    ds_read_b64_tr_b16 a[244:245], v57 offset:57344
    ds_read_b64_tr_b16 a[246:247], v57 offset:58368
    ds_read_b64_tr_b16 a[248:249], v58 offset:0
    ds_read_b64_tr_b16 a[250:251], v58 offset:1024
    ds_read_b64_tr_b16 a[252:253], v58 offset:8192
    ds_read_b64_tr_b16 a[254:255], v58 offset:9216
    ds_read_b64_tr_b16 v[80:81], v58 offset:16384
    ds_read_b64_tr_b16 v[82:83], v58 offset:17408
    ds_read_b64_tr_b16 v[84:85], v58 offset:24576
    ds_read_b64_tr_b16 v[86:87], v58 offset:25600
    s_waitcnt lgkmcnt(0)
    ds_read_b64_tr_b16 v[88:89], v58 offset:32768
    ds_read_b64_tr_b16 v[90:91], v58 offset:33792
    ds_read_b64_tr_b16 v[92:93], v58 offset:40960
    ds_read_b64_tr_b16 v[94:95], v58 offset:41984
    ds_read_b64_tr_b16 v[96:97], v58 offset:49152
    ds_read_b64_tr_b16 v[98:99], v58 offset:50176
    ds_read_b64_tr_b16 v[100:101], v58 offset:57344
    ds_read_b64_tr_b16 v[102:103], v58 offset:58368
    ds_read_b64_tr_b16 v[104:105], v59 offset:0
    ds_read_b64_tr_b16 v[106:107], v59 offset:1024
    ds_read_b64_tr_b16 v[108:109], v59 offset:8192
    ds_read_b64_tr_b16 v[110:111], v59 offset:9216
    s_waitcnt lgkmcnt(0)
    s_waitcnt lgkmcnt(0)
    s_barrier
    s_waitcnt vmcnt(35)
    ds_write_b128 v47, v[112:115] offset:0

    s_waitcnt vmcnt(34)
    ds_write_b128 v47, v[116:119] offset:4096

    s_waitcnt vmcnt(33)
    ds_write_b128 v47, v[120:123] offset:8192

    s_waitcnt vmcnt(32)
    ds_write_b128 v47, v[124:127] offset:12288

    s_waitcnt vmcnt(31)
    ds_write_b128 v47, v[128:131] offset:16384

    s_waitcnt vmcnt(30)
    ds_write_b128 v47, v[132:135] offset:20480

    s_waitcnt vmcnt(29)
    ds_write_b128 v47, v[136:139] offset:24576

    s_waitcnt vmcnt(28)
    ds_write_b128 v47, v[140:143] offset:28672

    s_waitcnt vmcnt(27)
    ds_write_b128 v47, v[144:147] offset:32768

    s_waitcnt vmcnt(26)
    ds_write_b128 v47, v[148:151] offset:36864

    s_waitcnt vmcnt(25)
    ds_write_b128 v47, v[152:155] offset:40960

    s_waitcnt vmcnt(24)
    ds_write_b128 v47, v[156:159] offset:45056

    s_waitcnt vmcnt(23)
    ds_write_b128 v47, v[160:163] offset:49152

    s_waitcnt vmcnt(22)
    ds_write_b128 v47, v[164:167] offset:53248

    s_waitcnt vmcnt(21)
    ds_write_b128 v47, v[168:171] offset:57344

    s_waitcnt vmcnt(20)
    ds_write_b128 v47, v[172:175] offset:61440

    s_waitcnt vmcnt(19)
    ds_write_b128 v48, v[176:179] offset:0

    s_waitcnt vmcnt(18)
    ds_write_b128 v48, v[180:183] offset:4096

    s_waitcnt vmcnt(17)
    ds_write_b128 v48, v[184:187] offset:8192

    s_waitcnt vmcnt(16)
    ds_write_b128 v48, v[188:191] offset:12288

    s_waitcnt vmcnt(15)
    ds_write_b128 v48, v[192:195] offset:16384

    s_waitcnt vmcnt(14)
    ds_write_b128 v48, v[196:199] offset:20480

    s_waitcnt vmcnt(13)
    ds_write_b128 v48, v[200:203] offset:24576

    s_waitcnt vmcnt(12)
    ds_write_b128 v48, v[204:207] offset:28672

    s_waitcnt vmcnt(11)
    ds_write_b128 v48, v[208:211] offset:32768

    s_waitcnt vmcnt(10)
    ds_write_b128 v48, v[212:215] offset:36864

    s_waitcnt vmcnt(9)
    ds_write_b128 v48, v[216:219] offset:40960

    s_waitcnt vmcnt(8)
    ds_write_b128 v48, v[220:223] offset:45056

    s_waitcnt vmcnt(7)
    ds_write_b128 v48, v[224:227] offset:49152

    s_waitcnt vmcnt(6)
    ds_write_b128 v48, v[228:231] offset:53248

    s_waitcnt vmcnt(5)
    ds_write_b128 v48, v[232:235] offset:57344

    s_waitcnt vmcnt(4)
    ds_write_b128 v48, v[236:239] offset:61440

    s_waitcnt vmcnt(3)
    ds_write_b128 v49, v[240:243] offset:0

    s_waitcnt vmcnt(2)
    ds_write_b128 v49, v[244:247] offset:4096

    s_waitcnt vmcnt(1)
    ds_write_b128 v49, v[248:251] offset:8192

    s_waitcnt vmcnt(0)
    ds_write_b128 v49, v[252:255] offset:12288

    s_waitcnt lgkmcnt(0)
    s_barrier
    ds_read_b64_tr_b16 v[112:113], v54 offset:0
    ds_read_b64_tr_b16 v[114:115], v54 offset:1024
    ds_read_b64_tr_b16 v[116:117], v54 offset:8192
    ds_read_b64_tr_b16 v[118:119], v54 offset:9216
    ds_read_b64_tr_b16 v[120:121], v54 offset:16384
    ds_read_b64_tr_b16 v[122:123], v54 offset:17408
    ds_read_b64_tr_b16 v[124:125], v54 offset:24576
    ds_read_b64_tr_b16 v[126:127], v54 offset:25600
    ds_read_b64_tr_b16 v[128:129], v54 offset:32768
    ds_read_b64_tr_b16 v[130:131], v54 offset:33792
    ds_read_b64_tr_b16 v[132:133], v54 offset:40960
    ds_read_b64_tr_b16 v[134:135], v54 offset:41984
    s_waitcnt lgkmcnt(0)
    ds_read_b64_tr_b16 v[136:137], v54 offset:49152
    ds_read_b64_tr_b16 v[138:139], v54 offset:50176
    ds_read_b64_tr_b16 v[140:141], v54 offset:57344
    ds_read_b64_tr_b16 v[142:143], v54 offset:58368
    ds_read_b64_tr_b16 v[144:145], v55 offset:0
    ds_read_b64_tr_b16 v[146:147], v55 offset:1024
    ds_read_b64_tr_b16 v[148:149], v55 offset:8192
    ds_read_b64_tr_b16 v[150:151], v55 offset:9216
    ds_read_b64_tr_b16 v[152:153], v55 offset:16384
    ds_read_b64_tr_b16 v[154:155], v55 offset:17408
    ds_read_b64_tr_b16 v[156:157], v55 offset:24576
    ds_read_b64_tr_b16 v[158:159], v55 offset:25600
    s_waitcnt lgkmcnt(0)
    ds_read_b64_tr_b16 v[160:161], v55 offset:32768
    ds_read_b64_tr_b16 v[162:163], v55 offset:33792
    ds_read_b64_tr_b16 v[164:165], v55 offset:40960
    ds_read_b64_tr_b16 v[166:167], v55 offset:41984
    ds_read_b64_tr_b16 v[168:169], v55 offset:49152
    ds_read_b64_tr_b16 v[170:171], v55 offset:50176
    ds_read_b64_tr_b16 v[172:173], v55 offset:57344
    ds_read_b64_tr_b16 v[174:175], v55 offset:58368
    ds_read_b64_tr_b16 v[176:177], v56 offset:0
    ds_read_b64_tr_b16 v[178:179], v56 offset:1024
    ds_read_b64_tr_b16 v[180:181], v56 offset:8192
    ds_read_b64_tr_b16 v[182:183], v56 offset:9216
    s_waitcnt lgkmcnt(0)
    ds_read_b64_tr_b16 v[184:185], v57 offset:0
    ds_read_b64_tr_b16 v[186:187], v57 offset:1024
    ds_read_b64_tr_b16 v[188:189], v57 offset:8192
    ds_read_b64_tr_b16 v[190:191], v57 offset:9216
    ds_read_b64_tr_b16 v[192:193], v57 offset:16384
    ds_read_b64_tr_b16 v[194:195], v57 offset:17408
    ds_read_b64_tr_b16 v[196:197], v57 offset:24576
    ds_read_b64_tr_b16 v[198:199], v57 offset:25600
    ds_read_b64_tr_b16 v[200:201], v57 offset:32768
    ds_read_b64_tr_b16 v[202:203], v57 offset:33792
    ds_read_b64_tr_b16 v[204:205], v57 offset:40960
    ds_read_b64_tr_b16 v[206:207], v57 offset:41984
    s_waitcnt lgkmcnt(0)
    ds_read_b64_tr_b16 v[208:209], v57 offset:49152
    ds_read_b64_tr_b16 v[210:211], v57 offset:50176
    ds_read_b64_tr_b16 v[212:213], v57 offset:57344
    ds_read_b64_tr_b16 v[214:215], v57 offset:58368
    ds_read_b64_tr_b16 v[216:217], v58 offset:0
    ds_read_b64_tr_b16 v[218:219], v58 offset:1024
    ds_read_b64_tr_b16 v[220:221], v58 offset:8192
    ds_read_b64_tr_b16 v[222:223], v58 offset:9216
    ds_read_b64_tr_b16 v[224:225], v58 offset:16384
    ds_read_b64_tr_b16 v[226:227], v58 offset:17408
    ds_read_b64_tr_b16 v[228:229], v58 offset:24576
    ds_read_b64_tr_b16 v[230:231], v58 offset:25600
    s_waitcnt lgkmcnt(0)
    ds_read_b64_tr_b16 v[232:233], v58 offset:32768
    ds_read_b64_tr_b16 v[234:235], v58 offset:33792
    ds_read_b64_tr_b16 v[236:237], v58 offset:40960
    ds_read_b64_tr_b16 v[238:239], v58 offset:41984
    ds_read_b64_tr_b16 v[240:241], v58 offset:49152
    ds_read_b64_tr_b16 v[242:243], v58 offset:50176
    ds_read_b64_tr_b16 v[244:245], v58 offset:57344
    ds_read_b64_tr_b16 v[246:247], v58 offset:58368
    ds_read_b64_tr_b16 v[248:249], v59 offset:0
    ds_read_b64_tr_b16 v[250:251], v59 offset:1024
    ds_read_b64_tr_b16 v[252:253], v59 offset:8192
    ds_read_b64_tr_b16 v[254:255], v59 offset:9216
    s_waitcnt lgkmcnt(0)
    s_waitcnt lgkmcnt(0)
    s_barrier
    s_mov_b32 s72, s14
    s_and_b32 s73, s15, 0xffff
    s_mov_b32 s74, 4718592
    s_mov_b32 s75, 0x00020000

    s_mul_i32 s36, s20, 147456
    v_lshlrev_b32 v46, 4, v0
    s_mov_b32 s38, 58255

    s_add_u32 s37, s36, 0
    buffer_load_dwordx4 v[4:7], v46, s[72:75], s37 offen

    s_add_u32 s37, s36, 4096
    buffer_load_dwordx4 v[8:11], v46, s[72:75], s37 offen

    s_add_u32 s37, s36, 8192
    buffer_load_dwordx4 v[12:15], v46, s[72:75], s37 offen

    s_add_u32 s37, s36, 12288
    buffer_load_dwordx4 v[16:19], v46, s[72:75], s37 offen

    s_add_u32 s37, s36, 16384
    buffer_load_dwordx4 v[20:23], v46, s[72:75], s37 offen

    s_add_u32 s37, s36, 20480
    buffer_load_dwordx4 v[24:27], v46, s[72:75], s37 offen

    s_add_u32 s37, s36, 24576
    buffer_load_dwordx4 v[28:31], v46, s[72:75], s37 offen

    s_add_u32 s37, s36, 28672
    buffer_load_dwordx4 v[32:35], v46, s[72:75], s37 offen

    s_add_u32 s37, s36, 32768
    buffer_load_dwordx4 v[36:39], v46, s[72:75], s37 offen

    v_add_u32 v47, 0, v0
    v_mul_lo_u32 v48, v47, s38
    v_lshrrev_b32 v48, 22, v48
    v_mul_u32_u24 v49, 72, v48
    v_sub_u32 v47, v47, v49
    v_bfe_u32 v49, v48, 1, 1
    v_bfe_u32 v50, v48, 3, 1
    v_lshl_add_u32 v49, v50, 1, v49
    v_lshrrev_b32 v50, 1, v47
    v_xor_b32 v49, v49, v50
    v_lshlrev_b32 v49, 5, v49
    v_and_b32 v47, 1, v47
    v_lshl_add_u32 v49, v47, 4, v49
    v_mul_u32_u24 v48, 1152, v48
    v_add_u32 v49, v49, v48
    s_waitcnt vmcnt(8)
    ds_write_b128 v49, v[4:7]

    v_add_u32 v47, 256, v0
    v_mul_lo_u32 v48, v47, s38
    v_lshrrev_b32 v48, 22, v48
    v_mul_u32_u24 v49, 72, v48
    v_sub_u32 v47, v47, v49
    v_bfe_u32 v49, v48, 1, 1
    v_bfe_u32 v50, v48, 3, 1
    v_lshl_add_u32 v49, v50, 1, v49
    v_lshrrev_b32 v50, 1, v47
    v_xor_b32 v49, v49, v50
    v_lshlrev_b32 v49, 5, v49
    v_and_b32 v47, 1, v47
    v_lshl_add_u32 v49, v47, 4, v49
    v_mul_u32_u24 v48, 1152, v48
    v_add_u32 v49, v49, v48
    s_waitcnt vmcnt(7)
    ds_write_b128 v49, v[8:11]

    v_add_u32 v47, 512, v0
    v_mul_lo_u32 v48, v47, s38
    v_lshrrev_b32 v48, 22, v48
    v_mul_u32_u24 v49, 72, v48
    v_sub_u32 v47, v47, v49
    v_bfe_u32 v49, v48, 1, 1
    v_bfe_u32 v50, v48, 3, 1
    v_lshl_add_u32 v49, v50, 1, v49
    v_lshrrev_b32 v50, 1, v47
    v_xor_b32 v49, v49, v50
    v_lshlrev_b32 v49, 5, v49
    v_and_b32 v47, 1, v47
    v_lshl_add_u32 v49, v47, 4, v49
    v_mul_u32_u24 v48, 1152, v48
    v_add_u32 v49, v49, v48
    s_waitcnt vmcnt(6)
    ds_write_b128 v49, v[12:15]

    v_add_u32 v47, 768, v0
    v_mul_lo_u32 v48, v47, s38
    v_lshrrev_b32 v48, 22, v48
    v_mul_u32_u24 v49, 72, v48
    v_sub_u32 v47, v47, v49
    v_bfe_u32 v49, v48, 1, 1
    v_bfe_u32 v50, v48, 3, 1
    v_lshl_add_u32 v49, v50, 1, v49
    v_lshrrev_b32 v50, 1, v47
    v_xor_b32 v49, v49, v50
    v_lshlrev_b32 v49, 5, v49
    v_and_b32 v47, 1, v47
    v_lshl_add_u32 v49, v47, 4, v49
    v_mul_u32_u24 v48, 1152, v48
    v_add_u32 v49, v49, v48
    s_waitcnt vmcnt(5)
    ds_write_b128 v49, v[16:19]

    v_add_u32 v47, 1024, v0
    v_mul_lo_u32 v48, v47, s38
    v_lshrrev_b32 v48, 22, v48
    v_mul_u32_u24 v49, 72, v48
    v_sub_u32 v47, v47, v49
    v_bfe_u32 v49, v48, 1, 1
    v_bfe_u32 v50, v48, 3, 1
    v_lshl_add_u32 v49, v50, 1, v49
    v_lshrrev_b32 v50, 1, v47
    v_xor_b32 v49, v49, v50
    v_lshlrev_b32 v49, 5, v49
    v_and_b32 v47, 1, v47
    v_lshl_add_u32 v49, v47, 4, v49
    v_mul_u32_u24 v48, 1152, v48
    v_add_u32 v49, v49, v48
    s_waitcnt vmcnt(4)
    ds_write_b128 v49, v[20:23]

    v_add_u32 v47, 1280, v0
    v_mul_lo_u32 v48, v47, s38
    v_lshrrev_b32 v48, 22, v48
    v_mul_u32_u24 v49, 72, v48
    v_sub_u32 v47, v47, v49
    v_bfe_u32 v49, v48, 1, 1
    v_bfe_u32 v50, v48, 3, 1
    v_lshl_add_u32 v49, v50, 1, v49
    v_lshrrev_b32 v50, 1, v47
    v_xor_b32 v49, v49, v50
    v_lshlrev_b32 v49, 5, v49
    v_and_b32 v47, 1, v47
    v_lshl_add_u32 v49, v47, 4, v49
    v_mul_u32_u24 v48, 1152, v48
    v_add_u32 v49, v49, v48
    s_waitcnt vmcnt(3)
    ds_write_b128 v49, v[24:27]

    v_add_u32 v47, 1536, v0
    v_mul_lo_u32 v48, v47, s38
    v_lshrrev_b32 v48, 22, v48
    v_mul_u32_u24 v49, 72, v48
    v_sub_u32 v47, v47, v49
    v_bfe_u32 v49, v48, 1, 1
    v_bfe_u32 v50, v48, 3, 1
    v_lshl_add_u32 v49, v50, 1, v49
    v_lshrrev_b32 v50, 1, v47
    v_xor_b32 v49, v49, v50
    v_lshlrev_b32 v49, 5, v49
    v_and_b32 v47, 1, v47
    v_lshl_add_u32 v49, v47, 4, v49
    v_mul_u32_u24 v48, 1152, v48
    v_add_u32 v49, v49, v48
    s_waitcnt vmcnt(2)
    ds_write_b128 v49, v[28:31]

    v_add_u32 v47, 1792, v0
    v_mul_lo_u32 v48, v47, s38
    v_lshrrev_b32 v48, 22, v48
    v_mul_u32_u24 v49, 72, v48
    v_sub_u32 v47, v47, v49
    v_bfe_u32 v49, v48, 1, 1
    v_bfe_u32 v50, v48, 3, 1
    v_lshl_add_u32 v49, v50, 1, v49
    v_lshrrev_b32 v50, 1, v47
    v_xor_b32 v49, v49, v50
    v_lshlrev_b32 v49, 5, v49
    v_and_b32 v47, 1, v47
    v_lshl_add_u32 v49, v47, 4, v49
    v_mul_u32_u24 v48, 1152, v48
    v_add_u32 v49, v49, v48
    s_waitcnt vmcnt(1)
    ds_write_b128 v49, v[32:35]

    v_add_u32 v47, 2048, v0
    v_mul_lo_u32 v48, v47, s38
    v_lshrrev_b32 v48, 22, v48
    v_mul_u32_u24 v49, 72, v48
    v_sub_u32 v47, v47, v49
    v_bfe_u32 v49, v48, 1, 1
    v_bfe_u32 v50, v48, 3, 1
    v_lshl_add_u32 v49, v50, 1, v49
    v_lshrrev_b32 v50, 1, v47
    v_xor_b32 v49, v49, v50
    v_lshlrev_b32 v49, 5, v49
    v_and_b32 v47, 1, v47
    v_lshl_add_u32 v49, v47, 4, v49
    v_mul_u32_u24 v48, 1152, v48
    v_add_u32 v49, v49, v48
    s_waitcnt vmcnt(0)
    ds_write_b128 v49, v[36:39]

    s_add_u32 s37, s36, 36864
    buffer_load_dwordx4 v[4:7], v46, s[72:75], s37 offen

    s_add_u32 s37, s36, 40960
    buffer_load_dwordx4 v[8:11], v46, s[72:75], s37 offen

    s_add_u32 s37, s36, 45056
    buffer_load_dwordx4 v[12:15], v46, s[72:75], s37 offen

    s_add_u32 s37, s36, 49152
    buffer_load_dwordx4 v[16:19], v46, s[72:75], s37 offen

    s_add_u32 s37, s36, 53248
    buffer_load_dwordx4 v[20:23], v46, s[72:75], s37 offen

    s_add_u32 s37, s36, 57344
    buffer_load_dwordx4 v[24:27], v46, s[72:75], s37 offen

    s_add_u32 s37, s36, 61440
    buffer_load_dwordx4 v[28:31], v46, s[72:75], s37 offen

    s_add_u32 s37, s36, 65536
    buffer_load_dwordx4 v[32:35], v46, s[72:75], s37 offen

    s_add_u32 s37, s36, 69632
    buffer_load_dwordx4 v[36:39], v46, s[72:75], s37 offen

    v_add_u32 v47, 2304, v0
    v_mul_lo_u32 v48, v47, s38
    v_lshrrev_b32 v48, 22, v48
    v_mul_u32_u24 v49, 72, v48
    v_sub_u32 v47, v47, v49
    v_bfe_u32 v49, v48, 1, 1
    v_bfe_u32 v50, v48, 3, 1
    v_lshl_add_u32 v49, v50, 1, v49
    v_lshrrev_b32 v50, 1, v47
    v_xor_b32 v49, v49, v50
    v_lshlrev_b32 v49, 5, v49
    v_and_b32 v47, 1, v47
    v_lshl_add_u32 v49, v47, 4, v49
    v_mul_u32_u24 v48, 1152, v48
    v_add_u32 v49, v49, v48
    s_waitcnt vmcnt(8)
    ds_write_b128 v49, v[4:7]

    v_add_u32 v47, 2560, v0
    v_mul_lo_u32 v48, v47, s38
    v_lshrrev_b32 v48, 22, v48
    v_mul_u32_u24 v49, 72, v48
    v_sub_u32 v47, v47, v49
    v_bfe_u32 v49, v48, 1, 1
    v_bfe_u32 v50, v48, 3, 1
    v_lshl_add_u32 v49, v50, 1, v49
    v_lshrrev_b32 v50, 1, v47
    v_xor_b32 v49, v49, v50
    v_lshlrev_b32 v49, 5, v49
    v_and_b32 v47, 1, v47
    v_lshl_add_u32 v49, v47, 4, v49
    v_mul_u32_u24 v48, 1152, v48
    v_add_u32 v49, v49, v48
    s_waitcnt vmcnt(7)
    ds_write_b128 v49, v[8:11]

    v_add_u32 v47, 2816, v0
    v_mul_lo_u32 v48, v47, s38
    v_lshrrev_b32 v48, 22, v48
    v_mul_u32_u24 v49, 72, v48
    v_sub_u32 v47, v47, v49
    v_bfe_u32 v49, v48, 1, 1
    v_bfe_u32 v50, v48, 3, 1
    v_lshl_add_u32 v49, v50, 1, v49
    v_lshrrev_b32 v50, 1, v47
    v_xor_b32 v49, v49, v50
    v_lshlrev_b32 v49, 5, v49
    v_and_b32 v47, 1, v47
    v_lshl_add_u32 v49, v47, 4, v49
    v_mul_u32_u24 v48, 1152, v48
    v_add_u32 v49, v49, v48
    s_waitcnt vmcnt(6)
    ds_write_b128 v49, v[12:15]

    v_add_u32 v47, 3072, v0
    v_mul_lo_u32 v48, v47, s38
    v_lshrrev_b32 v48, 22, v48
    v_mul_u32_u24 v49, 72, v48
    v_sub_u32 v47, v47, v49
    v_bfe_u32 v49, v48, 1, 1
    v_bfe_u32 v50, v48, 3, 1
    v_lshl_add_u32 v49, v50, 1, v49
    v_lshrrev_b32 v50, 1, v47
    v_xor_b32 v49, v49, v50
    v_lshlrev_b32 v49, 5, v49
    v_and_b32 v47, 1, v47
    v_lshl_add_u32 v49, v47, 4, v49
    v_mul_u32_u24 v48, 1152, v48
    v_add_u32 v49, v49, v48
    s_waitcnt vmcnt(5)
    ds_write_b128 v49, v[16:19]

    v_add_u32 v47, 3328, v0
    v_mul_lo_u32 v48, v47, s38
    v_lshrrev_b32 v48, 22, v48
    v_mul_u32_u24 v49, 72, v48
    v_sub_u32 v47, v47, v49
    v_bfe_u32 v49, v48, 1, 1
    v_bfe_u32 v50, v48, 3, 1
    v_lshl_add_u32 v49, v50, 1, v49
    v_lshrrev_b32 v50, 1, v47
    v_xor_b32 v49, v49, v50
    v_lshlrev_b32 v49, 5, v49
    v_and_b32 v47, 1, v47
    v_lshl_add_u32 v49, v47, 4, v49
    v_mul_u32_u24 v48, 1152, v48
    v_add_u32 v49, v49, v48
    s_waitcnt vmcnt(4)
    ds_write_b128 v49, v[20:23]

    v_add_u32 v47, 3584, v0
    v_mul_lo_u32 v48, v47, s38
    v_lshrrev_b32 v48, 22, v48
    v_mul_u32_u24 v49, 72, v48
    v_sub_u32 v47, v47, v49
    v_bfe_u32 v49, v48, 1, 1
    v_bfe_u32 v50, v48, 3, 1
    v_lshl_add_u32 v49, v50, 1, v49
    v_lshrrev_b32 v50, 1, v47
    v_xor_b32 v49, v49, v50
    v_lshlrev_b32 v49, 5, v49
    v_and_b32 v47, 1, v47
    v_lshl_add_u32 v49, v47, 4, v49
    v_mul_u32_u24 v48, 1152, v48
    v_add_u32 v49, v49, v48
    s_waitcnt vmcnt(3)
    ds_write_b128 v49, v[24:27]

    v_add_u32 v47, 3840, v0
    v_mul_lo_u32 v48, v47, s38
    v_lshrrev_b32 v48, 22, v48
    v_mul_u32_u24 v49, 72, v48
    v_sub_u32 v47, v47, v49
    v_bfe_u32 v49, v48, 1, 1
    v_bfe_u32 v50, v48, 3, 1
    v_lshl_add_u32 v49, v50, 1, v49
    v_lshrrev_b32 v50, 1, v47
    v_xor_b32 v49, v49, v50
    v_lshlrev_b32 v49, 5, v49
    v_and_b32 v47, 1, v47
    v_lshl_add_u32 v49, v47, 4, v49
    v_mul_u32_u24 v48, 1152, v48
    v_add_u32 v49, v49, v48
    s_waitcnt vmcnt(2)
    ds_write_b128 v49, v[28:31]

    v_add_u32 v47, 4096, v0
    v_mul_lo_u32 v48, v47, s38
    v_lshrrev_b32 v48, 22, v48
    v_mul_u32_u24 v49, 72, v48
    v_sub_u32 v47, v47, v49
    v_bfe_u32 v49, v48, 1, 1
    v_bfe_u32 v50, v48, 3, 1
    v_lshl_add_u32 v49, v50, 1, v49
    v_lshrrev_b32 v50, 1, v47
    v_xor_b32 v49, v49, v50
    v_lshlrev_b32 v49, 5, v49
    v_and_b32 v47, 1, v47
    v_lshl_add_u32 v49, v47, 4, v49
    v_mul_u32_u24 v48, 1152, v48
    v_add_u32 v49, v49, v48
    s_waitcnt vmcnt(1)
    ds_write_b128 v49, v[32:35]

    v_add_u32 v47, 4352, v0
    v_mul_lo_u32 v48, v47, s38
    v_lshrrev_b32 v48, 22, v48
    v_mul_u32_u24 v49, 72, v48
    v_sub_u32 v47, v47, v49
    v_bfe_u32 v49, v48, 1, 1
    v_bfe_u32 v50, v48, 3, 1
    v_lshl_add_u32 v49, v50, 1, v49
    v_lshrrev_b32 v50, 1, v47
    v_xor_b32 v49, v49, v50
    v_lshlrev_b32 v49, 5, v49
    v_and_b32 v47, 1, v47
    v_lshl_add_u32 v49, v47, 4, v49
    v_mul_u32_u24 v48, 1152, v48
    v_add_u32 v49, v49, v48
    s_waitcnt vmcnt(0)
    ds_write_b128 v49, v[36:39]

    s_add_u32 s37, s36, 73728
    buffer_load_dwordx4 v[4:7], v46, s[72:75], s37 offen

    s_add_u32 s37, s36, 77824
    buffer_load_dwordx4 v[8:11], v46, s[72:75], s37 offen

    s_add_u32 s37, s36, 81920
    buffer_load_dwordx4 v[12:15], v46, s[72:75], s37 offen

    s_add_u32 s37, s36, 86016
    buffer_load_dwordx4 v[16:19], v46, s[72:75], s37 offen

    s_add_u32 s37, s36, 90112
    buffer_load_dwordx4 v[20:23], v46, s[72:75], s37 offen

    s_add_u32 s37, s36, 94208
    buffer_load_dwordx4 v[24:27], v46, s[72:75], s37 offen

    s_add_u32 s37, s36, 98304
    buffer_load_dwordx4 v[28:31], v46, s[72:75], s37 offen

    s_add_u32 s37, s36, 102400
    buffer_load_dwordx4 v[32:35], v46, s[72:75], s37 offen

    s_add_u32 s37, s36, 106496
    buffer_load_dwordx4 v[36:39], v46, s[72:75], s37 offen

    v_add_u32 v47, 4608, v0
    v_mul_lo_u32 v48, v47, s38
    v_lshrrev_b32 v48, 22, v48
    v_mul_u32_u24 v49, 72, v48
    v_sub_u32 v47, v47, v49
    v_bfe_u32 v49, v48, 1, 1
    v_bfe_u32 v50, v48, 3, 1
    v_lshl_add_u32 v49, v50, 1, v49
    v_lshrrev_b32 v50, 1, v47
    v_xor_b32 v49, v49, v50
    v_lshlrev_b32 v49, 5, v49
    v_and_b32 v47, 1, v47
    v_lshl_add_u32 v49, v47, 4, v49
    v_mul_u32_u24 v48, 1152, v48
    v_add_u32 v49, v49, v48
    s_waitcnt vmcnt(8)
    ds_write_b128 v49, v[4:7]

    v_add_u32 v47, 4864, v0
    v_mul_lo_u32 v48, v47, s38
    v_lshrrev_b32 v48, 22, v48
    v_mul_u32_u24 v49, 72, v48
    v_sub_u32 v47, v47, v49
    v_bfe_u32 v49, v48, 1, 1
    v_bfe_u32 v50, v48, 3, 1
    v_lshl_add_u32 v49, v50, 1, v49
    v_lshrrev_b32 v50, 1, v47
    v_xor_b32 v49, v49, v50
    v_lshlrev_b32 v49, 5, v49
    v_and_b32 v47, 1, v47
    v_lshl_add_u32 v49, v47, 4, v49
    v_mul_u32_u24 v48, 1152, v48
    v_add_u32 v49, v49, v48
    s_waitcnt vmcnt(7)
    ds_write_b128 v49, v[8:11]

    v_add_u32 v47, 5120, v0
    v_mul_lo_u32 v48, v47, s38
    v_lshrrev_b32 v48, 22, v48
    v_mul_u32_u24 v49, 72, v48
    v_sub_u32 v47, v47, v49
    v_bfe_u32 v49, v48, 1, 1
    v_bfe_u32 v50, v48, 3, 1
    v_lshl_add_u32 v49, v50, 1, v49
    v_lshrrev_b32 v50, 1, v47
    v_xor_b32 v49, v49, v50
    v_lshlrev_b32 v49, 5, v49
    v_and_b32 v47, 1, v47
    v_lshl_add_u32 v49, v47, 4, v49
    v_mul_u32_u24 v48, 1152, v48
    v_add_u32 v49, v49, v48
    s_waitcnt vmcnt(6)
    ds_write_b128 v49, v[12:15]

    v_add_u32 v47, 5376, v0
    v_mul_lo_u32 v48, v47, s38
    v_lshrrev_b32 v48, 22, v48
    v_mul_u32_u24 v49, 72, v48
    v_sub_u32 v47, v47, v49
    v_bfe_u32 v49, v48, 1, 1
    v_bfe_u32 v50, v48, 3, 1
    v_lshl_add_u32 v49, v50, 1, v49
    v_lshrrev_b32 v50, 1, v47
    v_xor_b32 v49, v49, v50
    v_lshlrev_b32 v49, 5, v49
    v_and_b32 v47, 1, v47
    v_lshl_add_u32 v49, v47, 4, v49
    v_mul_u32_u24 v48, 1152, v48
    v_add_u32 v49, v49, v48
    s_waitcnt vmcnt(5)
    ds_write_b128 v49, v[16:19]

    v_add_u32 v47, 5632, v0
    v_mul_lo_u32 v48, v47, s38
    v_lshrrev_b32 v48, 22, v48
    v_mul_u32_u24 v49, 72, v48
    v_sub_u32 v47, v47, v49
    v_bfe_u32 v49, v48, 1, 1
    v_bfe_u32 v50, v48, 3, 1
    v_lshl_add_u32 v49, v50, 1, v49
    v_lshrrev_b32 v50, 1, v47
    v_xor_b32 v49, v49, v50
    v_lshlrev_b32 v49, 5, v49
    v_and_b32 v47, 1, v47
    v_lshl_add_u32 v49, v47, 4, v49
    v_mul_u32_u24 v48, 1152, v48
    v_add_u32 v49, v49, v48
    s_waitcnt vmcnt(4)
    ds_write_b128 v49, v[20:23]

    v_add_u32 v47, 5888, v0
    v_mul_lo_u32 v48, v47, s38
    v_lshrrev_b32 v48, 22, v48
    v_mul_u32_u24 v49, 72, v48
    v_sub_u32 v47, v47, v49
    v_bfe_u32 v49, v48, 1, 1
    v_bfe_u32 v50, v48, 3, 1
    v_lshl_add_u32 v49, v50, 1, v49
    v_lshrrev_b32 v50, 1, v47
    v_xor_b32 v49, v49, v50
    v_lshlrev_b32 v49, 5, v49
    v_and_b32 v47, 1, v47
    v_lshl_add_u32 v49, v47, 4, v49
    v_mul_u32_u24 v48, 1152, v48
    v_add_u32 v49, v49, v48
    s_waitcnt vmcnt(3)
    ds_write_b128 v49, v[24:27]

    v_add_u32 v47, 6144, v0
    v_mul_lo_u32 v48, v47, s38
    v_lshrrev_b32 v48, 22, v48
    v_mul_u32_u24 v49, 72, v48
    v_sub_u32 v47, v47, v49
    v_bfe_u32 v49, v48, 1, 1
    v_bfe_u32 v50, v48, 3, 1
    v_lshl_add_u32 v49, v50, 1, v49
    v_lshrrev_b32 v50, 1, v47
    v_xor_b32 v49, v49, v50
    v_lshlrev_b32 v49, 5, v49
    v_and_b32 v47, 1, v47
    v_lshl_add_u32 v49, v47, 4, v49
    v_mul_u32_u24 v48, 1152, v48
    v_add_u32 v49, v49, v48
    s_waitcnt vmcnt(2)
    ds_write_b128 v49, v[28:31]

    v_add_u32 v47, 6400, v0
    v_mul_lo_u32 v48, v47, s38
    v_lshrrev_b32 v48, 22, v48
    v_mul_u32_u24 v49, 72, v48
    v_sub_u32 v47, v47, v49
    v_bfe_u32 v49, v48, 1, 1
    v_bfe_u32 v50, v48, 3, 1
    v_lshl_add_u32 v49, v50, 1, v49
    v_lshrrev_b32 v50, 1, v47
    v_xor_b32 v49, v49, v50
    v_lshlrev_b32 v49, 5, v49
    v_and_b32 v47, 1, v47
    v_lshl_add_u32 v49, v47, 4, v49
    v_mul_u32_u24 v48, 1152, v48
    v_add_u32 v49, v49, v48
    s_waitcnt vmcnt(1)
    ds_write_b128 v49, v[32:35]

    v_add_u32 v47, 6656, v0
    v_mul_lo_u32 v48, v47, s38
    v_lshrrev_b32 v48, 22, v48
    v_mul_u32_u24 v49, 72, v48
    v_sub_u32 v47, v47, v49
    v_bfe_u32 v49, v48, 1, 1
    v_bfe_u32 v50, v48, 3, 1
    v_lshl_add_u32 v49, v50, 1, v49
    v_lshrrev_b32 v50, 1, v47
    v_xor_b32 v49, v49, v50
    v_lshlrev_b32 v49, 5, v49
    v_and_b32 v47, 1, v47
    v_lshl_add_u32 v49, v47, 4, v49
    v_mul_u32_u24 v48, 1152, v48
    v_add_u32 v49, v49, v48
    s_waitcnt vmcnt(0)
    ds_write_b128 v49, v[36:39]

    s_add_u32 s37, s36, 110592
    buffer_load_dwordx4 v[4:7], v46, s[72:75], s37 offen

    s_add_u32 s37, s36, 114688
    buffer_load_dwordx4 v[8:11], v46, s[72:75], s37 offen

    s_add_u32 s37, s36, 118784
    buffer_load_dwordx4 v[12:15], v46, s[72:75], s37 offen

    s_add_u32 s37, s36, 122880
    buffer_load_dwordx4 v[16:19], v46, s[72:75], s37 offen

    s_add_u32 s37, s36, 126976
    buffer_load_dwordx4 v[20:23], v46, s[72:75], s37 offen

    s_add_u32 s37, s36, 131072
    buffer_load_dwordx4 v[24:27], v46, s[72:75], s37 offen

    s_add_u32 s37, s36, 135168
    buffer_load_dwordx4 v[28:31], v46, s[72:75], s37 offen

    s_add_u32 s37, s36, 139264
    buffer_load_dwordx4 v[32:35], v46, s[72:75], s37 offen

    s_add_u32 s37, s36, 143360
    buffer_load_dwordx4 v[36:39], v46, s[72:75], s37 offen

    v_add_u32 v47, 6912, v0
    v_mul_lo_u32 v48, v47, s38
    v_lshrrev_b32 v48, 22, v48
    v_mul_u32_u24 v49, 72, v48
    v_sub_u32 v47, v47, v49
    v_bfe_u32 v49, v48, 1, 1
    v_bfe_u32 v50, v48, 3, 1
    v_lshl_add_u32 v49, v50, 1, v49
    v_lshrrev_b32 v50, 1, v47
    v_xor_b32 v49, v49, v50
    v_lshlrev_b32 v49, 5, v49
    v_and_b32 v47, 1, v47
    v_lshl_add_u32 v49, v47, 4, v49
    v_mul_u32_u24 v48, 1152, v48
    v_add_u32 v49, v49, v48
    s_waitcnt vmcnt(8)
    ds_write_b128 v49, v[4:7]

    v_add_u32 v47, 7168, v0
    v_mul_lo_u32 v48, v47, s38
    v_lshrrev_b32 v48, 22, v48
    v_mul_u32_u24 v49, 72, v48
    v_sub_u32 v47, v47, v49
    v_bfe_u32 v49, v48, 1, 1
    v_bfe_u32 v50, v48, 3, 1
    v_lshl_add_u32 v49, v50, 1, v49
    v_lshrrev_b32 v50, 1, v47
    v_xor_b32 v49, v49, v50
    v_lshlrev_b32 v49, 5, v49
    v_and_b32 v47, 1, v47
    v_lshl_add_u32 v49, v47, 4, v49
    v_mul_u32_u24 v48, 1152, v48
    v_add_u32 v49, v49, v48
    s_waitcnt vmcnt(7)
    ds_write_b128 v49, v[8:11]

    v_add_u32 v47, 7424, v0
    v_mul_lo_u32 v48, v47, s38
    v_lshrrev_b32 v48, 22, v48
    v_mul_u32_u24 v49, 72, v48
    v_sub_u32 v47, v47, v49
    v_bfe_u32 v49, v48, 1, 1
    v_bfe_u32 v50, v48, 3, 1
    v_lshl_add_u32 v49, v50, 1, v49
    v_lshrrev_b32 v50, 1, v47
    v_xor_b32 v49, v49, v50
    v_lshlrev_b32 v49, 5, v49
    v_and_b32 v47, 1, v47
    v_lshl_add_u32 v49, v47, 4, v49
    v_mul_u32_u24 v48, 1152, v48
    v_add_u32 v49, v49, v48
    s_waitcnt vmcnt(6)
    ds_write_b128 v49, v[12:15]

    v_add_u32 v47, 7680, v0
    v_mul_lo_u32 v48, v47, s38
    v_lshrrev_b32 v48, 22, v48
    v_mul_u32_u24 v49, 72, v48
    v_sub_u32 v47, v47, v49
    v_bfe_u32 v49, v48, 1, 1
    v_bfe_u32 v50, v48, 3, 1
    v_lshl_add_u32 v49, v50, 1, v49
    v_lshrrev_b32 v50, 1, v47
    v_xor_b32 v49, v49, v50
    v_lshlrev_b32 v49, 5, v49
    v_and_b32 v47, 1, v47
    v_lshl_add_u32 v49, v47, 4, v49
    v_mul_u32_u24 v48, 1152, v48
    v_add_u32 v49, v49, v48
    s_waitcnt vmcnt(5)
    ds_write_b128 v49, v[16:19]

    v_add_u32 v47, 7936, v0
    v_mul_lo_u32 v48, v47, s38
    v_lshrrev_b32 v48, 22, v48
    v_mul_u32_u24 v49, 72, v48
    v_sub_u32 v47, v47, v49
    v_bfe_u32 v49, v48, 1, 1
    v_bfe_u32 v50, v48, 3, 1
    v_lshl_add_u32 v49, v50, 1, v49
    v_lshrrev_b32 v50, 1, v47
    v_xor_b32 v49, v49, v50
    v_lshlrev_b32 v49, 5, v49
    v_and_b32 v47, 1, v47
    v_lshl_add_u32 v49, v47, 4, v49
    v_mul_u32_u24 v48, 1152, v48
    v_add_u32 v49, v49, v48
    s_waitcnt vmcnt(4)
    ds_write_b128 v49, v[20:23]

    v_add_u32 v47, 8192, v0
    v_mul_lo_u32 v48, v47, s38
    v_lshrrev_b32 v48, 22, v48
    v_mul_u32_u24 v49, 72, v48
    v_sub_u32 v47, v47, v49
    v_bfe_u32 v49, v48, 1, 1
    v_bfe_u32 v50, v48, 3, 1
    v_lshl_add_u32 v49, v50, 1, v49
    v_lshrrev_b32 v50, 1, v47
    v_xor_b32 v49, v49, v50
    v_lshlrev_b32 v49, 5, v49
    v_and_b32 v47, 1, v47
    v_lshl_add_u32 v49, v47, 4, v49
    v_mul_u32_u24 v48, 1152, v48
    v_add_u32 v49, v49, v48
    s_waitcnt vmcnt(3)
    ds_write_b128 v49, v[24:27]

    v_add_u32 v47, 8448, v0
    v_mul_lo_u32 v48, v47, s38
    v_lshrrev_b32 v48, 22, v48
    v_mul_u32_u24 v49, 72, v48
    v_sub_u32 v47, v47, v49
    v_bfe_u32 v49, v48, 1, 1
    v_bfe_u32 v50, v48, 3, 1
    v_lshl_add_u32 v49, v50, 1, v49
    v_lshrrev_b32 v50, 1, v47
    v_xor_b32 v49, v49, v50
    v_lshlrev_b32 v49, 5, v49
    v_and_b32 v47, 1, v47
    v_lshl_add_u32 v49, v47, 4, v49
    v_mul_u32_u24 v48, 1152, v48
    v_add_u32 v49, v49, v48
    s_waitcnt vmcnt(2)
    ds_write_b128 v49, v[28:31]

    v_add_u32 v47, 8704, v0
    v_mul_lo_u32 v48, v47, s38
    v_lshrrev_b32 v48, 22, v48
    v_mul_u32_u24 v49, 72, v48
    v_sub_u32 v47, v47, v49
    v_bfe_u32 v49, v48, 1, 1
    v_bfe_u32 v50, v48, 3, 1
    v_lshl_add_u32 v49, v50, 1, v49
    v_lshrrev_b32 v50, 1, v47
    v_xor_b32 v49, v49, v50
    v_lshlrev_b32 v49, 5, v49
    v_and_b32 v47, 1, v47
    v_lshl_add_u32 v49, v47, 4, v49
    v_mul_u32_u24 v48, 1152, v48
    v_add_u32 v49, v49, v48
    s_waitcnt vmcnt(1)
    ds_write_b128 v49, v[32:35]

    v_add_u32 v47, 8960, v0
    v_mul_lo_u32 v48, v47, s38
    v_lshrrev_b32 v48, 22, v48
    v_mul_u32_u24 v49, 72, v48
    v_sub_u32 v47, v47, v49
    v_bfe_u32 v49, v48, 1, 1
    v_bfe_u32 v50, v48, 3, 1
    v_lshl_add_u32 v49, v50, 1, v49
    v_lshrrev_b32 v50, 1, v47
    v_xor_b32 v49, v49, v50
    v_lshlrev_b32 v49, 5, v49
    v_and_b32 v47, 1, v47
    v_lshl_add_u32 v49, v47, 4, v49
    v_mul_u32_u24 v48, 1152, v48
    v_add_u32 v49, v49, v48
    s_waitcnt vmcnt(0)
    ds_write_b128 v49, v[36:39]

    s_waitcnt lgkmcnt(0)
    s_barrier
    v_lshrrev_b32 v45, 4, v74
    v_and_b32 v46, 15, v74
    v_lshrrev_b32 v47, 2, v46
    v_lshl_add_u32 v47, v45, 3, v47
    v_mul_u32_u24 v48, 1152, v47
    v_and_b32 v47, 3, v46
    v_lshl_add_u32 v48, v47, 3, v48
    v_lshrrev_b32 v47, 3, v46
    v_and_b32 v49, 1, v45
    v_lshl_add_u32 v49, v49, 1, v47
    s_mul_i32 s36, s21, 9
    s_mul_i32 s38, s21, 9216
    v_lshlrev_b32 v50, 4, v74
    v_add_u32 v50, s38, v50

    s_add_u32 s37, s36, 0
    v_xor_b32 v51, s37, v49
    v_lshl_add_u32 v51, v51, 5, v48
    v_add_u32 v51, 0, v51
    ds_read_b64_tr_b16 v[4:5], v51
    ds_read_b64_tr_b16 v[6:7], v51 offset:4608

    s_add_u32 s37, s36, 1
    v_xor_b32 v51, s37, v49
    v_lshl_add_u32 v51, v51, 5, v48
    v_add_u32 v51, 0, v51
    ds_read_b64_tr_b16 v[8:9], v51
    ds_read_b64_tr_b16 v[10:11], v51 offset:4608

    s_add_u32 s37, s36, 2
    v_xor_b32 v51, s37, v49
    v_lshl_add_u32 v51, v51, 5, v48
    v_add_u32 v51, 0, v51
    ds_read_b64_tr_b16 v[12:13], v51
    ds_read_b64_tr_b16 v[14:15], v51 offset:4608

    s_add_u32 s37, s36, 3
    v_xor_b32 v51, s37, v49
    v_lshl_add_u32 v51, v51, 5, v48
    v_add_u32 v51, 0, v51
    ds_read_b64_tr_b16 v[16:17], v51
    ds_read_b64_tr_b16 v[18:19], v51 offset:4608

    s_add_u32 s37, s36, 4
    v_xor_b32 v51, s37, v49
    v_lshl_add_u32 v51, v51, 5, v48
    v_add_u32 v51, 0, v51
    ds_read_b64_tr_b16 v[20:21], v51
    ds_read_b64_tr_b16 v[22:23], v51 offset:4608

    s_add_u32 s37, s36, 5
    v_xor_b32 v51, s37, v49
    v_lshl_add_u32 v51, v51, 5, v48
    v_add_u32 v51, 0, v51
    ds_read_b64_tr_b16 v[24:25], v51
    ds_read_b64_tr_b16 v[26:27], v51 offset:4608

    s_add_u32 s37, s36, 6
    v_xor_b32 v51, s37, v49
    v_lshl_add_u32 v51, v51, 5, v48
    v_add_u32 v51, 0, v51
    ds_read_b64_tr_b16 v[28:29], v51
    ds_read_b64_tr_b16 v[30:31], v51 offset:4608

    s_add_u32 s37, s36, 7
    v_xor_b32 v51, s37, v49
    v_lshl_add_u32 v51, v51, 5, v48
    v_add_u32 v51, 0, v51
    ds_read_b64_tr_b16 v[32:33], v51
    ds_read_b64_tr_b16 v[34:35], v51 offset:4608

    s_add_u32 s37, s36, 8
    v_xor_b32 v51, s37, v49
    v_lshl_add_u32 v51, v51, 5, v48
    v_add_u32 v51, 0, v51
    ds_read_b64_tr_b16 v[36:37], v51
    ds_read_b64_tr_b16 v[38:39], v51 offset:4608

    s_waitcnt lgkmcnt(0)
    s_barrier
    v_add_u32 v51, 0, v50

    ds_write_b128 v51, v[4:7] offset:0
    ds_write_b128 v51, v[8:11] offset:1024
    ds_write_b128 v51, v[12:15] offset:2048
    ds_write_b128 v51, v[16:19] offset:3072
    ds_write_b128 v51, v[20:23] offset:4096
    ds_write_b128 v51, v[24:27] offset:5120
    ds_write_b128 v51, v[28:31] offset:6144
    ds_write_b128 v51, v[32:35] offset:7168
    ds_write_b128 v51, v[36:39] offset:8192
    s_waitcnt lgkmcnt(0)
    s_barrier
    s_add_u32 s37, s36, 0
    v_xor_b32 v51, s37, v49
    v_lshl_add_u32 v51, v51, 5, v48
    v_add_u32 v51, 36864, v51
    ds_read_b64_tr_b16 v[4:5], v51
    ds_read_b64_tr_b16 v[6:7], v51 offset:4608

    s_add_u32 s37, s36, 1
    v_xor_b32 v51, s37, v49
    v_lshl_add_u32 v51, v51, 5, v48
    v_add_u32 v51, 36864, v51
    ds_read_b64_tr_b16 v[8:9], v51
    ds_read_b64_tr_b16 v[10:11], v51 offset:4608

    s_add_u32 s37, s36, 2
    v_xor_b32 v51, s37, v49
    v_lshl_add_u32 v51, v51, 5, v48
    v_add_u32 v51, 36864, v51
    ds_read_b64_tr_b16 v[12:13], v51
    ds_read_b64_tr_b16 v[14:15], v51 offset:4608

    s_add_u32 s37, s36, 3
    v_xor_b32 v51, s37, v49
    v_lshl_add_u32 v51, v51, 5, v48
    v_add_u32 v51, 36864, v51
    ds_read_b64_tr_b16 v[16:17], v51
    ds_read_b64_tr_b16 v[18:19], v51 offset:4608

    s_add_u32 s37, s36, 4
    v_xor_b32 v51, s37, v49
    v_lshl_add_u32 v51, v51, 5, v48
    v_add_u32 v51, 36864, v51
    ds_read_b64_tr_b16 v[20:21], v51
    ds_read_b64_tr_b16 v[22:23], v51 offset:4608

    s_add_u32 s37, s36, 5
    v_xor_b32 v51, s37, v49
    v_lshl_add_u32 v51, v51, 5, v48
    v_add_u32 v51, 36864, v51
    ds_read_b64_tr_b16 v[24:25], v51
    ds_read_b64_tr_b16 v[26:27], v51 offset:4608

    s_add_u32 s37, s36, 6
    v_xor_b32 v51, s37, v49
    v_lshl_add_u32 v51, v51, 5, v48
    v_add_u32 v51, 36864, v51
    ds_read_b64_tr_b16 v[28:29], v51
    ds_read_b64_tr_b16 v[30:31], v51 offset:4608

    s_add_u32 s37, s36, 7
    v_xor_b32 v51, s37, v49
    v_lshl_add_u32 v51, v51, 5, v48
    v_add_u32 v51, 36864, v51
    ds_read_b64_tr_b16 v[32:33], v51
    ds_read_b64_tr_b16 v[34:35], v51 offset:4608

    s_add_u32 s37, s36, 8
    v_xor_b32 v51, s37, v49
    v_lshl_add_u32 v51, v51, 5, v48
    v_add_u32 v51, 36864, v51
    ds_read_b64_tr_b16 v[36:37], v51
    ds_read_b64_tr_b16 v[38:39], v51 offset:4608

    s_waitcnt lgkmcnt(0)
    s_barrier
    v_add_u32 v51, 36864, v50

    ds_write_b128 v51, v[4:7] offset:0
    ds_write_b128 v51, v[8:11] offset:1024
    ds_write_b128 v51, v[12:15] offset:2048
    ds_write_b128 v51, v[16:19] offset:3072
    ds_write_b128 v51, v[20:23] offset:4096
    ds_write_b128 v51, v[24:27] offset:5120
    ds_write_b128 v51, v[28:31] offset:6144
    ds_write_b128 v51, v[32:35] offset:7168
    ds_write_b128 v51, v[36:39] offset:8192
    s_waitcnt lgkmcnt(0)
    s_barrier
    s_add_u32 s37, s36, 0
    v_xor_b32 v51, s37, v49
    v_lshl_add_u32 v51, v51, 5, v48
    v_add_u32 v51, 73728, v51
    ds_read_b64_tr_b16 v[4:5], v51
    ds_read_b64_tr_b16 v[6:7], v51 offset:4608

    s_add_u32 s37, s36, 1
    v_xor_b32 v51, s37, v49
    v_lshl_add_u32 v51, v51, 5, v48
    v_add_u32 v51, 73728, v51
    ds_read_b64_tr_b16 v[8:9], v51
    ds_read_b64_tr_b16 v[10:11], v51 offset:4608

    s_add_u32 s37, s36, 2
    v_xor_b32 v51, s37, v49
    v_lshl_add_u32 v51, v51, 5, v48
    v_add_u32 v51, 73728, v51
    ds_read_b64_tr_b16 v[12:13], v51
    ds_read_b64_tr_b16 v[14:15], v51 offset:4608

    s_add_u32 s37, s36, 3
    v_xor_b32 v51, s37, v49
    v_lshl_add_u32 v51, v51, 5, v48
    v_add_u32 v51, 73728, v51
    ds_read_b64_tr_b16 v[16:17], v51
    ds_read_b64_tr_b16 v[18:19], v51 offset:4608

    s_add_u32 s37, s36, 4
    v_xor_b32 v51, s37, v49
    v_lshl_add_u32 v51, v51, 5, v48
    v_add_u32 v51, 73728, v51
    ds_read_b64_tr_b16 v[20:21], v51
    ds_read_b64_tr_b16 v[22:23], v51 offset:4608

    s_add_u32 s37, s36, 5
    v_xor_b32 v51, s37, v49
    v_lshl_add_u32 v51, v51, 5, v48
    v_add_u32 v51, 73728, v51
    ds_read_b64_tr_b16 v[24:25], v51
    ds_read_b64_tr_b16 v[26:27], v51 offset:4608

    s_add_u32 s37, s36, 6
    v_xor_b32 v51, s37, v49
    v_lshl_add_u32 v51, v51, 5, v48
    v_add_u32 v51, 73728, v51
    ds_read_b64_tr_b16 v[28:29], v51
    ds_read_b64_tr_b16 v[30:31], v51 offset:4608

    s_add_u32 s37, s36, 7
    v_xor_b32 v51, s37, v49
    v_lshl_add_u32 v51, v51, 5, v48
    v_add_u32 v51, 73728, v51
    ds_read_b64_tr_b16 v[32:33], v51
    ds_read_b64_tr_b16 v[34:35], v51 offset:4608

    s_add_u32 s37, s36, 8
    v_xor_b32 v51, s37, v49
    v_lshl_add_u32 v51, v51, 5, v48
    v_add_u32 v51, 73728, v51
    ds_read_b64_tr_b16 v[36:37], v51
    ds_read_b64_tr_b16 v[38:39], v51 offset:4608

    s_waitcnt lgkmcnt(0)
    s_barrier
    v_add_u32 v51, 73728, v50

    ds_write_b128 v51, v[4:7] offset:0
    ds_write_b128 v51, v[8:11] offset:1024
    ds_write_b128 v51, v[12:15] offset:2048
    ds_write_b128 v51, v[16:19] offset:3072
    ds_write_b128 v51, v[20:23] offset:4096
    ds_write_b128 v51, v[24:27] offset:5120
    ds_write_b128 v51, v[28:31] offset:6144
    ds_write_b128 v51, v[32:35] offset:7168
    ds_write_b128 v51, v[36:39] offset:8192
    s_waitcnt lgkmcnt(0)
    s_barrier
    s_add_u32 s37, s36, 0
    v_xor_b32 v51, s37, v49
    v_lshl_add_u32 v51, v51, 5, v48
    v_add_u32 v51, 110592, v51
    ds_read_b64_tr_b16 v[4:5], v51
    ds_read_b64_tr_b16 v[6:7], v51 offset:4608

    s_add_u32 s37, s36, 1
    v_xor_b32 v51, s37, v49
    v_lshl_add_u32 v51, v51, 5, v48
    v_add_u32 v51, 110592, v51
    ds_read_b64_tr_b16 v[8:9], v51
    ds_read_b64_tr_b16 v[10:11], v51 offset:4608

    s_add_u32 s37, s36, 2
    v_xor_b32 v51, s37, v49
    v_lshl_add_u32 v51, v51, 5, v48
    v_add_u32 v51, 110592, v51
    ds_read_b64_tr_b16 v[12:13], v51
    ds_read_b64_tr_b16 v[14:15], v51 offset:4608

    s_add_u32 s37, s36, 3
    v_xor_b32 v51, s37, v49
    v_lshl_add_u32 v51, v51, 5, v48
    v_add_u32 v51, 110592, v51
    ds_read_b64_tr_b16 v[16:17], v51
    ds_read_b64_tr_b16 v[18:19], v51 offset:4608

    s_add_u32 s37, s36, 4
    v_xor_b32 v51, s37, v49
    v_lshl_add_u32 v51, v51, 5, v48
    v_add_u32 v51, 110592, v51
    ds_read_b64_tr_b16 v[20:21], v51
    ds_read_b64_tr_b16 v[22:23], v51 offset:4608

    s_add_u32 s37, s36, 5
    v_xor_b32 v51, s37, v49
    v_lshl_add_u32 v51, v51, 5, v48
    v_add_u32 v51, 110592, v51
    ds_read_b64_tr_b16 v[24:25], v51
    ds_read_b64_tr_b16 v[26:27], v51 offset:4608

    s_add_u32 s37, s36, 6
    v_xor_b32 v51, s37, v49
    v_lshl_add_u32 v51, v51, 5, v48
    v_add_u32 v51, 110592, v51
    ds_read_b64_tr_b16 v[28:29], v51
    ds_read_b64_tr_b16 v[30:31], v51 offset:4608

    s_add_u32 s37, s36, 7
    v_xor_b32 v51, s37, v49
    v_lshl_add_u32 v51, v51, 5, v48
    v_add_u32 v51, 110592, v51
    ds_read_b64_tr_b16 v[32:33], v51
    ds_read_b64_tr_b16 v[34:35], v51 offset:4608

    s_add_u32 s37, s36, 8
    v_xor_b32 v51, s37, v49
    v_lshl_add_u32 v51, v51, 5, v48
    v_add_u32 v51, 110592, v51
    ds_read_b64_tr_b16 v[36:37], v51
    ds_read_b64_tr_b16 v[38:39], v51 offset:4608

    s_waitcnt lgkmcnt(0)
    s_barrier
    v_add_u32 v51, 110592, v50

    ds_write_b128 v51, v[4:7] offset:0
    ds_write_b128 v51, v[8:11] offset:1024
    ds_write_b128 v51, v[12:15] offset:2048
    ds_write_b128 v51, v[16:19] offset:3072
    ds_write_b128 v51, v[20:23] offset:4096
    ds_write_b128 v51, v[24:27] offset:5120
    ds_write_b128 v51, v[28:31] offset:6144
    ds_write_b128 v51, v[32:35] offset:7168
    ds_write_b128 v51, v[36:39] offset:8192
    s_waitcnt lgkmcnt(0)
    s_barrier
    v_and_b32 v44, 7, v0
    v_bfe_u32 v45, v0, 4, 2
    v_and_b32 v46, 15, v0
    v_mul_u32_u24 v1, 1184, v44
    v_lshl_add_u32 v1, v45, 4, v1
    v_add_u32 v1, 147456, v1
    v_mul_u32_u24 v3, 272, v44
    v_lshl_add_u32 v3, v45, 4, v3
    v_add_u32 v3, 156928, v3
    v_mul_u32_u24 v2, 272, v46
    v_lshl_add_u32 v2, v45, 3, v2
    s_lshl_b32 s34, s21, 6
    s_add_u32 s34, s34, 156928
    v_add_u32 v2, s34, v2
    s_mov_b32 s22, 0

    s_mov_b32 s72, s16
    s_and_b32 s73, s17, 0xffff
    s_mov_b32 s74, 9216
    s_mov_b32 s75, 0x00020000

    v_add_u32 v44, 0, v0
    s_mov_b32 s34, 58255
    v_mul_lo_u32 v45, v44, s34
    v_lshrrev_b32 v45, 22, v45
    v_mul_u32_u24 v46, 72, v45
    v_sub_u32 v46, v44, v46
    v_mul_u32_u24 v45, 1184, v45
    v_lshl_add_u32 v45, v46, 4, v45
    v_add_u32 v45, 147456, v45
    v_lshlrev_b32 v46, 4, v44
    v_cmp_gt_u32 vcc, 576, v44
    s_and_saveexec_b64 s[76:77], vcc
    buffer_load_dwordx4 v[48:51], v46, s[72:75], 0 offen
    s_waitcnt vmcnt(0)
    ds_write_b128 v45, v[48:51]
    s_mov_b64 exec, s[76:77]

    v_add_u32 v44, 256, v0
    s_mov_b32 s34, 58255
    v_mul_lo_u32 v45, v44, s34
    v_lshrrev_b32 v45, 22, v45
    v_mul_u32_u24 v46, 72, v45
    v_sub_u32 v46, v44, v46
    v_mul_u32_u24 v45, 1184, v45
    v_lshl_add_u32 v45, v46, 4, v45
    v_add_u32 v45, 147456, v45
    v_lshlrev_b32 v46, 4, v44
    v_cmp_gt_u32 vcc, 576, v44
    s_and_saveexec_b64 s[76:77], vcc
    buffer_load_dwordx4 v[48:51], v46, s[72:75], 0 offen
    s_waitcnt vmcnt(0)
    ds_write_b128 v45, v[48:51]
    s_mov_b64 exec, s[76:77]

    v_add_u32 v44, 512, v0
    s_mov_b32 s34, 58255
    v_mul_lo_u32 v45, v44, s34
    v_lshrrev_b32 v45, 22, v45
    v_mul_u32_u24 v46, 72, v45
    v_sub_u32 v46, v44, v46
    v_mul_u32_u24 v45, 1184, v45
    v_lshl_add_u32 v45, v46, 4, v45
    v_add_u32 v45, 147456, v45
    v_lshlrev_b32 v46, 4, v44
    v_cmp_gt_u32 vcc, 576, v44
    s_and_saveexec_b64 s[76:77], vcc
    buffer_load_dwordx4 v[48:51], v46, s[72:75], 0 offen
    s_waitcnt vmcnt(0)
    ds_write_b128 v45, v[48:51]
    s_mov_b64 exec, s[76:77]

    s_and_b32 s34, s22, 3
    s_cmp_lg_u32 s34, 0
    s_cbranch_scc1 L_nokvwait_35
    s_lshr_b32 s34, s22, 2
    s_add_u32 s34, s34, 16
    s_lshl_b32 s34, s34, 5
    s_add_u32 s34, s34, s20
    s_lshl_b32 s34, s34, 2
    v_and_b32 v76, 1, v0
    v_lshlrev_b32 v76, 11, v76
    s_mov_b32 s32, 0

L_kvwait_36:
    buffer_load_dword v77, v76, s[96:99], s34 offen sc1
    s_add_u32 s32, s32, 1
    s_waitcnt vmcnt(0)
    v_cmp_eq_u32 vcc, 0, v77
    s_cmp_gt_u32 s32, 100000
    s_cbranch_scc1 L_nokvwait_35
    s_cbranch_vccnz L_kvwait_36

L_nokvwait_35:
    v_and_b32 v76, 15, v0
    v_bfe_u32 v77, v0, 4, 2
    v_lshlrev_b32 v78, 13, v76
    v_lshl_add_u32 v78, v77, 4, v78
    s_lshl_b32 s17, s22, 18
    s_lshl_b32 s18, s20, 8
    s_add_u32 s17, s17, s18
    s_add_u32 s18, s17, 131072
    v_lshlrev_b32 v79, 6, v76
    v_lshl_add_u32 v79, v77, 3, v79
    s_lshl_b32 s19, s21, 11
    v_add_u32 v79, s19, v79
    s_lshl_b32 s19, s22, 5
    s_add_u32 s19, s19, s20
    s_lshl_b32 s19, s19, 13

    buffer_load_dwordx4 v[4:7], v78, s[48:51], s17 offen offset:0
    buffer_load_dwordx4 v[20:23], v78, s[48:51], s18 offen offset:0
    buffer_load_dwordx4 v[8:11], v78, s[48:51], s17 offen offset:64
    buffer_load_dwordx4 v[24:27], v78, s[48:51], s18 offen offset:64
    buffer_load_dwordx4 v[12:15], v78, s[48:51], s17 offen offset:128
    buffer_load_dwordx4 v[28:31], v78, s[48:51], s18 offen offset:128
    buffer_load_dwordx4 v[16:19], v78, s[48:51], s17 offen offset:192
    buffer_load_dwordx4 v[32:35], v78, s[48:51], s18 offen offset:192
    buffer_load_dwordx2 v[36:37], v79, s[52:55], s19 offen offset:0
    buffer_load_dwordx2 v[38:39], v79, s[52:55], s19 offen offset:32
    buffer_load_dwordx2 v[40:41], v79, s[52:55], s19 offen offset:1024
    buffer_load_dwordx2 v[42:43], v79, s[52:55], s19 offen offset:1056
    s_waitcnt lgkmcnt(0)
    s_barrier
L_step_33:
    ds_read_b128 v[60:63], v1 offset:0
    ds_read_b128 v[64:67], v1 offset:64
    ds_read_b128 v[68:71], v1 offset:128
    ds_read_b128 v[72:75], v1 offset:192
    s_waitcnt lgkmcnt(3)
    v_mfma_f32_16x16x32_bf16 v[44:47], a[0:3], v[60:63], 0
    v_mfma_f32_16x16x32_bf16 v[48:51], a[72:75], v[60:63], 0
    v_mfma_f32_16x16x32_bf16 v[52:55], a[144:147], v[60:63], 0
    v_mfma_f32_16x16x32_bf16 v[56:59], a[216:219], v[60:63], 0
    ds_read_b128 v[60:63], v1 offset:256
    s_waitcnt lgkmcnt(3)
    v_mfma_f32_16x16x32_bf16 v[44:47], a[4:7], v[64:67], v[44:47]
    v_mfma_f32_16x16x32_bf16 v[48:51], a[76:79], v[64:67], v[48:51]
    v_mfma_f32_16x16x32_bf16 v[52:55], a[148:151], v[64:67], v[52:55]
    v_mfma_f32_16x16x32_bf16 v[56:59], a[220:223], v[64:67], v[56:59]
    ds_read_b128 v[64:67], v1 offset:320
    s_waitcnt lgkmcnt(3)
    v_mfma_f32_16x16x32_bf16 v[44:47], a[8:11], v[68:71], v[44:47]
    v_mfma_f32_16x16x32_bf16 v[48:51], a[80:83], v[68:71], v[48:51]
    v_mfma_f32_16x16x32_bf16 v[52:55], a[152:155], v[68:71], v[52:55]
    v_mfma_f32_16x16x32_bf16 v[56:59], a[224:227], v[68:71], v[56:59]
    ds_read_b128 v[68:71], v1 offset:384
    s_waitcnt lgkmcnt(3)
    v_mfma_f32_16x16x32_bf16 v[44:47], a[12:15], v[72:75], v[44:47]
    v_mfma_f32_16x16x32_bf16 v[48:51], a[84:87], v[72:75], v[48:51]
    v_mfma_f32_16x16x32_bf16 v[52:55], a[156:159], v[72:75], v[52:55]
    v_mfma_f32_16x16x32_bf16 v[56:59], a[228:231], v[72:75], v[56:59]
    ds_read_b128 v[72:75], v1 offset:448
    s_waitcnt lgkmcnt(3)
    v_mfma_f32_16x16x32_bf16 v[44:47], a[16:19], v[60:63], v[44:47]
    v_mfma_f32_16x16x32_bf16 v[48:51], a[88:91], v[60:63], v[48:51]
    v_mfma_f32_16x16x32_bf16 v[52:55], a[160:163], v[60:63], v[52:55]
    v_mfma_f32_16x16x32_bf16 v[56:59], a[232:235], v[60:63], v[56:59]
    ds_read_b128 v[60:63], v1 offset:512
    s_waitcnt lgkmcnt(3)
    v_mfma_f32_16x16x32_bf16 v[44:47], a[20:23], v[64:67], v[44:47]
    v_mfma_f32_16x16x32_bf16 v[48:51], a[92:95], v[64:67], v[48:51]
    v_mfma_f32_16x16x32_bf16 v[52:55], a[164:167], v[64:67], v[52:55]
    v_mfma_f32_16x16x32_bf16 v[56:59], a[236:239], v[64:67], v[56:59]
    ds_read_b128 v[64:67], v1 offset:576
    s_waitcnt lgkmcnt(3)
    v_mfma_f32_16x16x32_bf16 v[44:47], a[24:27], v[68:71], v[44:47]
    v_mfma_f32_16x16x32_bf16 v[48:51], a[96:99], v[68:71], v[48:51]
    v_mfma_f32_16x16x32_bf16 v[52:55], a[168:171], v[68:71], v[52:55]
    v_mfma_f32_16x16x32_bf16 v[56:59], a[240:243], v[68:71], v[56:59]
    ds_read_b128 v[68:71], v1 offset:640
    s_waitcnt lgkmcnt(3)
    v_mfma_f32_16x16x32_bf16 v[44:47], a[28:31], v[72:75], v[44:47]
    v_mfma_f32_16x16x32_bf16 v[48:51], a[100:103], v[72:75], v[48:51]
    v_mfma_f32_16x16x32_bf16 v[52:55], a[172:175], v[72:75], v[52:55]
    v_mfma_f32_16x16x32_bf16 v[56:59], a[244:247], v[72:75], v[56:59]
    ds_read_b128 v[72:75], v1 offset:704
    s_waitcnt lgkmcnt(3)
    v_mfma_f32_16x16x32_bf16 v[44:47], a[32:35], v[60:63], v[44:47]
    v_mfma_f32_16x16x32_bf16 v[48:51], a[104:107], v[60:63], v[48:51]
    v_mfma_f32_16x16x32_bf16 v[52:55], a[176:179], v[60:63], v[52:55]
    v_mfma_f32_16x16x32_bf16 v[56:59], a[248:251], v[60:63], v[56:59]
    ds_read_b128 v[60:63], v1 offset:768
    s_waitcnt lgkmcnt(3)
    v_mfma_f32_16x16x32_bf16 v[44:47], a[36:39], v[64:67], v[44:47]
    v_mfma_f32_16x16x32_bf16 v[48:51], a[108:111], v[64:67], v[48:51]
    v_mfma_f32_16x16x32_bf16 v[52:55], a[180:183], v[64:67], v[52:55]
    v_mfma_f32_16x16x32_bf16 v[56:59], a[252:255], v[64:67], v[56:59]
    ds_read_b128 v[64:67], v1 offset:832
    s_waitcnt lgkmcnt(3)
    v_mfma_f32_16x16x32_bf16 v[44:47], a[40:43], v[68:71], v[44:47]
    v_mfma_f32_16x16x32_bf16 v[48:51], a[112:115], v[68:71], v[48:51]
    v_mfma_f32_16x16x32_bf16 v[52:55], a[184:187], v[68:71], v[52:55]
    v_mfma_f32_16x16x32_bf16 v[56:59], v[80:83], v[68:71], v[56:59]
    ds_read_b128 v[68:71], v1 offset:896
    s_waitcnt lgkmcnt(3)
    v_mfma_f32_16x16x32_bf16 v[44:47], a[44:47], v[72:75], v[44:47]
    v_mfma_f32_16x16x32_bf16 v[48:51], a[116:119], v[72:75], v[48:51]
    v_mfma_f32_16x16x32_bf16 v[52:55], a[188:191], v[72:75], v[52:55]
    v_mfma_f32_16x16x32_bf16 v[56:59], v[84:87], v[72:75], v[56:59]
    ds_read_b128 v[72:75], v1 offset:960
    s_waitcnt lgkmcnt(3)
    v_mfma_f32_16x16x32_bf16 v[44:47], a[48:51], v[60:63], v[44:47]
    v_mfma_f32_16x16x32_bf16 v[48:51], a[120:123], v[60:63], v[48:51]
    v_mfma_f32_16x16x32_bf16 v[52:55], a[192:195], v[60:63], v[52:55]
    v_mfma_f32_16x16x32_bf16 v[56:59], v[88:91], v[60:63], v[56:59]
    ds_read_b128 v[60:63], v1 offset:1024
    s_waitcnt lgkmcnt(3)
    v_mfma_f32_16x16x32_bf16 v[44:47], a[52:55], v[64:67], v[44:47]
    v_mfma_f32_16x16x32_bf16 v[48:51], a[124:127], v[64:67], v[48:51]
    v_mfma_f32_16x16x32_bf16 v[52:55], a[196:199], v[64:67], v[52:55]
    v_mfma_f32_16x16x32_bf16 v[56:59], v[92:95], v[64:67], v[56:59]
    ds_read_b128 v[64:67], v1 offset:1088
    s_waitcnt lgkmcnt(3)
    v_mfma_f32_16x16x32_bf16 v[44:47], a[56:59], v[68:71], v[44:47]
    v_mfma_f32_16x16x32_bf16 v[48:51], a[128:131], v[68:71], v[48:51]
    v_mfma_f32_16x16x32_bf16 v[52:55], a[200:203], v[68:71], v[52:55]
    v_mfma_f32_16x16x32_bf16 v[56:59], v[96:99], v[68:71], v[56:59]
    s_waitcnt lgkmcnt(2)
    v_mfma_f32_16x16x32_bf16 v[44:47], a[60:63], v[72:75], v[44:47]
    v_mfma_f32_16x16x32_bf16 v[48:51], a[132:135], v[72:75], v[48:51]
    v_mfma_f32_16x16x32_bf16 v[52:55], a[204:207], v[72:75], v[52:55]
    v_mfma_f32_16x16x32_bf16 v[56:59], v[100:103], v[72:75], v[56:59]
    s_waitcnt lgkmcnt(1)
    v_mfma_f32_16x16x32_bf16 v[44:47], a[64:67], v[60:63], v[44:47]
    v_mfma_f32_16x16x32_bf16 v[48:51], a[136:139], v[60:63], v[48:51]
    v_mfma_f32_16x16x32_bf16 v[52:55], a[208:211], v[60:63], v[52:55]
    v_mfma_f32_16x16x32_bf16 v[56:59], v[104:107], v[60:63], v[56:59]
    s_waitcnt lgkmcnt(0)
    v_mfma_f32_16x16x32_bf16 v[44:47], a[68:71], v[64:67], v[44:47]
    v_mfma_f32_16x16x32_bf16 v[48:51], a[140:143], v[64:67], v[48:51]
    v_mfma_f32_16x16x32_bf16 v[52:55], a[212:215], v[64:67], v[52:55]
    v_mfma_f32_16x16x32_bf16 v[56:59], v[108:111], v[64:67], v[56:59]
    v_and_b32 v60, 15, v0
    v_bfe_u32 v61, v0, 4, 2
    v_lshlrev_b32 v62, 8, v60
    v_lshl_add_u32 v62, v61, 3, v62
    s_lshl_b32 s34, s21, 6
    v_add_u32 v62, s34, v62
    s_lshl_b32 s37, s22, 5
    s_add_u32 s37, s37, s20
    s_lshl_b32 s37, s37, 11
    s_mov_b64 exec, s[26:27]

    v_cvt_pk_bf16_f32 v44, v44, v45
    v_cvt_pk_bf16_f32 v45, v46, v47
    ds_write_b64 v2, v[44:45] offset:0

    v_cvt_pk_bf16_f32 v48, v48, v49
    v_cvt_pk_bf16_f32 v49, v50, v51
    ds_write_b64 v2, v[48:49] offset:32

    v_cvt_pk_bf16_f32 v52, v52, v53
    v_cvt_pk_bf16_f32 v53, v54, v55
    ds_write_b64 v2, v[52:53] offset:2176

    v_cvt_pk_bf16_f32 v56, v56, v57
    v_cvt_pk_bf16_f32 v57, v58, v59
    ds_write_b64 v2, v[56:57] offset:2208

    buffer_store_dwordx2 v[52:53], v62, s[56:59], s37 offen offset:0 sc1
    buffer_store_dwordx2 v[56:57], v62, s[56:59], s37 offen offset:32 sc1
    s_mov_b64 exec, -1
    s_waitcnt lgkmcnt(0)
    s_barrier

    ds_read_b128 v[72:75], v3 offset:0
    ds_read_b128 v[76:79], v3 offset:2176
    ds_read_b128 v[52:55], v1 offset:0
    ds_read_b128 v[56:59], v1 offset:64
    s_waitcnt lgkmcnt(1)
    v_mfma_f32_16x16x32_bf16 v[44:47], v[52:55], v[112:115], 0
    v_mfma_f32_16x16x32_bf16 v[48:51], v[52:55], v[184:187], 0
    s_waitcnt vmcnt(2)
    v_mfma_f32_16x16x32_bf16 v[60:63], v[76:79], v[72:75], 0
    v_mfma_f32_16x16x32_bf16 v[64:67], v[4:7], v[72:75], 0
    v_mfma_f32_16x16x32_bf16 v[68:71], v[20:23], v[72:75], 0
    ds_read_b128 v[52:55], v1 offset:128
    s_waitcnt lgkmcnt(1)
    v_mfma_f32_16x16x32_bf16 v[44:47], v[56:59], v[116:119], v[44:47]
    v_mfma_f32_16x16x32_bf16 v[48:51], v[56:59], v[188:191], v[48:51]
    ds_read_b128 v[72:75], v3 offset:64
    ds_read_b128 v[76:79], v3 offset:2240
    ds_read_b128 v[56:59], v1 offset:192
    s_waitcnt lgkmcnt(3)
    v_mfma_f32_16x16x32_bf16 v[44:47], v[52:55], v[120:123], v[44:47]
    v_mfma_f32_16x16x32_bf16 v[48:51], v[52:55], v[192:195], v[48:51]
    ds_read_b128 v[52:55], v1 offset:256
    s_waitcnt lgkmcnt(1)
    v_mfma_f32_16x16x32_bf16 v[44:47], v[56:59], v[124:127], v[44:47]
    v_mfma_f32_16x16x32_bf16 v[48:51], v[56:59], v[196:199], v[48:51]
    v_mfma_f32_16x16x32_bf16 v[60:63], v[76:79], v[72:75], v[60:63]
    v_mfma_f32_16x16x32_bf16 v[64:67], v[8:11], v[72:75], v[64:67]
    v_mfma_f32_16x16x32_bf16 v[68:71], v[24:27], v[72:75], v[68:71]
    ds_read_b128 v[56:59], v1 offset:320
    s_waitcnt lgkmcnt(1)
    v_mfma_f32_16x16x32_bf16 v[44:47], v[52:55], v[128:131], v[44:47]
    v_mfma_f32_16x16x32_bf16 v[48:51], v[52:55], v[200:203], v[48:51]
    ds_read_b128 v[72:75], v3 offset:128
    ds_read_b128 v[76:79], v3 offset:2304
    ds_read_b128 v[52:55], v1 offset:384
    s_waitcnt lgkmcnt(3)
    v_mfma_f32_16x16x32_bf16 v[44:47], v[56:59], v[132:135], v[44:47]
    v_mfma_f32_16x16x32_bf16 v[48:51], v[56:59], v[204:207], v[48:51]
    ds_read_b128 v[56:59], v1 offset:448
    s_waitcnt lgkmcnt(1)
    v_mfma_f32_16x16x32_bf16 v[44:47], v[52:55], v[136:139], v[44:47]
    v_mfma_f32_16x16x32_bf16 v[48:51], v[52:55], v[208:211], v[48:51]
    v_mfma_f32_16x16x32_bf16 v[60:63], v[76:79], v[72:75], v[60:63]
    v_mfma_f32_16x16x32_bf16 v[64:67], v[12:15], v[72:75], v[64:67]
    v_mfma_f32_16x16x32_bf16 v[68:71], v[28:31], v[72:75], v[68:71]
    ds_read_b128 v[52:55], v1 offset:512
    s_waitcnt lgkmcnt(1)
    v_mfma_f32_16x16x32_bf16 v[44:47], v[56:59], v[140:143], v[44:47]
    v_mfma_f32_16x16x32_bf16 v[48:51], v[56:59], v[212:215], v[48:51]
    ds_read_b128 v[72:75], v3 offset:192
    ds_read_b128 v[76:79], v3 offset:2368
    ds_read_b128 v[56:59], v1 offset:576
    s_waitcnt lgkmcnt(3)
    v_mfma_f32_16x16x32_bf16 v[44:47], v[52:55], v[144:147], v[44:47]
    v_mfma_f32_16x16x32_bf16 v[48:51], v[52:55], v[216:219], v[48:51]
    ds_read_b128 v[52:55], v1 offset:640
    s_waitcnt lgkmcnt(1)
    v_mfma_f32_16x16x32_bf16 v[44:47], v[56:59], v[148:151], v[44:47]
    v_mfma_f32_16x16x32_bf16 v[48:51], v[56:59], v[220:223], v[48:51]
    v_mfma_f32_16x16x32_bf16 v[60:63], v[76:79], v[72:75], v[60:63]
    v_mfma_f32_16x16x32_bf16 v[64:67], v[16:19], v[72:75], v[64:67]
    v_mfma_f32_16x16x32_bf16 v[68:71], v[32:35], v[72:75], v[68:71]
    ds_read_b128 v[56:59], v1 offset:704
    s_waitcnt lgkmcnt(1)
    v_mfma_f32_16x16x32_bf16 v[44:47], v[52:55], v[152:155], v[44:47]
    v_mfma_f32_16x16x32_bf16 v[48:51], v[52:55], v[224:227], v[48:51]
    ds_read_b128 v[52:55], v1 offset:768
    s_waitcnt lgkmcnt(1)
    v_mfma_f32_16x16x32_bf16 v[44:47], v[56:59], v[156:159], v[44:47]
    v_mfma_f32_16x16x32_bf16 v[48:51], v[56:59], v[228:231], v[48:51]
    s_cmp_ge_u32 s21, 2
    s_cbranch_scc1 L_nowarm_37
    s_cmp_eq_u32 s22, 63
    s_cbranch_scc1 L_nowarm_37
    s_add_u32 s38, s22, 1

    s_cmp_eq_u32 s21, 1
    s_cbranch_scc1 L_warmv_38
    v_bfe_u32 v78, v0, 1, 5
    v_lshlrev_b32 v78, 13, v78
    v_and_b32 v79, 1, v0
    v_lshl_add_u32 v78, v79, 7, v78
    s_lshl_b32 s39, s38, 18
    s_lshl_b32 s40, s20, 8
    s_add_u32 s39, s39, s40
    s_mov_b32 m0, 163456
    s_nop 0
    buffer_load_dword v78, s[48:51], s39 offen lds
    s_branch L_nowarm_37

L_warmv_38:
    v_and_b32 v78, 63, v0
    v_lshlrev_b32 v78, 7, v78
    s_lshl_b32 s39, s38, 5
    s_add_u32 s39, s39, s20
    s_lshl_b32 s39, s39, 13
    s_mov_b32 m0, 163456
    s_nop 0
    buffer_load_dword v78, s[52:55], s39 offen lds

L_nowarm_37:
    s_mov_b32 s34, 1035273459
    v_cvt_pk_bf16_f32 v72, v60, v61
    v_lshlrev_b32 v60, 16, v72
    v_and_b32 v61, 0xffff0000, v72

    v_mul_f32 v60, s34, v60
    v_mul_f32 v61, s34, v61

    v_cvt_pk_bf16_f32 v72, v60, v61
    v_lshlrev_b32 v60, 16, v72
    v_and_b32 v61, 0xffff0000, v72

    v_cvt_pk_bf16_f32 v72, v62, v63
    v_lshlrev_b32 v62, 16, v72
    v_and_b32 v63, 0xffff0000, v72

    v_mul_f32 v62, s34, v62
    v_mul_f32 v63, s34, v63

    v_cvt_pk_bf16_f32 v72, v62, v63
    v_lshlrev_b32 v62, 16, v72
    v_and_b32 v63, 0xffff0000, v72

    ds_read_b128 v[56:59], v1 offset:832
    s_waitcnt lgkmcnt(1)
    v_mfma_f32_16x16x32_bf16 v[44:47], v[52:55], v[160:163], v[44:47]
    v_mfma_f32_16x16x32_bf16 v[48:51], v[52:55], v[232:235], v[48:51]
    v_cvt_pk_bf16_f32 v72, v64, v65
    v_lshlrev_b32 v64, 16, v72
    v_and_b32 v65, 0xffff0000, v72

    v_mul_f32 v64, s34, v64
    v_mul_f32 v65, s34, v65

    v_cvt_pk_bf16_f32 v72, v64, v65
    v_lshlrev_b32 v64, 16, v72
    v_and_b32 v65, 0xffff0000, v72

    v_cvt_pk_bf16_f32 v72, v66, v67
    v_lshlrev_b32 v66, 16, v72
    v_and_b32 v67, 0xffff0000, v72

    v_mul_f32 v66, s34, v66
    v_mul_f32 v67, s34, v67

    v_cvt_pk_bf16_f32 v72, v66, v67
    v_lshlrev_b32 v66, 16, v72
    v_and_b32 v67, 0xffff0000, v72

    ds_read_b128 v[52:55], v1 offset:896
    s_waitcnt lgkmcnt(1)
    v_mfma_f32_16x16x32_bf16 v[44:47], v[56:59], v[164:167], v[44:47]
    v_mfma_f32_16x16x32_bf16 v[48:51], v[56:59], v[236:239], v[48:51]
    v_cvt_pk_bf16_f32 v72, v68, v69
    v_lshlrev_b32 v68, 16, v72
    v_and_b32 v69, 0xffff0000, v72

    v_mul_f32 v68, s34, v68
    v_mul_f32 v69, s34, v69

    v_cvt_pk_bf16_f32 v72, v68, v69
    v_lshlrev_b32 v68, 16, v72
    v_and_b32 v69, 0xffff0000, v72

    v_cvt_pk_bf16_f32 v72, v70, v71
    v_lshlrev_b32 v70, 16, v72
    v_and_b32 v71, 0xffff0000, v72

    v_mul_f32 v70, s34, v70
    v_mul_f32 v71, s34, v71

    v_cvt_pk_bf16_f32 v72, v70, v71
    v_lshlrev_b32 v70, 16, v72
    v_and_b32 v71, 0xffff0000, v72

    ds_read_b128 v[56:59], v1 offset:960
    s_waitcnt lgkmcnt(1)
    v_mfma_f32_16x16x32_bf16 v[44:47], v[52:55], v[168:171], v[44:47]
    v_mfma_f32_16x16x32_bf16 v[48:51], v[52:55], v[240:243], v[48:51]
    s_mov_b64 exec, s[28:29]
    s_not_b64 exec, exec

    v_mov_b32 v60, 0xce6e6b28
    v_mov_b32 v61, 0xce6e6b28
    v_mov_b32 v62, 0xce6e6b28
    v_mov_b32 v63, 0xce6e6b28
    s_mov_b64 exec, -1
    v_max3_f32 v72, v60, v61, v62
    v_max3_f32 v72, v72, v63, v64
    v_max3_f32 v72, v72, v65, v66
    v_max3_f32 v72, v72, v67, v68
    v_max3_f32 v72, v72, v69, v70
    v_max_f32 v72, v72, v71
    v_mov_b32 v73, v72
    s_nop 1
    v_permlane16_swap_b32 v72, v73
    s_nop 1
    v_max_f32 v72, v72, v73
    v_mov_b32 v73, v72
    s_nop 1
    v_permlane32_swap_b32 v72, v73
    s_nop 1
    v_max_f32 v72, v72, v73

    ds_read_b128 v[52:55], v1 offset:1024
    s_waitcnt lgkmcnt(1)
    v_mfma_f32_16x16x32_bf16 v[44:47], v[56:59], v[172:175], v[44:47]
    v_mfma_f32_16x16x32_bf16 v[48:51], v[56:59], v[244:247], v[48:51]
    s_mov_b32 s34, 0x3fb8aa3b
    v_mul_f32 v72, s34, v72

    v_fma_f32 v60, v60, s34, -v72
    v_fma_f32 v61, v61, s34, -v72
    v_fma_f32 v62, v62, s34, -v72
    v_fma_f32 v63, v63, s34, -v72
    v_fma_f32 v64, v64, s34, -v72
    v_fma_f32 v65, v65, s34, -v72
    v_fma_f32 v66, v66, s34, -v72
    v_fma_f32 v67, v67, s34, -v72
    v_fma_f32 v68, v68, s34, -v72
    v_fma_f32 v69, v69, s34, -v72
    v_fma_f32 v70, v70, s34, -v72
    v_fma_f32 v71, v71, s34, -v72
    v_exp_f32 v60, v60
    v_exp_f32 v61, v61
    v_exp_f32 v62, v62
    v_exp_f32 v63, v63
    v_exp_f32 v64, v64
    v_exp_f32 v65, v65
    ds_read_b128 v[56:59], v1 offset:1088
    s_waitcnt lgkmcnt(1)
    v_mfma_f32_16x16x32_bf16 v[44:47], v[52:55], v[176:179], v[44:47]
    v_mfma_f32_16x16x32_bf16 v[48:51], v[52:55], v[248:251], v[48:51]
    v_exp_f32 v66, v66
    v_exp_f32 v67, v67
    v_exp_f32 v68, v68
    v_exp_f32 v69, v69
    v_exp_f32 v70, v70
    v_exp_f32 v71, v71
    s_waitcnt lgkmcnt(0)
    v_mfma_f32_16x16x32_bf16 v[44:47], v[56:59], v[180:183], v[44:47]
    v_mfma_f32_16x16x32_bf16 v[48:51], v[56:59], v[252:255], v[48:51]
    v_add_f32 v74, v60, v61
    v_add_f32 v76, v62, v63

    v_add_f32 v74, v74, v64
    v_add_f32 v76, v76, v65

    v_add_f32 v74, v74, v66
    v_add_f32 v76, v76, v67

    v_add_f32 v74, v74, v68
    v_add_f32 v76, v76, v69

    v_add_f32 v74, v74, v70
    v_add_f32 v76, v76, v71

    v_add_f32 v74, v74, v76
    v_mov_b32 v75, v74
    s_nop 1
    v_permlane16_swap_b32 v74, v75
    s_nop 1
    v_add_f32 v74, v74, v75
    v_mov_b32 v75, v74
    s_nop 1
    v_permlane32_swap_b32 v74, v75
    s_nop 1
    v_add_f32 v74, v74, v75

    v_rcp_f32 v74, v74
    s_nop 0

    v_mul_f32 v60, v60, v74
    v_mul_f32 v61, v61, v74
    v_cvt_pk_bf16_f32 v60, v60, v61

    v_mul_f32 v62, v62, v74
    v_mul_f32 v63, v63, v74
    v_cvt_pk_bf16_f32 v61, v62, v63

    v_mul_f32 v64, v64, v74
    v_mul_f32 v65, v65, v74
    v_cvt_pk_bf16_f32 v62, v64, v65

    v_mul_f32 v66, v66, v74
    v_mul_f32 v67, v67, v74
    v_cvt_pk_bf16_f32 v63, v66, v67

    v_mul_f32 v68, v68, v74
    v_mul_f32 v69, v69, v74
    v_cvt_pk_bf16_f32 v64, v68, v69

    v_mul_f32 v70, v70, v74
    v_mul_f32 v71, v71, v74
    v_cvt_pk_bf16_f32 v65, v70, v71

    v_and_b32 v52, 15, v0
    v_bfe_u32 v53, v0, 4, 2
    v_lshlrev_b32 v54, 4, v52
    v_lshl_add_u32 v54, v53, 3, v54
    s_lshl_b32 s34, s21, 9
    v_add_u32 v54, s34, v54
    s_nop 3

    v_cvt_pk_bf16_f32 v76, v44, v45
    v_cvt_pk_bf16_f32 v77, v46, v47

    v_cvt_pk_bf16_f32 v78, v48, v49
    v_cvt_pk_bf16_f32 v79, v50, v51

    s_nop 1
    v_mfma_f32_16x16x16_bf16 v[44:47], v[76:77], v[60:61], 0
    v_mfma_f32_16x16x16_bf16 v[44:47], v[36:37], v[62:63], v[44:47]
    v_mfma_f32_16x16x16_bf16 v[44:47], v[38:39], v[64:65], v[44:47]
    v_mfma_f32_16x16x16_bf16 v[48:51], v[78:79], v[60:61], 0
    v_mfma_f32_16x16x16_bf16 v[48:51], v[40:41], v[62:63], v[48:51]
    v_mfma_f32_16x16x16_bf16 v[48:51], v[42:43], v[64:65], v[48:51]
    s_mov_b64 exec, s[28:29]
    buffer_store_dwordx2 v[76:77], v54, s[60:63], s37 offen offset:0 sc1
    buffer_store_dwordx2 v[78:79], v54, s[60:63], s37 offen offset:256 sc1
    s_mov_b64 exec, -1
    s_cmp_eq_u32 s22, 63
    s_cbranch_scc1 L_chain_done_34
    s_and_b32 s34, s22, 1
    s_mul_i32 s24, s34, 0x90000
    s_mul_i32 s25, s34, 18432
    s_lshr_b32 s23, s22, 1
    s_and_b32 s23, s23, 1
    s_add_u32 s23, s23, 1
    s_mul_i32 s35, s20, 576
    s_add_u32 s35, s35, s24
    s_mov_b64 exec, s[26:27]

    v_cvt_pk_bf16_f32 v44, v44, v45
    v_cvt_pk_bf16_f32 v45, v46, v47
    ds_write_b64 v2, v[44:45] offset:4352

    v_cvt_pk_bf16_f32 v48, v48, v49
    v_cvt_pk_bf16_f32 v49, v50, v51
    ds_write_b64 v2, v[48:49] offset:4384

    s_mov_b64 exec, -1
    v_and_b32 v76, 63, v0
    v_lshlrev_b32 v76, 4, v76
    s_mul_i32 s36, s21, 9216
    v_add_u32 v76, s36, v76
    v_add_u32 v77, 73728, v76
    v_and_b32 v78, 7, v0
    v_lshl_add_u32 v78, v78, 2, s21
    v_mul_u32_u24 v78, 18432, v78
    v_bfe_u32 v79, v0, 4, 2
    v_lshl_add_u32 v78, v79, 4, v78
    v_bfe_u32 v79, v0, 3, 1
    v_lshl_add_u32 v78, v79, 6, v78

    s_lshl_b32 s35, s20, 9
    s_add_u32 s35, s35, s24
    s_lshl_b32 s45, s20, 6
    s_add_u32 s45, s45, s24
    s_add_u32 s45, s45, 16384

    ds_read_b128 v[4:7], v76 offset:0
    ds_read_b128 v[8:11], v76 offset:36864
    ds_read_b128 v[12:15], v77 offset:0
    ds_read_b128 v[16:19], v77 offset:36864
    ds_read_b128 v[20:23], v76 offset:1024
    ds_read_b128 v[24:27], v76 offset:37888
    ds_read_b128 v[28:31], v77 offset:1024
    ds_read_b128 v[32:35], v77 offset:37888
    s_waitcnt lgkmcnt(8)
    s_barrier
    ds_read_b128 v[44:47], v3 offset:4352
    ds_read_b128 v[48:51], v3 offset:4416
    ds_read_b128 v[52:55], v3 offset:4480
    ds_read_b128 v[56:59], v3 offset:4544
    ds_read_b128 v[36:39], v76 offset:2048
    ds_read_b128 v[40:43], v76 offset:38912
    ds_read_b128 v[68:71], v77 offset:2048
    ds_read_b128 v[72:75], v77 offset:38912
    s_waitcnt lgkmcnt(4)
    v_mfma_f32_16x16x32_bf16 v[60:63], v[4:7], v[44:47], 0
    v_mfma_f32_16x16x32_bf16 v[60:63], v[8:11], v[48:51], v[60:63]
    v_mfma_f32_16x16x32_bf16 v[60:63], v[12:15], v[52:55], v[60:63]
    v_mfma_f32_16x16x32_bf16 v[60:63], v[16:19], v[56:59], v[60:63]
    ds_read_b128 v[4:7], v76 offset:3072
    ds_read_b128 v[8:11], v76 offset:39936
    ds_read_b128 v[12:15], v77 offset:3072
    ds_read_b128 v[16:19], v77 offset:39936
    v_mfma_f32_16x16x32_bf16 v[64:67], v[20:23], v[44:47], 0
    v_mfma_f32_16x16x32_bf16 v[64:67], v[24:27], v[48:51], v[64:67]
    v_mfma_f32_16x16x32_bf16 v[64:67], v[28:31], v[52:55], v[64:67]
    v_mfma_f32_16x16x32_bf16 v[64:67], v[32:35], v[56:59], v[64:67]
    ds_read_b128 v[20:23], v76 offset:4096
    ds_read_b128 v[24:27], v76 offset:40960
    ds_read_b128 v[28:31], v77 offset:4096
    ds_read_b128 v[32:35], v77 offset:40960
    s_nop 3
    v_mov_b32_dpp v60, v64 row_shr:8 row_mask:0xf bank_mask:0xc
    v_mov_b32_dpp v61, v65 row_shr:8 row_mask:0xf bank_mask:0xc
    v_mov_b32_dpp v62, v66 row_shr:8 row_mask:0xf bank_mask:0xc
    v_mov_b32_dpp v63, v67 row_shr:8 row_mask:0xf bank_mask:0xc
    v_bfi_b32 v60, 3, s23, v60
    v_bfi_b32 v61, 3, s23, v61
    v_bfi_b32 v62, 3, s23, v62
    v_bfi_b32 v63, 3, s23, v63
    buffer_store_dwordx4 v[60:63], v78, s[64:67], s35 offen offset:0 sc1
    s_nop 1
    s_waitcnt lgkmcnt(8)
    v_mfma_f32_16x16x32_bf16 v[60:63], v[36:39], v[44:47], 0
    v_mfma_f32_16x16x32_bf16 v[60:63], v[40:43], v[48:51], v[60:63]
    v_mfma_f32_16x16x32_bf16 v[60:63], v[68:71], v[52:55], v[60:63]
    v_mfma_f32_16x16x32_bf16 v[60:63], v[72:75], v[56:59], v[60:63]
    ds_read_b128 v[36:39], v76 offset:5120
    ds_read_b128 v[40:43], v76 offset:41984
    ds_read_b128 v[68:71], v77 offset:5120
    ds_read_b128 v[72:75], v77 offset:41984
    s_waitcnt lgkmcnt(8)
    v_mfma_f32_16x16x32_bf16 v[64:67], v[4:7], v[44:47], 0
    v_mfma_f32_16x16x32_bf16 v[64:67], v[8:11], v[48:51], v[64:67]
    v_mfma_f32_16x16x32_bf16 v[64:67], v[12:15], v[52:55], v[64:67]
    v_mfma_f32_16x16x32_bf16 v[64:67], v[16:19], v[56:59], v[64:67]
    ds_read_b128 v[4:7], v76 offset:6144
    ds_read_b128 v[8:11], v76 offset:43008
    ds_read_b128 v[12:15], v77 offset:6144
    ds_read_b128 v[16:19], v77 offset:43008
    s_nop 3
    v_mov_b32_dpp v60, v64 row_shr:8 row_mask:0xf bank_mask:0xc
    v_mov_b32_dpp v61, v65 row_shr:8 row_mask:0xf bank_mask:0xc
    v_mov_b32_dpp v62, v66 row_shr:8 row_mask:0xf bank_mask:0xc
    v_mov_b32_dpp v63, v67 row_shr:8 row_mask:0xf bank_mask:0xc
    v_bfi_b32 v60, 3, s23, v60
    v_bfi_b32 v61, 3, s23, v61
    v_bfi_b32 v62, 3, s23, v62
    v_bfi_b32 v63, 3, s23, v63
    buffer_store_dwordx4 v[60:63], v78, s[64:67], s35 offen offset:128 sc1
    s_nop 1
    s_waitcnt lgkmcnt(8)
    v_mfma_f32_16x16x32_bf16 v[60:63], v[20:23], v[44:47], 0
    v_mfma_f32_16x16x32_bf16 v[60:63], v[24:27], v[48:51], v[60:63]
    v_mfma_f32_16x16x32_bf16 v[60:63], v[28:31], v[52:55], v[60:63]
    v_mfma_f32_16x16x32_bf16 v[60:63], v[32:35], v[56:59], v[60:63]
    ds_read_b128 v[20:23], v76 offset:7168
    ds_read_b128 v[24:27], v76 offset:44032
    ds_read_b128 v[28:31], v77 offset:7168
    ds_read_b128 v[32:35], v77 offset:44032
    s_waitcnt lgkmcnt(8)
    v_mfma_f32_16x16x32_bf16 v[64:67], v[36:39], v[44:47], 0
    v_mfma_f32_16x16x32_bf16 v[64:67], v[40:43], v[48:51], v[64:67]
    v_mfma_f32_16x16x32_bf16 v[64:67], v[68:71], v[52:55], v[64:67]
    v_mfma_f32_16x16x32_bf16 v[64:67], v[72:75], v[56:59], v[64:67]
    ds_read_b128 v[36:39], v76 offset:8192
    ds_read_b128 v[40:43], v76 offset:45056
    ds_read_b128 v[68:71], v77 offset:8192
    ds_read_b128 v[72:75], v77 offset:45056
    s_nop 3
    v_mov_b32_dpp v60, v64 row_shr:8 row_mask:0xf bank_mask:0xc
    v_mov_b32_dpp v61, v65 row_shr:8 row_mask:0xf bank_mask:0xc
    v_mov_b32_dpp v62, v66 row_shr:8 row_mask:0xf bank_mask:0xc
    v_mov_b32_dpp v63, v67 row_shr:8 row_mask:0xf bank_mask:0xc
    v_bfi_b32 v60, 3, s23, v60
    v_bfi_b32 v61, 3, s23, v61
    v_bfi_b32 v62, 3, s23, v62
    v_bfi_b32 v63, 3, s23, v63
    buffer_store_dwordx4 v[60:63], v78, s[64:67], s35 offen offset:256 sc1
    s_nop 1
    s_waitcnt lgkmcnt(8)
    v_mfma_f32_16x16x32_bf16 v[60:63], v[4:7], v[44:47], 0
    v_mfma_f32_16x16x32_bf16 v[60:63], v[8:11], v[48:51], v[60:63]
    v_mfma_f32_16x16x32_bf16 v[60:63], v[12:15], v[52:55], v[60:63]
    v_mfma_f32_16x16x32_bf16 v[60:63], v[16:19], v[56:59], v[60:63]
    s_waitcnt lgkmcnt(4)
    v_mfma_f32_16x16x32_bf16 v[64:67], v[20:23], v[44:47], 0
    v_mfma_f32_16x16x32_bf16 v[64:67], v[24:27], v[48:51], v[64:67]
    v_mfma_f32_16x16x32_bf16 v[64:67], v[28:31], v[52:55], v[64:67]
    v_mfma_f32_16x16x32_bf16 v[64:67], v[32:35], v[56:59], v[64:67]
    s_nop 7
    v_mov_b32_dpp v60, v64 row_shr:8 row_mask:0xf bank_mask:0xc
    v_mov_b32_dpp v61, v65 row_shr:8 row_mask:0xf bank_mask:0xc
    v_mov_b32_dpp v62, v66 row_shr:8 row_mask:0xf bank_mask:0xc
    v_mov_b32_dpp v63, v67 row_shr:8 row_mask:0xf bank_mask:0xc
    v_bfi_b32 v60, 3, s23, v60
    v_bfi_b32 v61, 3, s23, v61
    v_bfi_b32 v62, 3, s23, v62
    v_bfi_b32 v63, 3, s23, v63
    buffer_store_dwordx4 v[60:63], v78, s[64:67], s35 offen offset:384 sc1
    s_nop 1
    s_waitcnt lgkmcnt(0)
    v_mfma_f32_16x16x32_bf16 v[60:63], v[36:39], v[44:47], 0
    v_mfma_f32_16x16x32_bf16 v[60:63], v[40:43], v[48:51], v[60:63]
    v_mfma_f32_16x16x32_bf16 v[60:63], v[68:71], v[52:55], v[60:63]
    v_mfma_f32_16x16x32_bf16 v[60:63], v[72:75], v[56:59], v[60:63]
    s_nop 7
    v_bfi_b32 v60, 3, s23, v60
    v_bfi_b32 v61, 3, s23, v61
    v_bfi_b32 v62, 3, s23, v62
    v_bfi_b32 v63, 3, s23, v63
    s_mov_b64 exec, s[26:27]
    buffer_store_dwordx4 v[60:63], v78, s[64:67], s45 offen sc1
    s_mov_b64 exec, -1

    v_bfe_u32 v44, v0, 3, 3
    v_lshlrev_b32 v44, 9, v44
    v_and_b32 v47, 7, v0
    v_lshl_add_u32 v44, v47, 4, v44
    v_and_b32 v47, 31, v0
    v_lshlrev_b32 v47, 6, v47
    s_mul_i32 s35, s20, 18432
    s_add_u32 s35, s35, s24
    s_lshl_b32 s36, s21, 4
    s_add_u32 s36, s36, s35
    s_add_u32 s36, s36, 16384
    s_lshl_b32 s37, s21, 7
    s_add_u32 s35, s35, s37
    s_add_u32 s37, s35, 4096
    s_add_u32 s38, s35, 8192
    s_add_u32 s39, s35, 12288
    s_mov_b32 s32, 0
    s_mov_b32 s42, 3641

    v_add_u32 v56, 0, v0
    v_mul_lo_u32 v57, v56, s42
    v_lshrrev_b32 v57, 19, v57
    v_mul_u32_u24 v58, 144, v57
    v_sub_u32 v56, v56, v58
    v_mul_u32_u24 v57, 1184, v57
    v_lshl_add_u32 v48, v56, 3, v57
    v_add_u32 v48, 147456, v48

    v_add_u32 v56, 256, v0
    v_mul_lo_u32 v57, v56, s42
    v_lshrrev_b32 v57, 19, v57
    v_mul_u32_u24 v58, 144, v57
    v_sub_u32 v56, v56, v58
    v_mul_u32_u24 v57, 1184, v57
    v_lshl_add_u32 v49, v56, 3, v57
    v_add_u32 v49, 147456, v49

    v_add_u32 v56, 512, v0
    v_mul_lo_u32 v57, v56, s42
    v_lshrrev_b32 v57, 19, v57
    v_mul_u32_u24 v58, 144, v57
    v_sub_u32 v56, v56, v58
    v_mul_u32_u24 v57, 1184, v57
    v_lshl_add_u32 v50, v56, 3, v57
    v_add_u32 v50, 147456, v50

    v_add_u32 v56, 768, v0
    v_mul_lo_u32 v57, v56, s42
    v_lshrrev_b32 v57, 19, v57
    v_mul_u32_u24 v58, 144, v57
    v_sub_u32 v56, v56, v58
    v_mul_u32_u24 v57, 1184, v57
    v_lshl_add_u32 v51, v56, 3, v57
    v_add_u32 v51, 147456, v51

    v_add_u32 v56, 1024, v0
    v_mul_lo_u32 v57, v56, s42
    v_lshrrev_b32 v57, 19, v57
    v_mul_u32_u24 v58, 144, v57
    v_sub_u32 v56, v56, v58
    v_mul_u32_u24 v57, 1184, v57
    v_lshl_add_u32 v52, v56, 3, v57
    v_add_u32 v52, 147456, v52

    s_sleep 16
    buffer_load_dwordx4 v[4:7], v44, s[64:67], s35 offen sc1
    buffer_load_dwordx4 v[8:11], v44, s[64:67], s37 offen sc1
    buffer_load_dwordx4 v[12:15], v44, s[64:67], s38 offen sc1
    buffer_load_dwordx4 v[16:19], v44, s[64:67], s39 offen sc1
    buffer_load_dwordx4 v[20:23], v47, s[64:67], s36 offen sc1
    s_sleep 4
    buffer_load_dwordx4 v[24:27], v44, s[64:67], s35 offen sc1
    buffer_load_dwordx4 v[28:31], v44, s[64:67], s37 offen sc1
    buffer_load_dwordx4 v[32:35], v44, s[64:67], s38 offen sc1
    buffer_load_dwordx4 v[36:39], v44, s[64:67], s39 offen sc1
    buffer_load_dwordx4 v[40:43], v47, s[64:67], s36 offen sc1
L_poll1_39:
    s_waitcnt vmcnt(5)
    v_and_b32 v45, v4, v5
    v_or_b32 v46, v4, v5
    v_and_b32 v45, v45, v6
    v_and_b32 v45, v45, v7
    v_or3_b32 v46, v46, v6, v7
    v_and_b32 v45, v45, v8
    v_and_b32 v45, v45, v9
    v_or3_b32 v46, v46, v8, v9
    v_and_b32 v45, v45, v10
    v_and_b32 v45, v45, v11
    v_or3_b32 v46, v46, v10, v11
    v_and_b32 v45, v45, v12
    v_and_b32 v45, v45, v13
    v_or3_b32 v46, v46, v12, v13
    v_and_b32 v45, v45, v14
    v_and_b32 v45, v45, v15
    v_or3_b32 v46, v46, v14, v15
    v_and_b32 v45, v45, v16
    v_and_b32 v45, v45, v17
    v_or3_b32 v46, v46, v16, v17
    v_and_b32 v45, v45, v18
    v_and_b32 v45, v45, v19
    v_or3_b32 v46, v46, v18, v19
    v_and_b32 v45, v45, v20
    v_and_b32 v45, v45, v21
    v_or3_b32 v46, v46, v20, v21
    v_and_b32 v45, v45, v22
    v_and_b32 v45, v45, v23
    v_or3_b32 v46, v46, v22, v23
    v_xor_b32 v45, s23, v45
    v_xor_b32 v46, s23, v46
    v_or_b32 v45, v45, v46
    v_and_b32 v45, 3, v45
    v_cmp_ne_u32 vcc, 0, v45
    s_nop 1
    s_cbranch_vccnz L_p1retA_41

L_poll1x_40:
    v_add_f32 v72, v4, v8
    v_add_f32_dpp v68, v20, v20 row_shr:1 row_mask:0xf bank_mask:0xf bound_ctrl:0
    v_add_f32 v73, v5, v9
    v_add_f32_dpp v69, v21, v21 row_shr:1 row_mask:0xf bank_mask:0xf bound_ctrl:0
    v_add_f32 v74, v6, v10
    v_add_f32_dpp v70, v22, v22 row_shr:1 row_mask:0xf bank_mask:0xf bound_ctrl:0
    v_add_f32 v75, v7, v11
    v_add_f32_dpp v71, v23, v23 row_shr:1 row_mask:0xf bank_mask:0xf bound_ctrl:0
    v_add_f32 v72, v72, v12
    v_add_f32_dpp v68, v68, v68 row_shr:2 row_mask:0xf bank_mask:0xf bound_ctrl:0
    v_add_f32 v73, v73, v13
    v_add_f32_dpp v69, v69, v69 row_shr:2 row_mask:0xf bank_mask:0xf bound_ctrl:0
    v_add_f32 v74, v74, v14
    v_add_f32_dpp v70, v70, v70 row_shr:2 row_mask:0xf bank_mask:0xf bound_ctrl:0
    v_add_f32 v75, v75, v15
    v_add_f32_dpp v71, v71, v71 row_shr:2 row_mask:0xf bank_mask:0xf bound_ctrl:0
    v_add_f32 v72, v72, v16
    v_add_f32_dpp v68, v68, v68 row_shr:4 row_mask:0xf bank_mask:0xf bound_ctrl:0
    v_add_f32 v73, v73, v17
    v_add_f32_dpp v69, v69, v69 row_shr:4 row_mask:0xf bank_mask:0xf bound_ctrl:0
    v_add_f32 v74, v74, v18
    v_add_f32_dpp v70, v70, v70 row_shr:4 row_mask:0xf bank_mask:0xf bound_ctrl:0
    v_add_f32 v75, v75, v19
    v_add_f32_dpp v71, v71, v71 row_shr:4 row_mask:0xf bank_mask:0xf bound_ctrl:0
    s_branch L_p1join_43
L_p1retA_41:
    buffer_load_dwordx4 v[4:7], v44, s[64:67], s35 offen sc1
    buffer_load_dwordx4 v[8:11], v44, s[64:67], s37 offen sc1
    buffer_load_dwordx4 v[12:15], v44, s[64:67], s38 offen sc1
    buffer_load_dwordx4 v[16:19], v44, s[64:67], s39 offen sc1
    buffer_load_dwordx4 v[20:23], v47, s[64:67], s36 offen sc1
    s_waitcnt vmcnt(5)
    v_and_b32 v45, v24, v25
    v_or_b32 v46, v24, v25
    v_and_b32 v45, v45, v26
    v_and_b32 v45, v45, v27
    v_or3_b32 v46, v46, v26, v27
    v_and_b32 v45, v45, v28
    v_and_b32 v45, v45, v29
    v_or3_b32 v46, v46, v28, v29
    v_and_b32 v45, v45, v30
    v_and_b32 v45, v45, v31
    v_or3_b32 v46, v46, v30, v31
    v_and_b32 v45, v45, v32
    v_and_b32 v45, v45, v33
    v_or3_b32 v46, v46, v32, v33
    v_and_b32 v45, v45, v34
    v_and_b32 v45, v45, v35
    v_or3_b32 v46, v46, v34, v35
    v_and_b32 v45, v45, v36
    v_and_b32 v45, v45, v37
    v_or3_b32 v46, v46, v36, v37
    v_and_b32 v45, v45, v38
    v_and_b32 v45, v45, v39
    v_or3_b32 v46, v46, v38, v39
    v_and_b32 v45, v45, v40
    v_and_b32 v45, v45, v41
    v_or3_b32 v46, v46, v40, v41
    v_and_b32 v45, v45, v42
    v_and_b32 v45, v45, v43
    v_or3_b32 v46, v46, v42, v43
    v_xor_b32 v45, s23, v45
    v_xor_b32 v46, s23, v46
    v_or_b32 v45, v45, v46
    v_and_b32 v45, 3, v45
    v_cmp_ne_u32 vcc, 0, v45
    s_nop 1
    s_cbranch_vccnz L_p1retB_42

    v_add_f32 v72, v24, v28
    v_add_f32_dpp v68, v40, v40 row_shr:1 row_mask:0xf bank_mask:0xf bound_ctrl:0
    v_add_f32 v73, v25, v29
    v_add_f32_dpp v69, v41, v41 row_shr:1 row_mask:0xf bank_mask:0xf bound_ctrl:0
    v_add_f32 v74, v26, v30
    v_add_f32_dpp v70, v42, v42 row_shr:1 row_mask:0xf bank_mask:0xf bound_ctrl:0
    v_add_f32 v75, v27, v31
    v_add_f32_dpp v71, v43, v43 row_shr:1 row_mask:0xf bank_mask:0xf bound_ctrl:0
    v_add_f32 v72, v72, v32
    v_add_f32_dpp v68, v68, v68 row_shr:2 row_mask:0xf bank_mask:0xf bound_ctrl:0
    v_add_f32 v73, v73, v33
    v_add_f32_dpp v69, v69, v69 row_shr:2 row_mask:0xf bank_mask:0xf bound_ctrl:0
    v_add_f32 v74, v74, v34
    v_add_f32_dpp v70, v70, v70 row_shr:2 row_mask:0xf bank_mask:0xf bound_ctrl:0
    v_add_f32 v75, v75, v35
    v_add_f32_dpp v71, v71, v71 row_shr:2 row_mask:0xf bank_mask:0xf bound_ctrl:0
    v_add_f32 v72, v72, v36
    v_add_f32_dpp v68, v68, v68 row_shr:4 row_mask:0xf bank_mask:0xf bound_ctrl:0
    v_add_f32 v73, v73, v37
    v_add_f32_dpp v69, v69, v69 row_shr:4 row_mask:0xf bank_mask:0xf bound_ctrl:0
    v_add_f32 v74, v74, v38
    v_add_f32_dpp v70, v70, v70 row_shr:4 row_mask:0xf bank_mask:0xf bound_ctrl:0
    v_add_f32 v75, v75, v39
    v_add_f32_dpp v71, v71, v71 row_shr:4 row_mask:0xf bank_mask:0xf bound_ctrl:0
    s_branch L_p1join_43
L_p1retB_42:
    buffer_load_dwordx4 v[24:27], v44, s[64:67], s35 offen sc1
    buffer_load_dwordx4 v[28:31], v44, s[64:67], s37 offen sc1
    buffer_load_dwordx4 v[32:35], v44, s[64:67], s38 offen sc1
    buffer_load_dwordx4 v[36:39], v44, s[64:67], s39 offen sc1
    buffer_load_dwordx4 v[40:43], v47, s[64:67], s36 offen sc1
    s_add_u32 s32, s32, 1
    s_cmp_gt_u32 s32, 100000
    s_cbranch_scc1 L_poll1x_40
    s_branch L_poll1_39

L_p1join_43:
    v_add_f32_dpp v72, v72, v72 row_shr:8 row_mask:0xf bank_mask:0xf bound_ctrl:0
    v_add_f32_dpp v68, v68, v68 row_shr:8 row_mask:0xf bank_mask:0xf bound_ctrl:0
    v_add_f32_dpp v73, v73, v73 row_shr:8 row_mask:0xf bank_mask:0xf bound_ctrl:0
    v_add_f32_dpp v69, v69, v69 row_shr:8 row_mask:0xf bank_mask:0xf bound_ctrl:0
    v_add_f32_dpp v74, v74, v74 row_shr:8 row_mask:0xf bank_mask:0xf bound_ctrl:0
    v_add_f32_dpp v70, v70, v70 row_shr:8 row_mask:0xf bank_mask:0xf bound_ctrl:0
    v_add_f32_dpp v75, v75, v75 row_shr:8 row_mask:0xf bank_mask:0xf bound_ctrl:0
    v_add_f32_dpp v71, v71, v71 row_shr:8 row_mask:0xf bank_mask:0xf bound_ctrl:0
    v_mov_b32 v56, v72
    v_mov_b32 v60, v68
    v_mov_b32 v57, v73
    v_mov_b32 v61, v69
    v_mov_b32 v58, v74
    v_mov_b32 v62, v70
    v_mov_b32 v59, v75
    v_mov_b32 v63, v71
    s_nop 0
    v_permlane16_swap_b32 v72, v56
    v_permlane16_swap_b32 v68, v60
    v_permlane16_swap_b32 v73, v57
    v_permlane16_swap_b32 v69, v61
    v_permlane16_swap_b32 v74, v58
    v_permlane16_swap_b32 v70, v62
    v_permlane16_swap_b32 v75, v59
    v_permlane16_swap_b32 v71, v63
    s_nop 0
    v_add_f32 v72, v72, v56
    v_add_f32 v68, v68, v60
    v_add_f32 v73, v73, v57
    v_add_f32 v69, v69, v61
    v_add_f32 v74, v74, v58
    v_add_f32 v70, v70, v62
    v_add_f32 v75, v75, v59
    v_add_f32 v71, v71, v63
    v_mov_b32 v56, v72
    v_mov_b32 v57, v73
    v_mov_b32 v58, v74
    v_mov_b32 v59, v75
    s_nop 1
    v_permlane32_swap_b32 v72, v56
    v_permlane32_swap_b32 v73, v57
    v_permlane32_swap_b32 v74, v58
    v_permlane32_swap_b32 v75, v59
    s_nop 0
    v_add_f32 v72, v72, v56
    v_add_f32 v73, v73, v57
    v_add_f32 v74, v74, v58
    v_add_f32 v75, v75, v59
    s_mov_b64 exec, 0x80000000
    v_mov_b32 v72, v68
    v_mov_b32 v73, v69
    v_mov_b32 v74, v70
    v_mov_b32 v75, v71
    s_mov_b64 exec, -1
    v_and_b32 v47, 7, v0
    v_lshlrev_b32 v47, 4, v47
    s_lshl_b32 s36, s21, 7
    v_add_u32 v47, s36, v47
    s_lshl_b32 s36, s21, 4
    s_add_u32 s36, s36, 512
    s_mov_b64 exec, 0x80000000
    v_mov_b32 v47, s36
    s_mov_b64 exec, -1

    v_cvt_pk_bf16_f32 v46, v72, v73
    v_lshlrev_b32 v72, 16, v46
    v_and_b32 v73, 0xffff0000, v46
    v_or_b32 v72, s23, v72
    v_or_b32 v73, s23, v73

    v_cvt_pk_bf16_f32 v46, v74, v75
    v_lshlrev_b32 v74, 16, v46
    v_and_b32 v75, 0xffff0000, v46
    v_or_b32 v74, s23, v74
    v_or_b32 v75, s23, v75

    s_mul_i32 s35, s20, 576
    s_add_u32 s35, s35, s25
    s_mov_b64 exec, 0x8000ff00
    buffer_store_dwordx4 v[72:75], v47, s[68:71], s35 offen sc1
    s_mov_b64 exec, -1

    s_add_u32 s22, s22, 1
    v_lshlrev_b32 v44, 4, v0

    s_cmp_lg_u32 s21, 3
    s_cbranch_scc1 L_nowflag_44
    s_add_u32 s38, s22, 1
    s_and_b32 s39, s38, 3
    s_cmp_lg_u32 s39, 0
    s_cbranch_scc1 L_nowflag_44
    s_cmp_ge_u32 s38, 64
    s_cbranch_scc1 L_nowflag_44
    s_lshr_b32 s39, s38, 2
    s_add_u32 s39, s39, 16
    s_lshl_b32 s39, s39, 5
    s_add_u32 s39, s39, s20
    s_lshl_b32 s39, s39, 2
    v_and_b32 v45, 1, v0
    v_lshlrev_b32 v45, 11, v45
    s_mov_b32 s32, 0

L_wflag_45:
    buffer_load_dword v46, v45, s[96:99], s39 offen sc1
    s_add_u32 s32, s32, 1
    s_waitcnt vmcnt(0)
    v_cmp_eq_u32 vcc, 0, v46
    s_cmp_gt_u32 s32, 100000
    s_cbranch_scc1 L_nowflag_44
    s_cbranch_vccnz L_wflag_45

L_nowflag_44:
    s_add_u32 s34, s25, 0
    s_add_u32 s35, s25, 4096
    s_add_u32 s36, s25, 8192
    s_add_u32 s37, s25, 12288
    s_add_u32 s38, s25, 16384
    s_cmp_ge_u32 s21, 2
    s_cselect_b32 s38, s34, s38
    s_mov_b32 s32, 0

L_poll2_46:
    s_add_u32 s32, s32, 1
    s_cmp_gt_u32 s32, 100000
    s_cbranch_scc1 L_poll2x_47

    buffer_load_dwordx4 v[56:59], v44, s[68:71], s34 offen sc1
    buffer_load_dwordx4 v[60:63], v44, s[68:71], s35 offen sc1
    buffer_load_dwordx4 v[64:67], v44, s[68:71], s36 offen sc1
    buffer_load_dwordx4 v[68:71], v44, s[68:71], s37 offen sc1
    buffer_load_dwordx4 v[72:75], v44, s[68:71], s38 offen sc1
    s_waitcnt vmcnt(0)
    v_and_b32 v45, v56, v57
    v_or_b32 v46, v56, v57
    v_and_b32 v45, v45, v58
    v_and_b32 v45, v45, v59
    v_or3_b32 v46, v46, v58, v59
    v_and_b32 v45, v45, v60
    v_and_b32 v45, v45, v61
    v_or3_b32 v46, v46, v60, v61
    v_and_b32 v45, v45, v62
    v_and_b32 v45, v45, v63
    v_or3_b32 v46, v46, v62, v63
    v_and_b32 v45, v45, v64
    v_and_b32 v45, v45, v65
    v_or3_b32 v46, v46, v64, v65
    v_and_b32 v45, v45, v66
    v_and_b32 v45, v45, v67
    v_or3_b32 v46, v46, v66, v67
    v_and_b32 v45, v45, v68
    v_and_b32 v45, v45, v69
    v_or3_b32 v46, v46, v68, v69
    v_and_b32 v45, v45, v70
    v_and_b32 v45, v45, v71
    v_or3_b32 v46, v46, v70, v71
    v_and_b32 v45, v45, v72
    v_and_b32 v45, v45, v73
    v_or3_b32 v46, v46, v72, v73
    v_and_b32 v45, v45, v74
    v_and_b32 v45, v45, v75
    v_or3_b32 v46, v46, v74, v75
    v_xor_b32 v45, s23, v45
    v_xor_b32 v46, s23, v46
    v_or_b32 v45, v45, v46
    v_and_b32 v45, 3, v45
    v_cmp_ne_u32 vcc, 0, v45
    s_nop 1
    s_cbranch_vccnz L_poll2_46

L_poll2x_47:
    v_perm_b32 v56, v57, v56, s33
    v_perm_b32 v57, v59, v58, s33
    ds_write_b64 v48, v[56:57]

    v_perm_b32 v60, v61, v60, s33
    v_perm_b32 v61, v63, v62, s33
    ds_write_b64 v49, v[60:61]

    v_perm_b32 v64, v65, v64, s33
    v_perm_b32 v65, v67, v66, s33
    ds_write_b64 v50, v[64:65]

    v_perm_b32 v68, v69, v68, s33
    v_perm_b32 v69, v71, v70, s33
    ds_write_b64 v51, v[68:69]

    s_cmp_ge_u32 s21, 2
    s_cbranch_scc1 L_skip4_48

    v_perm_b32 v72, v73, v72, s33
    v_perm_b32 v73, v75, v74, s33
    ds_write_b64 v52, v[72:73]

L_skip4_48:
    v_and_b32 v76, 15, v0
    v_bfe_u32 v77, v0, 4, 2
    v_lshlrev_b32 v78, 13, v76
    v_lshl_add_u32 v78, v77, 4, v78
    s_lshl_b32 s17, s22, 18
    s_lshl_b32 s18, s20, 8
    s_add_u32 s17, s17, s18
    s_add_u32 s18, s17, 131072
    v_lshlrev_b32 v79, 6, v76
    v_lshl_add_u32 v79, v77, 3, v79
    s_lshl_b32 s19, s21, 11
    v_add_u32 v79, s19, v79
    s_lshl_b32 s19, s22, 5
    s_add_u32 s19, s19, s20
    s_lshl_b32 s19, s19, 13

    buffer_load_dwordx4 v[4:7], v78, s[48:51], s17 offen offset:0
    buffer_load_dwordx4 v[20:23], v78, s[48:51], s18 offen offset:0
    buffer_load_dwordx4 v[8:11], v78, s[48:51], s17 offen offset:64
    buffer_load_dwordx4 v[24:27], v78, s[48:51], s18 offen offset:64
    buffer_load_dwordx4 v[12:15], v78, s[48:51], s17 offen offset:128
    buffer_load_dwordx4 v[28:31], v78, s[48:51], s18 offen offset:128
    buffer_load_dwordx4 v[16:19], v78, s[48:51], s17 offen offset:192
    buffer_load_dwordx4 v[32:35], v78, s[48:51], s18 offen offset:192
    buffer_load_dwordx2 v[36:37], v79, s[52:55], s19 offen offset:0
    buffer_load_dwordx2 v[38:39], v79, s[52:55], s19 offen offset:32
    buffer_load_dwordx2 v[40:41], v79, s[52:55], s19 offen offset:1024
    buffer_load_dwordx2 v[42:43], v79, s[52:55], s19 offen offset:1056
    s_waitcnt lgkmcnt(0)
    s_barrier

    s_cmp_lg_u32 s21, 1
    s_cbranch_scc1 L_noprog_49
    s_lshl_b32 s36, s20, 6
    v_mov_b32 v45, 8192
    v_mov_b32 v46, s22
    s_mov_b64 exec, 1
    buffer_store_dword v46, v45, s[96:99], s36 offen sc1
    s_mov_b64 exec, -1

L_noprog_49:
    s_branch L_step_33
L_chain_done_34:
    s_waitcnt vmcnt(0)
    s_barrier
    s_lshl_b32 s36, s20, 6
    v_mov_b32 v45, 8192
    v_mov_b32 v46, 64
    v_cmp_eq_u32 vcc, 0, v0
    s_and_saveexec_b64 s[76:77], vcc
    buffer_store_dword v46, v45, s[96:99], s36 offen sc1
    s_mov_b64 exec, s[76:77]

    s_branch L_end_1
L_worker_2:
    s_mov_b32 s80, s0
    s_mov_b32 s81, s1
    s_sub_u32 s64, s3, 32
    v_mov_b32 v168, v0
    v_accvgpr_write_b32 a0, v0
    v_and_b32 v169, 63, v0

    s_mov_b32 s65, 0
    s_mov_b32 s66, s64
    s_load_dwordx2 s[4:5], s[0:1], 120
    s_waitcnt lgkmcnt(0)
    s_add_u32 s68, s4, 135462912
    s_addc_u32 s69, s5, 0
    s_and_b32 s69, s69, 0xffff
    s_mov_b32 s70, 65536
    s_mov_b32 s71, 0x00020000

    s_load_dwordx2 s[6:7], s[80:81], 0
    s_sub_u32 s66, s64, 32
    s_cmp_lt_u32 s64, 64
    s_cselect_b32 s66, 512, s66
    s_cmp_lt_u32 s64, 32
    s_cselect_b32 s66, s64, s66
    s_movk_i32 s65, 160
    s_cselect_b32 s65, 512, s65
    s_waitcnt lgkmcnt(0)

    s_mov_b32 s8, s6
    s_and_b32 s9, s7, 0xffff
    s_mov_b32 s10, 2359296
    s_mov_b32 s11, 0x00020000

    s_add_u32 s12, s4, 65536
    s_addc_u32 s13, s5, 0
    s_and_b32 s13, s13, 0xffff
    s_mov_b32 s14, 2359296
    s_mov_b32 s15, 0x00020000

    s_add_u32 s16, s4, 0
    s_addc_u32 s17, s5, 0
    s_and_b32 s17, s17, 0xffff
    s_mov_b32 s18, 13824
    s_mov_b32 s19, 0x00020000

    v_accvgpr_read_b32 v168, a0
    s_nop 0
    v_and_b32 v169, 63, v168

    v_mov_b32 v0, v168
    v_and_b32 v1, 63, v0
    v_lshrrev_b32 v2, 6, v0
    s_nop 0
    v_readfirstlane_b32 s20, v2
    v_lshlrev_b32 v3, 4, v1
    v_lshlrev_b32 v2, 5, v1
    v_cmp_gt_u32 vcc, 8, v1
    s_mov_b64 s[44:45], vcc
    s_mov_b32 s22, 2304
    s_mov_b32 s23, 0
    buffer_load_dwordx4 v[40:43], v2, s[16:19], s22 offen sc1
    buffer_load_dwordx4 v[44:47], v2, s[16:19], s22 offen offset:16 sc1
    buffer_load_dwordx4 v[48:51], v2, s[16:19], s23 offen sc1
    buffer_load_dwordx4 v[52:55], v2, s[16:19], s23 offen offset:16 sc1
    s_mov_b64 exec, s[44:45]
    buffer_load_dwordx4 v[56:59], v2, s[16:19], s22 offen offset:2048 sc1
    buffer_load_dwordx4 v[60:63], v2, s[16:19], s22 offen offset:2064 sc1
    buffer_load_dwordx4 v[64:67], v2, s[16:19], s23 offen offset:2048 sc1
    buffer_load_dwordx4 v[68:71], v2, s[16:19], s23 offen offset:2064 sc1
    s_mov_b64 exec, -1
    s_waitcnt vmcnt(0)

    v_add_f32 v40, 1.0, v40
    v_add_f32 v41, 1.0, v41
    v_cvt_pk_bf16_f32 v33, v40, v41
    v_lshlrev_b32 v40, 16, v33
    v_and_b32 v41, 0xffff0000, v33

    v_add_f32 v42, 1.0, v42
    v_add_f32 v43, 1.0, v43
    v_cvt_pk_bf16_f32 v33, v42, v43
    v_lshlrev_b32 v42, 16, v33
    v_and_b32 v43, 0xffff0000, v33

    v_add_f32 v44, 1.0, v44
    v_add_f32 v45, 1.0, v45
    v_cvt_pk_bf16_f32 v33, v44, v45
    v_lshlrev_b32 v44, 16, v33
    v_and_b32 v45, 0xffff0000, v33

    v_add_f32 v46, 1.0, v46
    v_add_f32 v47, 1.0, v47
    v_cvt_pk_bf16_f32 v33, v46, v47
    v_lshlrev_b32 v46, 16, v33
    v_and_b32 v47, 0xffff0000, v33

    v_add_f32 v56, 1.0, v56
    v_add_f32 v57, 1.0, v57
    v_cvt_pk_bf16_f32 v33, v56, v57
    v_lshlrev_b32 v56, 16, v33
    v_and_b32 v57, 0xffff0000, v33

    v_add_f32 v58, 1.0, v58
    v_add_f32 v59, 1.0, v59
    v_cvt_pk_bf16_f32 v33, v58, v59
    v_lshlrev_b32 v58, 16, v33
    v_and_b32 v59, 0xffff0000, v33

    v_add_f32 v60, 1.0, v60
    v_add_f32 v61, 1.0, v61
    v_cvt_pk_bf16_f32 v33, v60, v61
    v_lshlrev_b32 v60, 16, v33
    v_and_b32 v61, 0xffff0000, v33

    v_add_f32 v62, 1.0, v62
    v_add_f32 v63, 1.0, v63
    v_cvt_pk_bf16_f32 v33, v62, v63
    v_lshlrev_b32 v62, 16, v33
    v_and_b32 v63, 0xffff0000, v33

L_lnloop_50:
    s_cmp_ge_u32 s66, 512
    s_cbranch_scc1 L_lnx_51
    s_lshl_b32 s21, s66, 2
    s_add_u32 s21, s21, s20
    s_mul_i32 s21, s21, 1152
    v_mov_b32 v8, 0
    v_mov_b32 v9, 0
    v_mov_b32 v10, 0
    v_mov_b32 v11, 0
    buffer_load_dwordx4 v[4:7], v3, s[8:11], s21 offen
    s_mov_b64 exec, s[44:45]
    buffer_load_dwordx4 v[8:11], v3, s[8:11], s21 offen offset:1024
    s_mov_b64 exec, -1
    s_waitcnt vmcnt(0)

    v_lshlrev_b32 v16, 16, v4
    v_and_b32 v17, 0xffff0000, v4
    v_lshlrev_b32 v18, 16, v5
    v_and_b32 v19, 0xffff0000, v5
    v_lshlrev_b32 v20, 16, v6
    v_and_b32 v21, 0xffff0000, v6
    v_lshlrev_b32 v22, 16, v7
    v_and_b32 v23, 0xffff0000, v7
    v_lshlrev_b32 v24, 16, v8
    v_and_b32 v25, 0xffff0000, v8
    v_lshlrev_b32 v26, 16, v9
    v_and_b32 v27, 0xffff0000, v9
    v_lshlrev_b32 v28, 16, v10
    v_and_b32 v29, 0xffff0000, v10
    v_lshlrev_b32 v30, 16, v11
    v_and_b32 v31, 0xffff0000, v11
    v_add_f32 v32, v16, v17
    v_add_f32 v32, v32, v18
    v_add_f32 v32, v32, v19
    v_add_f32 v32, v32, v20
    v_add_f32 v32, v32, v21
    v_add_f32 v32, v32, v22
    v_add_f32 v32, v32, v23
    v_add_f32 v32, v32, v24
    v_add_f32 v32, v32, v25
    v_add_f32 v32, v32, v26
    v_add_f32 v32, v32, v27
    v_add_f32 v32, v32, v28
    v_add_f32 v32, v32, v29
    v_add_f32 v32, v32, v30
    v_add_f32 v32, v32, v31
    ds_swizzle_b32 v33, v32 offset:1055
    s_waitcnt lgkmcnt(0)
    v_add_f32 v32, v32, v33

    ds_swizzle_b32 v33, v32 offset:2079
    s_waitcnt lgkmcnt(0)
    v_add_f32 v32, v32, v33

    ds_swizzle_b32 v33, v32 offset:4127
    s_waitcnt lgkmcnt(0)
    v_add_f32 v32, v32, v33

    ds_swizzle_b32 v33, v32 offset:8223
    s_waitcnt lgkmcnt(0)
    v_add_f32 v32, v32, v33

    ds_swizzle_b32 v33, v32 offset:16415
    s_waitcnt lgkmcnt(0)
    v_add_f32 v32, v32, v33

    s_nop 1
    v_readlane_b32 s26, v32, 32
    s_nop 3
    v_add_f32 v32, s26, v32
    s_nop 1
    v_readlane_b32 s26, v32, 0
    s_nop 3

    v_mov_b32 v33, 0x3ae38e39
    v_mul_f32 v34, s26, v33
    v_mov_b32 v32, 0
    v_sub_f32 v33, v16, v34
    v_fmac_f32 v32, v33, v33
    v_sub_f32 v33, v17, v34
    v_fmac_f32 v32, v33, v33
    v_sub_f32 v33, v18, v34
    v_fmac_f32 v32, v33, v33
    v_sub_f32 v33, v19, v34
    v_fmac_f32 v32, v33, v33
    v_sub_f32 v33, v20, v34
    v_fmac_f32 v32, v33, v33
    v_sub_f32 v33, v21, v34
    v_fmac_f32 v32, v33, v33
    v_sub_f32 v33, v22, v34
    v_fmac_f32 v32, v33, v33
    v_sub_f32 v33, v23, v34
    v_fmac_f32 v32, v33, v33
    s_mov_b64 exec, s[44:45]
    v_sub_f32 v33, v24, v34
    v_fmac_f32 v32, v33, v33
    v_sub_f32 v33, v25, v34
    v_fmac_f32 v32, v33, v33
    v_sub_f32 v33, v26, v34
    v_fmac_f32 v32, v33, v33
    v_sub_f32 v33, v27, v34
    v_fmac_f32 v32, v33, v33
    v_sub_f32 v33, v28, v34
    v_fmac_f32 v32, v33, v33
    v_sub_f32 v33, v29, v34
    v_fmac_f32 v32, v33, v33
    v_sub_f32 v33, v30, v34
    v_fmac_f32 v32, v33, v33
    v_sub_f32 v33, v31, v34
    v_fmac_f32 v32, v33, v33
    s_mov_b64 exec, -1
    ds_swizzle_b32 v33, v32 offset:1055
    s_waitcnt lgkmcnt(0)
    v_add_f32 v32, v32, v33

    ds_swizzle_b32 v33, v32 offset:2079
    s_waitcnt lgkmcnt(0)
    v_add_f32 v32, v32, v33

    ds_swizzle_b32 v33, v32 offset:4127
    s_waitcnt lgkmcnt(0)
    v_add_f32 v32, v32, v33

    ds_swizzle_b32 v33, v32 offset:8223
    s_waitcnt lgkmcnt(0)
    v_add_f32 v32, v32, v33

    ds_swizzle_b32 v33, v32 offset:16415
    s_waitcnt lgkmcnt(0)
    v_add_f32 v32, v32, v33

    s_nop 1
    v_readlane_b32 s26, v32, 32
    s_nop 3
    v_add_f32 v32, s26, v32
    s_nop 1
    v_readlane_b32 s26, v32, 0
    s_nop 3

    v_mov_b32 v33, 0x3ae38e39
    v_mul_f32 v35, s26, v33
    v_cvt_pk_bf16_f32 v33, v34, v35
    v_lshlrev_b32 v34, 16, v33
    v_and_b32 v35, 0xffff0000, v33

    v_add_f32 v35, 0x3727c5ac, v35
    v_cvt_pk_bf16_f32 v33, v35, v35
    v_lshlrev_b32 v35, 16, v33

    v_sqrt_f32 v35, v35
    s_nop 0
    v_cvt_pk_bf16_f32 v33, v35, v35
    v_lshlrev_b32 v35, 16, v33

    v_rcp_f32 v35, v35
    s_nop 0
    v_sub_f32 v16, v16, v34
    v_sub_f32 v17, v17, v34
    v_cvt_pk_bf16_f32 v33, v16, v17
    v_lshlrev_b32 v16, 16, v33
    v_and_b32 v17, 0xffff0000, v33

    v_mul_f32 v16, v16, v35
    v_mul_f32 v17, v17, v35
    v_cvt_pk_bf16_f32 v33, v16, v17
    v_lshlrev_b32 v16, 16, v33
    v_and_b32 v17, 0xffff0000, v33

    v_mul_f32 v16, v16, v40
    v_mul_f32 v17, v17, v41
    v_cvt_pk_bf16_f32 v33, v16, v17
    v_lshlrev_b32 v16, 16, v33
    v_and_b32 v17, 0xffff0000, v33

    v_add_f32 v16, v16, v48
    v_add_f32 v17, v17, v49
    v_cvt_pk_bf16_f32 v4, v16, v17

    v_sub_f32 v18, v18, v34
    v_sub_f32 v19, v19, v34
    v_cvt_pk_bf16_f32 v33, v18, v19
    v_lshlrev_b32 v18, 16, v33
    v_and_b32 v19, 0xffff0000, v33

    v_mul_f32 v18, v18, v35
    v_mul_f32 v19, v19, v35
    v_cvt_pk_bf16_f32 v33, v18, v19
    v_lshlrev_b32 v18, 16, v33
    v_and_b32 v19, 0xffff0000, v33

    v_mul_f32 v18, v18, v42
    v_mul_f32 v19, v19, v43
    v_cvt_pk_bf16_f32 v33, v18, v19
    v_lshlrev_b32 v18, 16, v33
    v_and_b32 v19, 0xffff0000, v33

    v_add_f32 v18, v18, v50
    v_add_f32 v19, v19, v51
    v_cvt_pk_bf16_f32 v5, v18, v19

    v_sub_f32 v20, v20, v34
    v_sub_f32 v21, v21, v34
    v_cvt_pk_bf16_f32 v33, v20, v21
    v_lshlrev_b32 v20, 16, v33
    v_and_b32 v21, 0xffff0000, v33

    v_mul_f32 v20, v20, v35
    v_mul_f32 v21, v21, v35
    v_cvt_pk_bf16_f32 v33, v20, v21
    v_lshlrev_b32 v20, 16, v33
    v_and_b32 v21, 0xffff0000, v33

    v_mul_f32 v20, v20, v44
    v_mul_f32 v21, v21, v45
    v_cvt_pk_bf16_f32 v33, v20, v21
    v_lshlrev_b32 v20, 16, v33
    v_and_b32 v21, 0xffff0000, v33

    v_add_f32 v20, v20, v52
    v_add_f32 v21, v21, v53
    v_cvt_pk_bf16_f32 v6, v20, v21

    v_sub_f32 v22, v22, v34
    v_sub_f32 v23, v23, v34
    v_cvt_pk_bf16_f32 v33, v22, v23
    v_lshlrev_b32 v22, 16, v33
    v_and_b32 v23, 0xffff0000, v33

    v_mul_f32 v22, v22, v35
    v_mul_f32 v23, v23, v35
    v_cvt_pk_bf16_f32 v33, v22, v23
    v_lshlrev_b32 v22, 16, v33
    v_and_b32 v23, 0xffff0000, v33

    v_mul_f32 v22, v22, v46
    v_mul_f32 v23, v23, v47
    v_cvt_pk_bf16_f32 v33, v22, v23
    v_lshlrev_b32 v22, 16, v33
    v_and_b32 v23, 0xffff0000, v33

    v_add_f32 v22, v22, v54
    v_add_f32 v23, v23, v55
    v_cvt_pk_bf16_f32 v7, v22, v23

    v_sub_f32 v24, v24, v34
    v_sub_f32 v25, v25, v34
    v_cvt_pk_bf16_f32 v33, v24, v25
    v_lshlrev_b32 v24, 16, v33
    v_and_b32 v25, 0xffff0000, v33

    v_mul_f32 v24, v24, v35
    v_mul_f32 v25, v25, v35
    v_cvt_pk_bf16_f32 v33, v24, v25
    v_lshlrev_b32 v24, 16, v33
    v_and_b32 v25, 0xffff0000, v33

    v_mul_f32 v24, v24, v56
    v_mul_f32 v25, v25, v57
    v_cvt_pk_bf16_f32 v33, v24, v25
    v_lshlrev_b32 v24, 16, v33
    v_and_b32 v25, 0xffff0000, v33

    v_add_f32 v24, v24, v64
    v_add_f32 v25, v25, v65
    v_cvt_pk_bf16_f32 v8, v24, v25

    v_sub_f32 v26, v26, v34
    v_sub_f32 v27, v27, v34
    v_cvt_pk_bf16_f32 v33, v26, v27
    v_lshlrev_b32 v26, 16, v33
    v_and_b32 v27, 0xffff0000, v33

    v_mul_f32 v26, v26, v35
    v_mul_f32 v27, v27, v35
    v_cvt_pk_bf16_f32 v33, v26, v27
    v_lshlrev_b32 v26, 16, v33
    v_and_b32 v27, 0xffff0000, v33

    v_mul_f32 v26, v26, v58
    v_mul_f32 v27, v27, v59
    v_cvt_pk_bf16_f32 v33, v26, v27
    v_lshlrev_b32 v26, 16, v33
    v_and_b32 v27, 0xffff0000, v33

    v_add_f32 v26, v26, v66
    v_add_f32 v27, v27, v67
    v_cvt_pk_bf16_f32 v9, v26, v27

    v_sub_f32 v28, v28, v34
    v_sub_f32 v29, v29, v34
    v_cvt_pk_bf16_f32 v33, v28, v29
    v_lshlrev_b32 v28, 16, v33
    v_and_b32 v29, 0xffff0000, v33

    v_mul_f32 v28, v28, v35
    v_mul_f32 v29, v29, v35
    v_cvt_pk_bf16_f32 v33, v28, v29
    v_lshlrev_b32 v28, 16, v33
    v_and_b32 v29, 0xffff0000, v33

    v_mul_f32 v28, v28, v60
    v_mul_f32 v29, v29, v61
    v_cvt_pk_bf16_f32 v33, v28, v29
    v_lshlrev_b32 v28, 16, v33
    v_and_b32 v29, 0xffff0000, v33

    v_add_f32 v28, v28, v68
    v_add_f32 v29, v29, v69
    v_cvt_pk_bf16_f32 v10, v28, v29

    v_sub_f32 v30, v30, v34
    v_sub_f32 v31, v31, v34
    v_cvt_pk_bf16_f32 v33, v30, v31
    v_lshlrev_b32 v30, 16, v33
    v_and_b32 v31, 0xffff0000, v33

    v_mul_f32 v30, v30, v35
    v_mul_f32 v31, v31, v35
    v_cvt_pk_bf16_f32 v33, v30, v31
    v_lshlrev_b32 v30, 16, v33
    v_and_b32 v31, 0xffff0000, v33

    v_mul_f32 v30, v30, v62
    v_mul_f32 v31, v31, v63
    v_cvt_pk_bf16_f32 v33, v30, v31
    v_lshlrev_b32 v30, 16, v33
    v_and_b32 v31, 0xffff0000, v33

    v_add_f32 v30, v30, v70
    v_add_f32 v31, v31, v71
    v_cvt_pk_bf16_f32 v11, v30, v31

    buffer_store_dwordx4 v[4:7], v3, s[12:15], s21 offen sc1
    s_mov_b64 exec, s[44:45]
    buffer_store_dwordx4 v[8:11], v3, s[12:15], s21 offen offset:1024 sc1
    s_mov_b64 exec, -1
    s_lshr_b32 s72, s66, 5
    s_lshl_b32 s72, s72, 6

    v_accvgpr_read_b32 v168, a0
    s_nop 0
    v_and_b32 v169, 63, v168

    s_waitcnt vmcnt(0)
    s_barrier
    v_cmp_eq_u32 vcc, 0, v168
    s_and_saveexec_b64 s[76:77], vcc
    s_cbranch_execz L_sig_52
    v_mov_b32 v140, 17408
    v_mov_b32 v141, 1

    buffer_atomic_add v141, v140, s[68:71], s72 offen
L_sig_52:
    s_mov_b64 exec, s[76:77]
    s_add_u32 s66, s66, s65
    s_branch L_lnloop_50

L_lnx_51:
    s_mov_b32 s66, s64
L_qloop_53:
    s_cmp_ge_u32 s66, 1536
    s_cbranch_scc1 L_qloopx_54
    s_and_b32 s34, s66, 31
    s_cmp_ge_u32 s66, 1024
    s_cbranch_scc1 L_qdec2_55
    s_lshr_b32 s32, s66, 6
    s_lshr_b32 s33, s66, 5
    s_and_b32 s33, s33, 1
    s_add_u32 s33, s33, 1
    s_branch L_qdec3_56

L_qdec2_55:
    s_sub_u32 s32, s66, 1024
    s_lshr_b32 s32, s32, 5
    s_mov_b32 s33, 0

L_qdec3_56:
    s_lshl_b32 s72, s32, 6
    v_accvgpr_read_b32 v168, a0
    s_nop 0
    v_and_b32 v169, 63, v168

    v_lshrrev_b32 v140, 6, v168
    s_nop 0
    v_readfirstlane_b32 s78, v140
    s_cmp_lg_u32 s78, 0
    s_cbranch_scc1 L_wpollx_58
    v_mov_b32 v140, 17408
    s_mov_b32 s79, 0

L_wpoll_57:
    buffer_load_dword v141, v140, s[68:71], s72 offen sc1
    s_add_u32 s79, s79, 1
    s_waitcnt vmcnt(0)
    v_readfirstlane_b32 s78, v141
    s_cmp_ge_u32 s78, 32
    s_cbranch_scc1 L_wpollx_58
    s_cmp_gt_u32 s79, 200000
    s_cbranch_scc1 L_wpollx_58
    s_sleep 24
    s_branch L_wpoll_57

L_wpollx_58:
    s_barrier
    s_load_dwordx4 s[44:47], s[80:81], 16
    s_load_dwordx2 s[48:49], s[80:81], 32
    s_lshl_b32 s30, s32, 7
    s_waitcnt lgkmcnt(0)
    s_cmp_eq_u32 s33, 1
    s_cselect_b32 s6, s46, s44
    s_cselect_b32 s7, s47, s45
    s_cmp_eq_u32 s33, 2
    s_cselect_b32 s6, s48, s6
    s_cselect_b32 s7, s49, s7

    s_add_u32 s8, s4, 65536
    s_addc_u32 s9, s5, 0
    s_and_b32 s9, s9, 0xffff
    s_mov_b32 s10, 2359296
    s_mov_b32 s11, 0x00020000

    s_mov_b32 s12, s6
    s_and_b32 s13, s7, 0xffff
    s_mov_b32 s14, 4718592
    s_mov_b32 s15, 0x00020000

    s_mul_i32 s35, s30, 1152
    s_lshl_b32 s36, s34, 8

    s_add_u32 s20, s35, 0
    s_add_u32 s24, s36, 0
    s_add_u32 s21, s35, 36864
    s_add_u32 s25, s36, 131072
    s_add_u32 s22, s35, 73728
    s_add_u32 s26, s36, 262144
    s_add_u32 s23, s35, 110592
    s_add_u32 s27, s36, 393216
    v_mov_b32 v0, v168
    v_mov_b32 v168, v0
    v_and_b32 v169, 63, v0
    v_lshrrev_b32 v140, 3, v0
    v_and_b32 v141, 7, v0
    s_mov_b32 s40, 1152
    v_mul_lo_u32 v128, v140, s40
    v_lshl_add_u32 v128, v141, 4, v128
    v_lshrrev_b32 v142, 4, v0
    v_and_b32 v142, 7, v142
    v_xor_b32 v142, v142, v141
    v_lshlrev_b32 v142, 4, v142
    v_lshl_add_u32 v130, v140, 7, v142

    v_lshrrev_b32 v140, 4, v0
    v_and_b32 v141, 15, v0
    s_mov_b32 s40, 8192
    v_mul_lo_u32 v129, v140, s40
    v_lshl_add_u32 v129, v141, 4, v129

    v_lshrrev_b32 v142, 2, v141
    v_and_b32 v143, 3, v140
    v_xor_b32 v142, v142, v143
    v_lshlrev_b32 v142, 6, v142
    v_and_b32 v143, 3, v141
    v_lshl_add_u32 v142, v143, 4, v142
    v_lshl_add_u32 v131, v140, 8, v142
    v_add_u32 v131, 16384, v131
    v_lshrrev_b32 v140, 7, v0
    v_and_b32 v141, 31, v0
    v_lshl_add_u32 v140, v140, 6, v141
    v_lshrrev_b32 v141, 1, v140
    v_and_b32 v141, 7, v141
    v_lshrrev_b32 v142, 5, v169

    v_add_u32 v143, 0, v142
    v_xor_b32 v143, v143, v141
    v_lshlrev_b32 v143, 4, v143
    v_lshl_add_u32 v132, v140, 7, v143

    v_add_u32 v143, 2, v142
    v_xor_b32 v143, v143, v141
    v_lshlrev_b32 v143, 4, v143
    v_lshl_add_u32 v133, v140, 7, v143

    v_add_u32 v143, 4, v142
    v_xor_b32 v143, v143, v141
    v_lshlrev_b32 v143, 4, v143
    v_lshl_add_u32 v134, v140, 7, v143

    v_add_u32 v143, 6, v142
    v_xor_b32 v143, v143, v141
    v_lshlrev_b32 v143, 4, v143
    v_lshl_add_u32 v135, v140, 7, v143

    v_lshrrev_b32 v140, 4, v169
    v_and_b32 v141, 15, v169
    v_lshrrev_b32 v142, 1, v140
    v_lshlrev_b32 v142, 3, v142
    v_lshrrev_b32 v143, 2, v141
    v_add_u32 v142, v142, v143
    v_and_b32 v140, 1, v140
    v_lshlrev_b32 v140, 5, v140
    v_and_b32 v141, 3, v141
    v_lshl_add_u32 v140, v141, 3, v140
    v_lshl_add_u32 v140, v142, 8, v140
    v_add_u32 v140, 16384, v140
    v_lshrrev_b32 v141, 6, v0
    v_and_b32 v141, 1, v141
    v_lshlrev_b32 v141, 1, v141

    v_add_u32 v142, 0, v141
    v_xor_b32 v142, v142, v143
    v_lshl_add_u32 v136, v142, 6, v140

    v_add_u32 v142, 1, v141
    v_xor_b32 v142, v142, v143
    v_lshl_add_u32 v137, v142, 6, v140

    v_mov_b32 v0, 0
    v_mov_b32 v1, 0
    v_mov_b32 v2, 0
    v_mov_b32 v3, 0
    v_mov_b32 v4, 0
    v_mov_b32 v5, 0
    v_mov_b32 v6, 0
    v_mov_b32 v7, 0
    v_mov_b32 v8, 0
    v_mov_b32 v9, 0
    v_mov_b32 v10, 0
    v_mov_b32 v11, 0
    v_mov_b32 v12, 0
    v_mov_b32 v13, 0
    v_mov_b32 v14, 0
    v_mov_b32 v15, 0
    v_mov_b32 v16, 0
    v_mov_b32 v17, 0
    v_mov_b32 v18, 0
    v_mov_b32 v19, 0
    v_mov_b32 v20, 0
    v_mov_b32 v21, 0
    v_mov_b32 v22, 0
    v_mov_b32 v23, 0
    v_mov_b32 v24, 0
    v_mov_b32 v25, 0
    v_mov_b32 v26, 0
    v_mov_b32 v27, 0
    v_mov_b32 v28, 0
    v_mov_b32 v29, 0
    v_mov_b32 v30, 0
    v_mov_b32 v31, 0
    v_mov_b32 v32, 0
    v_mov_b32 v33, 0
    v_mov_b32 v34, 0
    v_mov_b32 v35, 0
    v_mov_b32 v36, 0
    v_mov_b32 v37, 0
    v_mov_b32 v38, 0
    v_mov_b32 v39, 0
    v_mov_b32 v40, 0
    v_mov_b32 v41, 0
    v_mov_b32 v42, 0
    v_mov_b32 v43, 0
    v_mov_b32 v44, 0
    v_mov_b32 v45, 0
    v_mov_b32 v46, 0
    v_mov_b32 v47, 0
    v_mov_b32 v48, 0
    v_mov_b32 v49, 0
    v_mov_b32 v50, 0
    v_mov_b32 v51, 0
    v_mov_b32 v52, 0
    v_mov_b32 v53, 0
    v_mov_b32 v54, 0
    v_mov_b32 v55, 0
    v_mov_b32 v56, 0
    v_mov_b32 v57, 0
    v_mov_b32 v58, 0
    v_mov_b32 v59, 0
    v_mov_b32 v60, 0
    v_mov_b32 v61, 0
    v_mov_b32 v62, 0
    v_mov_b32 v63, 0
    s_cmp_eq_u32 s33, 2
    s_cbranch_scc1 L_vpath_59

    buffer_load_dwordx4 v[96:99], v128, s[8:11], s20 offen
    buffer_load_dwordx4 v[100:103], v128, s[8:11], s21 offen
    buffer_load_dwordx4 v[104:107], v128, s[8:11], s22 offen
    buffer_load_dwordx4 v[108:111], v128, s[8:11], s23 offen
    buffer_load_dwordx4 v[112:115], v129, s[12:15], s24 offen
    buffer_load_dwordx4 v[116:119], v129, s[12:15], s25 offen
    buffer_load_dwordx4 v[120:123], v129, s[12:15], s26 offen
    buffer_load_dwordx4 v[124:127], v129, s[12:15], s27 offen
    s_add_u32 s20, s20, 128
    s_add_u32 s21, s21, 128
    s_add_u32 s22, s22, 128
    s_add_u32 s23, s23, 128
    s_add_u32 s24, s24, 524288
    s_add_u32 s25, s25, 524288
    s_add_u32 s26, s26, 524288
    s_add_u32 s27, s27, 524288
    buffer_load_dwordx4 v[176:179], v128, s[8:11], s20 offen
    buffer_load_dwordx4 v[180:183], v128, s[8:11], s21 offen
    buffer_load_dwordx4 v[184:187], v128, s[8:11], s22 offen
    buffer_load_dwordx4 v[188:191], v128, s[8:11], s23 offen
    buffer_load_dwordx4 v[192:195], v129, s[12:15], s24 offen
    buffer_load_dwordx4 v[196:199], v129, s[12:15], s25 offen
    buffer_load_dwordx4 v[200:203], v129, s[12:15], s26 offen
    buffer_load_dwordx4 v[204:207], v129, s[12:15], s27 offen
    s_add_u32 s20, s20, 128
    s_add_u32 s21, s21, 128
    s_add_u32 s22, s22, 128
    s_add_u32 s23, s23, 128
    s_add_u32 s24, s24, 524288
    s_add_u32 s25, s25, 524288
    s_add_u32 s26, s26, 524288
    s_add_u32 s27, s27, 524288
    buffer_load_dwordx4 v[208:211], v128, s[8:11], s20 offen
    buffer_load_dwordx4 v[212:215], v128, s[8:11], s21 offen
    buffer_load_dwordx4 v[216:219], v128, s[8:11], s22 offen
    buffer_load_dwordx4 v[220:223], v128, s[8:11], s23 offen
    buffer_load_dwordx4 v[224:227], v129, s[12:15], s24 offen
    buffer_load_dwordx4 v[228:231], v129, s[12:15], s25 offen
    buffer_load_dwordx4 v[232:235], v129, s[12:15], s26 offen
    buffer_load_dwordx4 v[236:239], v129, s[12:15], s27 offen
    s_add_u32 s20, s20, 128
    s_add_u32 s21, s21, 128
    s_add_u32 s22, s22, 128
    s_add_u32 s23, s23, 128
    s_add_u32 s24, s24, 524288
    s_add_u32 s25, s25, 524288
    s_add_u32 s26, s26, 524288
    s_add_u32 s27, s27, 524288
    s_waitcnt vmcnt(20)
    ds_write_b128 v130, v[96:99] offset:0
    ds_write_b128 v130, v[100:103] offset:4096
    ds_write_b128 v130, v[104:107] offset:8192
    ds_write_b128 v130, v[108:111] offset:12288
    s_waitcnt vmcnt(16)
    ds_write_b128 v131, v[112:115] offset:0
    ds_write_b128 v131, v[116:119] offset:4096
    ds_write_b128 v131, v[120:123] offset:8192
    ds_write_b128 v131, v[124:127] offset:12288
    s_waitcnt lgkmcnt(0)
    s_barrier
    buffer_load_dwordx4 v[96:99], v128, s[8:11], s20 offen
    buffer_load_dwordx4 v[100:103], v128, s[8:11], s21 offen
    buffer_load_dwordx4 v[104:107], v128, s[8:11], s22 offen
    buffer_load_dwordx4 v[108:111], v128, s[8:11], s23 offen
    buffer_load_dwordx4 v[112:115], v129, s[12:15], s24 offen
    buffer_load_dwordx4 v[116:119], v129, s[12:15], s25 offen
    buffer_load_dwordx4 v[120:123], v129, s[12:15], s26 offen
    buffer_load_dwordx4 v[124:127], v129, s[12:15], s27 offen
    s_add_u32 s20, s20, 128
    s_add_u32 s21, s21, 128
    s_add_u32 s22, s22, 128
    s_add_u32 s23, s23, 128
    s_add_u32 s24, s24, 524288
    s_add_u32 s25, s25, 524288
    s_add_u32 s26, s26, 524288
    s_add_u32 s27, s27, 524288
    ds_read_b128 v[64:67], v132 offset:0
    ds_read_b128 v[68:71], v132 offset:4096
    ds_read_b64_tr_b16 v[72:73], v136 offset:0
    ds_read_b64_tr_b16 v[74:75], v136 offset:1024
    ds_read_b64_tr_b16 v[76:77], v137 offset:0
    ds_read_b64_tr_b16 v[78:79], v137 offset:1024
    ds_read_b128 v[80:83], v133 offset:0
    ds_read_b128 v[84:87], v133 offset:4096
    ds_read_b64_tr_b16 v[88:89], v136 offset:4096
    ds_read_b64_tr_b16 v[90:91], v136 offset:5120
    ds_read_b64_tr_b16 v[92:93], v137 offset:4096
    ds_read_b64_tr_b16 v[94:95], v137 offset:5120
    s_waitcnt lgkmcnt(6)
    v_mfma_f32_32x32x16_bf16 v[0:15], v[72:75], v[64:67], v[0:15]
    v_mfma_f32_32x32x16_bf16 v[16:31], v[76:79], v[64:67], v[16:31]
    v_mfma_f32_32x32x16_bf16 v[32:47], v[72:75], v[68:71], v[32:47]
    v_mfma_f32_32x32x16_bf16 v[48:63], v[76:79], v[68:71], v[48:63]
    ds_read_b128 v[64:67], v134 offset:0
    ds_read_b128 v[68:71], v134 offset:4096
    ds_read_b64_tr_b16 v[72:73], v136 offset:8192
    ds_read_b64_tr_b16 v[74:75], v136 offset:9216
    ds_read_b64_tr_b16 v[76:77], v137 offset:8192
    ds_read_b64_tr_b16 v[78:79], v137 offset:9216
    s_waitcnt lgkmcnt(6)
    v_mfma_f32_32x32x16_bf16 v[0:15], v[88:91], v[80:83], v[0:15]
    v_mfma_f32_32x32x16_bf16 v[16:31], v[92:95], v[80:83], v[16:31]
    v_mfma_f32_32x32x16_bf16 v[32:47], v[88:91], v[84:87], v[32:47]
    v_mfma_f32_32x32x16_bf16 v[48:63], v[92:95], v[84:87], v[48:63]
    ds_read_b128 v[80:83], v135 offset:0
    ds_read_b128 v[84:87], v135 offset:4096
    ds_read_b64_tr_b16 v[88:89], v136 offset:12288
    ds_read_b64_tr_b16 v[90:91], v136 offset:13312
    ds_read_b64_tr_b16 v[92:93], v137 offset:12288
    ds_read_b64_tr_b16 v[94:95], v137 offset:13312
    s_waitcnt lgkmcnt(6)
    v_mfma_f32_32x32x16_bf16 v[0:15], v[72:75], v[64:67], v[0:15]
    v_mfma_f32_32x32x16_bf16 v[16:31], v[76:79], v[64:67], v[16:31]
    v_mfma_f32_32x32x16_bf16 v[32:47], v[72:75], v[68:71], v[32:47]
    v_mfma_f32_32x32x16_bf16 v[48:63], v[76:79], v[68:71], v[48:63]
    s_waitcnt lgkmcnt(0)
    v_mfma_f32_32x32x16_bf16 v[0:15], v[88:91], v[80:83], v[0:15]
    v_mfma_f32_32x32x16_bf16 v[16:31], v[92:95], v[80:83], v[16:31]
    v_mfma_f32_32x32x16_bf16 v[32:47], v[88:91], v[84:87], v[32:47]
    v_mfma_f32_32x32x16_bf16 v[48:63], v[92:95], v[84:87], v[48:63]
    s_waitcnt vmcnt(20)
    ds_write_b128 v130, v[176:179] offset:32768
    ds_write_b128 v130, v[180:183] offset:36864
    ds_write_b128 v130, v[184:187] offset:40960
    ds_write_b128 v130, v[188:191] offset:45056
    s_waitcnt vmcnt(16)
    ds_write_b128 v131, v[192:195] offset:32768
    ds_write_b128 v131, v[196:199] offset:36864
    ds_write_b128 v131, v[200:203] offset:40960
    ds_write_b128 v131, v[204:207] offset:45056
    s_waitcnt lgkmcnt(0)
    s_barrier
    buffer_load_dwordx4 v[176:179], v128, s[8:11], s20 offen
    buffer_load_dwordx4 v[180:183], v128, s[8:11], s21 offen
    buffer_load_dwordx4 v[184:187], v128, s[8:11], s22 offen
    buffer_load_dwordx4 v[188:191], v128, s[8:11], s23 offen
    buffer_load_dwordx4 v[192:195], v129, s[12:15], s24 offen
    buffer_load_dwordx4 v[196:199], v129, s[12:15], s25 offen
    buffer_load_dwordx4 v[200:203], v129, s[12:15], s26 offen
    buffer_load_dwordx4 v[204:207], v129, s[12:15], s27 offen
    s_add_u32 s20, s20, 128
    s_add_u32 s21, s21, 128
    s_add_u32 s22, s22, 128
    s_add_u32 s23, s23, 128
    s_add_u32 s24, s24, 524288
    s_add_u32 s25, s25, 524288
    s_add_u32 s26, s26, 524288
    s_add_u32 s27, s27, 524288
    ds_read_b128 v[64:67], v132 offset:32768
    ds_read_b128 v[68:71], v132 offset:36864
    ds_read_b64_tr_b16 v[72:73], v136 offset:32768
    ds_read_b64_tr_b16 v[74:75], v136 offset:33792
    ds_read_b64_tr_b16 v[76:77], v137 offset:32768
    ds_read_b64_tr_b16 v[78:79], v137 offset:33792
    ds_read_b128 v[80:83], v133 offset:32768
    ds_read_b128 v[84:87], v133 offset:36864
    ds_read_b64_tr_b16 v[88:89], v136 offset:36864
    ds_read_b64_tr_b16 v[90:91], v136 offset:37888
    ds_read_b64_tr_b16 v[92:93], v137 offset:36864
    ds_read_b64_tr_b16 v[94:95], v137 offset:37888
    s_waitcnt lgkmcnt(6)
    v_mfma_f32_32x32x16_bf16 v[0:15], v[72:75], v[64:67], v[0:15]
    v_mfma_f32_32x32x16_bf16 v[16:31], v[76:79], v[64:67], v[16:31]
    v_mfma_f32_32x32x16_bf16 v[32:47], v[72:75], v[68:71], v[32:47]
    v_mfma_f32_32x32x16_bf16 v[48:63], v[76:79], v[68:71], v[48:63]
    ds_read_b128 v[64:67], v134 offset:32768
    ds_read_b128 v[68:71], v134 offset:36864
    ds_read_b64_tr_b16 v[72:73], v136 offset:40960
    ds_read_b64_tr_b16 v[74:75], v136 offset:41984
    ds_read_b64_tr_b16 v[76:77], v137 offset:40960
    ds_read_b64_tr_b16 v[78:79], v137 offset:41984
    s_waitcnt lgkmcnt(6)
    v_mfma_f32_32x32x16_bf16 v[0:15], v[88:91], v[80:83], v[0:15]
    v_mfma_f32_32x32x16_bf16 v[16:31], v[92:95], v[80:83], v[16:31]
    v_mfma_f32_32x32x16_bf16 v[32:47], v[88:91], v[84:87], v[32:47]
    v_mfma_f32_32x32x16_bf16 v[48:63], v[92:95], v[84:87], v[48:63]
    ds_read_b128 v[80:83], v135 offset:32768
    ds_read_b128 v[84:87], v135 offset:36864
    ds_read_b64_tr_b16 v[88:89], v136 offset:45056
    ds_read_b64_tr_b16 v[90:91], v136 offset:46080
    ds_read_b64_tr_b16 v[92:93], v137 offset:45056
    ds_read_b64_tr_b16 v[94:95], v137 offset:46080
    s_waitcnt lgkmcnt(6)
    v_mfma_f32_32x32x16_bf16 v[0:15], v[72:75], v[64:67], v[0:15]
    v_mfma_f32_32x32x16_bf16 v[16:31], v[76:79], v[64:67], v[16:31]
    v_mfma_f32_32x32x16_bf16 v[32:47], v[72:75], v[68:71], v[32:47]
    v_mfma_f32_32x32x16_bf16 v[48:63], v[76:79], v[68:71], v[48:63]
    s_waitcnt lgkmcnt(0)
    v_mfma_f32_32x32x16_bf16 v[0:15], v[88:91], v[80:83], v[0:15]
    v_mfma_f32_32x32x16_bf16 v[16:31], v[92:95], v[80:83], v[16:31]
    v_mfma_f32_32x32x16_bf16 v[32:47], v[88:91], v[84:87], v[32:47]
    v_mfma_f32_32x32x16_bf16 v[48:63], v[92:95], v[84:87], v[48:63]
    s_waitcnt vmcnt(20)
    ds_write_b128 v130, v[208:211] offset:0
    ds_write_b128 v130, v[212:215] offset:4096
    ds_write_b128 v130, v[216:219] offset:8192
    ds_write_b128 v130, v[220:223] offset:12288
    s_waitcnt vmcnt(16)
    ds_write_b128 v131, v[224:227] offset:0
    ds_write_b128 v131, v[228:231] offset:4096
    ds_write_b128 v131, v[232:235] offset:8192
    ds_write_b128 v131, v[236:239] offset:12288
    s_waitcnt lgkmcnt(0)
    s_barrier
    buffer_load_dwordx4 v[208:211], v128, s[8:11], s20 offen
    buffer_load_dwordx4 v[212:215], v128, s[8:11], s21 offen
    buffer_load_dwordx4 v[216:219], v128, s[8:11], s22 offen
    buffer_load_dwordx4 v[220:223], v128, s[8:11], s23 offen
    buffer_load_dwordx4 v[224:227], v129, s[12:15], s24 offen
    buffer_load_dwordx4 v[228:231], v129, s[12:15], s25 offen
    buffer_load_dwordx4 v[232:235], v129, s[12:15], s26 offen
    buffer_load_dwordx4 v[236:239], v129, s[12:15], s27 offen
    s_add_u32 s20, s20, 128
    s_add_u32 s21, s21, 128
    s_add_u32 s22, s22, 128
    s_add_u32 s23, s23, 128
    s_add_u32 s24, s24, 524288
    s_add_u32 s25, s25, 524288
    s_add_u32 s26, s26, 524288
    s_add_u32 s27, s27, 524288
    ds_read_b128 v[64:67], v132 offset:0
    ds_read_b128 v[68:71], v132 offset:4096
    ds_read_b64_tr_b16 v[72:73], v136 offset:0
    ds_read_b64_tr_b16 v[74:75], v136 offset:1024
    ds_read_b64_tr_b16 v[76:77], v137 offset:0
    ds_read_b64_tr_b16 v[78:79], v137 offset:1024
    ds_read_b128 v[80:83], v133 offset:0
    ds_read_b128 v[84:87], v133 offset:4096
    ds_read_b64_tr_b16 v[88:89], v136 offset:4096
    ds_read_b64_tr_b16 v[90:91], v136 offset:5120
    ds_read_b64_tr_b16 v[92:93], v137 offset:4096
    ds_read_b64_tr_b16 v[94:95], v137 offset:5120
    s_waitcnt lgkmcnt(6)
    v_mfma_f32_32x32x16_bf16 v[0:15], v[72:75], v[64:67], v[0:15]
    v_mfma_f32_32x32x16_bf16 v[16:31], v[76:79], v[64:67], v[16:31]
    v_mfma_f32_32x32x16_bf16 v[32:47], v[72:75], v[68:71], v[32:47]
    v_mfma_f32_32x32x16_bf16 v[48:63], v[76:79], v[68:71], v[48:63]
    ds_read_b128 v[64:67], v134 offset:0
    ds_read_b128 v[68:71], v134 offset:4096
    ds_read_b64_tr_b16 v[72:73], v136 offset:8192
    ds_read_b64_tr_b16 v[74:75], v136 offset:9216
    ds_read_b64_tr_b16 v[76:77], v137 offset:8192
    ds_read_b64_tr_b16 v[78:79], v137 offset:9216
    s_waitcnt lgkmcnt(6)
    v_mfma_f32_32x32x16_bf16 v[0:15], v[88:91], v[80:83], v[0:15]
    v_mfma_f32_32x32x16_bf16 v[16:31], v[92:95], v[80:83], v[16:31]
    v_mfma_f32_32x32x16_bf16 v[32:47], v[88:91], v[84:87], v[32:47]
    v_mfma_f32_32x32x16_bf16 v[48:63], v[92:95], v[84:87], v[48:63]
    ds_read_b128 v[80:83], v135 offset:0
    ds_read_b128 v[84:87], v135 offset:4096
    ds_read_b64_tr_b16 v[88:89], v136 offset:12288
    ds_read_b64_tr_b16 v[90:91], v136 offset:13312
    ds_read_b64_tr_b16 v[92:93], v137 offset:12288
    ds_read_b64_tr_b16 v[94:95], v137 offset:13312
    s_waitcnt lgkmcnt(6)
    v_mfma_f32_32x32x16_bf16 v[0:15], v[72:75], v[64:67], v[0:15]
    v_mfma_f32_32x32x16_bf16 v[16:31], v[76:79], v[64:67], v[16:31]
    v_mfma_f32_32x32x16_bf16 v[32:47], v[72:75], v[68:71], v[32:47]
    v_mfma_f32_32x32x16_bf16 v[48:63], v[76:79], v[68:71], v[48:63]
    s_waitcnt lgkmcnt(0)
    v_mfma_f32_32x32x16_bf16 v[0:15], v[88:91], v[80:83], v[0:15]
    v_mfma_f32_32x32x16_bf16 v[16:31], v[92:95], v[80:83], v[16:31]
    v_mfma_f32_32x32x16_bf16 v[32:47], v[88:91], v[84:87], v[32:47]
    v_mfma_f32_32x32x16_bf16 v[48:63], v[92:95], v[84:87], v[48:63]
    s_waitcnt vmcnt(20)
    ds_write_b128 v130, v[96:99] offset:32768
    ds_write_b128 v130, v[100:103] offset:36864
    ds_write_b128 v130, v[104:107] offset:40960
    ds_write_b128 v130, v[108:111] offset:45056
    s_waitcnt vmcnt(16)
    ds_write_b128 v131, v[112:115] offset:32768
    ds_write_b128 v131, v[116:119] offset:36864
    ds_write_b128 v131, v[120:123] offset:40960
    ds_write_b128 v131, v[124:127] offset:45056
    s_waitcnt lgkmcnt(0)
    s_barrier
    buffer_load_dwordx4 v[96:99], v128, s[8:11], s20 offen
    buffer_load_dwordx4 v[100:103], v128, s[8:11], s21 offen
    buffer_load_dwordx4 v[104:107], v128, s[8:11], s22 offen
    buffer_load_dwordx4 v[108:111], v128, s[8:11], s23 offen
    buffer_load_dwordx4 v[112:115], v129, s[12:15], s24 offen
    buffer_load_dwordx4 v[116:119], v129, s[12:15], s25 offen
    buffer_load_dwordx4 v[120:123], v129, s[12:15], s26 offen
    buffer_load_dwordx4 v[124:127], v129, s[12:15], s27 offen
    s_add_u32 s20, s20, 128
    s_add_u32 s21, s21, 128
    s_add_u32 s22, s22, 128
    s_add_u32 s23, s23, 128
    s_add_u32 s24, s24, 524288
    s_add_u32 s25, s25, 524288
    s_add_u32 s26, s26, 524288
    s_add_u32 s27, s27, 524288
    ds_read_b128 v[64:67], v132 offset:32768
    ds_read_b128 v[68:71], v132 offset:36864
    ds_read_b64_tr_b16 v[72:73], v136 offset:32768
    ds_read_b64_tr_b16 v[74:75], v136 offset:33792
    ds_read_b64_tr_b16 v[76:77], v137 offset:32768
    ds_read_b64_tr_b16 v[78:79], v137 offset:33792
    ds_read_b128 v[80:83], v133 offset:32768
    ds_read_b128 v[84:87], v133 offset:36864
    ds_read_b64_tr_b16 v[88:89], v136 offset:36864
    ds_read_b64_tr_b16 v[90:91], v136 offset:37888
    ds_read_b64_tr_b16 v[92:93], v137 offset:36864
    ds_read_b64_tr_b16 v[94:95], v137 offset:37888
    s_waitcnt lgkmcnt(6)
    v_mfma_f32_32x32x16_bf16 v[0:15], v[72:75], v[64:67], v[0:15]
    v_mfma_f32_32x32x16_bf16 v[16:31], v[76:79], v[64:67], v[16:31]
    v_mfma_f32_32x32x16_bf16 v[32:47], v[72:75], v[68:71], v[32:47]
    v_mfma_f32_32x32x16_bf16 v[48:63], v[76:79], v[68:71], v[48:63]
    ds_read_b128 v[64:67], v134 offset:32768
    ds_read_b128 v[68:71], v134 offset:36864
    ds_read_b64_tr_b16 v[72:73], v136 offset:40960
    ds_read_b64_tr_b16 v[74:75], v136 offset:41984
    ds_read_b64_tr_b16 v[76:77], v137 offset:40960
    ds_read_b64_tr_b16 v[78:79], v137 offset:41984
    s_waitcnt lgkmcnt(6)
    v_mfma_f32_32x32x16_bf16 v[0:15], v[88:91], v[80:83], v[0:15]
    v_mfma_f32_32x32x16_bf16 v[16:31], v[92:95], v[80:83], v[16:31]
    v_mfma_f32_32x32x16_bf16 v[32:47], v[88:91], v[84:87], v[32:47]
    v_mfma_f32_32x32x16_bf16 v[48:63], v[92:95], v[84:87], v[48:63]
    ds_read_b128 v[80:83], v135 offset:32768
    ds_read_b128 v[84:87], v135 offset:36864
    ds_read_b64_tr_b16 v[88:89], v136 offset:45056
    ds_read_b64_tr_b16 v[90:91], v136 offset:46080
    ds_read_b64_tr_b16 v[92:93], v137 offset:45056
    ds_read_b64_tr_b16 v[94:95], v137 offset:46080
    s_waitcnt lgkmcnt(6)
    v_mfma_f32_32x32x16_bf16 v[0:15], v[72:75], v[64:67], v[0:15]
    v_mfma_f32_32x32x16_bf16 v[16:31], v[76:79], v[64:67], v[16:31]
    v_mfma_f32_32x32x16_bf16 v[32:47], v[72:75], v[68:71], v[32:47]
    v_mfma_f32_32x32x16_bf16 v[48:63], v[76:79], v[68:71], v[48:63]
    s_waitcnt lgkmcnt(0)
    v_mfma_f32_32x32x16_bf16 v[0:15], v[88:91], v[80:83], v[0:15]
    v_mfma_f32_32x32x16_bf16 v[16:31], v[92:95], v[80:83], v[16:31]
    v_mfma_f32_32x32x16_bf16 v[32:47], v[88:91], v[84:87], v[32:47]
    v_mfma_f32_32x32x16_bf16 v[48:63], v[92:95], v[84:87], v[48:63]
    s_waitcnt vmcnt(20)
    ds_write_b128 v130, v[176:179] offset:0
    ds_write_b128 v130, v[180:183] offset:4096
    ds_write_b128 v130, v[184:187] offset:8192
    ds_write_b128 v130, v[188:191] offset:12288
    s_waitcnt vmcnt(16)
    ds_write_b128 v131, v[192:195] offset:0
    ds_write_b128 v131, v[196:199] offset:4096
    ds_write_b128 v131, v[200:203] offset:8192
    ds_write_b128 v131, v[204:207] offset:12288
    s_waitcnt lgkmcnt(0)
    s_barrier
    buffer_load_dwordx4 v[176:179], v128, s[8:11], s20 offen
    buffer_load_dwordx4 v[180:183], v128, s[8:11], s21 offen
    buffer_load_dwordx4 v[184:187], v128, s[8:11], s22 offen
    buffer_load_dwordx4 v[188:191], v128, s[8:11], s23 offen
    buffer_load_dwordx4 v[192:195], v129, s[12:15], s24 offen
    buffer_load_dwordx4 v[196:199], v129, s[12:15], s25 offen
    buffer_load_dwordx4 v[200:203], v129, s[12:15], s26 offen
    buffer_load_dwordx4 v[204:207], v129, s[12:15], s27 offen
    s_add_u32 s20, s20, 128
    s_add_u32 s21, s21, 128
    s_add_u32 s22, s22, 128
    s_add_u32 s23, s23, 128
    s_add_u32 s24, s24, 524288
    s_add_u32 s25, s25, 524288
    s_add_u32 s26, s26, 524288
    s_add_u32 s27, s27, 524288
    ds_read_b128 v[64:67], v132 offset:0
    ds_read_b128 v[68:71], v132 offset:4096
    ds_read_b64_tr_b16 v[72:73], v136 offset:0
    ds_read_b64_tr_b16 v[74:75], v136 offset:1024
    ds_read_b64_tr_b16 v[76:77], v137 offset:0
    ds_read_b64_tr_b16 v[78:79], v137 offset:1024
    ds_read_b128 v[80:83], v133 offset:0
    ds_read_b128 v[84:87], v133 offset:4096
    ds_read_b64_tr_b16 v[88:89], v136 offset:4096
    ds_read_b64_tr_b16 v[90:91], v136 offset:5120
    ds_read_b64_tr_b16 v[92:93], v137 offset:4096
    ds_read_b64_tr_b16 v[94:95], v137 offset:5120
    s_waitcnt lgkmcnt(6)
    v_mfma_f32_32x32x16_bf16 v[0:15], v[72:75], v[64:67], v[0:15]
    v_mfma_f32_32x32x16_bf16 v[16:31], v[76:79], v[64:67], v[16:31]
    v_mfma_f32_32x32x16_bf16 v[32:47], v[72:75], v[68:71], v[32:47]
    v_mfma_f32_32x32x16_bf16 v[48:63], v[76:79], v[68:71], v[48:63]
    ds_read_b128 v[64:67], v134 offset:0
    ds_read_b128 v[68:71], v134 offset:4096
    ds_read_b64_tr_b16 v[72:73], v136 offset:8192
    ds_read_b64_tr_b16 v[74:75], v136 offset:9216
    ds_read_b64_tr_b16 v[76:77], v137 offset:8192
    ds_read_b64_tr_b16 v[78:79], v137 offset:9216
    s_waitcnt lgkmcnt(6)
    v_mfma_f32_32x32x16_bf16 v[0:15], v[88:91], v[80:83], v[0:15]
    v_mfma_f32_32x32x16_bf16 v[16:31], v[92:95], v[80:83], v[16:31]
    v_mfma_f32_32x32x16_bf16 v[32:47], v[88:91], v[84:87], v[32:47]
    v_mfma_f32_32x32x16_bf16 v[48:63], v[92:95], v[84:87], v[48:63]
    ds_read_b128 v[80:83], v135 offset:0
    ds_read_b128 v[84:87], v135 offset:4096
    ds_read_b64_tr_b16 v[88:89], v136 offset:12288
    ds_read_b64_tr_b16 v[90:91], v136 offset:13312
    ds_read_b64_tr_b16 v[92:93], v137 offset:12288
    ds_read_b64_tr_b16 v[94:95], v137 offset:13312
    s_waitcnt lgkmcnt(6)
    v_mfma_f32_32x32x16_bf16 v[0:15], v[72:75], v[64:67], v[0:15]
    v_mfma_f32_32x32x16_bf16 v[16:31], v[76:79], v[64:67], v[16:31]
    v_mfma_f32_32x32x16_bf16 v[32:47], v[72:75], v[68:71], v[32:47]
    v_mfma_f32_32x32x16_bf16 v[48:63], v[76:79], v[68:71], v[48:63]
    s_waitcnt lgkmcnt(0)
    v_mfma_f32_32x32x16_bf16 v[0:15], v[88:91], v[80:83], v[0:15]
    v_mfma_f32_32x32x16_bf16 v[16:31], v[92:95], v[80:83], v[16:31]
    v_mfma_f32_32x32x16_bf16 v[32:47], v[88:91], v[84:87], v[32:47]
    v_mfma_f32_32x32x16_bf16 v[48:63], v[92:95], v[84:87], v[48:63]
    s_waitcnt vmcnt(20)
    ds_write_b128 v130, v[208:211] offset:32768
    ds_write_b128 v130, v[212:215] offset:36864
    ds_write_b128 v130, v[216:219] offset:40960
    ds_write_b128 v130, v[220:223] offset:45056
    s_waitcnt vmcnt(16)
    ds_write_b128 v131, v[224:227] offset:32768
    ds_write_b128 v131, v[228:231] offset:36864
    ds_write_b128 v131, v[232:235] offset:40960
    ds_write_b128 v131, v[236:239] offset:45056
    s_waitcnt lgkmcnt(0)
    s_barrier
    buffer_load_dwordx4 v[208:211], v128, s[8:11], s20 offen
    buffer_load_dwordx4 v[212:215], v128, s[8:11], s21 offen
    buffer_load_dwordx4 v[216:219], v128, s[8:11], s22 offen
    buffer_load_dwordx4 v[220:223], v128, s[8:11], s23 offen
    buffer_load_dwordx4 v[224:227], v129, s[12:15], s24 offen
    buffer_load_dwordx4 v[228:231], v129, s[12:15], s25 offen
    buffer_load_dwordx4 v[232:235], v129, s[12:15], s26 offen
    buffer_load_dwordx4 v[236:239], v129, s[12:15], s27 offen
    s_add_u32 s20, s20, 128
    s_add_u32 s21, s21, 128
    s_add_u32 s22, s22, 128
    s_add_u32 s23, s23, 128
    s_add_u32 s24, s24, 524288
    s_add_u32 s25, s25, 524288
    s_add_u32 s26, s26, 524288
    s_add_u32 s27, s27, 524288
    ds_read_b128 v[64:67], v132 offset:32768
    ds_read_b128 v[68:71], v132 offset:36864
    ds_read_b64_tr_b16 v[72:73], v136 offset:32768
    ds_read_b64_tr_b16 v[74:75], v136 offset:33792
    ds_read_b64_tr_b16 v[76:77], v137 offset:32768
    ds_read_b64_tr_b16 v[78:79], v137 offset:33792
    ds_read_b128 v[80:83], v133 offset:32768
    ds_read_b128 v[84:87], v133 offset:36864
    ds_read_b64_tr_b16 v[88:89], v136 offset:36864
    ds_read_b64_tr_b16 v[90:91], v136 offset:37888
    ds_read_b64_tr_b16 v[92:93], v137 offset:36864
    ds_read_b64_tr_b16 v[94:95], v137 offset:37888
    s_waitcnt lgkmcnt(6)
    v_mfma_f32_32x32x16_bf16 v[0:15], v[72:75], v[64:67], v[0:15]
    v_mfma_f32_32x32x16_bf16 v[16:31], v[76:79], v[64:67], v[16:31]
    v_mfma_f32_32x32x16_bf16 v[32:47], v[72:75], v[68:71], v[32:47]
    v_mfma_f32_32x32x16_bf16 v[48:63], v[76:79], v[68:71], v[48:63]
    ds_read_b128 v[64:67], v134 offset:32768
    ds_read_b128 v[68:71], v134 offset:36864
    ds_read_b64_tr_b16 v[72:73], v136 offset:40960
    ds_read_b64_tr_b16 v[74:75], v136 offset:41984
    ds_read_b64_tr_b16 v[76:77], v137 offset:40960
    ds_read_b64_tr_b16 v[78:79], v137 offset:41984
    s_waitcnt lgkmcnt(6)
    v_mfma_f32_32x32x16_bf16 v[0:15], v[88:91], v[80:83], v[0:15]
    v_mfma_f32_32x32x16_bf16 v[16:31], v[92:95], v[80:83], v[16:31]
    v_mfma_f32_32x32x16_bf16 v[32:47], v[88:91], v[84:87], v[32:47]
    v_mfma_f32_32x32x16_bf16 v[48:63], v[92:95], v[84:87], v[48:63]
    ds_read_b128 v[80:83], v135 offset:32768
    ds_read_b128 v[84:87], v135 offset:36864
    ds_read_b64_tr_b16 v[88:89], v136 offset:45056
    ds_read_b64_tr_b16 v[90:91], v136 offset:46080
    ds_read_b64_tr_b16 v[92:93], v137 offset:45056
    ds_read_b64_tr_b16 v[94:95], v137 offset:46080
    s_waitcnt lgkmcnt(6)
    v_mfma_f32_32x32x16_bf16 v[0:15], v[72:75], v[64:67], v[0:15]
    v_mfma_f32_32x32x16_bf16 v[16:31], v[76:79], v[64:67], v[16:31]
    v_mfma_f32_32x32x16_bf16 v[32:47], v[72:75], v[68:71], v[32:47]
    v_mfma_f32_32x32x16_bf16 v[48:63], v[76:79], v[68:71], v[48:63]
    s_waitcnt lgkmcnt(0)
    v_mfma_f32_32x32x16_bf16 v[0:15], v[88:91], v[80:83], v[0:15]
    v_mfma_f32_32x32x16_bf16 v[16:31], v[92:95], v[80:83], v[16:31]
    v_mfma_f32_32x32x16_bf16 v[32:47], v[88:91], v[84:87], v[32:47]
    v_mfma_f32_32x32x16_bf16 v[48:63], v[92:95], v[84:87], v[48:63]
    s_waitcnt vmcnt(20)
    ds_write_b128 v130, v[96:99] offset:0
    ds_write_b128 v130, v[100:103] offset:4096
    ds_write_b128 v130, v[104:107] offset:8192
    ds_write_b128 v130, v[108:111] offset:12288
    s_waitcnt vmcnt(16)
    ds_write_b128 v131, v[112:115] offset:0
    ds_write_b128 v131, v[116:119] offset:4096
    ds_write_b128 v131, v[120:123] offset:8192
    ds_write_b128 v131, v[124:127] offset:12288
    s_waitcnt lgkmcnt(0)
    s_barrier
    ds_read_b128 v[64:67], v132 offset:0
    ds_read_b128 v[68:71], v132 offset:4096
    ds_read_b64_tr_b16 v[72:73], v136 offset:0
    ds_read_b64_tr_b16 v[74:75], v136 offset:1024
    ds_read_b64_tr_b16 v[76:77], v137 offset:0
    ds_read_b64_tr_b16 v[78:79], v137 offset:1024
    ds_read_b128 v[80:83], v133 offset:0
    ds_read_b128 v[84:87], v133 offset:4096
    ds_read_b64_tr_b16 v[88:89], v136 offset:4096
    ds_read_b64_tr_b16 v[90:91], v136 offset:5120
    ds_read_b64_tr_b16 v[92:93], v137 offset:4096
    ds_read_b64_tr_b16 v[94:95], v137 offset:5120
    s_waitcnt lgkmcnt(6)
    v_mfma_f32_32x32x16_bf16 v[0:15], v[72:75], v[64:67], v[0:15]
    v_mfma_f32_32x32x16_bf16 v[16:31], v[76:79], v[64:67], v[16:31]
    v_mfma_f32_32x32x16_bf16 v[32:47], v[72:75], v[68:71], v[32:47]
    v_mfma_f32_32x32x16_bf16 v[48:63], v[76:79], v[68:71], v[48:63]
    ds_read_b128 v[64:67], v134 offset:0
    ds_read_b128 v[68:71], v134 offset:4096
    ds_read_b64_tr_b16 v[72:73], v136 offset:8192
    ds_read_b64_tr_b16 v[74:75], v136 offset:9216
    ds_read_b64_tr_b16 v[76:77], v137 offset:8192
    ds_read_b64_tr_b16 v[78:79], v137 offset:9216
    s_waitcnt lgkmcnt(6)
    v_mfma_f32_32x32x16_bf16 v[0:15], v[88:91], v[80:83], v[0:15]
    v_mfma_f32_32x32x16_bf16 v[16:31], v[92:95], v[80:83], v[16:31]
    v_mfma_f32_32x32x16_bf16 v[32:47], v[88:91], v[84:87], v[32:47]
    v_mfma_f32_32x32x16_bf16 v[48:63], v[92:95], v[84:87], v[48:63]
    ds_read_b128 v[80:83], v135 offset:0
    ds_read_b128 v[84:87], v135 offset:4096
    ds_read_b64_tr_b16 v[88:89], v136 offset:12288
    ds_read_b64_tr_b16 v[90:91], v136 offset:13312
    ds_read_b64_tr_b16 v[92:93], v137 offset:12288
    ds_read_b64_tr_b16 v[94:95], v137 offset:13312
    s_waitcnt lgkmcnt(6)
    v_mfma_f32_32x32x16_bf16 v[0:15], v[72:75], v[64:67], v[0:15]
    v_mfma_f32_32x32x16_bf16 v[16:31], v[76:79], v[64:67], v[16:31]
    v_mfma_f32_32x32x16_bf16 v[32:47], v[72:75], v[68:71], v[32:47]
    v_mfma_f32_32x32x16_bf16 v[48:63], v[76:79], v[68:71], v[48:63]
    s_waitcnt lgkmcnt(0)
    v_mfma_f32_32x32x16_bf16 v[0:15], v[88:91], v[80:83], v[0:15]
    v_mfma_f32_32x32x16_bf16 v[16:31], v[92:95], v[80:83], v[16:31]
    v_mfma_f32_32x32x16_bf16 v[32:47], v[88:91], v[84:87], v[32:47]
    v_mfma_f32_32x32x16_bf16 v[48:63], v[92:95], v[84:87], v[48:63]
    s_waitcnt vmcnt(12)
    ds_write_b128 v130, v[176:179] offset:32768
    ds_write_b128 v130, v[180:183] offset:36864
    ds_write_b128 v130, v[184:187] offset:40960
    ds_write_b128 v130, v[188:191] offset:45056
    s_waitcnt vmcnt(8)
    ds_write_b128 v131, v[192:195] offset:32768
    ds_write_b128 v131, v[196:199] offset:36864
    ds_write_b128 v131, v[200:203] offset:40960
    ds_write_b128 v131, v[204:207] offset:45056
    s_waitcnt lgkmcnt(0)
    s_barrier
    ds_read_b128 v[64:67], v132 offset:32768
    ds_read_b128 v[68:71], v132 offset:36864
    ds_read_b64_tr_b16 v[72:73], v136 offset:32768
    ds_read_b64_tr_b16 v[74:75], v136 offset:33792
    ds_read_b64_tr_b16 v[76:77], v137 offset:32768
    ds_read_b64_tr_b16 v[78:79], v137 offset:33792
    ds_read_b128 v[80:83], v133 offset:32768
    ds_read_b128 v[84:87], v133 offset:36864
    ds_read_b64_tr_b16 v[88:89], v136 offset:36864
    ds_read_b64_tr_b16 v[90:91], v136 offset:37888
    ds_read_b64_tr_b16 v[92:93], v137 offset:36864
    ds_read_b64_tr_b16 v[94:95], v137 offset:37888
    s_waitcnt lgkmcnt(6)
    v_mfma_f32_32x32x16_bf16 v[0:15], v[72:75], v[64:67], v[0:15]
    v_mfma_f32_32x32x16_bf16 v[16:31], v[76:79], v[64:67], v[16:31]
    v_mfma_f32_32x32x16_bf16 v[32:47], v[72:75], v[68:71], v[32:47]
    v_mfma_f32_32x32x16_bf16 v[48:63], v[76:79], v[68:71], v[48:63]
    ds_read_b128 v[64:67], v134 offset:32768
    ds_read_b128 v[68:71], v134 offset:36864
    ds_read_b64_tr_b16 v[72:73], v136 offset:40960
    ds_read_b64_tr_b16 v[74:75], v136 offset:41984
    ds_read_b64_tr_b16 v[76:77], v137 offset:40960
    ds_read_b64_tr_b16 v[78:79], v137 offset:41984
    s_waitcnt lgkmcnt(6)
    v_mfma_f32_32x32x16_bf16 v[0:15], v[88:91], v[80:83], v[0:15]
    v_mfma_f32_32x32x16_bf16 v[16:31], v[92:95], v[80:83], v[16:31]
    v_mfma_f32_32x32x16_bf16 v[32:47], v[88:91], v[84:87], v[32:47]
    v_mfma_f32_32x32x16_bf16 v[48:63], v[92:95], v[84:87], v[48:63]
    ds_read_b128 v[80:83], v135 offset:32768
    ds_read_b128 v[84:87], v135 offset:36864
    ds_read_b64_tr_b16 v[88:89], v136 offset:45056
    ds_read_b64_tr_b16 v[90:91], v136 offset:46080
    ds_read_b64_tr_b16 v[92:93], v137 offset:45056
    ds_read_b64_tr_b16 v[94:95], v137 offset:46080
    s_waitcnt lgkmcnt(6)
    v_mfma_f32_32x32x16_bf16 v[0:15], v[72:75], v[64:67], v[0:15]
    v_mfma_f32_32x32x16_bf16 v[16:31], v[76:79], v[64:67], v[16:31]
    v_mfma_f32_32x32x16_bf16 v[32:47], v[72:75], v[68:71], v[32:47]
    v_mfma_f32_32x32x16_bf16 v[48:63], v[76:79], v[68:71], v[48:63]
    s_waitcnt lgkmcnt(0)
    v_mfma_f32_32x32x16_bf16 v[0:15], v[88:91], v[80:83], v[0:15]
    v_mfma_f32_32x32x16_bf16 v[16:31], v[92:95], v[80:83], v[16:31]
    v_mfma_f32_32x32x16_bf16 v[32:47], v[88:91], v[84:87], v[32:47]
    v_mfma_f32_32x32x16_bf16 v[48:63], v[92:95], v[84:87], v[48:63]
    s_waitcnt vmcnt(4)
    ds_write_b128 v130, v[208:211] offset:0
    ds_write_b128 v130, v[212:215] offset:4096
    ds_write_b128 v130, v[216:219] offset:8192
    ds_write_b128 v130, v[220:223] offset:12288
    s_waitcnt vmcnt(0)
    ds_write_b128 v131, v[224:227] offset:0
    ds_write_b128 v131, v[228:231] offset:4096
    ds_write_b128 v131, v[232:235] offset:8192
    ds_write_b128 v131, v[236:239] offset:12288
    s_waitcnt lgkmcnt(0)
    s_barrier
    ds_read_b128 v[64:67], v132 offset:0
    ds_read_b128 v[68:71], v132 offset:4096
    ds_read_b64_tr_b16 v[72:73], v136 offset:0
    ds_read_b64_tr_b16 v[74:75], v136 offset:1024
    ds_read_b64_tr_b16 v[76:77], v137 offset:0
    ds_read_b64_tr_b16 v[78:79], v137 offset:1024
    ds_read_b128 v[80:83], v133 offset:0
    ds_read_b128 v[84:87], v133 offset:4096
    ds_read_b64_tr_b16 v[88:89], v136 offset:4096
    ds_read_b64_tr_b16 v[90:91], v136 offset:5120
    ds_read_b64_tr_b16 v[92:93], v137 offset:4096
    ds_read_b64_tr_b16 v[94:95], v137 offset:5120
    s_waitcnt lgkmcnt(6)
    v_mfma_f32_32x32x16_bf16 v[0:15], v[72:75], v[64:67], v[0:15]
    v_mfma_f32_32x32x16_bf16 v[16:31], v[76:79], v[64:67], v[16:31]
    v_mfma_f32_32x32x16_bf16 v[32:47], v[72:75], v[68:71], v[32:47]
    v_mfma_f32_32x32x16_bf16 v[48:63], v[76:79], v[68:71], v[48:63]
    ds_read_b128 v[64:67], v134 offset:0
    ds_read_b128 v[68:71], v134 offset:4096
    ds_read_b64_tr_b16 v[72:73], v136 offset:8192
    ds_read_b64_tr_b16 v[74:75], v136 offset:9216
    ds_read_b64_tr_b16 v[76:77], v137 offset:8192
    ds_read_b64_tr_b16 v[78:79], v137 offset:9216
    s_waitcnt lgkmcnt(6)
    v_mfma_f32_32x32x16_bf16 v[0:15], v[88:91], v[80:83], v[0:15]
    v_mfma_f32_32x32x16_bf16 v[16:31], v[92:95], v[80:83], v[16:31]
    v_mfma_f32_32x32x16_bf16 v[32:47], v[88:91], v[84:87], v[32:47]
    v_mfma_f32_32x32x16_bf16 v[48:63], v[92:95], v[84:87], v[48:63]
    ds_read_b128 v[80:83], v135 offset:0
    ds_read_b128 v[84:87], v135 offset:4096
    ds_read_b64_tr_b16 v[88:89], v136 offset:12288
    ds_read_b64_tr_b16 v[90:91], v136 offset:13312
    ds_read_b64_tr_b16 v[92:93], v137 offset:12288
    ds_read_b64_tr_b16 v[94:95], v137 offset:13312
    s_waitcnt lgkmcnt(6)
    v_mfma_f32_32x32x16_bf16 v[0:15], v[72:75], v[64:67], v[0:15]
    v_mfma_f32_32x32x16_bf16 v[16:31], v[76:79], v[64:67], v[16:31]
    v_mfma_f32_32x32x16_bf16 v[32:47], v[72:75], v[68:71], v[32:47]
    v_mfma_f32_32x32x16_bf16 v[48:63], v[76:79], v[68:71], v[48:63]
    s_waitcnt lgkmcnt(0)
    v_mfma_f32_32x32x16_bf16 v[0:15], v[88:91], v[80:83], v[0:15]
    v_mfma_f32_32x32x16_bf16 v[16:31], v[92:95], v[80:83], v[16:31]
    v_mfma_f32_32x32x16_bf16 v[32:47], v[88:91], v[84:87], v[32:47]
    v_mfma_f32_32x32x16_bf16 v[48:63], v[92:95], v[84:87], v[48:63]
    s_barrier
    s_nop 7
    s_nop 7
    v_lshrrev_b32 v140, 7, v168
    v_lshrrev_b32 v141, 6, v168
    v_and_b32 v141, 1, v141
    v_and_b32 v142, 31, v169
    v_lshrrev_b32 v143, 5, v169

    v_lshl_add_u32 v142, v140, 6, v142
    v_mul_u32_u24 v142, 272, v142
    v_lshlrev_b32 v144, 7, v141
    v_lshl_add_u32 v144, v143, 3, v144
    v_add_u32 v142, v142, v144

    v_cvt_pk_bf16_f32 v146, v0, v1
    v_cvt_pk_bf16_f32 v147, v2, v3
    ds_write_b64 v142, v[146:147] offset:0

    v_cvt_pk_bf16_f32 v146, v4, v5
    v_cvt_pk_bf16_f32 v147, v6, v7
    ds_write_b64 v142, v[146:147] offset:16

    v_cvt_pk_bf16_f32 v146, v8, v9
    v_cvt_pk_bf16_f32 v147, v10, v11
    ds_write_b64 v142, v[146:147] offset:32

    v_cvt_pk_bf16_f32 v146, v12, v13
    v_cvt_pk_bf16_f32 v147, v14, v15
    ds_write_b64 v142, v[146:147] offset:48

    v_cvt_pk_bf16_f32 v146, v16, v17
    v_cvt_pk_bf16_f32 v147, v18, v19
    ds_write_b64 v142, v[146:147] offset:64

    v_cvt_pk_bf16_f32 v146, v20, v21
    v_cvt_pk_bf16_f32 v147, v22, v23
    ds_write_b64 v142, v[146:147] offset:80

    v_cvt_pk_bf16_f32 v146, v24, v25
    v_cvt_pk_bf16_f32 v147, v26, v27
    ds_write_b64 v142, v[146:147] offset:96

    v_cvt_pk_bf16_f32 v146, v28, v29
    v_cvt_pk_bf16_f32 v147, v30, v31
    ds_write_b64 v142, v[146:147] offset:112

    v_cvt_pk_bf16_f32 v146, v32, v33
    v_cvt_pk_bf16_f32 v147, v34, v35
    ds_write_b64 v142, v[146:147] offset:8704

    v_cvt_pk_bf16_f32 v146, v36, v37
    v_cvt_pk_bf16_f32 v147, v38, v39
    ds_write_b64 v142, v[146:147] offset:8720

    v_cvt_pk_bf16_f32 v146, v40, v41
    v_cvt_pk_bf16_f32 v147, v42, v43
    ds_write_b64 v142, v[146:147] offset:8736

    v_cvt_pk_bf16_f32 v146, v44, v45
    v_cvt_pk_bf16_f32 v147, v46, v47
    ds_write_b64 v142, v[146:147] offset:8752

    v_cvt_pk_bf16_f32 v146, v48, v49
    v_cvt_pk_bf16_f32 v147, v50, v51
    ds_write_b64 v142, v[146:147] offset:8768

    v_cvt_pk_bf16_f32 v146, v52, v53
    v_cvt_pk_bf16_f32 v147, v54, v55
    ds_write_b64 v142, v[146:147] offset:8784

    v_cvt_pk_bf16_f32 v146, v56, v57
    v_cvt_pk_bf16_f32 v147, v58, v59
    ds_write_b64 v142, v[146:147] offset:8800

    v_cvt_pk_bf16_f32 v146, v60, v61
    v_cvt_pk_bf16_f32 v147, v62, v63
    ds_write_b64 v142, v[146:147] offset:8816

    s_waitcnt lgkmcnt(0)
    s_barrier
    s_mul_i32 s36, s33, 16777216
    s_add_u32 s36, s36, 4194304
    s_add_u32 s50, s4, s36
    s_addc_u32 s51, s5, 0

    s_mov_b32 s16, s50
    s_and_b32 s17, s51, 0xffff
    s_mov_b32 s18, 16777216
    s_mov_b32 s19, 0x00020000

    v_lshrrev_b32 v141, 4, v168
    v_and_b32 v142, 15, v168
    v_mul_u32_u24 v140, 272, v141
    v_lshl_add_u32 v140, v142, 4, v140

    v_lshlrev_b32 v143, 13, v141
    v_lshl_add_u32 v143, v142, 4, v143
    s_lshl_b32 s36, s30, 13
    s_lshl_b32 s37, s34, 8
    s_add_u32 s36, s36, s37

    ds_read_b128 v[64:67], v140 offset:0
    ds_read_b128 v[68:71], v140 offset:4352
    ds_read_b128 v[72:75], v140 offset:8704
    ds_read_b128 v[76:79], v140 offset:13056
    ds_read_b128 v[80:83], v140 offset:17408
    ds_read_b128 v[84:87], v140 offset:21760
    ds_read_b128 v[88:91], v140 offset:26112
    ds_read_b128 v[92:95], v140 offset:30464
    s_waitcnt lgkmcnt(7)
    buffer_store_dwordx4 v[64:67], v143, s[16:19], s36 offen sc1
    s_add_u32 s36, s36, 131072

    s_waitcnt lgkmcnt(6)
    buffer_store_dwordx4 v[68:71], v143, s[16:19], s36 offen sc1
    s_add_u32 s36, s36, 131072

    s_waitcnt lgkmcnt(5)
    buffer_store_dwordx4 v[72:75], v143, s[16:19], s36 offen sc1
    s_add_u32 s36, s36, 131072

    s_waitcnt lgkmcnt(4)
    buffer_store_dwordx4 v[76:79], v143, s[16:19], s36 offen sc1
    s_add_u32 s36, s36, 131072

    s_waitcnt lgkmcnt(3)
    buffer_store_dwordx4 v[80:83], v143, s[16:19], s36 offen sc1
    s_add_u32 s36, s36, 131072

    s_waitcnt lgkmcnt(2)
    buffer_store_dwordx4 v[84:87], v143, s[16:19], s36 offen sc1
    s_add_u32 s36, s36, 131072

    s_waitcnt lgkmcnt(1)
    buffer_store_dwordx4 v[88:91], v143, s[16:19], s36 offen sc1
    s_add_u32 s36, s36, 131072

    s_waitcnt lgkmcnt(0)
    buffer_store_dwordx4 v[92:95], v143, s[16:19], s36 offen sc1
    s_add_u32 s36, s36, 131072

    s_branch L_qkvdone_60
L_vpath_59:
    buffer_load_dwordx4 v[96:99], v128, s[8:11], s20 offen
    buffer_load_dwordx4 v[100:103], v128, s[8:11], s21 offen
    buffer_load_dwordx4 v[104:107], v128, s[8:11], s22 offen
    buffer_load_dwordx4 v[108:111], v128, s[8:11], s23 offen
    buffer_load_dwordx4 v[112:115], v129, s[12:15], s24 offen
    buffer_load_dwordx4 v[116:119], v129, s[12:15], s25 offen
    buffer_load_dwordx4 v[120:123], v129, s[12:15], s26 offen
    buffer_load_dwordx4 v[124:127], v129, s[12:15], s27 offen
    s_add_u32 s20, s20, 128
    s_add_u32 s21, s21, 128
    s_add_u32 s22, s22, 128
    s_add_u32 s23, s23, 128
    s_add_u32 s24, s24, 524288
    s_add_u32 s25, s25, 524288
    s_add_u32 s26, s26, 524288
    s_add_u32 s27, s27, 524288
    buffer_load_dwordx4 v[176:179], v128, s[8:11], s20 offen
    buffer_load_dwordx4 v[180:183], v128, s[8:11], s21 offen
    buffer_load_dwordx4 v[184:187], v128, s[8:11], s22 offen
    buffer_load_dwordx4 v[188:191], v128, s[8:11], s23 offen
    buffer_load_dwordx4 v[192:195], v129, s[12:15], s24 offen
    buffer_load_dwordx4 v[196:199], v129, s[12:15], s25 offen
    buffer_load_dwordx4 v[200:203], v129, s[12:15], s26 offen
    buffer_load_dwordx4 v[204:207], v129, s[12:15], s27 offen
    s_add_u32 s20, s20, 128
    s_add_u32 s21, s21, 128
    s_add_u32 s22, s22, 128
    s_add_u32 s23, s23, 128
    s_add_u32 s24, s24, 524288
    s_add_u32 s25, s25, 524288
    s_add_u32 s26, s26, 524288
    s_add_u32 s27, s27, 524288
    buffer_load_dwordx4 v[208:211], v128, s[8:11], s20 offen
    buffer_load_dwordx4 v[212:215], v128, s[8:11], s21 offen
    buffer_load_dwordx4 v[216:219], v128, s[8:11], s22 offen
    buffer_load_dwordx4 v[220:223], v128, s[8:11], s23 offen
    buffer_load_dwordx4 v[224:227], v129, s[12:15], s24 offen
    buffer_load_dwordx4 v[228:231], v129, s[12:15], s25 offen
    buffer_load_dwordx4 v[232:235], v129, s[12:15], s26 offen
    buffer_load_dwordx4 v[236:239], v129, s[12:15], s27 offen
    s_add_u32 s20, s20, 128
    s_add_u32 s21, s21, 128
    s_add_u32 s22, s22, 128
    s_add_u32 s23, s23, 128
    s_add_u32 s24, s24, 524288
    s_add_u32 s25, s25, 524288
    s_add_u32 s26, s26, 524288
    s_add_u32 s27, s27, 524288
    s_waitcnt vmcnt(20)
    ds_write_b128 v130, v[96:99] offset:0
    ds_write_b128 v130, v[100:103] offset:4096
    ds_write_b128 v130, v[104:107] offset:8192
    ds_write_b128 v130, v[108:111] offset:12288
    s_waitcnt vmcnt(16)
    ds_write_b128 v131, v[112:115] offset:0
    ds_write_b128 v131, v[116:119] offset:4096
    ds_write_b128 v131, v[120:123] offset:8192
    ds_write_b128 v131, v[124:127] offset:12288
    s_waitcnt lgkmcnt(0)
    s_barrier
    buffer_load_dwordx4 v[96:99], v128, s[8:11], s20 offen
    buffer_load_dwordx4 v[100:103], v128, s[8:11], s21 offen
    buffer_load_dwordx4 v[104:107], v128, s[8:11], s22 offen
    buffer_load_dwordx4 v[108:111], v128, s[8:11], s23 offen
    buffer_load_dwordx4 v[112:115], v129, s[12:15], s24 offen
    buffer_load_dwordx4 v[116:119], v129, s[12:15], s25 offen
    buffer_load_dwordx4 v[120:123], v129, s[12:15], s26 offen
    buffer_load_dwordx4 v[124:127], v129, s[12:15], s27 offen
    s_add_u32 s20, s20, 128
    s_add_u32 s21, s21, 128
    s_add_u32 s22, s22, 128
    s_add_u32 s23, s23, 128
    s_add_u32 s24, s24, 524288
    s_add_u32 s25, s25, 524288
    s_add_u32 s26, s26, 524288
    s_add_u32 s27, s27, 524288
    ds_read_b128 v[64:67], v132 offset:0
    ds_read_b128 v[68:71], v132 offset:4096
    ds_read_b64_tr_b16 v[72:73], v136 offset:0
    ds_read_b64_tr_b16 v[74:75], v136 offset:1024
    ds_read_b64_tr_b16 v[76:77], v137 offset:0
    ds_read_b64_tr_b16 v[78:79], v137 offset:1024
    ds_read_b128 v[80:83], v133 offset:0
    ds_read_b128 v[84:87], v133 offset:4096
    ds_read_b64_tr_b16 v[88:89], v136 offset:4096
    ds_read_b64_tr_b16 v[90:91], v136 offset:5120
    ds_read_b64_tr_b16 v[92:93], v137 offset:4096
    ds_read_b64_tr_b16 v[94:95], v137 offset:5120
    s_waitcnt lgkmcnt(6)
    v_mfma_f32_32x32x16_bf16 v[0:15], v[64:67], v[72:75], v[0:15]
    v_mfma_f32_32x32x16_bf16 v[16:31], v[64:67], v[76:79], v[16:31]
    v_mfma_f32_32x32x16_bf16 v[32:47], v[68:71], v[72:75], v[32:47]
    v_mfma_f32_32x32x16_bf16 v[48:63], v[68:71], v[76:79], v[48:63]
    ds_read_b128 v[64:67], v134 offset:0
    ds_read_b128 v[68:71], v134 offset:4096
    ds_read_b64_tr_b16 v[72:73], v136 offset:8192
    ds_read_b64_tr_b16 v[74:75], v136 offset:9216
    ds_read_b64_tr_b16 v[76:77], v137 offset:8192
    ds_read_b64_tr_b16 v[78:79], v137 offset:9216
    s_waitcnt lgkmcnt(6)
    v_mfma_f32_32x32x16_bf16 v[0:15], v[80:83], v[88:91], v[0:15]
    v_mfma_f32_32x32x16_bf16 v[16:31], v[80:83], v[92:95], v[16:31]
    v_mfma_f32_32x32x16_bf16 v[32:47], v[84:87], v[88:91], v[32:47]
    v_mfma_f32_32x32x16_bf16 v[48:63], v[84:87], v[92:95], v[48:63]
    ds_read_b128 v[80:83], v135 offset:0
    ds_read_b128 v[84:87], v135 offset:4096
    ds_read_b64_tr_b16 v[88:89], v136 offset:12288
    ds_read_b64_tr_b16 v[90:91], v136 offset:13312
    ds_read_b64_tr_b16 v[92:93], v137 offset:12288
    ds_read_b64_tr_b16 v[94:95], v137 offset:13312
    s_waitcnt lgkmcnt(6)
    v_mfma_f32_32x32x16_bf16 v[0:15], v[64:67], v[72:75], v[0:15]
    v_mfma_f32_32x32x16_bf16 v[16:31], v[64:67], v[76:79], v[16:31]
    v_mfma_f32_32x32x16_bf16 v[32:47], v[68:71], v[72:75], v[32:47]
    v_mfma_f32_32x32x16_bf16 v[48:63], v[68:71], v[76:79], v[48:63]
    s_waitcnt lgkmcnt(0)
    v_mfma_f32_32x32x16_bf16 v[0:15], v[80:83], v[88:91], v[0:15]
    v_mfma_f32_32x32x16_bf16 v[16:31], v[80:83], v[92:95], v[16:31]
    v_mfma_f32_32x32x16_bf16 v[32:47], v[84:87], v[88:91], v[32:47]
    v_mfma_f32_32x32x16_bf16 v[48:63], v[84:87], v[92:95], v[48:63]
    s_waitcnt vmcnt(20)
    ds_write_b128 v130, v[176:179] offset:32768
    ds_write_b128 v130, v[180:183] offset:36864
    ds_write_b128 v130, v[184:187] offset:40960
    ds_write_b128 v130, v[188:191] offset:45056
    s_waitcnt vmcnt(16)
    ds_write_b128 v131, v[192:195] offset:32768
    ds_write_b128 v131, v[196:199] offset:36864
    ds_write_b128 v131, v[200:203] offset:40960
    ds_write_b128 v131, v[204:207] offset:45056
    s_waitcnt lgkmcnt(0)
    s_barrier
    buffer_load_dwordx4 v[176:179], v128, s[8:11], s20 offen
    buffer_load_dwordx4 v[180:183], v128, s[8:11], s21 offen
    buffer_load_dwordx4 v[184:187], v128, s[8:11], s22 offen
    buffer_load_dwordx4 v[188:191], v128, s[8:11], s23 offen
    buffer_load_dwordx4 v[192:195], v129, s[12:15], s24 offen
    buffer_load_dwordx4 v[196:199], v129, s[12:15], s25 offen
    buffer_load_dwordx4 v[200:203], v129, s[12:15], s26 offen
    buffer_load_dwordx4 v[204:207], v129, s[12:15], s27 offen
    s_add_u32 s20, s20, 128
    s_add_u32 s21, s21, 128
    s_add_u32 s22, s22, 128
    s_add_u32 s23, s23, 128
    s_add_u32 s24, s24, 524288
    s_add_u32 s25, s25, 524288
    s_add_u32 s26, s26, 524288
    s_add_u32 s27, s27, 524288
    ds_read_b128 v[64:67], v132 offset:32768
    ds_read_b128 v[68:71], v132 offset:36864
    ds_read_b64_tr_b16 v[72:73], v136 offset:32768
    ds_read_b64_tr_b16 v[74:75], v136 offset:33792
    ds_read_b64_tr_b16 v[76:77], v137 offset:32768
    ds_read_b64_tr_b16 v[78:79], v137 offset:33792
    ds_read_b128 v[80:83], v133 offset:32768
    ds_read_b128 v[84:87], v133 offset:36864
    ds_read_b64_tr_b16 v[88:89], v136 offset:36864
    ds_read_b64_tr_b16 v[90:91], v136 offset:37888
    ds_read_b64_tr_b16 v[92:93], v137 offset:36864
    ds_read_b64_tr_b16 v[94:95], v137 offset:37888
    s_waitcnt lgkmcnt(6)
    v_mfma_f32_32x32x16_bf16 v[0:15], v[64:67], v[72:75], v[0:15]
    v_mfma_f32_32x32x16_bf16 v[16:31], v[64:67], v[76:79], v[16:31]
    v_mfma_f32_32x32x16_bf16 v[32:47], v[68:71], v[72:75], v[32:47]
    v_mfma_f32_32x32x16_bf16 v[48:63], v[68:71], v[76:79], v[48:63]
    ds_read_b128 v[64:67], v134 offset:32768
    ds_read_b128 v[68:71], v134 offset:36864
    ds_read_b64_tr_b16 v[72:73], v136 offset:40960
    ds_read_b64_tr_b16 v[74:75], v136 offset:41984
    ds_read_b64_tr_b16 v[76:77], v137 offset:40960
    ds_read_b64_tr_b16 v[78:79], v137 offset:41984
    s_waitcnt lgkmcnt(6)
    v_mfma_f32_32x32x16_bf16 v[0:15], v[80:83], v[88:91], v[0:15]
    v_mfma_f32_32x32x16_bf16 v[16:31], v[80:83], v[92:95], v[16:31]
    v_mfma_f32_32x32x16_bf16 v[32:47], v[84:87], v[88:91], v[32:47]
    v_mfma_f32_32x32x16_bf16 v[48:63], v[84:87], v[92:95], v[48:63]
    ds_read_b128 v[80:83], v135 offset:32768
    ds_read_b128 v[84:87], v135 offset:36864
    ds_read_b64_tr_b16 v[88:89], v136 offset:45056
    ds_read_b64_tr_b16 v[90:91], v136 offset:46080
    ds_read_b64_tr_b16 v[92:93], v137 offset:45056
    ds_read_b64_tr_b16 v[94:95], v137 offset:46080
    s_waitcnt lgkmcnt(6)
    v_mfma_f32_32x32x16_bf16 v[0:15], v[64:67], v[72:75], v[0:15]
    v_mfma_f32_32x32x16_bf16 v[16:31], v[64:67], v[76:79], v[16:31]
    v_mfma_f32_32x32x16_bf16 v[32:47], v[68:71], v[72:75], v[32:47]
    v_mfma_f32_32x32x16_bf16 v[48:63], v[68:71], v[76:79], v[48:63]
    s_waitcnt lgkmcnt(0)
    v_mfma_f32_32x32x16_bf16 v[0:15], v[80:83], v[88:91], v[0:15]
    v_mfma_f32_32x32x16_bf16 v[16:31], v[80:83], v[92:95], v[16:31]
    v_mfma_f32_32x32x16_bf16 v[32:47], v[84:87], v[88:91], v[32:47]
    v_mfma_f32_32x32x16_bf16 v[48:63], v[84:87], v[92:95], v[48:63]
    s_waitcnt vmcnt(20)
    ds_write_b128 v130, v[208:211] offset:0
    ds_write_b128 v130, v[212:215] offset:4096
    ds_write_b128 v130, v[216:219] offset:8192
    ds_write_b128 v130, v[220:223] offset:12288
    s_waitcnt vmcnt(16)
    ds_write_b128 v131, v[224:227] offset:0
    ds_write_b128 v131, v[228:231] offset:4096
    ds_write_b128 v131, v[232:235] offset:8192
    ds_write_b128 v131, v[236:239] offset:12288
    s_waitcnt lgkmcnt(0)
    s_barrier
    buffer_load_dwordx4 v[208:211], v128, s[8:11], s20 offen
    buffer_load_dwordx4 v[212:215], v128, s[8:11], s21 offen
    buffer_load_dwordx4 v[216:219], v128, s[8:11], s22 offen
    buffer_load_dwordx4 v[220:223], v128, s[8:11], s23 offen
    buffer_load_dwordx4 v[224:227], v129, s[12:15], s24 offen
    buffer_load_dwordx4 v[228:231], v129, s[12:15], s25 offen
    buffer_load_dwordx4 v[232:235], v129, s[12:15], s26 offen
    buffer_load_dwordx4 v[236:239], v129, s[12:15], s27 offen
    s_add_u32 s20, s20, 128
    s_add_u32 s21, s21, 128
    s_add_u32 s22, s22, 128
    s_add_u32 s23, s23, 128
    s_add_u32 s24, s24, 524288
    s_add_u32 s25, s25, 524288
    s_add_u32 s26, s26, 524288
    s_add_u32 s27, s27, 524288
    ds_read_b128 v[64:67], v132 offset:0
    ds_read_b128 v[68:71], v132 offset:4096
    ds_read_b64_tr_b16 v[72:73], v136 offset:0
    ds_read_b64_tr_b16 v[74:75], v136 offset:1024
    ds_read_b64_tr_b16 v[76:77], v137 offset:0
    ds_read_b64_tr_b16 v[78:79], v137 offset:1024
    ds_read_b128 v[80:83], v133 offset:0
    ds_read_b128 v[84:87], v133 offset:4096
    ds_read_b64_tr_b16 v[88:89], v136 offset:4096
    ds_read_b64_tr_b16 v[90:91], v136 offset:5120
    ds_read_b64_tr_b16 v[92:93], v137 offset:4096
    ds_read_b64_tr_b16 v[94:95], v137 offset:5120
    s_waitcnt lgkmcnt(6)
    v_mfma_f32_32x32x16_bf16 v[0:15], v[64:67], v[72:75], v[0:15]
    v_mfma_f32_32x32x16_bf16 v[16:31], v[64:67], v[76:79], v[16:31]
    v_mfma_f32_32x32x16_bf16 v[32:47], v[68:71], v[72:75], v[32:47]
    v_mfma_f32_32x32x16_bf16 v[48:63], v[68:71], v[76:79], v[48:63]
    ds_read_b128 v[64:67], v134 offset:0
    ds_read_b128 v[68:71], v134 offset:4096
    ds_read_b64_tr_b16 v[72:73], v136 offset:8192
    ds_read_b64_tr_b16 v[74:75], v136 offset:9216
    ds_read_b64_tr_b16 v[76:77], v137 offset:8192
    ds_read_b64_tr_b16 v[78:79], v137 offset:9216
    s_waitcnt lgkmcnt(6)
    v_mfma_f32_32x32x16_bf16 v[0:15], v[80:83], v[88:91], v[0:15]
    v_mfma_f32_32x32x16_bf16 v[16:31], v[80:83], v[92:95], v[16:31]
    v_mfma_f32_32x32x16_bf16 v[32:47], v[84:87], v[88:91], v[32:47]
    v_mfma_f32_32x32x16_bf16 v[48:63], v[84:87], v[92:95], v[48:63]
    ds_read_b128 v[80:83], v135 offset:0
    ds_read_b128 v[84:87], v135 offset:4096
    ds_read_b64_tr_b16 v[88:89], v136 offset:12288
    ds_read_b64_tr_b16 v[90:91], v136 offset:13312
    ds_read_b64_tr_b16 v[92:93], v137 offset:12288
    ds_read_b64_tr_b16 v[94:95], v137 offset:13312
    s_waitcnt lgkmcnt(6)
    v_mfma_f32_32x32x16_bf16 v[0:15], v[64:67], v[72:75], v[0:15]
    v_mfma_f32_32x32x16_bf16 v[16:31], v[64:67], v[76:79], v[16:31]
    v_mfma_f32_32x32x16_bf16 v[32:47], v[68:71], v[72:75], v[32:47]
    v_mfma_f32_32x32x16_bf16 v[48:63], v[68:71], v[76:79], v[48:63]
    s_waitcnt lgkmcnt(0)
    v_mfma_f32_32x32x16_bf16 v[0:15], v[80:83], v[88:91], v[0:15]
    v_mfma_f32_32x32x16_bf16 v[16:31], v[80:83], v[92:95], v[16:31]
    v_mfma_f32_32x32x16_bf16 v[32:47], v[84:87], v[88:91], v[32:47]
    v_mfma_f32_32x32x16_bf16 v[48:63], v[84:87], v[92:95], v[48:63]
    s_waitcnt vmcnt(20)
    ds_write_b128 v130, v[96:99] offset:32768
    ds_write_b128 v130, v[100:103] offset:36864
    ds_write_b128 v130, v[104:107] offset:40960
    ds_write_b128 v130, v[108:111] offset:45056
    s_waitcnt vmcnt(16)
    ds_write_b128 v131, v[112:115] offset:32768
    ds_write_b128 v131, v[116:119] offset:36864
    ds_write_b128 v131, v[120:123] offset:40960
    ds_write_b128 v131, v[124:127] offset:45056
    s_waitcnt lgkmcnt(0)
    s_barrier
    buffer_load_dwordx4 v[96:99], v128, s[8:11], s20 offen
    buffer_load_dwordx4 v[100:103], v128, s[8:11], s21 offen
    buffer_load_dwordx4 v[104:107], v128, s[8:11], s22 offen
    buffer_load_dwordx4 v[108:111], v128, s[8:11], s23 offen
    buffer_load_dwordx4 v[112:115], v129, s[12:15], s24 offen
    buffer_load_dwordx4 v[116:119], v129, s[12:15], s25 offen
    buffer_load_dwordx4 v[120:123], v129, s[12:15], s26 offen
    buffer_load_dwordx4 v[124:127], v129, s[12:15], s27 offen
    s_add_u32 s20, s20, 128
    s_add_u32 s21, s21, 128
    s_add_u32 s22, s22, 128
    s_add_u32 s23, s23, 128
    s_add_u32 s24, s24, 524288
    s_add_u32 s25, s25, 524288
    s_add_u32 s26, s26, 524288
    s_add_u32 s27, s27, 524288
    ds_read_b128 v[64:67], v132 offset:32768
    ds_read_b128 v[68:71], v132 offset:36864
    ds_read_b64_tr_b16 v[72:73], v136 offset:32768
    ds_read_b64_tr_b16 v[74:75], v136 offset:33792
    ds_read_b64_tr_b16 v[76:77], v137 offset:32768
    ds_read_b64_tr_b16 v[78:79], v137 offset:33792
    ds_read_b128 v[80:83], v133 offset:32768
    ds_read_b128 v[84:87], v133 offset:36864
    ds_read_b64_tr_b16 v[88:89], v136 offset:36864
    ds_read_b64_tr_b16 v[90:91], v136 offset:37888
    ds_read_b64_tr_b16 v[92:93], v137 offset:36864
    ds_read_b64_tr_b16 v[94:95], v137 offset:37888
    s_waitcnt lgkmcnt(6)
    v_mfma_f32_32x32x16_bf16 v[0:15], v[64:67], v[72:75], v[0:15]
    v_mfma_f32_32x32x16_bf16 v[16:31], v[64:67], v[76:79], v[16:31]
    v_mfma_f32_32x32x16_bf16 v[32:47], v[68:71], v[72:75], v[32:47]
    v_mfma_f32_32x32x16_bf16 v[48:63], v[68:71], v[76:79], v[48:63]
    ds_read_b128 v[64:67], v134 offset:32768
    ds_read_b128 v[68:71], v134 offset:36864
    ds_read_b64_tr_b16 v[72:73], v136 offset:40960
    ds_read_b64_tr_b16 v[74:75], v136 offset:41984
    ds_read_b64_tr_b16 v[76:77], v137 offset:40960
    ds_read_b64_tr_b16 v[78:79], v137 offset:41984
    s_waitcnt lgkmcnt(6)
    v_mfma_f32_32x32x16_bf16 v[0:15], v[80:83], v[88:91], v[0:15]
    v_mfma_f32_32x32x16_bf16 v[16:31], v[80:83], v[92:95], v[16:31]
    v_mfma_f32_32x32x16_bf16 v[32:47], v[84:87], v[88:91], v[32:47]
    v_mfma_f32_32x32x16_bf16 v[48:63], v[84:87], v[92:95], v[48:63]
    ds_read_b128 v[80:83], v135 offset:32768
    ds_read_b128 v[84:87], v135 offset:36864
    ds_read_b64_tr_b16 v[88:89], v136 offset:45056
    ds_read_b64_tr_b16 v[90:91], v136 offset:46080
    ds_read_b64_tr_b16 v[92:93], v137 offset:45056
    ds_read_b64_tr_b16 v[94:95], v137 offset:46080
    s_waitcnt lgkmcnt(6)
    v_mfma_f32_32x32x16_bf16 v[0:15], v[64:67], v[72:75], v[0:15]
    v_mfma_f32_32x32x16_bf16 v[16:31], v[64:67], v[76:79], v[16:31]
    v_mfma_f32_32x32x16_bf16 v[32:47], v[68:71], v[72:75], v[32:47]
    v_mfma_f32_32x32x16_bf16 v[48:63], v[68:71], v[76:79], v[48:63]
    s_waitcnt lgkmcnt(0)
    v_mfma_f32_32x32x16_bf16 v[0:15], v[80:83], v[88:91], v[0:15]
    v_mfma_f32_32x32x16_bf16 v[16:31], v[80:83], v[92:95], v[16:31]
    v_mfma_f32_32x32x16_bf16 v[32:47], v[84:87], v[88:91], v[32:47]
    v_mfma_f32_32x32x16_bf16 v[48:63], v[84:87], v[92:95], v[48:63]
    s_waitcnt vmcnt(20)
    ds_write_b128 v130, v[176:179] offset:0
    ds_write_b128 v130, v[180:183] offset:4096
    ds_write_b128 v130, v[184:187] offset:8192
    ds_write_b128 v130, v[188:191] offset:12288
    s_waitcnt vmcnt(16)
    ds_write_b128 v131, v[192:195] offset:0
    ds_write_b128 v131, v[196:199] offset:4096
    ds_write_b128 v131, v[200:203] offset:8192
    ds_write_b128 v131, v[204:207] offset:12288
    s_waitcnt lgkmcnt(0)
    s_barrier
    buffer_load_dwordx4 v[176:179], v128, s[8:11], s20 offen
    buffer_load_dwordx4 v[180:183], v128, s[8:11], s21 offen
    buffer_load_dwordx4 v[184:187], v128, s[8:11], s22 offen
    buffer_load_dwordx4 v[188:191], v128, s[8:11], s23 offen
    buffer_load_dwordx4 v[192:195], v129, s[12:15], s24 offen
    buffer_load_dwordx4 v[196:199], v129, s[12:15], s25 offen
    buffer_load_dwordx4 v[200:203], v129, s[12:15], s26 offen
    buffer_load_dwordx4 v[204:207], v129, s[12:15], s27 offen
    s_add_u32 s20, s20, 128
    s_add_u32 s21, s21, 128
    s_add_u32 s22, s22, 128
    s_add_u32 s23, s23, 128
    s_add_u32 s24, s24, 524288
    s_add_u32 s25, s25, 524288
    s_add_u32 s26, s26, 524288
    s_add_u32 s27, s27, 524288
    ds_read_b128 v[64:67], v132 offset:0
    ds_read_b128 v[68:71], v132 offset:4096
    ds_read_b64_tr_b16 v[72:73], v136 offset:0
    ds_read_b64_tr_b16 v[74:75], v136 offset:1024
    ds_read_b64_tr_b16 v[76:77], v137 offset:0
    ds_read_b64_tr_b16 v[78:79], v137 offset:1024
    ds_read_b128 v[80:83], v133 offset:0
    ds_read_b128 v[84:87], v133 offset:4096
    ds_read_b64_tr_b16 v[88:89], v136 offset:4096
    ds_read_b64_tr_b16 v[90:91], v136 offset:5120
    ds_read_b64_tr_b16 v[92:93], v137 offset:4096
    ds_read_b64_tr_b16 v[94:95], v137 offset:5120
    s_waitcnt lgkmcnt(6)
    v_mfma_f32_32x32x16_bf16 v[0:15], v[64:67], v[72:75], v[0:15]
    v_mfma_f32_32x32x16_bf16 v[16:31], v[64:67], v[76:79], v[16:31]
    v_mfma_f32_32x32x16_bf16 v[32:47], v[68:71], v[72:75], v[32:47]
    v_mfma_f32_32x32x16_bf16 v[48:63], v[68:71], v[76:79], v[48:63]
    ds_read_b128 v[64:67], v134 offset:0
    ds_read_b128 v[68:71], v134 offset:4096
    ds_read_b64_tr_b16 v[72:73], v136 offset:8192
    ds_read_b64_tr_b16 v[74:75], v136 offset:9216
    ds_read_b64_tr_b16 v[76:77], v137 offset:8192
    ds_read_b64_tr_b16 v[78:79], v137 offset:9216
    s_waitcnt lgkmcnt(6)
    v_mfma_f32_32x32x16_bf16 v[0:15], v[80:83], v[88:91], v[0:15]
    v_mfma_f32_32x32x16_bf16 v[16:31], v[80:83], v[92:95], v[16:31]
    v_mfma_f32_32x32x16_bf16 v[32:47], v[84:87], v[88:91], v[32:47]
    v_mfma_f32_32x32x16_bf16 v[48:63], v[84:87], v[92:95], v[48:63]
    ds_read_b128 v[80:83], v135 offset:0
    ds_read_b128 v[84:87], v135 offset:4096
    ds_read_b64_tr_b16 v[88:89], v136 offset:12288
    ds_read_b64_tr_b16 v[90:91], v136 offset:13312
    ds_read_b64_tr_b16 v[92:93], v137 offset:12288
    ds_read_b64_tr_b16 v[94:95], v137 offset:13312
    s_waitcnt lgkmcnt(6)
    v_mfma_f32_32x32x16_bf16 v[0:15], v[64:67], v[72:75], v[0:15]
    v_mfma_f32_32x32x16_bf16 v[16:31], v[64:67], v[76:79], v[16:31]
    v_mfma_f32_32x32x16_bf16 v[32:47], v[68:71], v[72:75], v[32:47]
    v_mfma_f32_32x32x16_bf16 v[48:63], v[68:71], v[76:79], v[48:63]
    s_waitcnt lgkmcnt(0)
    v_mfma_f32_32x32x16_bf16 v[0:15], v[80:83], v[88:91], v[0:15]
    v_mfma_f32_32x32x16_bf16 v[16:31], v[80:83], v[92:95], v[16:31]
    v_mfma_f32_32x32x16_bf16 v[32:47], v[84:87], v[88:91], v[32:47]
    v_mfma_f32_32x32x16_bf16 v[48:63], v[84:87], v[92:95], v[48:63]
    s_waitcnt vmcnt(20)
    ds_write_b128 v130, v[208:211] offset:32768
    ds_write_b128 v130, v[212:215] offset:36864
    ds_write_b128 v130, v[216:219] offset:40960
    ds_write_b128 v130, v[220:223] offset:45056
    s_waitcnt vmcnt(16)
    ds_write_b128 v131, v[224:227] offset:32768
    ds_write_b128 v131, v[228:231] offset:36864
    ds_write_b128 v131, v[232:235] offset:40960
    ds_write_b128 v131, v[236:239] offset:45056
    s_waitcnt lgkmcnt(0)
    s_barrier
    buffer_load_dwordx4 v[208:211], v128, s[8:11], s20 offen
    buffer_load_dwordx4 v[212:215], v128, s[8:11], s21 offen
    buffer_load_dwordx4 v[216:219], v128, s[8:11], s22 offen
    buffer_load_dwordx4 v[220:223], v128, s[8:11], s23 offen
    buffer_load_dwordx4 v[224:227], v129, s[12:15], s24 offen
    buffer_load_dwordx4 v[228:231], v129, s[12:15], s25 offen
    buffer_load_dwordx4 v[232:235], v129, s[12:15], s26 offen
    buffer_load_dwordx4 v[236:239], v129, s[12:15], s27 offen
    s_add_u32 s20, s20, 128
    s_add_u32 s21, s21, 128
    s_add_u32 s22, s22, 128
    s_add_u32 s23, s23, 128
    s_add_u32 s24, s24, 524288
    s_add_u32 s25, s25, 524288
    s_add_u32 s26, s26, 524288
    s_add_u32 s27, s27, 524288
    ds_read_b128 v[64:67], v132 offset:32768
    ds_read_b128 v[68:71], v132 offset:36864
    ds_read_b64_tr_b16 v[72:73], v136 offset:32768
    ds_read_b64_tr_b16 v[74:75], v136 offset:33792
    ds_read_b64_tr_b16 v[76:77], v137 offset:32768
    ds_read_b64_tr_b16 v[78:79], v137 offset:33792
    ds_read_b128 v[80:83], v133 offset:32768
    ds_read_b128 v[84:87], v133 offset:36864
    ds_read_b64_tr_b16 v[88:89], v136 offset:36864
    ds_read_b64_tr_b16 v[90:91], v136 offset:37888
    ds_read_b64_tr_b16 v[92:93], v137 offset:36864
    ds_read_b64_tr_b16 v[94:95], v137 offset:37888
    s_waitcnt lgkmcnt(6)
    v_mfma_f32_32x32x16_bf16 v[0:15], v[64:67], v[72:75], v[0:15]
    v_mfma_f32_32x32x16_bf16 v[16:31], v[64:67], v[76:79], v[16:31]
    v_mfma_f32_32x32x16_bf16 v[32:47], v[68:71], v[72:75], v[32:47]
    v_mfma_f32_32x32x16_bf16 v[48:63], v[68:71], v[76:79], v[48:63]
    ds_read_b128 v[64:67], v134 offset:32768
    ds_read_b128 v[68:71], v134 offset:36864
    ds_read_b64_tr_b16 v[72:73], v136 offset:40960
    ds_read_b64_tr_b16 v[74:75], v136 offset:41984
    ds_read_b64_tr_b16 v[76:77], v137 offset:40960
    ds_read_b64_tr_b16 v[78:79], v137 offset:41984
    s_waitcnt lgkmcnt(6)
    v_mfma_f32_32x32x16_bf16 v[0:15], v[80:83], v[88:91], v[0:15]
    v_mfma_f32_32x32x16_bf16 v[16:31], v[80:83], v[92:95], v[16:31]
    v_mfma_f32_32x32x16_bf16 v[32:47], v[84:87], v[88:91], v[32:47]
    v_mfma_f32_32x32x16_bf16 v[48:63], v[84:87], v[92:95], v[48:63]
    ds_read_b128 v[80:83], v135 offset:32768
    ds_read_b128 v[84:87], v135 offset:36864
    ds_read_b64_tr_b16 v[88:89], v136 offset:45056
    ds_read_b64_tr_b16 v[90:91], v136 offset:46080
    ds_read_b64_tr_b16 v[92:93], v137 offset:45056
    ds_read_b64_tr_b16 v[94:95], v137 offset:46080
    s_waitcnt lgkmcnt(6)
    v_mfma_f32_32x32x16_bf16 v[0:15], v[64:67], v[72:75], v[0:15]
    v_mfma_f32_32x32x16_bf16 v[16:31], v[64:67], v[76:79], v[16:31]
    v_mfma_f32_32x32x16_bf16 v[32:47], v[68:71], v[72:75], v[32:47]
    v_mfma_f32_32x32x16_bf16 v[48:63], v[68:71], v[76:79], v[48:63]
    s_waitcnt lgkmcnt(0)
    v_mfma_f32_32x32x16_bf16 v[0:15], v[80:83], v[88:91], v[0:15]
    v_mfma_f32_32x32x16_bf16 v[16:31], v[80:83], v[92:95], v[16:31]
    v_mfma_f32_32x32x16_bf16 v[32:47], v[84:87], v[88:91], v[32:47]
    v_mfma_f32_32x32x16_bf16 v[48:63], v[84:87], v[92:95], v[48:63]
    s_waitcnt vmcnt(20)
    ds_write_b128 v130, v[96:99] offset:0
    ds_write_b128 v130, v[100:103] offset:4096
    ds_write_b128 v130, v[104:107] offset:8192
    ds_write_b128 v130, v[108:111] offset:12288
    s_waitcnt vmcnt(16)
    ds_write_b128 v131, v[112:115] offset:0
    ds_write_b128 v131, v[116:119] offset:4096
    ds_write_b128 v131, v[120:123] offset:8192
    ds_write_b128 v131, v[124:127] offset:12288
    s_waitcnt lgkmcnt(0)
    s_barrier
    ds_read_b128 v[64:67], v132 offset:0
    ds_read_b128 v[68:71], v132 offset:4096
    ds_read_b64_tr_b16 v[72:73], v136 offset:0
    ds_read_b64_tr_b16 v[74:75], v136 offset:1024
    ds_read_b64_tr_b16 v[76:77], v137 offset:0
    ds_read_b64_tr_b16 v[78:79], v137 offset:1024
    ds_read_b128 v[80:83], v133 offset:0
    ds_read_b128 v[84:87], v133 offset:4096
    ds_read_b64_tr_b16 v[88:89], v136 offset:4096
    ds_read_b64_tr_b16 v[90:91], v136 offset:5120
    ds_read_b64_tr_b16 v[92:93], v137 offset:4096
    ds_read_b64_tr_b16 v[94:95], v137 offset:5120
    s_waitcnt lgkmcnt(6)
    v_mfma_f32_32x32x16_bf16 v[0:15], v[64:67], v[72:75], v[0:15]
    v_mfma_f32_32x32x16_bf16 v[16:31], v[64:67], v[76:79], v[16:31]
    v_mfma_f32_32x32x16_bf16 v[32:47], v[68:71], v[72:75], v[32:47]
    v_mfma_f32_32x32x16_bf16 v[48:63], v[68:71], v[76:79], v[48:63]
    ds_read_b128 v[64:67], v134 offset:0
    ds_read_b128 v[68:71], v134 offset:4096
    ds_read_b64_tr_b16 v[72:73], v136 offset:8192
    ds_read_b64_tr_b16 v[74:75], v136 offset:9216
    ds_read_b64_tr_b16 v[76:77], v137 offset:8192
    ds_read_b64_tr_b16 v[78:79], v137 offset:9216
    s_waitcnt lgkmcnt(6)
    v_mfma_f32_32x32x16_bf16 v[0:15], v[80:83], v[88:91], v[0:15]
    v_mfma_f32_32x32x16_bf16 v[16:31], v[80:83], v[92:95], v[16:31]
    v_mfma_f32_32x32x16_bf16 v[32:47], v[84:87], v[88:91], v[32:47]
    v_mfma_f32_32x32x16_bf16 v[48:63], v[84:87], v[92:95], v[48:63]
    ds_read_b128 v[80:83], v135 offset:0
    ds_read_b128 v[84:87], v135 offset:4096
    ds_read_b64_tr_b16 v[88:89], v136 offset:12288
    ds_read_b64_tr_b16 v[90:91], v136 offset:13312
    ds_read_b64_tr_b16 v[92:93], v137 offset:12288
    ds_read_b64_tr_b16 v[94:95], v137 offset:13312
    s_waitcnt lgkmcnt(6)
    v_mfma_f32_32x32x16_bf16 v[0:15], v[64:67], v[72:75], v[0:15]
    v_mfma_f32_32x32x16_bf16 v[16:31], v[64:67], v[76:79], v[16:31]
    v_mfma_f32_32x32x16_bf16 v[32:47], v[68:71], v[72:75], v[32:47]
    v_mfma_f32_32x32x16_bf16 v[48:63], v[68:71], v[76:79], v[48:63]
    s_waitcnt lgkmcnt(0)
    v_mfma_f32_32x32x16_bf16 v[0:15], v[80:83], v[88:91], v[0:15]
    v_mfma_f32_32x32x16_bf16 v[16:31], v[80:83], v[92:95], v[16:31]
    v_mfma_f32_32x32x16_bf16 v[32:47], v[84:87], v[88:91], v[32:47]
    v_mfma_f32_32x32x16_bf16 v[48:63], v[84:87], v[92:95], v[48:63]
    s_waitcnt vmcnt(12)
    ds_write_b128 v130, v[176:179] offset:32768
    ds_write_b128 v130, v[180:183] offset:36864
    ds_write_b128 v130, v[184:187] offset:40960
    ds_write_b128 v130, v[188:191] offset:45056
    s_waitcnt vmcnt(8)
    ds_write_b128 v131, v[192:195] offset:32768
    ds_write_b128 v131, v[196:199] offset:36864
    ds_write_b128 v131, v[200:203] offset:40960
    ds_write_b128 v131, v[204:207] offset:45056
    s_waitcnt lgkmcnt(0)
    s_barrier
    ds_read_b128 v[64:67], v132 offset:32768
    ds_read_b128 v[68:71], v132 offset:36864
    ds_read_b64_tr_b16 v[72:73], v136 offset:32768
    ds_read_b64_tr_b16 v[74:75], v136 offset:33792
    ds_read_b64_tr_b16 v[76:77], v137 offset:32768
    ds_read_b64_tr_b16 v[78:79], v137 offset:33792
    ds_read_b128 v[80:83], v133 offset:32768
    ds_read_b128 v[84:87], v133 offset:36864
    ds_read_b64_tr_b16 v[88:89], v136 offset:36864
    ds_read_b64_tr_b16 v[90:91], v136 offset:37888
    ds_read_b64_tr_b16 v[92:93], v137 offset:36864
    ds_read_b64_tr_b16 v[94:95], v137 offset:37888
    s_waitcnt lgkmcnt(6)
    v_mfma_f32_32x32x16_bf16 v[0:15], v[64:67], v[72:75], v[0:15]
    v_mfma_f32_32x32x16_bf16 v[16:31], v[64:67], v[76:79], v[16:31]
    v_mfma_f32_32x32x16_bf16 v[32:47], v[68:71], v[72:75], v[32:47]
    v_mfma_f32_32x32x16_bf16 v[48:63], v[68:71], v[76:79], v[48:63]
    ds_read_b128 v[64:67], v134 offset:32768
    ds_read_b128 v[68:71], v134 offset:36864
    ds_read_b64_tr_b16 v[72:73], v136 offset:40960
    ds_read_b64_tr_b16 v[74:75], v136 offset:41984
    ds_read_b64_tr_b16 v[76:77], v137 offset:40960
    ds_read_b64_tr_b16 v[78:79], v137 offset:41984
    s_waitcnt lgkmcnt(6)
    v_mfma_f32_32x32x16_bf16 v[0:15], v[80:83], v[88:91], v[0:15]
    v_mfma_f32_32x32x16_bf16 v[16:31], v[80:83], v[92:95], v[16:31]
    v_mfma_f32_32x32x16_bf16 v[32:47], v[84:87], v[88:91], v[32:47]
    v_mfma_f32_32x32x16_bf16 v[48:63], v[84:87], v[92:95], v[48:63]
    ds_read_b128 v[80:83], v135 offset:32768
    ds_read_b128 v[84:87], v135 offset:36864
    ds_read_b64_tr_b16 v[88:89], v136 offset:45056
    ds_read_b64_tr_b16 v[90:91], v136 offset:46080
    ds_read_b64_tr_b16 v[92:93], v137 offset:45056
    ds_read_b64_tr_b16 v[94:95], v137 offset:46080
    s_waitcnt lgkmcnt(6)
    v_mfma_f32_32x32x16_bf16 v[0:15], v[64:67], v[72:75], v[0:15]
    v_mfma_f32_32x32x16_bf16 v[16:31], v[64:67], v[76:79], v[16:31]
    v_mfma_f32_32x32x16_bf16 v[32:47], v[68:71], v[72:75], v[32:47]
    v_mfma_f32_32x32x16_bf16 v[48:63], v[68:71], v[76:79], v[48:63]
    s_waitcnt lgkmcnt(0)
    v_mfma_f32_32x32x16_bf16 v[0:15], v[80:83], v[88:91], v[0:15]
    v_mfma_f32_32x32x16_bf16 v[16:31], v[80:83], v[92:95], v[16:31]
    v_mfma_f32_32x32x16_bf16 v[32:47], v[84:87], v[88:91], v[32:47]
    v_mfma_f32_32x32x16_bf16 v[48:63], v[84:87], v[92:95], v[48:63]
    s_waitcnt vmcnt(4)
    ds_write_b128 v130, v[208:211] offset:0
    ds_write_b128 v130, v[212:215] offset:4096
    ds_write_b128 v130, v[216:219] offset:8192
    ds_write_b128 v130, v[220:223] offset:12288
    s_waitcnt vmcnt(0)
    ds_write_b128 v131, v[224:227] offset:0
    ds_write_b128 v131, v[228:231] offset:4096
    ds_write_b128 v131, v[232:235] offset:8192
    ds_write_b128 v131, v[236:239] offset:12288
    s_waitcnt lgkmcnt(0)
    s_barrier
    ds_read_b128 v[64:67], v132 offset:0
    ds_read_b128 v[68:71], v132 offset:4096
    ds_read_b64_tr_b16 v[72:73], v136 offset:0
    ds_read_b64_tr_b16 v[74:75], v136 offset:1024
    ds_read_b64_tr_b16 v[76:77], v137 offset:0
    ds_read_b64_tr_b16 v[78:79], v137 offset:1024
    ds_read_b128 v[80:83], v133 offset:0
    ds_read_b128 v[84:87], v133 offset:4096
    ds_read_b64_tr_b16 v[88:89], v136 offset:4096
    ds_read_b64_tr_b16 v[90:91], v136 offset:5120
    ds_read_b64_tr_b16 v[92:93], v137 offset:4096
    ds_read_b64_tr_b16 v[94:95], v137 offset:5120
    s_waitcnt lgkmcnt(6)
    v_mfma_f32_32x32x16_bf16 v[0:15], v[64:67], v[72:75], v[0:15]
    v_mfma_f32_32x32x16_bf16 v[16:31], v[64:67], v[76:79], v[16:31]
    v_mfma_f32_32x32x16_bf16 v[32:47], v[68:71], v[72:75], v[32:47]
    v_mfma_f32_32x32x16_bf16 v[48:63], v[68:71], v[76:79], v[48:63]
    ds_read_b128 v[64:67], v134 offset:0
    ds_read_b128 v[68:71], v134 offset:4096
    ds_read_b64_tr_b16 v[72:73], v136 offset:8192
    ds_read_b64_tr_b16 v[74:75], v136 offset:9216
    ds_read_b64_tr_b16 v[76:77], v137 offset:8192
    ds_read_b64_tr_b16 v[78:79], v137 offset:9216
    s_waitcnt lgkmcnt(6)
    v_mfma_f32_32x32x16_bf16 v[0:15], v[80:83], v[88:91], v[0:15]
    v_mfma_f32_32x32x16_bf16 v[16:31], v[80:83], v[92:95], v[16:31]
    v_mfma_f32_32x32x16_bf16 v[32:47], v[84:87], v[88:91], v[32:47]
    v_mfma_f32_32x32x16_bf16 v[48:63], v[84:87], v[92:95], v[48:63]
    ds_read_b128 v[80:83], v135 offset:0
    ds_read_b128 v[84:87], v135 offset:4096
    ds_read_b64_tr_b16 v[88:89], v136 offset:12288
    ds_read_b64_tr_b16 v[90:91], v136 offset:13312
    ds_read_b64_tr_b16 v[92:93], v137 offset:12288
    ds_read_b64_tr_b16 v[94:95], v137 offset:13312
    s_waitcnt lgkmcnt(6)
    v_mfma_f32_32x32x16_bf16 v[0:15], v[64:67], v[72:75], v[0:15]
    v_mfma_f32_32x32x16_bf16 v[16:31], v[64:67], v[76:79], v[16:31]
    v_mfma_f32_32x32x16_bf16 v[32:47], v[68:71], v[72:75], v[32:47]
    v_mfma_f32_32x32x16_bf16 v[48:63], v[68:71], v[76:79], v[48:63]
    s_waitcnt lgkmcnt(0)
    v_mfma_f32_32x32x16_bf16 v[0:15], v[80:83], v[88:91], v[0:15]
    v_mfma_f32_32x32x16_bf16 v[16:31], v[80:83], v[92:95], v[16:31]
    v_mfma_f32_32x32x16_bf16 v[32:47], v[84:87], v[88:91], v[32:47]
    v_mfma_f32_32x32x16_bf16 v[48:63], v[84:87], v[92:95], v[48:63]
    s_barrier
    s_nop 7
    s_nop 7
    v_lshrrev_b32 v140, 7, v168
    v_lshrrev_b32 v141, 6, v168
    v_and_b32 v141, 1, v141
    v_and_b32 v142, 31, v169
    v_lshrrev_b32 v143, 5, v169

    v_lshl_add_u32 v142, v141, 6, v142
    v_mul_u32_u24 v142, 272, v142
    v_lshlrev_b32 v144, 7, v140
    v_lshl_add_u32 v144, v143, 3, v144
    v_add_u32 v142, v142, v144

    v_cvt_pk_bf16_f32 v146, v0, v1
    v_cvt_pk_bf16_f32 v147, v2, v3
    ds_write_b64 v142, v[146:147] offset:0

    v_cvt_pk_bf16_f32 v146, v4, v5
    v_cvt_pk_bf16_f32 v147, v6, v7
    ds_write_b64 v142, v[146:147] offset:16

    v_cvt_pk_bf16_f32 v146, v8, v9
    v_cvt_pk_bf16_f32 v147, v10, v11
    ds_write_b64 v142, v[146:147] offset:32

    v_cvt_pk_bf16_f32 v146, v12, v13
    v_cvt_pk_bf16_f32 v147, v14, v15
    ds_write_b64 v142, v[146:147] offset:48

    v_cvt_pk_bf16_f32 v146, v16, v17
    v_cvt_pk_bf16_f32 v147, v18, v19
    ds_write_b64 v142, v[146:147] offset:8704

    v_cvt_pk_bf16_f32 v146, v20, v21
    v_cvt_pk_bf16_f32 v147, v22, v23
    ds_write_b64 v142, v[146:147] offset:8720

    v_cvt_pk_bf16_f32 v146, v24, v25
    v_cvt_pk_bf16_f32 v147, v26, v27
    ds_write_b64 v142, v[146:147] offset:8736

    v_cvt_pk_bf16_f32 v146, v28, v29
    v_cvt_pk_bf16_f32 v147, v30, v31
    ds_write_b64 v142, v[146:147] offset:8752

    v_cvt_pk_bf16_f32 v146, v32, v33
    v_cvt_pk_bf16_f32 v147, v34, v35
    ds_write_b64 v142, v[146:147] offset:64

    v_cvt_pk_bf16_f32 v146, v36, v37
    v_cvt_pk_bf16_f32 v147, v38, v39
    ds_write_b64 v142, v[146:147] offset:80

    v_cvt_pk_bf16_f32 v146, v40, v41
    v_cvt_pk_bf16_f32 v147, v42, v43
    ds_write_b64 v142, v[146:147] offset:96

    v_cvt_pk_bf16_f32 v146, v44, v45
    v_cvt_pk_bf16_f32 v147, v46, v47
    ds_write_b64 v142, v[146:147] offset:112

    v_cvt_pk_bf16_f32 v146, v48, v49
    v_cvt_pk_bf16_f32 v147, v50, v51
    ds_write_b64 v142, v[146:147] offset:8768

    v_cvt_pk_bf16_f32 v146, v52, v53
    v_cvt_pk_bf16_f32 v147, v54, v55
    ds_write_b64 v142, v[146:147] offset:8784

    v_cvt_pk_bf16_f32 v146, v56, v57
    v_cvt_pk_bf16_f32 v147, v58, v59
    ds_write_b64 v142, v[146:147] offset:8800

    v_cvt_pk_bf16_f32 v146, v60, v61
    v_cvt_pk_bf16_f32 v147, v62, v63
    ds_write_b64 v142, v[146:147] offset:8816

    s_waitcnt lgkmcnt(0)
    s_barrier
    s_add_u32 s16, s4, 37748736
    s_addc_u32 s17, s5, 0
    s_and_b32 s17, s17, 0xffff
    s_mov_b32 s18, 16777216
    s_mov_b32 s19, 0x00020000

    v_lshrrev_b32 v141, 4, v168
    v_and_b32 v142, 15, v168
    v_mul_u32_u24 v140, 272, v141
    v_lshl_add_u32 v140, v142, 4, v140

    v_lshrrev_b32 v143, 2, v142
    v_lshlrev_b32 v143, 18, v143
    v_lshl_add_u32 v143, v141, 6, v143
    v_and_b32 v144, 3, v142
    v_lshl_add_u32 v143, v144, 4, v143
    s_lshr_b32 s36, s30, 5
    s_lshl_b32 s36, s36, 18
    s_lshl_b32 s37, s34, 13
    s_add_u32 s36, s36, s37

    ds_read_b128 v[64:67], v140 offset:0
    ds_read_b128 v[68:71], v140 offset:4352
    ds_read_b128 v[72:75], v140 offset:8704
    ds_read_b128 v[76:79], v140 offset:13056
    ds_read_b128 v[80:83], v140 offset:17408
    ds_read_b128 v[84:87], v140 offset:21760
    ds_read_b128 v[88:91], v140 offset:26112
    ds_read_b128 v[92:95], v140 offset:30464
    s_waitcnt lgkmcnt(7)
    buffer_store_dwordx4 v[64:67], v143, s[16:19], s36 offen sc1
    s_add_u32 s36, s36, 1024

    s_waitcnt lgkmcnt(6)
    buffer_store_dwordx4 v[68:71], v143, s[16:19], s36 offen sc1
    s_add_u32 s36, s36, 1024

    s_waitcnt lgkmcnt(5)
    buffer_store_dwordx4 v[72:75], v143, s[16:19], s36 offen sc1
    s_add_u32 s36, s36, 1024

    s_waitcnt lgkmcnt(4)
    buffer_store_dwordx4 v[76:79], v143, s[16:19], s36 offen sc1
    s_add_u32 s36, s36, 1024

    s_waitcnt lgkmcnt(3)
    buffer_store_dwordx4 v[80:83], v143, s[16:19], s36 offen sc1
    s_add_u32 s36, s36, 1024

    s_waitcnt lgkmcnt(2)
    buffer_store_dwordx4 v[84:87], v143, s[16:19], s36 offen sc1
    s_add_u32 s36, s36, 1024

    s_waitcnt lgkmcnt(1)
    buffer_store_dwordx4 v[88:91], v143, s[16:19], s36 offen sc1
    s_add_u32 s36, s36, 1024

    s_waitcnt lgkmcnt(0)
    buffer_store_dwordx4 v[92:95], v143, s[16:19], s36 offen sc1
    s_add_u32 s36, s36, 1024

L_qkvdone_60:
    s_lshl_b32 s72, s33, 4
    s_add_u32 s72, s72, s32
    s_lshl_b32 s72, s72, 5
    s_add_u32 s72, s72, s34
    s_lshl_b32 s72, s72, 2

    v_accvgpr_read_b32 v168, a0
    s_nop 0
    v_and_b32 v169, 63, v168

    s_waitcnt vmcnt(0)
    s_barrier
    v_cmp_eq_u32 vcc, 0, v168
    s_and_saveexec_b64 s[76:77], vcc
    s_cbranch_execz L_sig_61
    v_mov_b32 v140, 0
    v_mov_b32 v141, 1

    buffer_store_dword v141, v140, s[68:71], s72 offen sc1
L_sig_61:
    s_mov_b64 exec, s[76:77]
    s_add_u32 s66, s66, 224
    s_branch L_qloop_53

L_qloopx_54:
    s_mov_b32 s65, 0
    s_mov_b32 s66, s64
    s_sub_u32 s66, s64, 0
    s_cmp_ge_u32 s66, 32
    s_cbranch_scc1 L_rskip_62
    s_mov_b32 s65, 0

L_rloop_63:
    s_lshl_b32 s72, s65, 5
    s_add_u32 s72, s72, s66
    s_lshl_b32 s72, s72, 2

    v_accvgpr_read_b32 v168, a0
    s_nop 0
    v_and_b32 v169, 63, v168

    v_lshrrev_b32 v140, 6, v168
    s_nop 0
    v_readfirstlane_b32 s78, v140
    s_cmp_lg_u32 s78, 0
    s_cbranch_scc1 L_wpollx_65
    v_mov_b32 v140, 0
    s_mov_b32 s79, 0

L_wpoll_64:
    buffer_load_dword v141, v140, s[68:71], s72 offen sc1
    s_add_u32 s79, s79, 1
    s_waitcnt vmcnt(0)
    v_readfirstlane_b32 s78, v141
    s_cmp_ge_u32 s78, 1
    s_cbranch_scc1 L_wpollx_65
    s_cmp_gt_u32 s79, 200000
    s_cbranch_scc1 L_wpollx_65
    s_sleep 24
    s_branch L_wpoll_64

L_wpollx_65:
    s_barrier
    v_accvgpr_read_b32 v168, a0
    s_nop 0
    v_and_b32 v169, 63, v168

    v_lshrrev_b32 v140, 6, v168
    s_nop 0
    v_readfirstlane_b32 s78, v140
    s_cmp_lg_u32 s78, 0
    s_cbranch_scc1 L_wpollx_67
    v_mov_b32 v140, 2048
    s_mov_b32 s79, 0

L_wpoll_66:
    buffer_load_dword v141, v140, s[68:71], s72 offen sc1
    s_add_u32 s79, s79, 1
    s_waitcnt vmcnt(0)
    v_readfirstlane_b32 s78, v141
    s_cmp_ge_u32 s78, 1
    s_cbranch_scc1 L_wpollx_67
    s_cmp_gt_u32 s79, 200000
    s_cbranch_scc1 L_wpollx_67
    s_sleep 24
    s_branch L_wpoll_66

L_wpollx_67:
    s_barrier
    v_accvgpr_read_b32 v168, a0
    s_nop 0
    v_and_b32 v169, 63, v168

    v_lshrrev_b32 v140, 6, v168
    s_nop 0
    v_readfirstlane_b32 s78, v140
    s_cmp_lg_u32 s78, 0
    s_cbranch_scc1 L_wpollx_69
    v_mov_b32 v140, 4096
    s_mov_b32 s79, 0

L_wpoll_68:
    buffer_load_dword v141, v140, s[68:71], s72 offen sc1
    s_add_u32 s79, s79, 1
    s_waitcnt vmcnt(0)
    v_readfirstlane_b32 s78, v141
    s_cmp_ge_u32 s78, 1
    s_cbranch_scc1 L_wpollx_69
    s_cmp_gt_u32 s79, 200000
    s_cbranch_scc1 L_wpollx_69
    s_sleep 24
    s_branch L_wpoll_68

L_wpollx_69:
    s_barrier
    s_lshl_b32 s72, s66, 6
    s_add_u32 s72, s72, 8192
    s_lshl_b32 s73, s65, 2
    s_add_u32 s73, s73, 4

    v_accvgpr_read_b32 v168, a0
    s_nop 0
    v_and_b32 v169, 63, v168

    v_lshrrev_b32 v140, 6, v168
    s_nop 0
    v_readfirstlane_b32 s78, v140
    s_cmp_lg_u32 s78, 0
    s_cbranch_scc1 L_wpollx_71
    v_mov_b32 v140, 0
    s_mov_b32 s79, 0

L_wpoll_70:
    buffer_load_dword v141, v140, s[68:71], s72 offen sc1
    s_add_u32 s79, s79, 1
    s_waitcnt vmcnt(0)
    v_readfirstlane_b32 s78, v141
    s_cmp_ge_u32 s78, s73
    s_cbranch_scc1 L_wpollx_71
    s_cmp_gt_u32 s79, 200000
    s_cbranch_scc1 L_wpollx_71
    s_sleep 24
    s_branch L_wpoll_70

L_wpollx_71:
    s_barrier
    v_mov_b32 v0, v168
    v_lshrrev_b32 v1, 6, v0
    v_and_b32 v2, 63, v0
    s_nop 0
    v_readfirstlane_b32 s20, v1
    s_lshl_b32 s21, s65, 2
    s_add_u32 s21, s21, s20
    s_mov_b32 s22, s66

    s_add_u32 s8, s4, 4194304
    s_addc_u32 s9, s5, 0
    s_and_b32 s9, s9, 0xffff
    s_mov_b32 s10, 16777216
    s_mov_b32 s11, 0x00020000

    s_add_u32 s12, s4, 20971520
    s_addc_u32 s13, s5, 0
    s_and_b32 s13, s13, 0xffff
    s_mov_b32 s14, 16777216
    s_mov_b32 s15, 0x00020000

    s_add_u32 s16, s4, 37748736
    s_addc_u32 s17, s5, 0
    s_and_b32 s17, s17, 0xffff
    s_mov_b32 s18, 16777216
    s_mov_b32 s19, 0x00020000

    s_add_u32 s24, s4, 54525952
    s_addc_u32 s25, s5, 0
    s_and_b32 s25, s25, 0xffff
    s_mov_b32 s26, 4194304
    s_mov_b32 s27, 0x00020000

    s_add_u32 s28, s4, 58720256
    s_addc_u32 s29, s5, 0
    s_and_b32 s29, s29, 0xffff
    s_mov_b32 s30, 4194304
    s_mov_b32 s31, 0x00020000

    s_add_u32 s32, s4, 67108864
    s_addc_u32 s33, s5, 0
    s_and_b32 s33, s33, 0xffff
    s_mov_b32 s34, 16777216
    s_mov_b32 s35, 0x00020000

    v_and_b32 v3, 31, v2
    v_lshrrev_b32 v4, 5, v2
    v_lshlrev_b32 v5, 13, v3
    v_lshl_add_u32 v5, v4, 4, v5
    s_lshl_b32 s36, s21, 18
    s_lshl_b32 s37, s22, 8
    s_add_u32 s36, s36, s37
    v_and_b32 v6, 7, v2
    v_lshlrev_b32 v6, 8, v6
    v_lshl_add_u32 v6, v4, 4, v6
    s_lshl_b32 s38, s21, 5
    s_add_u32 s38, s38, s22
    s_lshl_b32 s39, s38, 13
    s_lshl_b32 s38, s38, 11
    s_add_u32 s42, s39, 4096
    v_lshlrev_b32 v7, 6, v3
    v_lshl_add_u32 v7, v4, 4, v7
    v_lshlrev_b32 v8, 4, v3

    buffer_load_dwordx4 v[16:19], v5, s[8:11], s36 offen offset:0
    buffer_load_dwordx4 v[48:51], v5, s[12:15], s36 offen offset:0
    buffer_load_dwordx4 v[80:83], v6, s[24:27], s38 offen offset:0
    buffer_load_dwordx4 v[20:23], v5, s[8:11], s36 offen offset:32
    buffer_load_dwordx4 v[52:55], v5, s[12:15], s36 offen offset:32
    buffer_load_dwordx4 v[84:87], v6, s[24:27], s38 offen offset:32
    buffer_load_dwordx4 v[24:27], v5, s[8:11], s36 offen offset:64
    buffer_load_dwordx4 v[56:59], v5, s[12:15], s36 offen offset:64
    buffer_load_dwordx4 v[88:91], v6, s[24:27], s38 offen offset:64
    buffer_load_dwordx4 v[28:31], v5, s[8:11], s36 offen offset:96
    buffer_load_dwordx4 v[60:63], v5, s[12:15], s36 offen offset:96
    buffer_load_dwordx4 v[92:95], v6, s[24:27], s38 offen offset:96
    buffer_load_dwordx4 v[32:35], v5, s[8:11], s36 offen offset:128
    buffer_load_dwordx4 v[64:67], v5, s[12:15], s36 offen offset:128
    buffer_load_dwordx4 v[96:99], v6, s[24:27], s38 offen offset:128
    buffer_load_dwordx4 v[36:39], v5, s[8:11], s36 offen offset:160
    buffer_load_dwordx4 v[68:71], v5, s[12:15], s36 offen offset:160
    buffer_load_dwordx4 v[100:103], v6, s[24:27], s38 offen offset:160
    buffer_load_dwordx4 v[40:43], v5, s[8:11], s36 offen offset:192
    buffer_load_dwordx4 v[72:75], v5, s[12:15], s36 offen offset:192
    buffer_load_dwordx4 v[104:107], v6, s[24:27], s38 offen offset:192
    buffer_load_dwordx4 v[44:47], v5, s[8:11], s36 offen offset:224
    buffer_load_dwordx4 v[76:79], v5, s[12:15], s36 offen offset:224
    buffer_load_dwordx4 v[108:111], v6, s[24:27], s38 offen offset:224
    buffer_load_dwordx4 v[112:115], v7, s[16:19], s39 offen offset:0
    buffer_load_dwordx4 v[116:119], v7, s[16:19], s39 offen offset:32
    buffer_load_dwordx4 v[176:179], v8, s[28:31], s38 offen offset:0
    buffer_load_dwordx4 v[120:123], v7, s[16:19], s39 offen offset:2048
    buffer_load_dwordx4 v[124:127], v7, s[16:19], s39 offen offset:2080
    buffer_load_dwordx4 v[180:183], v8, s[28:31], s38 offen offset:512
    buffer_load_dwordx4 v[128:131], v7, s[16:19], s42 offen offset:0
    buffer_load_dwordx4 v[132:135], v7, s[16:19], s42 offen offset:32
    buffer_load_dwordx4 v[184:187], v8, s[28:31], s38 offen offset:1024
    buffer_load_dwordx4 v[136:139], v7, s[16:19], s42 offen offset:2048
    buffer_load_dwordx4 v[140:143], v7, s[16:19], s42 offen offset:2080
    buffer_load_dwordx4 v[188:191], v8, s[28:31], s38 offen offset:1536
    s_waitcnt vmcnt(33)
    v_mfma_f32_32x32x16_bf16 v[192:207], v[48:51], v[16:19], 0
    v_mfma_f32_32x32x16_bf16 v[208:223], v[80:83], v[16:19], 0
    s_waitcnt vmcnt(30)
    v_mfma_f32_32x32x16_bf16 v[192:207], v[52:55], v[20:23], v[192:207]
    v_mfma_f32_32x32x16_bf16 v[208:223], v[84:87], v[20:23], v[208:223]
    s_waitcnt vmcnt(27)
    v_mfma_f32_32x32x16_bf16 v[192:207], v[56:59], v[24:27], v[192:207]
    v_mfma_f32_32x32x16_bf16 v[208:223], v[88:91], v[24:27], v[208:223]
    s_waitcnt vmcnt(24)
    v_mfma_f32_32x32x16_bf16 v[192:207], v[60:63], v[28:31], v[192:207]
    v_mfma_f32_32x32x16_bf16 v[208:223], v[92:95], v[28:31], v[208:223]
    s_waitcnt vmcnt(21)
    v_mfma_f32_32x32x16_bf16 v[192:207], v[64:67], v[32:35], v[192:207]
    v_mfma_f32_32x32x16_bf16 v[208:223], v[96:99], v[32:35], v[208:223]
    s_waitcnt vmcnt(18)
    v_mfma_f32_32x32x16_bf16 v[192:207], v[68:71], v[36:39], v[192:207]
    v_mfma_f32_32x32x16_bf16 v[208:223], v[100:103], v[36:39], v[208:223]
    s_waitcnt vmcnt(15)
    v_mfma_f32_32x32x16_bf16 v[192:207], v[72:75], v[40:43], v[192:207]
    v_mfma_f32_32x32x16_bf16 v[208:223], v[104:107], v[40:43], v[208:223]
    s_waitcnt vmcnt(12)
    v_mfma_f32_32x32x16_bf16 v[192:207], v[76:79], v[44:47], v[192:207]
    v_mfma_f32_32x32x16_bf16 v[208:223], v[108:111], v[44:47], v[208:223]
    s_nop 7
    s_nop 7
    s_mov_b32 s40, 1035273459
    v_lshlrev_b32 v9, 2, v4
    v_sub_u32 v9, v3, v9
    v_mov_b32 v10, 0xce6e6b28

    v_cvt_pk_bf16_f32 v224, v192, v193
    v_lshlrev_b32 v192, 16, v224
    v_and_b32 v193, 0xffff0000, v224

    v_mul_f32 v192, s40, v192
    v_mul_f32 v193, s40, v193

    v_cvt_pk_bf16_f32 v224, v192, v193
    v_lshlrev_b32 v192, 16, v224
    v_and_b32 v193, 0xffff0000, v224

    v_cvt_pk_bf16_f32 v224, v194, v195
    v_lshlrev_b32 v194, 16, v224
    v_and_b32 v195, 0xffff0000, v224

    v_mul_f32 v194, s40, v194
    v_mul_f32 v195, s40, v195

    v_cvt_pk_bf16_f32 v224, v194, v195
    v_lshlrev_b32 v194, 16, v224
    v_and_b32 v195, 0xffff0000, v224

    v_cvt_pk_bf16_f32 v224, v196, v197
    v_lshlrev_b32 v196, 16, v224
    v_and_b32 v197, 0xffff0000, v224

    v_mul_f32 v196, s40, v196
    v_mul_f32 v197, s40, v197

    v_cvt_pk_bf16_f32 v224, v196, v197
    v_lshlrev_b32 v196, 16, v224
    v_and_b32 v197, 0xffff0000, v224

    v_cvt_pk_bf16_f32 v224, v198, v199
    v_lshlrev_b32 v198, 16, v224
    v_and_b32 v199, 0xffff0000, v224

    v_mul_f32 v198, s40, v198
    v_mul_f32 v199, s40, v199

    v_cvt_pk_bf16_f32 v224, v198, v199
    v_lshlrev_b32 v198, 16, v224
    v_and_b32 v199, 0xffff0000, v224

    v_cvt_pk_bf16_f32 v224, v200, v201
    v_lshlrev_b32 v200, 16, v224
    v_and_b32 v201, 0xffff0000, v224

    v_mul_f32 v200, s40, v200
    v_mul_f32 v201, s40, v201

    v_cvt_pk_bf16_f32 v224, v200, v201
    v_lshlrev_b32 v200, 16, v224
    v_and_b32 v201, 0xffff0000, v224

    v_cvt_pk_bf16_f32 v224, v202, v203
    v_lshlrev_b32 v202, 16, v224
    v_and_b32 v203, 0xffff0000, v224

    v_mul_f32 v202, s40, v202
    v_mul_f32 v203, s40, v203

    v_cvt_pk_bf16_f32 v224, v202, v203
    v_lshlrev_b32 v202, 16, v224
    v_and_b32 v203, 0xffff0000, v224

    v_cvt_pk_bf16_f32 v224, v204, v205
    v_lshlrev_b32 v204, 16, v224
    v_and_b32 v205, 0xffff0000, v224

    v_mul_f32 v204, s40, v204
    v_mul_f32 v205, s40, v205

    v_cvt_pk_bf16_f32 v224, v204, v205
    v_lshlrev_b32 v204, 16, v224
    v_and_b32 v205, 0xffff0000, v224

    v_cvt_pk_bf16_f32 v224, v206, v207
    v_lshlrev_b32 v206, 16, v224
    v_and_b32 v207, 0xffff0000, v224

    v_mul_f32 v206, s40, v206
    v_mul_f32 v207, s40, v207

    v_cvt_pk_bf16_f32 v224, v206, v207
    v_lshlrev_b32 v206, 16, v224
    v_and_b32 v207, 0xffff0000, v224

    v_cvt_pk_bf16_f32 v224, v208, v209
    v_lshlrev_b32 v208, 16, v224
    v_and_b32 v209, 0xffff0000, v224

    v_mul_f32 v208, s40, v208
    v_mul_f32 v209, s40, v209

    v_cvt_pk_bf16_f32 v224, v208, v209
    v_lshlrev_b32 v208, 16, v224
    v_and_b32 v209, 0xffff0000, v224

    v_cvt_pk_bf16_f32 v224, v210, v211
    v_lshlrev_b32 v210, 16, v224
    v_and_b32 v211, 0xffff0000, v224

    v_mul_f32 v210, s40, v210
    v_mul_f32 v211, s40, v211

    v_cvt_pk_bf16_f32 v224, v210, v211
    v_lshlrev_b32 v210, 16, v224
    v_and_b32 v211, 0xffff0000, v224

    v_cmp_le_i32 vcc, 0, v9
    s_nop 1
    v_cndmask_b32 v192, v10, v192, vcc

    v_cmp_le_i32 vcc, 1, v9
    s_nop 1
    v_cndmask_b32 v193, v10, v193, vcc

    v_cmp_le_i32 vcc, 2, v9
    s_nop 1
    v_cndmask_b32 v194, v10, v194, vcc

    v_cmp_le_i32 vcc, 3, v9
    s_nop 1
    v_cndmask_b32 v195, v10, v195, vcc

    v_cmp_le_i32 vcc, 8, v9
    s_nop 1
    v_cndmask_b32 v196, v10, v196, vcc

    v_cmp_le_i32 vcc, 9, v9
    s_nop 1
    v_cndmask_b32 v197, v10, v197, vcc

    v_cmp_le_i32 vcc, 10, v9
    s_nop 1
    v_cndmask_b32 v198, v10, v198, vcc

    v_cmp_le_i32 vcc, 11, v9
    s_nop 1
    v_cndmask_b32 v199, v10, v199, vcc

    v_cmp_le_i32 vcc, 16, v9
    s_nop 1
    v_cndmask_b32 v200, v10, v200, vcc

    v_cmp_le_i32 vcc, 17, v9
    s_nop 1
    v_cndmask_b32 v201, v10, v201, vcc

    v_cmp_le_i32 vcc, 18, v9
    s_nop 1
    v_cndmask_b32 v202, v10, v202, vcc

    v_cmp_le_i32 vcc, 19, v9
    s_nop 1
    v_cndmask_b32 v203, v10, v203, vcc

    v_cmp_le_i32 vcc, 24, v9
    s_nop 1
    v_cndmask_b32 v204, v10, v204, vcc

    v_cmp_le_i32 vcc, 25, v9
    s_nop 1
    v_cndmask_b32 v205, v10, v205, vcc

    v_cmp_le_i32 vcc, 26, v9
    s_nop 1
    v_cndmask_b32 v206, v10, v206, vcc

    v_cmp_le_i32 vcc, 27, v9
    s_nop 1
    v_cndmask_b32 v207, v10, v207, vcc

    v_max_f32 v224, v192, v193
    v_max_f32 v224, v224, v194
    v_max_f32 v224, v224, v195
    v_max_f32 v224, v224, v196
    v_max_f32 v224, v224, v197
    v_max_f32 v224, v224, v198
    v_max_f32 v224, v224, v199
    v_max_f32 v224, v224, v200
    v_max_f32 v224, v224, v201
    v_max_f32 v224, v224, v202
    v_max_f32 v224, v224, v203
    v_max_f32 v224, v224, v204
    v_max_f32 v224, v224, v205
    v_max_f32 v224, v224, v206
    v_max_f32 v224, v224, v207
    v_max_f32 v224, v224, v208
    v_max_f32 v224, v224, v209
    v_max_f32 v224, v224, v210
    v_max_f32 v224, v224, v211
    v_mov_b32 v225, v224
    s_nop 1
    v_permlane32_swap_b32 v224, v225
    s_nop 1
    v_max_f32 v224, v224, v225
    s_mov_b32 s41, 0x3fb8aa3b
    v_mul_f32 v224, s41, v224
    v_mov_b32 v226, 0

    v_fma_f32 v192, v192, s41, -v224
    v_exp_f32 v192, v192
    s_nop 0
    v_add_f32 v226, v226, v192

    v_fma_f32 v193, v193, s41, -v224
    v_exp_f32 v193, v193
    s_nop 0
    v_add_f32 v226, v226, v193

    v_fma_f32 v194, v194, s41, -v224
    v_exp_f32 v194, v194
    s_nop 0
    v_add_f32 v226, v226, v194

    v_fma_f32 v195, v195, s41, -v224
    v_exp_f32 v195, v195
    s_nop 0
    v_add_f32 v226, v226, v195

    v_fma_f32 v196, v196, s41, -v224
    v_exp_f32 v196, v196
    s_nop 0
    v_add_f32 v226, v226, v196

    v_fma_f32 v197, v197, s41, -v224
    v_exp_f32 v197, v197
    s_nop 0
    v_add_f32 v226, v226, v197

    v_fma_f32 v198, v198, s41, -v224
    v_exp_f32 v198, v198
    s_nop 0
    v_add_f32 v226, v226, v198

    v_fma_f32 v199, v199, s41, -v224
    v_exp_f32 v199, v199
    s_nop 0
    v_add_f32 v226, v226, v199

    v_fma_f32 v200, v200, s41, -v224
    v_exp_f32 v200, v200
    s_nop 0
    v_add_f32 v226, v226, v200

    v_fma_f32 v201, v201, s41, -v224
    v_exp_f32 v201, v201
    s_nop 0
    v_add_f32 v226, v226, v201

    v_fma_f32 v202, v202, s41, -v224
    v_exp_f32 v202, v202
    s_nop 0
    v_add_f32 v226, v226, v202

    v_fma_f32 v203, v203, s41, -v224
    v_exp_f32 v203, v203
    s_nop 0
    v_add_f32 v226, v226, v203

    v_fma_f32 v204, v204, s41, -v224
    v_exp_f32 v204, v204
    s_nop 0
    v_add_f32 v226, v226, v204

    v_fma_f32 v205, v205, s41, -v224
    v_exp_f32 v205, v205
    s_nop 0
    v_add_f32 v226, v226, v205

    v_fma_f32 v206, v206, s41, -v224
    v_exp_f32 v206, v206
    s_nop 0
    v_add_f32 v226, v226, v206

    v_fma_f32 v207, v207, s41, -v224
    v_exp_f32 v207, v207
    s_nop 0
    v_add_f32 v226, v226, v207

    v_fma_f32 v208, v208, s41, -v224
    v_exp_f32 v208, v208
    s_nop 0
    v_add_f32 v226, v226, v208

    v_fma_f32 v209, v209, s41, -v224
    v_exp_f32 v209, v209
    s_nop 0
    v_add_f32 v226, v226, v209

    v_fma_f32 v210, v210, s41, -v224
    v_exp_f32 v210, v210
    s_nop 0
    v_add_f32 v226, v226, v210

    v_fma_f32 v211, v211, s41, -v224
    v_exp_f32 v211, v211
    s_nop 0
    v_add_f32 v226, v226, v211

    v_mov_b32 v227, v226
    s_nop 1
    v_permlane32_swap_b32 v226, v227
    s_nop 1
    v_add_f32 v226, v226, v227
    v_rcp_f32 v226, v226
    s_nop 0

    v_mul_f32 v192, v192, v226
    v_mul_f32 v193, v193, v226
    v_cvt_pk_bf16_f32 v232, v192, v193

    v_mul_f32 v194, v194, v226
    v_mul_f32 v195, v195, v226
    v_cvt_pk_bf16_f32 v233, v194, v195

    v_mul_f32 v196, v196, v226
    v_mul_f32 v197, v197, v226
    v_cvt_pk_bf16_f32 v234, v196, v197

    v_mul_f32 v198, v198, v226
    v_mul_f32 v199, v199, v226
    v_cvt_pk_bf16_f32 v235, v198, v199

    v_mul_f32 v200, v200, v226
    v_mul_f32 v201, v201, v226
    v_cvt_pk_bf16_f32 v236, v200, v201

    v_mul_f32 v202, v202, v226
    v_mul_f32 v203, v203, v226
    v_cvt_pk_bf16_f32 v237, v202, v203

    v_mul_f32 v204, v204, v226
    v_mul_f32 v205, v205, v226
    v_cvt_pk_bf16_f32 v238, v204, v205

    v_mul_f32 v206, v206, v226
    v_mul_f32 v207, v207, v226
    v_cvt_pk_bf16_f32 v239, v206, v207

    v_mul_f32 v208, v208, v226
    v_mul_f32 v209, v209, v226
    v_cvt_pk_bf16_f32 v240, v208, v209

    v_mul_f32 v210, v210, v226
    v_mul_f32 v211, v211, v226
    v_cvt_pk_bf16_f32 v241, v210, v211

    v_mov_b32 v242, 0
    v_mov_b32 v243, 0
    s_nop 1

    v_permlane32_swap_b32 v232, v234
    v_permlane32_swap_b32 v233, v235

    v_permlane32_swap_b32 v236, v238
    v_permlane32_swap_b32 v237, v239

    v_permlane32_swap_b32 v240, v242
    v_permlane32_swap_b32 v241, v243
    s_nop 1
    s_waitcnt vmcnt(0)

    v_mfma_f32_32x32x16_bf16 v[16:31], v[176:179], v[240:243], 0
    v_mfma_f32_32x32x16_bf16 v[16:31], v[112:115], v[232:235], v[16:31]
    v_mfma_f32_32x32x16_bf16 v[16:31], v[116:119], v[236:239], v[16:31]
    v_mfma_f32_32x32x16_bf16 v[32:47], v[180:183], v[240:243], 0
    v_mfma_f32_32x32x16_bf16 v[32:47], v[120:123], v[232:235], v[32:47]
    v_mfma_f32_32x32x16_bf16 v[32:47], v[124:127], v[236:239], v[32:47]
    v_mfma_f32_32x32x16_bf16 v[48:63], v[184:187], v[240:243], 0
    v_mfma_f32_32x32x16_bf16 v[48:63], v[128:131], v[232:235], v[48:63]
    v_mfma_f32_32x32x16_bf16 v[48:63], v[132:135], v[236:239], v[48:63]
    v_mfma_f32_32x32x16_bf16 v[64:79], v[188:191], v[240:243], 0
    v_mfma_f32_32x32x16_bf16 v[64:79], v[136:139], v[232:235], v[64:79]
    v_mfma_f32_32x32x16_bf16 v[64:79], v[140:143], v[236:239], v[64:79]
    s_nop 7
    s_nop 7
    v_lshlrev_b32 v5, 13, v3
    v_lshl_add_u32 v5, v4, 3, v5

    v_cvt_pk_bf16_f32 v224, v16, v17
    v_cvt_pk_bf16_f32 v225, v18, v19
    buffer_store_dwordx2 v[224:225], v5, s[32:35], s36 offen offset:0 sc1
    s_nop 0

    v_cvt_pk_bf16_f32 v224, v20, v21
    v_cvt_pk_bf16_f32 v225, v22, v23
    buffer_store_dwordx2 v[224:225], v5, s[32:35], s36 offen offset:16 sc1
    s_nop 0

    v_cvt_pk_bf16_f32 v224, v24, v25
    v_cvt_pk_bf16_f32 v225, v26, v27
    buffer_store_dwordx2 v[224:225], v5, s[32:35], s36 offen offset:32 sc1
    s_nop 0

    v_cvt_pk_bf16_f32 v224, v28, v29
    v_cvt_pk_bf16_f32 v225, v30, v31
    buffer_store_dwordx2 v[224:225], v5, s[32:35], s36 offen offset:48 sc1
    s_nop 0

    v_cvt_pk_bf16_f32 v224, v32, v33
    v_cvt_pk_bf16_f32 v225, v34, v35
    buffer_store_dwordx2 v[224:225], v5, s[32:35], s36 offen offset:64 sc1
    s_nop 0

    v_cvt_pk_bf16_f32 v224, v36, v37
    v_cvt_pk_bf16_f32 v225, v38, v39
    buffer_store_dwordx2 v[224:225], v5, s[32:35], s36 offen offset:80 sc1
    s_nop 0

    v_cvt_pk_bf16_f32 v224, v40, v41
    v_cvt_pk_bf16_f32 v225, v42, v43
    buffer_store_dwordx2 v[224:225], v5, s[32:35], s36 offen offset:96 sc1
    s_nop 0

    v_cvt_pk_bf16_f32 v224, v44, v45
    v_cvt_pk_bf16_f32 v225, v46, v47
    buffer_store_dwordx2 v[224:225], v5, s[32:35], s36 offen offset:112 sc1
    s_nop 0

    v_cvt_pk_bf16_f32 v224, v48, v49
    v_cvt_pk_bf16_f32 v225, v50, v51
    buffer_store_dwordx2 v[224:225], v5, s[32:35], s36 offen offset:128 sc1
    s_nop 0

    v_cvt_pk_bf16_f32 v224, v52, v53
    v_cvt_pk_bf16_f32 v225, v54, v55
    buffer_store_dwordx2 v[224:225], v5, s[32:35], s36 offen offset:144 sc1
    s_nop 0

    v_cvt_pk_bf16_f32 v224, v56, v57
    v_cvt_pk_bf16_f32 v225, v58, v59
    buffer_store_dwordx2 v[224:225], v5, s[32:35], s36 offen offset:160 sc1
    s_nop 0

    v_cvt_pk_bf16_f32 v224, v60, v61
    v_cvt_pk_bf16_f32 v225, v62, v63
    buffer_store_dwordx2 v[224:225], v5, s[32:35], s36 offen offset:176 sc1
    s_nop 0

    v_cvt_pk_bf16_f32 v224, v64, v65
    v_cvt_pk_bf16_f32 v225, v66, v67
    buffer_store_dwordx2 v[224:225], v5, s[32:35], s36 offen offset:192 sc1
    s_nop 0

    v_cvt_pk_bf16_f32 v224, v68, v69
    v_cvt_pk_bf16_f32 v225, v70, v71
    buffer_store_dwordx2 v[224:225], v5, s[32:35], s36 offen offset:208 sc1
    s_nop 0

    v_cvt_pk_bf16_f32 v224, v72, v73
    v_cvt_pk_bf16_f32 v225, v74, v75
    buffer_store_dwordx2 v[224:225], v5, s[32:35], s36 offen offset:224 sc1
    s_nop 0

    v_cvt_pk_bf16_f32 v224, v76, v77
    v_cvt_pk_bf16_f32 v225, v78, v79
    buffer_store_dwordx2 v[224:225], v5, s[32:35], s36 offen offset:240 sc1
    s_nop 0

    s_lshl_b32 s72, s65, 6

    v_accvgpr_read_b32 v168, a0
    s_nop 0
    v_and_b32 v169, 63, v168

    s_waitcnt vmcnt(0)
    s_barrier
    v_cmp_eq_u32 vcc, 0, v168
    s_and_saveexec_b64 s[76:77], vcc
    s_cbranch_execz L_sig_72
    v_mov_b32 v140, 12288
    v_mov_b32 v141, 1

    buffer_atomic_add v141, v140, s[68:71], s72 offen
L_sig_72:
    s_mov_b64 exec, s[76:77]
    s_add_u32 s65, s65, 1
    s_cmp_lt_u32 s65, 16
    s_cbranch_scc1 L_rloop_63
    s_branch L_end_1

L_rskip_62:
    s_sub_u32 s66, s64, 32
    s_cmp_ge_u32 s66, 40
    s_cbranch_scc1 L_rskip_73
    s_mov_b32 s65, 0

L_rloop_74:
    v_accvgpr_read_b32 v168, a0
    s_nop 0
    v_and_b32 v169, 63, v168

    s_load_dwordx2 s[6:7], s[80:81], 40
    s_mul_i32 s33, s66, 52429
    s_lshr_b32 s33, s33, 18
    s_mul_i32 s32, s33, 5
    s_sub_u32 s32, s66, s32
    s_lshl_b32 s30, s65, 7
    s_waitcnt lgkmcnt(0)

    s_add_u32 s8, s4, 67108864
    s_addc_u32 s9, s5, 0
    s_and_b32 s9, s9, 0xffff
    s_mov_b32 s10, 16777216
    s_mov_b32 s11, 0x00020000

    s_mov_b32 s12, s6
    s_and_b32 s13, s7, 0xffff
    s_mov_b32 s14, 4718592
    s_mov_b32 s15, 0x00020000

    s_mul_i32 s35, s30, 8192
    s_lshl_b32 s37, s33, 10
    s_add_u32 s35, s35, s37
    s_lshl_b32 s36, s32, 8
    s_mul_i32 s37, s33, 589824
    s_add_u32 s36, s36, s37

    s_add_u32 s20, s35, 0
    s_add_u32 s24, s36, 0
    s_add_u32 s21, s35, 262144
    s_add_u32 s25, s36, 18432
    s_add_u32 s22, s35, 524288
    s_add_u32 s26, s36, 36864
    s_add_u32 s23, s35, 786432
    s_add_u32 s27, s36, 55296
    v_mov_b32 v0, v168
    v_mov_b32 v168, v0
    v_and_b32 v169, 63, v0
    v_lshrrev_b32 v140, 3, v0
    v_and_b32 v141, 7, v0
    s_mov_b32 s40, 8192
    v_mul_lo_u32 v128, v140, s40
    v_lshl_add_u32 v128, v141, 4, v128
    v_lshrrev_b32 v142, 4, v0
    v_and_b32 v142, 7, v142
    v_xor_b32 v142, v142, v141
    v_lshlrev_b32 v142, 4, v142
    v_lshl_add_u32 v130, v140, 7, v142

    v_lshrrev_b32 v140, 4, v0
    v_and_b32 v141, 15, v0
    s_mov_b32 s40, 1152
    v_mul_lo_u32 v129, v140, s40
    v_lshl_add_u32 v129, v141, 4, v129

    v_lshrrev_b32 v142, 2, v141
    v_and_b32 v143, 3, v140
    v_xor_b32 v142, v142, v143
    v_lshlrev_b32 v142, 6, v142
    v_and_b32 v143, 3, v141
    v_lshl_add_u32 v142, v143, 4, v142
    v_lshl_add_u32 v131, v140, 8, v142
    v_add_u32 v131, 16384, v131
    v_lshrrev_b32 v140, 7, v0
    v_and_b32 v141, 31, v0
    v_lshl_add_u32 v140, v140, 6, v141
    v_lshrrev_b32 v141, 1, v140
    v_and_b32 v141, 7, v141
    v_lshrrev_b32 v142, 5, v169

    v_add_u32 v143, 0, v142
    v_xor_b32 v143, v143, v141
    v_lshlrev_b32 v143, 4, v143
    v_lshl_add_u32 v132, v140, 7, v143

    v_add_u32 v143, 2, v142
    v_xor_b32 v143, v143, v141
    v_lshlrev_b32 v143, 4, v143
    v_lshl_add_u32 v133, v140, 7, v143

    v_add_u32 v143, 4, v142
    v_xor_b32 v143, v143, v141
    v_lshlrev_b32 v143, 4, v143
    v_lshl_add_u32 v134, v140, 7, v143

    v_add_u32 v143, 6, v142
    v_xor_b32 v143, v143, v141
    v_lshlrev_b32 v143, 4, v143
    v_lshl_add_u32 v135, v140, 7, v143

    v_lshrrev_b32 v140, 4, v169
    v_and_b32 v141, 15, v169
    v_lshrrev_b32 v142, 1, v140
    v_lshlrev_b32 v142, 3, v142
    v_lshrrev_b32 v143, 2, v141
    v_add_u32 v142, v142, v143
    v_and_b32 v140, 1, v140
    v_lshlrev_b32 v140, 5, v140
    v_and_b32 v141, 3, v141
    v_lshl_add_u32 v140, v141, 3, v140
    v_lshl_add_u32 v140, v142, 8, v140
    v_add_u32 v140, 16384, v140
    v_lshrrev_b32 v141, 6, v0
    v_and_b32 v141, 1, v141
    v_lshlrev_b32 v141, 1, v141

    v_add_u32 v142, 0, v141
    v_xor_b32 v142, v142, v143
    v_lshl_add_u32 v136, v142, 6, v140

    v_add_u32 v142, 1, v141
    v_xor_b32 v142, v142, v143
    v_lshl_add_u32 v137, v142, 6, v140

    v_mov_b32 v0, 0
    v_mov_b32 v1, 0
    v_mov_b32 v2, 0
    v_mov_b32 v3, 0
    v_mov_b32 v4, 0
    v_mov_b32 v5, 0
    v_mov_b32 v6, 0
    v_mov_b32 v7, 0
    v_mov_b32 v8, 0
    v_mov_b32 v9, 0
    v_mov_b32 v10, 0
    v_mov_b32 v11, 0
    v_mov_b32 v12, 0
    v_mov_b32 v13, 0
    v_mov_b32 v14, 0
    v_mov_b32 v15, 0
    v_mov_b32 v16, 0
    v_mov_b32 v17, 0
    v_mov_b32 v18, 0
    v_mov_b32 v19, 0
    v_mov_b32 v20, 0
    v_mov_b32 v21, 0
    v_mov_b32 v22, 0
    v_mov_b32 v23, 0
    v_mov_b32 v24, 0
    v_mov_b32 v25, 0
    v_mov_b32 v26, 0
    v_mov_b32 v27, 0
    v_mov_b32 v28, 0
    v_mov_b32 v29, 0
    v_mov_b32 v30, 0
    v_mov_b32 v31, 0
    v_mov_b32 v32, 0
    v_mov_b32 v33, 0
    v_mov_b32 v34, 0
    v_mov_b32 v35, 0
    v_mov_b32 v36, 0
    v_mov_b32 v37, 0
    v_mov_b32 v38, 0
    v_mov_b32 v39, 0
    v_mov_b32 v40, 0
    v_mov_b32 v41, 0
    v_mov_b32 v42, 0
    v_mov_b32 v43, 0
    v_mov_b32 v44, 0
    v_mov_b32 v45, 0
    v_mov_b32 v46, 0
    v_mov_b32 v47, 0
    v_mov_b32 v48, 0
    v_mov_b32 v49, 0
    v_mov_b32 v50, 0
    v_mov_b32 v51, 0
    v_mov_b32 v52, 0
    v_mov_b32 v53, 0
    v_mov_b32 v54, 0
    v_mov_b32 v55, 0
    v_mov_b32 v56, 0
    v_mov_b32 v57, 0
    v_mov_b32 v58, 0
    v_mov_b32 v59, 0
    v_mov_b32 v60, 0
    v_mov_b32 v61, 0
    v_mov_b32 v62, 0
    v_mov_b32 v63, 0
    s_lshl_b32 s72, s65, 6
    v_accvgpr_read_b32 v168, a0
    s_nop 0
    v_and_b32 v169, 63, v168

    v_lshrrev_b32 v140, 6, v168
    s_nop 0
    v_readfirstlane_b32 s78, v140
    s_cmp_lg_u32 s78, 0
    s_cbranch_scc1 L_wpollx_76
    v_mov_b32 v140, 12288
    s_mov_b32 s79, 0

L_wpoll_75:
    buffer_load_dword v141, v140, s[68:71], s72 offen sc1
    s_add_u32 s79, s79, 1
    s_waitcnt vmcnt(0)
    v_readfirstlane_b32 s78, v141
    s_cmp_ge_u32 s78, 32
    s_cbranch_scc1 L_wpollx_76
    s_cmp_gt_u32 s79, 200000
    s_cbranch_scc1 L_wpollx_76
    s_sleep 24
    s_branch L_wpoll_75

L_wpollx_76:
    s_barrier
    buffer_load_dwordx4 v[96:99], v128, s[8:11], s20 offen
    buffer_load_dwordx4 v[100:103], v128, s[8:11], s21 offen
    buffer_load_dwordx4 v[104:107], v128, s[8:11], s22 offen
    buffer_load_dwordx4 v[108:111], v128, s[8:11], s23 offen
    buffer_load_dwordx4 v[112:115], v129, s[12:15], s24 offen
    buffer_load_dwordx4 v[116:119], v129, s[12:15], s25 offen
    buffer_load_dwordx4 v[120:123], v129, s[12:15], s26 offen
    buffer_load_dwordx4 v[124:127], v129, s[12:15], s27 offen
    s_add_u32 s20, s20, 128
    s_add_u32 s21, s21, 128
    s_add_u32 s22, s22, 128
    s_add_u32 s23, s23, 128
    s_add_u32 s24, s24, 73728
    s_add_u32 s25, s25, 73728
    s_add_u32 s26, s26, 73728
    s_add_u32 s27, s27, 73728
    buffer_load_dwordx4 v[176:179], v128, s[8:11], s20 offen
    buffer_load_dwordx4 v[180:183], v128, s[8:11], s21 offen
    buffer_load_dwordx4 v[184:187], v128, s[8:11], s22 offen
    buffer_load_dwordx4 v[188:191], v128, s[8:11], s23 offen
    buffer_load_dwordx4 v[192:195], v129, s[12:15], s24 offen
    buffer_load_dwordx4 v[196:199], v129, s[12:15], s25 offen
    buffer_load_dwordx4 v[200:203], v129, s[12:15], s26 offen
    buffer_load_dwordx4 v[204:207], v129, s[12:15], s27 offen
    s_add_u32 s20, s20, 128
    s_add_u32 s21, s21, 128
    s_add_u32 s22, s22, 128
    s_add_u32 s23, s23, 128
    s_add_u32 s24, s24, 73728
    s_add_u32 s25, s25, 73728
    s_add_u32 s26, s26, 73728
    s_add_u32 s27, s27, 73728
    buffer_load_dwordx4 v[208:211], v128, s[8:11], s20 offen
    buffer_load_dwordx4 v[212:215], v128, s[8:11], s21 offen
    buffer_load_dwordx4 v[216:219], v128, s[8:11], s22 offen
    buffer_load_dwordx4 v[220:223], v128, s[8:11], s23 offen
    buffer_load_dwordx4 v[224:227], v129, s[12:15], s24 offen
    buffer_load_dwordx4 v[228:231], v129, s[12:15], s25 offen
    buffer_load_dwordx4 v[232:235], v129, s[12:15], s26 offen
    buffer_load_dwordx4 v[236:239], v129, s[12:15], s27 offen
    s_add_u32 s20, s20, 128
    s_add_u32 s21, s21, 128
    s_add_u32 s22, s22, 128
    s_add_u32 s23, s23, 128
    s_add_u32 s24, s24, 73728
    s_add_u32 s25, s25, 73728
    s_add_u32 s26, s26, 73728
    s_add_u32 s27, s27, 73728
    s_waitcnt vmcnt(20)
    ds_write_b128 v130, v[96:99] offset:0
    ds_write_b128 v130, v[100:103] offset:4096
    ds_write_b128 v130, v[104:107] offset:8192
    ds_write_b128 v130, v[108:111] offset:12288
    s_waitcnt vmcnt(16)
    ds_write_b128 v131, v[112:115] offset:0
    ds_write_b128 v131, v[116:119] offset:4096
    ds_write_b128 v131, v[120:123] offset:8192
    ds_write_b128 v131, v[124:127] offset:12288
    s_waitcnt lgkmcnt(0)
    s_barrier
    buffer_load_dwordx4 v[96:99], v128, s[8:11], s20 offen
    buffer_load_dwordx4 v[100:103], v128, s[8:11], s21 offen
    buffer_load_dwordx4 v[104:107], v128, s[8:11], s22 offen
    buffer_load_dwordx4 v[108:111], v128, s[8:11], s23 offen
    buffer_load_dwordx4 v[112:115], v129, s[12:15], s24 offen
    buffer_load_dwordx4 v[116:119], v129, s[12:15], s25 offen
    buffer_load_dwordx4 v[120:123], v129, s[12:15], s26 offen
    buffer_load_dwordx4 v[124:127], v129, s[12:15], s27 offen
    s_add_u32 s20, s20, 128
    s_add_u32 s21, s21, 128
    s_add_u32 s22, s22, 128
    s_add_u32 s23, s23, 128
    s_add_u32 s24, s24, 73728
    s_add_u32 s25, s25, 73728
    s_add_u32 s26, s26, 73728
    s_add_u32 s27, s27, 73728
    ds_read_b128 v[64:67], v132 offset:0
    ds_read_b128 v[68:71], v132 offset:4096
    ds_read_b64_tr_b16 v[72:73], v136 offset:0
    ds_read_b64_tr_b16 v[74:75], v136 offset:1024
    ds_read_b64_tr_b16 v[76:77], v137 offset:0
    ds_read_b64_tr_b16 v[78:79], v137 offset:1024
    ds_read_b128 v[80:83], v133 offset:0
    ds_read_b128 v[84:87], v133 offset:4096
    ds_read_b64_tr_b16 v[88:89], v136 offset:4096
    ds_read_b64_tr_b16 v[90:91], v136 offset:5120
    ds_read_b64_tr_b16 v[92:93], v137 offset:4096
    ds_read_b64_tr_b16 v[94:95], v137 offset:5120
    s_waitcnt lgkmcnt(6)
    v_mfma_f32_32x32x16_bf16 v[0:15], v[72:75], v[64:67], v[0:15]
    v_mfma_f32_32x32x16_bf16 v[16:31], v[76:79], v[64:67], v[16:31]
    v_mfma_f32_32x32x16_bf16 v[32:47], v[72:75], v[68:71], v[32:47]
    v_mfma_f32_32x32x16_bf16 v[48:63], v[76:79], v[68:71], v[48:63]
    ds_read_b128 v[64:67], v134 offset:0
    ds_read_b128 v[68:71], v134 offset:4096
    ds_read_b64_tr_b16 v[72:73], v136 offset:8192
    ds_read_b64_tr_b16 v[74:75], v136 offset:9216
    ds_read_b64_tr_b16 v[76:77], v137 offset:8192
    ds_read_b64_tr_b16 v[78:79], v137 offset:9216
    s_waitcnt lgkmcnt(6)
    v_mfma_f32_32x32x16_bf16 v[0:15], v[88:91], v[80:83], v[0:15]
    v_mfma_f32_32x32x16_bf16 v[16:31], v[92:95], v[80:83], v[16:31]
    v_mfma_f32_32x32x16_bf16 v[32:47], v[88:91], v[84:87], v[32:47]
    v_mfma_f32_32x32x16_bf16 v[48:63], v[92:95], v[84:87], v[48:63]
    ds_read_b128 v[80:83], v135 offset:0
    ds_read_b128 v[84:87], v135 offset:4096
    ds_read_b64_tr_b16 v[88:89], v136 offset:12288
    ds_read_b64_tr_b16 v[90:91], v136 offset:13312
    ds_read_b64_tr_b16 v[92:93], v137 offset:12288
    ds_read_b64_tr_b16 v[94:95], v137 offset:13312
    s_waitcnt lgkmcnt(6)
    v_mfma_f32_32x32x16_bf16 v[0:15], v[72:75], v[64:67], v[0:15]
    v_mfma_f32_32x32x16_bf16 v[16:31], v[76:79], v[64:67], v[16:31]
    v_mfma_f32_32x32x16_bf16 v[32:47], v[72:75], v[68:71], v[32:47]
    v_mfma_f32_32x32x16_bf16 v[48:63], v[76:79], v[68:71], v[48:63]
    s_waitcnt lgkmcnt(0)
    v_mfma_f32_32x32x16_bf16 v[0:15], v[88:91], v[80:83], v[0:15]
    v_mfma_f32_32x32x16_bf16 v[16:31], v[92:95], v[80:83], v[16:31]
    v_mfma_f32_32x32x16_bf16 v[32:47], v[88:91], v[84:87], v[32:47]
    v_mfma_f32_32x32x16_bf16 v[48:63], v[92:95], v[84:87], v[48:63]
    s_waitcnt vmcnt(20)
    ds_write_b128 v130, v[176:179] offset:32768
    ds_write_b128 v130, v[180:183] offset:36864
    ds_write_b128 v130, v[184:187] offset:40960
    ds_write_b128 v130, v[188:191] offset:45056
    s_waitcnt vmcnt(16)
    ds_write_b128 v131, v[192:195] offset:32768
    ds_write_b128 v131, v[196:199] offset:36864
    ds_write_b128 v131, v[200:203] offset:40960
    ds_write_b128 v131, v[204:207] offset:45056
    s_waitcnt lgkmcnt(0)
    s_barrier
    buffer_load_dwordx4 v[176:179], v128, s[8:11], s20 offen
    buffer_load_dwordx4 v[180:183], v128, s[8:11], s21 offen
    buffer_load_dwordx4 v[184:187], v128, s[8:11], s22 offen
    buffer_load_dwordx4 v[188:191], v128, s[8:11], s23 offen
    buffer_load_dwordx4 v[192:195], v129, s[12:15], s24 offen
    buffer_load_dwordx4 v[196:199], v129, s[12:15], s25 offen
    buffer_load_dwordx4 v[200:203], v129, s[12:15], s26 offen
    buffer_load_dwordx4 v[204:207], v129, s[12:15], s27 offen
    s_add_u32 s20, s20, 128
    s_add_u32 s21, s21, 128
    s_add_u32 s22, s22, 128
    s_add_u32 s23, s23, 128
    s_add_u32 s24, s24, 73728
    s_add_u32 s25, s25, 73728
    s_add_u32 s26, s26, 73728
    s_add_u32 s27, s27, 73728
    ds_read_b128 v[64:67], v132 offset:32768
    ds_read_b128 v[68:71], v132 offset:36864
    ds_read_b64_tr_b16 v[72:73], v136 offset:32768
    ds_read_b64_tr_b16 v[74:75], v136 offset:33792
    ds_read_b64_tr_b16 v[76:77], v137 offset:32768
    ds_read_b64_tr_b16 v[78:79], v137 offset:33792
    ds_read_b128 v[80:83], v133 offset:32768
    ds_read_b128 v[84:87], v133 offset:36864
    ds_read_b64_tr_b16 v[88:89], v136 offset:36864
    ds_read_b64_tr_b16 v[90:91], v136 offset:37888
    ds_read_b64_tr_b16 v[92:93], v137 offset:36864
    ds_read_b64_tr_b16 v[94:95], v137 offset:37888
    s_waitcnt lgkmcnt(6)
    v_mfma_f32_32x32x16_bf16 v[0:15], v[72:75], v[64:67], v[0:15]
    v_mfma_f32_32x32x16_bf16 v[16:31], v[76:79], v[64:67], v[16:31]
    v_mfma_f32_32x32x16_bf16 v[32:47], v[72:75], v[68:71], v[32:47]
    v_mfma_f32_32x32x16_bf16 v[48:63], v[76:79], v[68:71], v[48:63]
    ds_read_b128 v[64:67], v134 offset:32768
    ds_read_b128 v[68:71], v134 offset:36864
    ds_read_b64_tr_b16 v[72:73], v136 offset:40960
    ds_read_b64_tr_b16 v[74:75], v136 offset:41984
    ds_read_b64_tr_b16 v[76:77], v137 offset:40960
    ds_read_b64_tr_b16 v[78:79], v137 offset:41984
    s_waitcnt lgkmcnt(6)
    v_mfma_f32_32x32x16_bf16 v[0:15], v[88:91], v[80:83], v[0:15]
    v_mfma_f32_32x32x16_bf16 v[16:31], v[92:95], v[80:83], v[16:31]
    v_mfma_f32_32x32x16_bf16 v[32:47], v[88:91], v[84:87], v[32:47]
    v_mfma_f32_32x32x16_bf16 v[48:63], v[92:95], v[84:87], v[48:63]
    ds_read_b128 v[80:83], v135 offset:32768
    ds_read_b128 v[84:87], v135 offset:36864
    ds_read_b64_tr_b16 v[88:89], v136 offset:45056
    ds_read_b64_tr_b16 v[90:91], v136 offset:46080
    ds_read_b64_tr_b16 v[92:93], v137 offset:45056
    ds_read_b64_tr_b16 v[94:95], v137 offset:46080
    s_waitcnt lgkmcnt(6)
    v_mfma_f32_32x32x16_bf16 v[0:15], v[72:75], v[64:67], v[0:15]
    v_mfma_f32_32x32x16_bf16 v[16:31], v[76:79], v[64:67], v[16:31]
    v_mfma_f32_32x32x16_bf16 v[32:47], v[72:75], v[68:71], v[32:47]
    v_mfma_f32_32x32x16_bf16 v[48:63], v[76:79], v[68:71], v[48:63]
    s_waitcnt lgkmcnt(0)
    v_mfma_f32_32x32x16_bf16 v[0:15], v[88:91], v[80:83], v[0:15]
    v_mfma_f32_32x32x16_bf16 v[16:31], v[92:95], v[80:83], v[16:31]
    v_mfma_f32_32x32x16_bf16 v[32:47], v[88:91], v[84:87], v[32:47]
    v_mfma_f32_32x32x16_bf16 v[48:63], v[92:95], v[84:87], v[48:63]
    s_waitcnt vmcnt(20)
    ds_write_b128 v130, v[208:211] offset:0
    ds_write_b128 v130, v[212:215] offset:4096
    ds_write_b128 v130, v[216:219] offset:8192
    ds_write_b128 v130, v[220:223] offset:12288
    s_waitcnt vmcnt(16)
    ds_write_b128 v131, v[224:227] offset:0
    ds_write_b128 v131, v[228:231] offset:4096
    ds_write_b128 v131, v[232:235] offset:8192
    ds_write_b128 v131, v[236:239] offset:12288
    s_waitcnt lgkmcnt(0)
    s_barrier
    buffer_load_dwordx4 v[208:211], v128, s[8:11], s20 offen
    buffer_load_dwordx4 v[212:215], v128, s[8:11], s21 offen
    buffer_load_dwordx4 v[216:219], v128, s[8:11], s22 offen
    buffer_load_dwordx4 v[220:223], v128, s[8:11], s23 offen
    buffer_load_dwordx4 v[224:227], v129, s[12:15], s24 offen
    buffer_load_dwordx4 v[228:231], v129, s[12:15], s25 offen
    buffer_load_dwordx4 v[232:235], v129, s[12:15], s26 offen
    buffer_load_dwordx4 v[236:239], v129, s[12:15], s27 offen
    s_add_u32 s20, s20, 128
    s_add_u32 s21, s21, 128
    s_add_u32 s22, s22, 128
    s_add_u32 s23, s23, 128
    s_add_u32 s24, s24, 73728
    s_add_u32 s25, s25, 73728
    s_add_u32 s26, s26, 73728
    s_add_u32 s27, s27, 73728
    ds_read_b128 v[64:67], v132 offset:0
    ds_read_b128 v[68:71], v132 offset:4096
    ds_read_b64_tr_b16 v[72:73], v136 offset:0
    ds_read_b64_tr_b16 v[74:75], v136 offset:1024
    ds_read_b64_tr_b16 v[76:77], v137 offset:0
    ds_read_b64_tr_b16 v[78:79], v137 offset:1024
    ds_read_b128 v[80:83], v133 offset:0
    ds_read_b128 v[84:87], v133 offset:4096
    ds_read_b64_tr_b16 v[88:89], v136 offset:4096
    ds_read_b64_tr_b16 v[90:91], v136 offset:5120
    ds_read_b64_tr_b16 v[92:93], v137 offset:4096
    ds_read_b64_tr_b16 v[94:95], v137 offset:5120
    s_waitcnt lgkmcnt(6)
    v_mfma_f32_32x32x16_bf16 v[0:15], v[72:75], v[64:67], v[0:15]
    v_mfma_f32_32x32x16_bf16 v[16:31], v[76:79], v[64:67], v[16:31]
    v_mfma_f32_32x32x16_bf16 v[32:47], v[72:75], v[68:71], v[32:47]
    v_mfma_f32_32x32x16_bf16 v[48:63], v[76:79], v[68:71], v[48:63]
    ds_read_b128 v[64:67], v134 offset:0
    ds_read_b128 v[68:71], v134 offset:4096
    ds_read_b64_tr_b16 v[72:73], v136 offset:8192
    ds_read_b64_tr_b16 v[74:75], v136 offset:9216
    ds_read_b64_tr_b16 v[76:77], v137 offset:8192
    ds_read_b64_tr_b16 v[78:79], v137 offset:9216
    s_waitcnt lgkmcnt(6)
    v_mfma_f32_32x32x16_bf16 v[0:15], v[88:91], v[80:83], v[0:15]
    v_mfma_f32_32x32x16_bf16 v[16:31], v[92:95], v[80:83], v[16:31]
    v_mfma_f32_32x32x16_bf16 v[32:47], v[88:91], v[84:87], v[32:47]
    v_mfma_f32_32x32x16_bf16 v[48:63], v[92:95], v[84:87], v[48:63]
    ds_read_b128 v[80:83], v135 offset:0
    ds_read_b128 v[84:87], v135 offset:4096
    ds_read_b64_tr_b16 v[88:89], v136 offset:12288
    ds_read_b64_tr_b16 v[90:91], v136 offset:13312
    ds_read_b64_tr_b16 v[92:93], v137 offset:12288
    ds_read_b64_tr_b16 v[94:95], v137 offset:13312
    s_waitcnt lgkmcnt(6)
    v_mfma_f32_32x32x16_bf16 v[0:15], v[72:75], v[64:67], v[0:15]
    v_mfma_f32_32x32x16_bf16 v[16:31], v[76:79], v[64:67], v[16:31]
    v_mfma_f32_32x32x16_bf16 v[32:47], v[72:75], v[68:71], v[32:47]
    v_mfma_f32_32x32x16_bf16 v[48:63], v[76:79], v[68:71], v[48:63]
    s_waitcnt lgkmcnt(0)
    v_mfma_f32_32x32x16_bf16 v[0:15], v[88:91], v[80:83], v[0:15]
    v_mfma_f32_32x32x16_bf16 v[16:31], v[92:95], v[80:83], v[16:31]
    v_mfma_f32_32x32x16_bf16 v[32:47], v[88:91], v[84:87], v[32:47]
    v_mfma_f32_32x32x16_bf16 v[48:63], v[92:95], v[84:87], v[48:63]
    s_waitcnt vmcnt(20)
    ds_write_b128 v130, v[96:99] offset:32768
    ds_write_b128 v130, v[100:103] offset:36864
    ds_write_b128 v130, v[104:107] offset:40960
    ds_write_b128 v130, v[108:111] offset:45056
    s_waitcnt vmcnt(16)
    ds_write_b128 v131, v[112:115] offset:32768
    ds_write_b128 v131, v[116:119] offset:36864
    ds_write_b128 v131, v[120:123] offset:40960
    ds_write_b128 v131, v[124:127] offset:45056
    s_waitcnt lgkmcnt(0)
    s_barrier
    buffer_load_dwordx4 v[96:99], v128, s[8:11], s20 offen
    buffer_load_dwordx4 v[100:103], v128, s[8:11], s21 offen
    buffer_load_dwordx4 v[104:107], v128, s[8:11], s22 offen
    buffer_load_dwordx4 v[108:111], v128, s[8:11], s23 offen
    buffer_load_dwordx4 v[112:115], v129, s[12:15], s24 offen
    buffer_load_dwordx4 v[116:119], v129, s[12:15], s25 offen
    buffer_load_dwordx4 v[120:123], v129, s[12:15], s26 offen
    buffer_load_dwordx4 v[124:127], v129, s[12:15], s27 offen
    s_add_u32 s20, s20, 128
    s_add_u32 s21, s21, 128
    s_add_u32 s22, s22, 128
    s_add_u32 s23, s23, 128
    s_add_u32 s24, s24, 73728
    s_add_u32 s25, s25, 73728
    s_add_u32 s26, s26, 73728
    s_add_u32 s27, s27, 73728
    ds_read_b128 v[64:67], v132 offset:32768
    ds_read_b128 v[68:71], v132 offset:36864
    ds_read_b64_tr_b16 v[72:73], v136 offset:32768
    ds_read_b64_tr_b16 v[74:75], v136 offset:33792
    ds_read_b64_tr_b16 v[76:77], v137 offset:32768
    ds_read_b64_tr_b16 v[78:79], v137 offset:33792
    ds_read_b128 v[80:83], v133 offset:32768
    ds_read_b128 v[84:87], v133 offset:36864
    ds_read_b64_tr_b16 v[88:89], v136 offset:36864
    ds_read_b64_tr_b16 v[90:91], v136 offset:37888
    ds_read_b64_tr_b16 v[92:93], v137 offset:36864
    ds_read_b64_tr_b16 v[94:95], v137 offset:37888
    s_waitcnt lgkmcnt(6)
    v_mfma_f32_32x32x16_bf16 v[0:15], v[72:75], v[64:67], v[0:15]
    v_mfma_f32_32x32x16_bf16 v[16:31], v[76:79], v[64:67], v[16:31]
    v_mfma_f32_32x32x16_bf16 v[32:47], v[72:75], v[68:71], v[32:47]
    v_mfma_f32_32x32x16_bf16 v[48:63], v[76:79], v[68:71], v[48:63]
    ds_read_b128 v[64:67], v134 offset:32768
    ds_read_b128 v[68:71], v134 offset:36864
    ds_read_b64_tr_b16 v[72:73], v136 offset:40960
    ds_read_b64_tr_b16 v[74:75], v136 offset:41984
    ds_read_b64_tr_b16 v[76:77], v137 offset:40960
    ds_read_b64_tr_b16 v[78:79], v137 offset:41984
    s_waitcnt lgkmcnt(6)
    v_mfma_f32_32x32x16_bf16 v[0:15], v[88:91], v[80:83], v[0:15]
    v_mfma_f32_32x32x16_bf16 v[16:31], v[92:95], v[80:83], v[16:31]
    v_mfma_f32_32x32x16_bf16 v[32:47], v[88:91], v[84:87], v[32:47]
    v_mfma_f32_32x32x16_bf16 v[48:63], v[92:95], v[84:87], v[48:63]
    ds_read_b128 v[80:83], v135 offset:32768
    ds_read_b128 v[84:87], v135 offset:36864
    ds_read_b64_tr_b16 v[88:89], v136 offset:45056
    ds_read_b64_tr_b16 v[90:91], v136 offset:46080
    ds_read_b64_tr_b16 v[92:93], v137 offset:45056
    ds_read_b64_tr_b16 v[94:95], v137 offset:46080
    s_waitcnt lgkmcnt(6)
    v_mfma_f32_32x32x16_bf16 v[0:15], v[72:75], v[64:67], v[0:15]
    v_mfma_f32_32x32x16_bf16 v[16:31], v[76:79], v[64:67], v[16:31]
    v_mfma_f32_32x32x16_bf16 v[32:47], v[72:75], v[68:71], v[32:47]
    v_mfma_f32_32x32x16_bf16 v[48:63], v[76:79], v[68:71], v[48:63]
    s_waitcnt lgkmcnt(0)
    v_mfma_f32_32x32x16_bf16 v[0:15], v[88:91], v[80:83], v[0:15]
    v_mfma_f32_32x32x16_bf16 v[16:31], v[92:95], v[80:83], v[16:31]
    v_mfma_f32_32x32x16_bf16 v[32:47], v[88:91], v[84:87], v[32:47]
    v_mfma_f32_32x32x16_bf16 v[48:63], v[92:95], v[84:87], v[48:63]
    s_waitcnt vmcnt(20)
    ds_write_b128 v130, v[176:179] offset:0
    ds_write_b128 v130, v[180:183] offset:4096
    ds_write_b128 v130, v[184:187] offset:8192
    ds_write_b128 v130, v[188:191] offset:12288
    s_waitcnt vmcnt(16)
    ds_write_b128 v131, v[192:195] offset:0
    ds_write_b128 v131, v[196:199] offset:4096
    ds_write_b128 v131, v[200:203] offset:8192
    ds_write_b128 v131, v[204:207] offset:12288
    s_waitcnt lgkmcnt(0)
    s_barrier
    buffer_load_dwordx4 v[176:179], v128, s[8:11], s20 offen
    buffer_load_dwordx4 v[180:183], v128, s[8:11], s21 offen
    buffer_load_dwordx4 v[184:187], v128, s[8:11], s22 offen
    buffer_load_dwordx4 v[188:191], v128, s[8:11], s23 offen
    buffer_load_dwordx4 v[192:195], v129, s[12:15], s24 offen
    buffer_load_dwordx4 v[196:199], v129, s[12:15], s25 offen
    buffer_load_dwordx4 v[200:203], v129, s[12:15], s26 offen
    buffer_load_dwordx4 v[204:207], v129, s[12:15], s27 offen
    s_add_u32 s20, s20, 128
    s_add_u32 s21, s21, 128
    s_add_u32 s22, s22, 128
    s_add_u32 s23, s23, 128
    s_add_u32 s24, s24, 73728
    s_add_u32 s25, s25, 73728
    s_add_u32 s26, s26, 73728
    s_add_u32 s27, s27, 73728
    ds_read_b128 v[64:67], v132 offset:0
    ds_read_b128 v[68:71], v132 offset:4096
    ds_read_b64_tr_b16 v[72:73], v136 offset:0
    ds_read_b64_tr_b16 v[74:75], v136 offset:1024
    ds_read_b64_tr_b16 v[76:77], v137 offset:0
    ds_read_b64_tr_b16 v[78:79], v137 offset:1024
    ds_read_b128 v[80:83], v133 offset:0
    ds_read_b128 v[84:87], v133 offset:4096
    ds_read_b64_tr_b16 v[88:89], v136 offset:4096
    ds_read_b64_tr_b16 v[90:91], v136 offset:5120
    ds_read_b64_tr_b16 v[92:93], v137 offset:4096
    ds_read_b64_tr_b16 v[94:95], v137 offset:5120
    s_waitcnt lgkmcnt(6)
    v_mfma_f32_32x32x16_bf16 v[0:15], v[72:75], v[64:67], v[0:15]
    v_mfma_f32_32x32x16_bf16 v[16:31], v[76:79], v[64:67], v[16:31]
    v_mfma_f32_32x32x16_bf16 v[32:47], v[72:75], v[68:71], v[32:47]
    v_mfma_f32_32x32x16_bf16 v[48:63], v[76:79], v[68:71], v[48:63]
    ds_read_b128 v[64:67], v134 offset:0
    ds_read_b128 v[68:71], v134 offset:4096
    ds_read_b64_tr_b16 v[72:73], v136 offset:8192
    ds_read_b64_tr_b16 v[74:75], v136 offset:9216
    ds_read_b64_tr_b16 v[76:77], v137 offset:8192
    ds_read_b64_tr_b16 v[78:79], v137 offset:9216
    s_waitcnt lgkmcnt(6)
    v_mfma_f32_32x32x16_bf16 v[0:15], v[88:91], v[80:83], v[0:15]
    v_mfma_f32_32x32x16_bf16 v[16:31], v[92:95], v[80:83], v[16:31]
    v_mfma_f32_32x32x16_bf16 v[32:47], v[88:91], v[84:87], v[32:47]
    v_mfma_f32_32x32x16_bf16 v[48:63], v[92:95], v[84:87], v[48:63]
    ds_read_b128 v[80:83], v135 offset:0
    ds_read_b128 v[84:87], v135 offset:4096
    ds_read_b64_tr_b16 v[88:89], v136 offset:12288
    ds_read_b64_tr_b16 v[90:91], v136 offset:13312
    ds_read_b64_tr_b16 v[92:93], v137 offset:12288
    ds_read_b64_tr_b16 v[94:95], v137 offset:13312
    s_waitcnt lgkmcnt(6)
    v_mfma_f32_32x32x16_bf16 v[0:15], v[72:75], v[64:67], v[0:15]
    v_mfma_f32_32x32x16_bf16 v[16:31], v[76:79], v[64:67], v[16:31]
    v_mfma_f32_32x32x16_bf16 v[32:47], v[72:75], v[68:71], v[32:47]
    v_mfma_f32_32x32x16_bf16 v[48:63], v[76:79], v[68:71], v[48:63]
    s_waitcnt lgkmcnt(0)
    v_mfma_f32_32x32x16_bf16 v[0:15], v[88:91], v[80:83], v[0:15]
    v_mfma_f32_32x32x16_bf16 v[16:31], v[92:95], v[80:83], v[16:31]
    v_mfma_f32_32x32x16_bf16 v[32:47], v[88:91], v[84:87], v[32:47]
    v_mfma_f32_32x32x16_bf16 v[48:63], v[92:95], v[84:87], v[48:63]
    s_waitcnt vmcnt(20)
    ds_write_b128 v130, v[208:211] offset:32768
    ds_write_b128 v130, v[212:215] offset:36864
    ds_write_b128 v130, v[216:219] offset:40960
    ds_write_b128 v130, v[220:223] offset:45056
    s_waitcnt vmcnt(16)
    ds_write_b128 v131, v[224:227] offset:32768
    ds_write_b128 v131, v[228:231] offset:36864
    ds_write_b128 v131, v[232:235] offset:40960
    ds_write_b128 v131, v[236:239] offset:45056
    s_waitcnt lgkmcnt(0)
    s_barrier
    ds_read_b128 v[64:67], v132 offset:32768
    ds_read_b128 v[68:71], v132 offset:36864
    ds_read_b64_tr_b16 v[72:73], v136 offset:32768
    ds_read_b64_tr_b16 v[74:75], v136 offset:33792
    ds_read_b64_tr_b16 v[76:77], v137 offset:32768
    ds_read_b64_tr_b16 v[78:79], v137 offset:33792
    ds_read_b128 v[80:83], v133 offset:32768
    ds_read_b128 v[84:87], v133 offset:36864
    ds_read_b64_tr_b16 v[88:89], v136 offset:36864
    ds_read_b64_tr_b16 v[90:91], v136 offset:37888
    ds_read_b64_tr_b16 v[92:93], v137 offset:36864
    ds_read_b64_tr_b16 v[94:95], v137 offset:37888
    s_waitcnt lgkmcnt(6)
    v_mfma_f32_32x32x16_bf16 v[0:15], v[72:75], v[64:67], v[0:15]
    v_mfma_f32_32x32x16_bf16 v[16:31], v[76:79], v[64:67], v[16:31]
    v_mfma_f32_32x32x16_bf16 v[32:47], v[72:75], v[68:71], v[32:47]
    v_mfma_f32_32x32x16_bf16 v[48:63], v[76:79], v[68:71], v[48:63]
    ds_read_b128 v[64:67], v134 offset:32768
    ds_read_b128 v[68:71], v134 offset:36864
    ds_read_b64_tr_b16 v[72:73], v136 offset:40960
    ds_read_b64_tr_b16 v[74:75], v136 offset:41984
    ds_read_b64_tr_b16 v[76:77], v137 offset:40960
    ds_read_b64_tr_b16 v[78:79], v137 offset:41984
    s_waitcnt lgkmcnt(6)
    v_mfma_f32_32x32x16_bf16 v[0:15], v[88:91], v[80:83], v[0:15]
    v_mfma_f32_32x32x16_bf16 v[16:31], v[92:95], v[80:83], v[16:31]
    v_mfma_f32_32x32x16_bf16 v[32:47], v[88:91], v[84:87], v[32:47]
    v_mfma_f32_32x32x16_bf16 v[48:63], v[92:95], v[84:87], v[48:63]
    ds_read_b128 v[80:83], v135 offset:32768
    ds_read_b128 v[84:87], v135 offset:36864
    ds_read_b64_tr_b16 v[88:89], v136 offset:45056
    ds_read_b64_tr_b16 v[90:91], v136 offset:46080
    ds_read_b64_tr_b16 v[92:93], v137 offset:45056
    ds_read_b64_tr_b16 v[94:95], v137 offset:46080
    s_waitcnt lgkmcnt(6)
    v_mfma_f32_32x32x16_bf16 v[0:15], v[72:75], v[64:67], v[0:15]
    v_mfma_f32_32x32x16_bf16 v[16:31], v[76:79], v[64:67], v[16:31]
    v_mfma_f32_32x32x16_bf16 v[32:47], v[72:75], v[68:71], v[32:47]
    v_mfma_f32_32x32x16_bf16 v[48:63], v[76:79], v[68:71], v[48:63]
    s_waitcnt lgkmcnt(0)
    v_mfma_f32_32x32x16_bf16 v[0:15], v[88:91], v[80:83], v[0:15]
    v_mfma_f32_32x32x16_bf16 v[16:31], v[92:95], v[80:83], v[16:31]
    v_mfma_f32_32x32x16_bf16 v[32:47], v[88:91], v[84:87], v[32:47]
    v_mfma_f32_32x32x16_bf16 v[48:63], v[92:95], v[84:87], v[48:63]
    s_waitcnt vmcnt(12)
    ds_write_b128 v130, v[96:99] offset:0
    ds_write_b128 v130, v[100:103] offset:4096
    ds_write_b128 v130, v[104:107] offset:8192
    ds_write_b128 v130, v[108:111] offset:12288
    s_waitcnt vmcnt(8)
    ds_write_b128 v131, v[112:115] offset:0
    ds_write_b128 v131, v[116:119] offset:4096
    ds_write_b128 v131, v[120:123] offset:8192
    ds_write_b128 v131, v[124:127] offset:12288
    s_waitcnt lgkmcnt(0)
    s_barrier
    ds_read_b128 v[64:67], v132 offset:0
    ds_read_b128 v[68:71], v132 offset:4096
    ds_read_b64_tr_b16 v[72:73], v136 offset:0
    ds_read_b64_tr_b16 v[74:75], v136 offset:1024
    ds_read_b64_tr_b16 v[76:77], v137 offset:0
    ds_read_b64_tr_b16 v[78:79], v137 offset:1024
    ds_read_b128 v[80:83], v133 offset:0
    ds_read_b128 v[84:87], v133 offset:4096
    ds_read_b64_tr_b16 v[88:89], v136 offset:4096
    ds_read_b64_tr_b16 v[90:91], v136 offset:5120
    ds_read_b64_tr_b16 v[92:93], v137 offset:4096
    ds_read_b64_tr_b16 v[94:95], v137 offset:5120
    s_waitcnt lgkmcnt(6)
    v_mfma_f32_32x32x16_bf16 v[0:15], v[72:75], v[64:67], v[0:15]
    v_mfma_f32_32x32x16_bf16 v[16:31], v[76:79], v[64:67], v[16:31]
    v_mfma_f32_32x32x16_bf16 v[32:47], v[72:75], v[68:71], v[32:47]
    v_mfma_f32_32x32x16_bf16 v[48:63], v[76:79], v[68:71], v[48:63]
    ds_read_b128 v[64:67], v134 offset:0
    ds_read_b128 v[68:71], v134 offset:4096
    ds_read_b64_tr_b16 v[72:73], v136 offset:8192
    ds_read_b64_tr_b16 v[74:75], v136 offset:9216
    ds_read_b64_tr_b16 v[76:77], v137 offset:8192
    ds_read_b64_tr_b16 v[78:79], v137 offset:9216
    s_waitcnt lgkmcnt(6)
    v_mfma_f32_32x32x16_bf16 v[0:15], v[88:91], v[80:83], v[0:15]
    v_mfma_f32_32x32x16_bf16 v[16:31], v[92:95], v[80:83], v[16:31]
    v_mfma_f32_32x32x16_bf16 v[32:47], v[88:91], v[84:87], v[32:47]
    v_mfma_f32_32x32x16_bf16 v[48:63], v[92:95], v[84:87], v[48:63]
    ds_read_b128 v[80:83], v135 offset:0
    ds_read_b128 v[84:87], v135 offset:4096
    ds_read_b64_tr_b16 v[88:89], v136 offset:12288
    ds_read_b64_tr_b16 v[90:91], v136 offset:13312
    ds_read_b64_tr_b16 v[92:93], v137 offset:12288
    ds_read_b64_tr_b16 v[94:95], v137 offset:13312
    s_waitcnt lgkmcnt(6)
    v_mfma_f32_32x32x16_bf16 v[0:15], v[72:75], v[64:67], v[0:15]
    v_mfma_f32_32x32x16_bf16 v[16:31], v[76:79], v[64:67], v[16:31]
    v_mfma_f32_32x32x16_bf16 v[32:47], v[72:75], v[68:71], v[32:47]
    v_mfma_f32_32x32x16_bf16 v[48:63], v[76:79], v[68:71], v[48:63]
    s_waitcnt lgkmcnt(0)
    v_mfma_f32_32x32x16_bf16 v[0:15], v[88:91], v[80:83], v[0:15]
    v_mfma_f32_32x32x16_bf16 v[16:31], v[92:95], v[80:83], v[16:31]
    v_mfma_f32_32x32x16_bf16 v[32:47], v[88:91], v[84:87], v[32:47]
    v_mfma_f32_32x32x16_bf16 v[48:63], v[92:95], v[84:87], v[48:63]
    s_waitcnt vmcnt(4)
    ds_write_b128 v130, v[176:179] offset:32768
    ds_write_b128 v130, v[180:183] offset:36864
    ds_write_b128 v130, v[184:187] offset:40960
    ds_write_b128 v130, v[188:191] offset:45056
    s_waitcnt vmcnt(0)
    ds_write_b128 v131, v[192:195] offset:32768
    ds_write_b128 v131, v[196:199] offset:36864
    ds_write_b128 v131, v[200:203] offset:40960
    ds_write_b128 v131, v[204:207] offset:45056
    s_waitcnt lgkmcnt(0)
    s_barrier
    ds_read_b128 v[64:67], v132 offset:32768
    ds_read_b128 v[68:71], v132 offset:36864
    ds_read_b64_tr_b16 v[72:73], v136 offset:32768
    ds_read_b64_tr_b16 v[74:75], v136 offset:33792
    ds_read_b64_tr_b16 v[76:77], v137 offset:32768
    ds_read_b64_tr_b16 v[78:79], v137 offset:33792
    ds_read_b128 v[80:83], v133 offset:32768
    ds_read_b128 v[84:87], v133 offset:36864
    ds_read_b64_tr_b16 v[88:89], v136 offset:36864
    ds_read_b64_tr_b16 v[90:91], v136 offset:37888
    ds_read_b64_tr_b16 v[92:93], v137 offset:36864
    ds_read_b64_tr_b16 v[94:95], v137 offset:37888
    s_waitcnt lgkmcnt(6)
    v_mfma_f32_32x32x16_bf16 v[0:15], v[72:75], v[64:67], v[0:15]
    v_mfma_f32_32x32x16_bf16 v[16:31], v[76:79], v[64:67], v[16:31]
    v_mfma_f32_32x32x16_bf16 v[32:47], v[72:75], v[68:71], v[32:47]
    v_mfma_f32_32x32x16_bf16 v[48:63], v[76:79], v[68:71], v[48:63]
    ds_read_b128 v[64:67], v134 offset:32768
    ds_read_b128 v[68:71], v134 offset:36864
    ds_read_b64_tr_b16 v[72:73], v136 offset:40960
    ds_read_b64_tr_b16 v[74:75], v136 offset:41984
    ds_read_b64_tr_b16 v[76:77], v137 offset:40960
    ds_read_b64_tr_b16 v[78:79], v137 offset:41984
    s_waitcnt lgkmcnt(6)
    v_mfma_f32_32x32x16_bf16 v[0:15], v[88:91], v[80:83], v[0:15]
    v_mfma_f32_32x32x16_bf16 v[16:31], v[92:95], v[80:83], v[16:31]
    v_mfma_f32_32x32x16_bf16 v[32:47], v[88:91], v[84:87], v[32:47]
    v_mfma_f32_32x32x16_bf16 v[48:63], v[92:95], v[84:87], v[48:63]
    ds_read_b128 v[80:83], v135 offset:32768
    ds_read_b128 v[84:87], v135 offset:36864
    ds_read_b64_tr_b16 v[88:89], v136 offset:45056
    ds_read_b64_tr_b16 v[90:91], v136 offset:46080
    ds_read_b64_tr_b16 v[92:93], v137 offset:45056
    ds_read_b64_tr_b16 v[94:95], v137 offset:46080
    s_waitcnt lgkmcnt(6)
    v_mfma_f32_32x32x16_bf16 v[0:15], v[72:75], v[64:67], v[0:15]
    v_mfma_f32_32x32x16_bf16 v[16:31], v[76:79], v[64:67], v[16:31]
    v_mfma_f32_32x32x16_bf16 v[32:47], v[72:75], v[68:71], v[32:47]
    v_mfma_f32_32x32x16_bf16 v[48:63], v[76:79], v[68:71], v[48:63]
    s_waitcnt lgkmcnt(0)
    v_mfma_f32_32x32x16_bf16 v[0:15], v[88:91], v[80:83], v[0:15]
    v_mfma_f32_32x32x16_bf16 v[16:31], v[92:95], v[80:83], v[16:31]
    v_mfma_f32_32x32x16_bf16 v[32:47], v[88:91], v[84:87], v[32:47]
    v_mfma_f32_32x32x16_bf16 v[48:63], v[92:95], v[84:87], v[48:63]
    s_barrier
    s_nop 7
    s_nop 7
    s_add_u32 s16, s4, 150994944
    s_addc_u32 s17, s5, 0
    s_and_b32 s17, s17, 0xffff
    s_mov_b32 s18, 37748736
    s_mov_b32 s19, 0x00020000

    v_lshrrev_b32 v140, 7, v168
    v_lshrrev_b32 v141, 6, v168
    v_and_b32 v141, 1, v141
    v_and_b32 v142, 31, v169
    v_lshrrev_b32 v143, 5, v169
    v_lshl_add_u32 v142, v140, 6, v142
    v_mul_u32_u24 v142, 528, v142
    v_lshlrev_b32 v144, 8, v141
    v_lshl_add_u32 v144, v143, 4, v144
    v_add_u32 v142, v142, v144

    ds_write_b128 v142, v[0:3] offset:0
    ds_write_b128 v142, v[4:7] offset:32
    ds_write_b128 v142, v[8:11] offset:64
    ds_write_b128 v142, v[12:15] offset:96
    ds_write_b128 v142, v[16:19] offset:128
    ds_write_b128 v142, v[20:23] offset:160
    ds_write_b128 v142, v[24:27] offset:192
    ds_write_b128 v142, v[28:31] offset:224
    ds_write_b128 v142, v[32:35] offset:16896
    ds_write_b128 v142, v[36:39] offset:16928
    ds_write_b128 v142, v[40:43] offset:16960
    ds_write_b128 v142, v[44:47] offset:16992
    ds_write_b128 v142, v[48:51] offset:17024
    ds_write_b128 v142, v[52:55] offset:17056
    ds_write_b128 v142, v[56:59] offset:17088
    ds_write_b128 v142, v[60:63] offset:17120
    s_waitcnt lgkmcnt(0)
    s_barrier
    v_lshrrev_b32 v141, 5, v168
    v_and_b32 v142, 31, v168
    v_mul_u32_u24 v140, 528, v141
    v_lshl_add_u32 v140, v142, 4, v140
    v_mul_u32_u24 v143, 2304, v141
    v_lshl_add_u32 v143, v142, 4, v143
    s_lshl_b32 s37, s32, 7
    v_lshl_add_u32 v144, v142, 2, s37
    s_mul_i32 s36, s65, 8
    s_add_u32 s36, s36, s33
    s_mul_i32 s36, s36, 294912
    s_lshl_b32 s37, s32, 9
    s_add_u32 s36, s36, s37
    v_add_u32 v145, 33792, v140

    ds_read_b128 v[0:3], v140 offset:0
    ds_read_b128 v[4:7], v140 offset:4224
    ds_read_b128 v[8:11], v140 offset:8448
    ds_read_b128 v[12:15], v140 offset:12672
    ds_read_b128 v[16:19], v140 offset:16896
    ds_read_b128 v[20:23], v140 offset:21120
    ds_read_b128 v[24:27], v140 offset:25344
    ds_read_b128 v[28:31], v140 offset:29568
    ds_read_b128 v[32:35], v145 offset:0
    ds_read_b128 v[36:39], v145 offset:4224
    ds_read_b128 v[40:43], v145 offset:8448
    ds_read_b128 v[44:47], v145 offset:12672
    ds_read_b128 v[48:51], v145 offset:16896
    ds_read_b128 v[52:55], v145 offset:21120
    ds_read_b128 v[56:59], v145 offset:25344
    ds_read_b128 v[60:63], v145 offset:29568
    v_cmp_gt_u32 vcc, 576, v144
    s_and_saveexec_b64 s[60:61], vcc

    s_waitcnt lgkmcnt(15)
    buffer_store_dwordx4 v[0:3], v143, s[16:19], s36 offen sc1
    s_add_u32 s36, s36, 18432

    s_waitcnt lgkmcnt(14)
    buffer_store_dwordx4 v[4:7], v143, s[16:19], s36 offen sc1
    s_add_u32 s36, s36, 18432

    s_waitcnt lgkmcnt(13)
    buffer_store_dwordx4 v[8:11], v143, s[16:19], s36 offen sc1
    s_add_u32 s36, s36, 18432

    s_waitcnt lgkmcnt(12)
    buffer_store_dwordx4 v[12:15], v143, s[16:19], s36 offen sc1
    s_add_u32 s36, s36, 18432

    s_waitcnt lgkmcnt(11)
    buffer_store_dwordx4 v[16:19], v143, s[16:19], s36 offen sc1
    s_add_u32 s36, s36, 18432

    s_waitcnt lgkmcnt(10)
    buffer_store_dwordx4 v[20:23], v143, s[16:19], s36 offen sc1
    s_add_u32 s36, s36, 18432

    s_waitcnt lgkmcnt(9)
    buffer_store_dwordx4 v[24:27], v143, s[16:19], s36 offen sc1
    s_add_u32 s36, s36, 18432

    s_waitcnt lgkmcnt(8)
    buffer_store_dwordx4 v[28:31], v143, s[16:19], s36 offen sc1
    s_add_u32 s36, s36, 18432

    s_waitcnt lgkmcnt(7)
    buffer_store_dwordx4 v[32:35], v143, s[16:19], s36 offen sc1
    s_add_u32 s36, s36, 18432

    s_waitcnt lgkmcnt(6)
    buffer_store_dwordx4 v[36:39], v143, s[16:19], s36 offen sc1
    s_add_u32 s36, s36, 18432

    s_waitcnt lgkmcnt(5)
    buffer_store_dwordx4 v[40:43], v143, s[16:19], s36 offen sc1
    s_add_u32 s36, s36, 18432

    s_waitcnt lgkmcnt(4)
    buffer_store_dwordx4 v[44:47], v143, s[16:19], s36 offen sc1
    s_add_u32 s36, s36, 18432

    s_waitcnt lgkmcnt(3)
    buffer_store_dwordx4 v[48:51], v143, s[16:19], s36 offen sc1
    s_add_u32 s36, s36, 18432

    s_waitcnt lgkmcnt(2)
    buffer_store_dwordx4 v[52:55], v143, s[16:19], s36 offen sc1
    s_add_u32 s36, s36, 18432

    s_waitcnt lgkmcnt(1)
    buffer_store_dwordx4 v[56:59], v143, s[16:19], s36 offen sc1
    s_add_u32 s36, s36, 18432

    s_waitcnt lgkmcnt(0)
    buffer_store_dwordx4 v[60:63], v143, s[16:19], s36 offen sc1
    s_add_u32 s36, s36, 18432

    s_mov_b64 exec, s[60:61]
    s_lshl_b32 s72, s65, 6
    v_accvgpr_read_b32 v168, a0
    s_nop 0
    v_and_b32 v169, 63, v168

    s_waitcnt vmcnt(0)
    s_barrier
    v_cmp_eq_u32 vcc, 0, v168
    s_and_saveexec_b64 s[76:77], vcc
    s_cbranch_execz L_sig_77
    v_mov_b32 v140, 13312
    v_mov_b32 v141, 1

    buffer_atomic_add v141, v140, s[68:71], s72 offen
L_sig_77:
    s_mov_b64 exec, s[76:77]
    s_add_u32 s65, s65, 1
    s_cmp_lt_u32 s65, 16
    s_cbranch_scc1 L_rloop_74
    s_branch L_end_1

L_rskip_73:
    s_sub_u32 s66, s64, 72
    s_cmp_ge_u32 s66, 16
    s_cbranch_scc1 L_rskip_78
    s_mov_b32 s65, 0

L_rloop_79:
    s_lshl_b32 s72, s65, 6
    v_accvgpr_read_b32 v168, a0
    s_nop 0
    v_and_b32 v169, 63, v168

    v_lshrrev_b32 v140, 6, v168
    s_nop 0
    v_readfirstlane_b32 s78, v140
    s_cmp_lg_u32 s78, 0
    s_cbranch_scc1 L_wpollx_81
    v_mov_b32 v140, 13312
    s_mov_b32 s79, 0

L_wpoll_80:
    buffer_load_dword v141, v140, s[68:71], s72 offen sc1
    s_add_u32 s79, s79, 1
    s_waitcnt vmcnt(0)
    v_readfirstlane_b32 s78, v141
    s_cmp_ge_u32 s78, 40
    s_cbranch_scc1 L_wpollx_81
    s_cmp_gt_u32 s79, 200000
    s_cbranch_scc1 L_wpollx_81
    s_sleep 24
    s_branch L_wpoll_80

L_wpollx_81:
    s_barrier
    s_load_dwordx2 s[6:7], s[80:81], 0
    s_add_u32 s8, s4, 150994944
    s_addc_u32 s9, s5, 0
    s_and_b32 s9, s9, 0xffff
    s_mov_b32 s10, 37748736
    s_mov_b32 s11, 0x00020000

    s_add_u32 s16, s4, 0
    s_addc_u32 s17, s5, 0
    s_and_b32 s17, s17, 0xffff
    s_mov_b32 s18, 13824
    s_mov_b32 s19, 0x00020000

    s_add_u32 s24, s4, 83886080
    s_addc_u32 s25, s5, 0
    s_and_b32 s25, s25, 0xffff
    s_mov_b32 s26, 2359296
    s_mov_b32 s27, 0x00020000

    s_add_u32 s28, s4, 88080384
    s_addc_u32 s29, s5, 0
    s_and_b32 s29, s29, 0xffff
    s_mov_b32 s30, 2359296
    s_mov_b32 s31, 0x00020000

    s_waitcnt lgkmcnt(0)
    s_mov_b32 s12, s6
    s_and_b32 s13, s7, 0xffff
    s_mov_b32 s14, 2359296
    s_mov_b32 s15, 0x00020000

    v_mov_b32 v0, v168
    v_and_b32 v1, 63, v0
    v_lshrrev_b32 v2, 6, v0
    s_nop 0
    v_readfirstlane_b32 s20, v2
    s_lshl_b32 s21, s66, 3
    s_lshl_b32 s22, s20, 1
    s_add_u32 s21, s21, s22
    v_lshlrev_b32 v3, 4, v1
    v_lshlrev_b32 v2, 5, v1
    v_cmp_gt_u32 vcc, 8, v1
    s_mov_b64 s[44:45], vcc
    s_mov_b32 s46, 4608
    buffer_load_dwordx4 v[72:75], v2, s[16:19], s46 offen
    buffer_load_dwordx4 v[76:79], v2, s[16:19], s46 offen offset:16
    s_mov_b64 exec, s[44:45]
    buffer_load_dwordx4 v[80:83], v2, s[16:19], s46 offen offset:2048
    buffer_load_dwordx4 v[84:87], v2, s[16:19], s46 offen offset:2064
    s_mov_b64 exec, -1

    s_mov_b32 s22, 9216
    s_mov_b32 s23, 6912
    buffer_load_dwordx4 v[40:43], v2, s[16:19], s22 offen
    buffer_load_dwordx4 v[44:47], v2, s[16:19], s22 offen offset:16
    buffer_load_dwordx4 v[48:51], v2, s[16:19], s23 offen
    buffer_load_dwordx4 v[52:55], v2, s[16:19], s23 offen offset:16
    s_mov_b64 exec, s[44:45]
    buffer_load_dwordx4 v[56:59], v2, s[16:19], s22 offen offset:2048
    buffer_load_dwordx4 v[60:63], v2, s[16:19], s22 offen offset:2064
    buffer_load_dwordx4 v[64:67], v2, s[16:19], s23 offen offset:2048
    buffer_load_dwordx4 v[68:71], v2, s[16:19], s23 offen offset:2064
    s_mov_b64 exec, -1
    s_waitcnt vmcnt(0)

    v_add_f32 v40, 1.0, v40
    v_add_f32 v41, 1.0, v41

    v_cvt_pk_bf16_f32 v33, v40, v41
    v_lshlrev_b32 v40, 16, v33
    v_and_b32 v41, 0xffff0000, v33

    v_add_f32 v42, 1.0, v42
    v_add_f32 v43, 1.0, v43

    v_cvt_pk_bf16_f32 v33, v42, v43
    v_lshlrev_b32 v42, 16, v33
    v_and_b32 v43, 0xffff0000, v33

    v_add_f32 v44, 1.0, v44
    v_add_f32 v45, 1.0, v45

    v_cvt_pk_bf16_f32 v33, v44, v45
    v_lshlrev_b32 v44, 16, v33
    v_and_b32 v45, 0xffff0000, v33

    v_add_f32 v46, 1.0, v46
    v_add_f32 v47, 1.0, v47

    v_cvt_pk_bf16_f32 v33, v46, v47
    v_lshlrev_b32 v46, 16, v33
    v_and_b32 v47, 0xffff0000, v33

    v_add_f32 v56, 1.0, v56
    v_add_f32 v57, 1.0, v57

    v_cvt_pk_bf16_f32 v33, v56, v57
    v_lshlrev_b32 v56, 16, v33
    v_and_b32 v57, 0xffff0000, v33

    v_add_f32 v58, 1.0, v58
    v_add_f32 v59, 1.0, v59

    v_cvt_pk_bf16_f32 v33, v58, v59
    v_lshlrev_b32 v58, 16, v33
    v_and_b32 v59, 0xffff0000, v33

    v_add_f32 v60, 1.0, v60
    v_add_f32 v61, 1.0, v61

    v_cvt_pk_bf16_f32 v33, v60, v61
    v_lshlrev_b32 v60, 16, v33
    v_and_b32 v61, 0xffff0000, v33

    v_add_f32 v62, 1.0, v62
    v_add_f32 v63, 1.0, v63

    v_cvt_pk_bf16_f32 v33, v62, v63
    v_lshlrev_b32 v62, 16, v33
    v_and_b32 v63, 0xffff0000, v33

    s_add_u32 s47, s21, 0
    s_mul_i32 s48, s47, 2304
    s_mul_i32 s49, s65, 2359296
    s_add_u32 s48, s48, s49
    s_lshl_b32 s49, s65, 7
    s_add_u32 s49, s49, s47
    s_mul_i32 s49, s49, 1152

    buffer_load_dwordx4 v[96:99], v2, s[8:11], s48 offen
    buffer_load_dwordx4 v[100:103], v2, s[8:11], s48 offen offset:16
    s_mov_b64 exec, s[44:45]
    buffer_load_dwordx4 v[104:107], v2, s[8:11], s48 offen offset:2048
    buffer_load_dwordx4 v[108:111], v2, s[8:11], s48 offen offset:2064
    s_mov_b64 exec, -1
    s_add_u32 s48, s48, 294912

    buffer_load_dwordx4 v[112:115], v2, s[8:11], s48 offen
    buffer_load_dwordx4 v[116:119], v2, s[8:11], s48 offen offset:16
    s_mov_b64 exec, s[44:45]
    buffer_load_dwordx4 v[120:123], v2, s[8:11], s48 offen offset:2048
    buffer_load_dwordx4 v[124:127], v2, s[8:11], s48 offen offset:2064
    s_mov_b64 exec, -1
    s_add_u32 s48, s48, 294912

    buffer_load_dwordx4 v[128:131], v2, s[8:11], s48 offen
    buffer_load_dwordx4 v[132:135], v2, s[8:11], s48 offen offset:16
    s_mov_b64 exec, s[44:45]
    buffer_load_dwordx4 v[136:139], v2, s[8:11], s48 offen offset:2048
    buffer_load_dwordx4 v[140:143], v2, s[8:11], s48 offen offset:2064
    s_mov_b64 exec, -1
    s_add_u32 s48, s48, 294912

    buffer_load_dwordx4 v[144:147], v2, s[8:11], s48 offen
    buffer_load_dwordx4 v[148:151], v2, s[8:11], s48 offen offset:16
    s_mov_b64 exec, s[44:45]
    buffer_load_dwordx4 v[152:155], v2, s[8:11], s48 offen offset:2048
    buffer_load_dwordx4 v[156:159], v2, s[8:11], s48 offen offset:2064
    s_mov_b64 exec, -1
    s_add_u32 s48, s48, 294912

    buffer_load_dwordx4 v[160:163], v2, s[8:11], s48 offen
    buffer_load_dwordx4 v[164:167], v2, s[8:11], s48 offen offset:16
    s_mov_b64 exec, s[44:45]
    buffer_load_dwordx4 v[168:171], v2, s[8:11], s48 offen offset:2048
    buffer_load_dwordx4 v[172:175], v2, s[8:11], s48 offen offset:2064
    s_mov_b64 exec, -1
    s_add_u32 s48, s48, 294912

    buffer_load_dwordx4 v[176:179], v2, s[8:11], s48 offen
    buffer_load_dwordx4 v[180:183], v2, s[8:11], s48 offen offset:16
    s_mov_b64 exec, s[44:45]
    buffer_load_dwordx4 v[184:187], v2, s[8:11], s48 offen offset:2048
    buffer_load_dwordx4 v[188:191], v2, s[8:11], s48 offen offset:2064
    s_mov_b64 exec, -1
    s_add_u32 s48, s48, 294912

    buffer_load_dwordx4 v[192:195], v2, s[8:11], s48 offen
    buffer_load_dwordx4 v[196:199], v2, s[8:11], s48 offen offset:16
    s_mov_b64 exec, s[44:45]
    buffer_load_dwordx4 v[200:203], v2, s[8:11], s48 offen offset:2048
    buffer_load_dwordx4 v[204:207], v2, s[8:11], s48 offen offset:2064
    s_mov_b64 exec, -1
    s_add_u32 s48, s48, 294912

    buffer_load_dwordx4 v[208:211], v2, s[8:11], s48 offen
    buffer_load_dwordx4 v[212:215], v2, s[8:11], s48 offen offset:16
    s_mov_b64 exec, s[44:45]
    buffer_load_dwordx4 v[216:219], v2, s[8:11], s48 offen offset:2048
    buffer_load_dwordx4 v[220:223], v2, s[8:11], s48 offen offset:2064
    s_mov_b64 exec, -1
    s_add_u32 s48, s48, 294912

    v_mov_b32 v8, 0
    v_mov_b32 v9, 0
    v_mov_b32 v10, 0
    v_mov_b32 v11, 0
    buffer_load_dwordx4 v[4:7], v3, s[12:15], s49 offen
    s_mov_b64 exec, s[44:45]
    buffer_load_dwordx4 v[8:11], v3, s[12:15], s49 offen offset:1024
    s_mov_b64 exec, -1
    s_waitcnt vmcnt(0)

    v_add_f32 v96, v96, v112
    v_add_f32 v97, v97, v113
    v_add_f32 v98, v98, v114
    v_add_f32 v99, v99, v115
    v_add_f32 v100, v100, v116
    v_add_f32 v101, v101, v117
    v_add_f32 v102, v102, v118
    v_add_f32 v103, v103, v119
    v_add_f32 v104, v104, v120
    v_add_f32 v105, v105, v121
    v_add_f32 v106, v106, v122
    v_add_f32 v107, v107, v123
    v_add_f32 v108, v108, v124
    v_add_f32 v109, v109, v125
    v_add_f32 v110, v110, v126
    v_add_f32 v111, v111, v127
    v_add_f32 v96, v96, v128
    v_add_f32 v97, v97, v129
    v_add_f32 v98, v98, v130
    v_add_f32 v99, v99, v131
    v_add_f32 v100, v100, v132
    v_add_f32 v101, v101, v133
    v_add_f32 v102, v102, v134
    v_add_f32 v103, v103, v135
    v_add_f32 v104, v104, v136
    v_add_f32 v105, v105, v137
    v_add_f32 v106, v106, v138
    v_add_f32 v107, v107, v139
    v_add_f32 v108, v108, v140
    v_add_f32 v109, v109, v141
    v_add_f32 v110, v110, v142
    v_add_f32 v111, v111, v143
    v_add_f32 v96, v96, v144
    v_add_f32 v97, v97, v145
    v_add_f32 v98, v98, v146
    v_add_f32 v99, v99, v147
    v_add_f32 v100, v100, v148
    v_add_f32 v101, v101, v149
    v_add_f32 v102, v102, v150
    v_add_f32 v103, v103, v151
    v_add_f32 v104, v104, v152
    v_add_f32 v105, v105, v153
    v_add_f32 v106, v106, v154
    v_add_f32 v107, v107, v155
    v_add_f32 v108, v108, v156
    v_add_f32 v109, v109, v157
    v_add_f32 v110, v110, v158
    v_add_f32 v111, v111, v159
    v_add_f32 v96, v96, v160
    v_add_f32 v97, v97, v161
    v_add_f32 v98, v98, v162
    v_add_f32 v99, v99, v163
    v_add_f32 v100, v100, v164
    v_add_f32 v101, v101, v165
    v_add_f32 v102, v102, v166
    v_add_f32 v103, v103, v167
    v_add_f32 v104, v104, v168
    v_add_f32 v105, v105, v169
    v_add_f32 v106, v106, v170
    v_add_f32 v107, v107, v171
    v_add_f32 v108, v108, v172
    v_add_f32 v109, v109, v173
    v_add_f32 v110, v110, v174
    v_add_f32 v111, v111, v175
    v_add_f32 v96, v96, v176
    v_add_f32 v97, v97, v177
    v_add_f32 v98, v98, v178
    v_add_f32 v99, v99, v179
    v_add_f32 v100, v100, v180
    v_add_f32 v101, v101, v181
    v_add_f32 v102, v102, v182
    v_add_f32 v103, v103, v183
    v_add_f32 v104, v104, v184
    v_add_f32 v105, v105, v185
    v_add_f32 v106, v106, v186
    v_add_f32 v107, v107, v187
    v_add_f32 v108, v108, v188
    v_add_f32 v109, v109, v189
    v_add_f32 v110, v110, v190
    v_add_f32 v111, v111, v191
    v_add_f32 v96, v96, v192
    v_add_f32 v97, v97, v193
    v_add_f32 v98, v98, v194
    v_add_f32 v99, v99, v195
    v_add_f32 v100, v100, v196
    v_add_f32 v101, v101, v197
    v_add_f32 v102, v102, v198
    v_add_f32 v103, v103, v199
    v_add_f32 v104, v104, v200
    v_add_f32 v105, v105, v201
    v_add_f32 v106, v106, v202
    v_add_f32 v107, v107, v203
    v_add_f32 v108, v108, v204
    v_add_f32 v109, v109, v205
    v_add_f32 v110, v110, v206
    v_add_f32 v111, v111, v207
    v_add_f32 v96, v96, v208
    v_add_f32 v97, v97, v209
    v_add_f32 v98, v98, v210
    v_add_f32 v99, v99, v211
    v_add_f32 v100, v100, v212
    v_add_f32 v101, v101, v213
    v_add_f32 v102, v102, v214
    v_add_f32 v103, v103, v215
    v_add_f32 v104, v104, v216
    v_add_f32 v105, v105, v217
    v_add_f32 v106, v106, v218
    v_add_f32 v107, v107, v219
    v_add_f32 v108, v108, v220
    v_add_f32 v109, v109, v221
    v_add_f32 v110, v110, v222
    v_add_f32 v111, v111, v223
    v_cvt_pk_bf16_f32 v33, v96, v97
    v_lshlrev_b32 v96, 16, v33
    v_and_b32 v97, 0xffff0000, v33

    v_mul_f32 v96, v96, v72
    v_mul_f32 v97, v97, v73

    v_cvt_pk_bf16_f32 v33, v96, v97
    v_lshlrev_b32 v96, 16, v33
    v_and_b32 v97, 0xffff0000, v33

    v_lshlrev_b32 v16, 16, v4
    v_and_b32 v17, 0xffff0000, v4
    v_add_f32 v16, v16, v96
    v_add_f32 v17, v17, v97
    v_cvt_pk_bf16_f32 v4, v16, v17
    v_lshlrev_b32 v16, 16, v4
    v_and_b32 v17, 0xffff0000, v4

    v_cvt_pk_bf16_f32 v33, v98, v99
    v_lshlrev_b32 v98, 16, v33
    v_and_b32 v99, 0xffff0000, v33

    v_mul_f32 v98, v98, v74
    v_mul_f32 v99, v99, v75

    v_cvt_pk_bf16_f32 v33, v98, v99
    v_lshlrev_b32 v98, 16, v33
    v_and_b32 v99, 0xffff0000, v33

    v_lshlrev_b32 v18, 16, v5
    v_and_b32 v19, 0xffff0000, v5
    v_add_f32 v18, v18, v98
    v_add_f32 v19, v19, v99
    v_cvt_pk_bf16_f32 v5, v18, v19
    v_lshlrev_b32 v18, 16, v5
    v_and_b32 v19, 0xffff0000, v5

    v_cvt_pk_bf16_f32 v33, v100, v101
    v_lshlrev_b32 v100, 16, v33
    v_and_b32 v101, 0xffff0000, v33

    v_mul_f32 v100, v100, v76
    v_mul_f32 v101, v101, v77

    v_cvt_pk_bf16_f32 v33, v100, v101
    v_lshlrev_b32 v100, 16, v33
    v_and_b32 v101, 0xffff0000, v33

    v_lshlrev_b32 v20, 16, v6
    v_and_b32 v21, 0xffff0000, v6
    v_add_f32 v20, v20, v100
    v_add_f32 v21, v21, v101
    v_cvt_pk_bf16_f32 v6, v20, v21
    v_lshlrev_b32 v20, 16, v6
    v_and_b32 v21, 0xffff0000, v6

    v_cvt_pk_bf16_f32 v33, v102, v103
    v_lshlrev_b32 v102, 16, v33
    v_and_b32 v103, 0xffff0000, v33

    v_mul_f32 v102, v102, v78
    v_mul_f32 v103, v103, v79

    v_cvt_pk_bf16_f32 v33, v102, v103
    v_lshlrev_b32 v102, 16, v33
    v_and_b32 v103, 0xffff0000, v33

    v_lshlrev_b32 v22, 16, v7
    v_and_b32 v23, 0xffff0000, v7
    v_add_f32 v22, v22, v102
    v_add_f32 v23, v23, v103
    v_cvt_pk_bf16_f32 v7, v22, v23
    v_lshlrev_b32 v22, 16, v7
    v_and_b32 v23, 0xffff0000, v7

    v_cvt_pk_bf16_f32 v33, v104, v105
    v_lshlrev_b32 v104, 16, v33
    v_and_b32 v105, 0xffff0000, v33

    v_mul_f32 v104, v104, v80
    v_mul_f32 v105, v105, v81

    v_cvt_pk_bf16_f32 v33, v104, v105
    v_lshlrev_b32 v104, 16, v33
    v_and_b32 v105, 0xffff0000, v33

    v_lshlrev_b32 v24, 16, v8
    v_and_b32 v25, 0xffff0000, v8
    v_add_f32 v24, v24, v104
    v_add_f32 v25, v25, v105
    v_cvt_pk_bf16_f32 v8, v24, v25
    v_lshlrev_b32 v24, 16, v8
    v_and_b32 v25, 0xffff0000, v8

    v_cvt_pk_bf16_f32 v33, v106, v107
    v_lshlrev_b32 v106, 16, v33
    v_and_b32 v107, 0xffff0000, v33

    v_mul_f32 v106, v106, v82
    v_mul_f32 v107, v107, v83

    v_cvt_pk_bf16_f32 v33, v106, v107
    v_lshlrev_b32 v106, 16, v33
    v_and_b32 v107, 0xffff0000, v33

    v_lshlrev_b32 v26, 16, v9
    v_and_b32 v27, 0xffff0000, v9
    v_add_f32 v26, v26, v106
    v_add_f32 v27, v27, v107
    v_cvt_pk_bf16_f32 v9, v26, v27
    v_lshlrev_b32 v26, 16, v9
    v_and_b32 v27, 0xffff0000, v9

    v_cvt_pk_bf16_f32 v33, v108, v109
    v_lshlrev_b32 v108, 16, v33
    v_and_b32 v109, 0xffff0000, v33

    v_mul_f32 v108, v108, v84
    v_mul_f32 v109, v109, v85

    v_cvt_pk_bf16_f32 v33, v108, v109
    v_lshlrev_b32 v108, 16, v33
    v_and_b32 v109, 0xffff0000, v33

    v_lshlrev_b32 v28, 16, v10
    v_and_b32 v29, 0xffff0000, v10
    v_add_f32 v28, v28, v108
    v_add_f32 v29, v29, v109
    v_cvt_pk_bf16_f32 v10, v28, v29
    v_lshlrev_b32 v28, 16, v10
    v_and_b32 v29, 0xffff0000, v10

    v_cvt_pk_bf16_f32 v33, v110, v111
    v_lshlrev_b32 v110, 16, v33
    v_and_b32 v111, 0xffff0000, v33

    v_mul_f32 v110, v110, v86
    v_mul_f32 v111, v111, v87

    v_cvt_pk_bf16_f32 v33, v110, v111
    v_lshlrev_b32 v110, 16, v33
    v_and_b32 v111, 0xffff0000, v33

    v_lshlrev_b32 v30, 16, v11
    v_and_b32 v31, 0xffff0000, v11
    v_add_f32 v30, v30, v110
    v_add_f32 v31, v31, v111
    v_cvt_pk_bf16_f32 v11, v30, v31
    v_lshlrev_b32 v30, 16, v11
    v_and_b32 v31, 0xffff0000, v11

    buffer_store_dwordx4 v[4:7], v3, s[24:27], s49 offen sc1
    s_mov_b64 exec, s[44:45]
    buffer_store_dwordx4 v[8:11], v3, s[24:27], s49 offen offset:1024 sc1
    s_mov_b64 exec, -1

    s_not_b64 exec, s[44:45]
    v_mov_b32 v24, 0
    v_mov_b32 v25, 0
    v_mov_b32 v26, 0
    v_mov_b32 v27, 0
    v_mov_b32 v28, 0
    v_mov_b32 v29, 0
    v_mov_b32 v30, 0
    v_mov_b32 v31, 0
    s_mov_b64 exec, -1
    v_add_f32 v32, v16, v17
    v_add_f32 v32, v32, v18
    v_add_f32 v32, v32, v19
    v_add_f32 v32, v32, v20
    v_add_f32 v32, v32, v21
    v_add_f32 v32, v32, v22
    v_add_f32 v32, v32, v23
    v_add_f32 v32, v32, v24
    v_add_f32 v32, v32, v25
    v_add_f32 v32, v32, v26
    v_add_f32 v32, v32, v27
    v_add_f32 v32, v32, v28
    v_add_f32 v32, v32, v29
    v_add_f32 v32, v32, v30
    v_add_f32 v32, v32, v31
    ds_swizzle_b32 v33, v32 offset:1055
    s_waitcnt lgkmcnt(0)
    v_add_f32 v32, v32, v33

    ds_swizzle_b32 v33, v32 offset:2079
    s_waitcnt lgkmcnt(0)
    v_add_f32 v32, v32, v33

    ds_swizzle_b32 v33, v32 offset:4127
    s_waitcnt lgkmcnt(0)
    v_add_f32 v32, v32, v33

    ds_swizzle_b32 v33, v32 offset:8223
    s_waitcnt lgkmcnt(0)
    v_add_f32 v32, v32, v33

    ds_swizzle_b32 v33, v32 offset:16415
    s_waitcnt lgkmcnt(0)
    v_add_f32 v32, v32, v33

    s_nop 1
    v_readlane_b32 s26, v32, 32
    s_nop 3
    v_add_f32 v32, s26, v32
    s_nop 1
    v_readlane_b32 s26, v32, 0
    s_nop 3

    v_mov_b32 v33, 0x3ae38e39
    v_mul_f32 v34, s26, v33
    v_mov_b32 v32, 0

    v_sub_f32 v33, v16, v34
    v_fmac_f32 v32, v33, v33

    v_sub_f32 v33, v17, v34
    v_fmac_f32 v32, v33, v33

    v_sub_f32 v33, v18, v34
    v_fmac_f32 v32, v33, v33

    v_sub_f32 v33, v19, v34
    v_fmac_f32 v32, v33, v33

    v_sub_f32 v33, v20, v34
    v_fmac_f32 v32, v33, v33

    v_sub_f32 v33, v21, v34
    v_fmac_f32 v32, v33, v33

    v_sub_f32 v33, v22, v34
    v_fmac_f32 v32, v33, v33

    v_sub_f32 v33, v23, v34
    v_fmac_f32 v32, v33, v33

    s_mov_b64 exec, s[44:45]
    v_sub_f32 v33, v24, v34
    v_fmac_f32 v32, v33, v33

    v_sub_f32 v33, v25, v34
    v_fmac_f32 v32, v33, v33

    v_sub_f32 v33, v26, v34
    v_fmac_f32 v32, v33, v33

    v_sub_f32 v33, v27, v34
    v_fmac_f32 v32, v33, v33

    v_sub_f32 v33, v28, v34
    v_fmac_f32 v32, v33, v33

    v_sub_f32 v33, v29, v34
    v_fmac_f32 v32, v33, v33

    v_sub_f32 v33, v30, v34
    v_fmac_f32 v32, v33, v33

    v_sub_f32 v33, v31, v34
    v_fmac_f32 v32, v33, v33

    s_mov_b64 exec, -1
    ds_swizzle_b32 v33, v32 offset:1055
    s_waitcnt lgkmcnt(0)
    v_add_f32 v32, v32, v33

    ds_swizzle_b32 v33, v32 offset:2079
    s_waitcnt lgkmcnt(0)
    v_add_f32 v32, v32, v33

    ds_swizzle_b32 v33, v32 offset:4127
    s_waitcnt lgkmcnt(0)
    v_add_f32 v32, v32, v33

    ds_swizzle_b32 v33, v32 offset:8223
    s_waitcnt lgkmcnt(0)
    v_add_f32 v32, v32, v33

    ds_swizzle_b32 v33, v32 offset:16415
    s_waitcnt lgkmcnt(0)
    v_add_f32 v32, v32, v33

    s_nop 1
    v_readlane_b32 s26, v32, 32
    s_nop 3
    v_add_f32 v32, s26, v32
    s_nop 1
    v_readlane_b32 s26, v32, 0
    s_nop 3

    v_mov_b32 v33, 0x3ae38e39
    v_mul_f32 v35, s26, v33

    v_cvt_pk_bf16_f32 v33, v34, v35
    v_lshlrev_b32 v34, 16, v33
    v_and_b32 v35, 0xffff0000, v33

    v_add_f32 v35, 0x3727c5ac, v35
    v_cvt_pk_bf16_f32 v33, v35, v35
    v_lshlrev_b32 v35, 16, v33

    v_sqrt_f32 v35, v35
    s_nop 0
    v_cvt_pk_bf16_f32 v33, v35, v35
    v_lshlrev_b32 v35, 16, v33

    v_rcp_f32 v35, v35
    s_nop 0
    v_sub_f32 v16, v16, v34
    v_sub_f32 v17, v17, v34

    v_cvt_pk_bf16_f32 v33, v16, v17
    v_lshlrev_b32 v16, 16, v33
    v_and_b32 v17, 0xffff0000, v33

    v_mul_f32 v16, v16, v35
    v_mul_f32 v17, v17, v35

    v_cvt_pk_bf16_f32 v33, v16, v17
    v_lshlrev_b32 v16, 16, v33
    v_and_b32 v17, 0xffff0000, v33

    v_mul_f32 v16, v16, v40
    v_mul_f32 v17, v17, v41

    v_cvt_pk_bf16_f32 v33, v16, v17
    v_lshlrev_b32 v16, 16, v33
    v_and_b32 v17, 0xffff0000, v33

    v_add_f32 v16, v16, v48
    v_add_f32 v17, v17, v49
    v_cvt_pk_bf16_f32 v88, v16, v17

    v_sub_f32 v18, v18, v34
    v_sub_f32 v19, v19, v34

    v_cvt_pk_bf16_f32 v33, v18, v19
    v_lshlrev_b32 v18, 16, v33
    v_and_b32 v19, 0xffff0000, v33

    v_mul_f32 v18, v18, v35
    v_mul_f32 v19, v19, v35

    v_cvt_pk_bf16_f32 v33, v18, v19
    v_lshlrev_b32 v18, 16, v33
    v_and_b32 v19, 0xffff0000, v33

    v_mul_f32 v18, v18, v42
    v_mul_f32 v19, v19, v43

    v_cvt_pk_bf16_f32 v33, v18, v19
    v_lshlrev_b32 v18, 16, v33
    v_and_b32 v19, 0xffff0000, v33

    v_add_f32 v18, v18, v50
    v_add_f32 v19, v19, v51
    v_cvt_pk_bf16_f32 v89, v18, v19

    v_sub_f32 v20, v20, v34
    v_sub_f32 v21, v21, v34

    v_cvt_pk_bf16_f32 v33, v20, v21
    v_lshlrev_b32 v20, 16, v33
    v_and_b32 v21, 0xffff0000, v33

    v_mul_f32 v20, v20, v35
    v_mul_f32 v21, v21, v35

    v_cvt_pk_bf16_f32 v33, v20, v21
    v_lshlrev_b32 v20, 16, v33
    v_and_b32 v21, 0xffff0000, v33

    v_mul_f32 v20, v20, v44
    v_mul_f32 v21, v21, v45

    v_cvt_pk_bf16_f32 v33, v20, v21
    v_lshlrev_b32 v20, 16, v33
    v_and_b32 v21, 0xffff0000, v33

    v_add_f32 v20, v20, v52
    v_add_f32 v21, v21, v53
    v_cvt_pk_bf16_f32 v90, v20, v21

    v_sub_f32 v22, v22, v34
    v_sub_f32 v23, v23, v34

    v_cvt_pk_bf16_f32 v33, v22, v23
    v_lshlrev_b32 v22, 16, v33
    v_and_b32 v23, 0xffff0000, v33

    v_mul_f32 v22, v22, v35
    v_mul_f32 v23, v23, v35

    v_cvt_pk_bf16_f32 v33, v22, v23
    v_lshlrev_b32 v22, 16, v33
    v_and_b32 v23, 0xffff0000, v33

    v_mul_f32 v22, v22, v46
    v_mul_f32 v23, v23, v47

    v_cvt_pk_bf16_f32 v33, v22, v23
    v_lshlrev_b32 v22, 16, v33
    v_and_b32 v23, 0xffff0000, v33

    v_add_f32 v22, v22, v54
    v_add_f32 v23, v23, v55
    v_cvt_pk_bf16_f32 v91, v22, v23

    v_sub_f32 v24, v24, v34
    v_sub_f32 v25, v25, v34

    v_cvt_pk_bf16_f32 v33, v24, v25
    v_lshlrev_b32 v24, 16, v33
    v_and_b32 v25, 0xffff0000, v33

    v_mul_f32 v24, v24, v35
    v_mul_f32 v25, v25, v35

    v_cvt_pk_bf16_f32 v33, v24, v25
    v_lshlrev_b32 v24, 16, v33
    v_and_b32 v25, 0xffff0000, v33

    v_mul_f32 v24, v24, v56
    v_mul_f32 v25, v25, v57

    v_cvt_pk_bf16_f32 v33, v24, v25
    v_lshlrev_b32 v24, 16, v33
    v_and_b32 v25, 0xffff0000, v33

    v_add_f32 v24, v24, v64
    v_add_f32 v25, v25, v65
    v_cvt_pk_bf16_f32 v92, v24, v25

    v_sub_f32 v26, v26, v34
    v_sub_f32 v27, v27, v34

    v_cvt_pk_bf16_f32 v33, v26, v27
    v_lshlrev_b32 v26, 16, v33
    v_and_b32 v27, 0xffff0000, v33

    v_mul_f32 v26, v26, v35
    v_mul_f32 v27, v27, v35

    v_cvt_pk_bf16_f32 v33, v26, v27
    v_lshlrev_b32 v26, 16, v33
    v_and_b32 v27, 0xffff0000, v33

    v_mul_f32 v26, v26, v58
    v_mul_f32 v27, v27, v59

    v_cvt_pk_bf16_f32 v33, v26, v27
    v_lshlrev_b32 v26, 16, v33
    v_and_b32 v27, 0xffff0000, v33

    v_add_f32 v26, v26, v66
    v_add_f32 v27, v27, v67
    v_cvt_pk_bf16_f32 v93, v26, v27

    v_sub_f32 v28, v28, v34
    v_sub_f32 v29, v29, v34

    v_cvt_pk_bf16_f32 v33, v28, v29
    v_lshlrev_b32 v28, 16, v33
    v_and_b32 v29, 0xffff0000, v33

    v_mul_f32 v28, v28, v35
    v_mul_f32 v29, v29, v35

    v_cvt_pk_bf16_f32 v33, v28, v29
    v_lshlrev_b32 v28, 16, v33
    v_and_b32 v29, 0xffff0000, v33

    v_mul_f32 v28, v28, v60
    v_mul_f32 v29, v29, v61

    v_cvt_pk_bf16_f32 v33, v28, v29
    v_lshlrev_b32 v28, 16, v33
    v_and_b32 v29, 0xffff0000, v33

    v_add_f32 v28, v28, v68
    v_add_f32 v29, v29, v69
    v_cvt_pk_bf16_f32 v94, v28, v29

    v_sub_f32 v30, v30, v34
    v_sub_f32 v31, v31, v34

    v_cvt_pk_bf16_f32 v33, v30, v31
    v_lshlrev_b32 v30, 16, v33
    v_and_b32 v31, 0xffff0000, v33

    v_mul_f32 v30, v30, v35
    v_mul_f32 v31, v31, v35

    v_cvt_pk_bf16_f32 v33, v30, v31
    v_lshlrev_b32 v30, 16, v33
    v_and_b32 v31, 0xffff0000, v33

    v_mul_f32 v30, v30, v62
    v_mul_f32 v31, v31, v63

    v_cvt_pk_bf16_f32 v33, v30, v31
    v_lshlrev_b32 v30, 16, v33
    v_and_b32 v31, 0xffff0000, v33

    v_add_f32 v30, v30, v70
    v_add_f32 v31, v31, v71
    v_cvt_pk_bf16_f32 v95, v30, v31

    buffer_store_dwordx4 v[88:91], v3, s[28:31], s49 offen sc1
    s_mov_b64 exec, s[44:45]
    buffer_store_dwordx4 v[92:95], v3, s[28:31], s49 offen offset:1024 sc1
    s_mov_b64 exec, -1
    s_nop 1

    s_add_u32 s47, s21, 1
    s_mul_i32 s48, s47, 2304
    s_mul_i32 s49, s65, 2359296
    s_add_u32 s48, s48, s49
    s_lshl_b32 s49, s65, 7
    s_add_u32 s49, s49, s47
    s_mul_i32 s49, s49, 1152

    buffer_load_dwordx4 v[96:99], v2, s[8:11], s48 offen
    buffer_load_dwordx4 v[100:103], v2, s[8:11], s48 offen offset:16
    s_mov_b64 exec, s[44:45]
    buffer_load_dwordx4 v[104:107], v2, s[8:11], s48 offen offset:2048
    buffer_load_dwordx4 v[108:111], v2, s[8:11], s48 offen offset:2064
    s_mov_b64 exec, -1
    s_add_u32 s48, s48, 294912

    buffer_load_dwordx4 v[112:115], v2, s[8:11], s48 offen
    buffer_load_dwordx4 v[116:119], v2, s[8:11], s48 offen offset:16
    s_mov_b64 exec, s[44:45]
    buffer_load_dwordx4 v[120:123], v2, s[8:11], s48 offen offset:2048
    buffer_load_dwordx4 v[124:127], v2, s[8:11], s48 offen offset:2064
    s_mov_b64 exec, -1
    s_add_u32 s48, s48, 294912

    buffer_load_dwordx4 v[128:131], v2, s[8:11], s48 offen
    buffer_load_dwordx4 v[132:135], v2, s[8:11], s48 offen offset:16
    s_mov_b64 exec, s[44:45]
    buffer_load_dwordx4 v[136:139], v2, s[8:11], s48 offen offset:2048
    buffer_load_dwordx4 v[140:143], v2, s[8:11], s48 offen offset:2064
    s_mov_b64 exec, -1
    s_add_u32 s48, s48, 294912

    buffer_load_dwordx4 v[144:147], v2, s[8:11], s48 offen
    buffer_load_dwordx4 v[148:151], v2, s[8:11], s48 offen offset:16
    s_mov_b64 exec, s[44:45]
    buffer_load_dwordx4 v[152:155], v2, s[8:11], s48 offen offset:2048
    buffer_load_dwordx4 v[156:159], v2, s[8:11], s48 offen offset:2064
    s_mov_b64 exec, -1
    s_add_u32 s48, s48, 294912

    buffer_load_dwordx4 v[160:163], v2, s[8:11], s48 offen
    buffer_load_dwordx4 v[164:167], v2, s[8:11], s48 offen offset:16
    s_mov_b64 exec, s[44:45]
    buffer_load_dwordx4 v[168:171], v2, s[8:11], s48 offen offset:2048
    buffer_load_dwordx4 v[172:175], v2, s[8:11], s48 offen offset:2064
    s_mov_b64 exec, -1
    s_add_u32 s48, s48, 294912

    buffer_load_dwordx4 v[176:179], v2, s[8:11], s48 offen
    buffer_load_dwordx4 v[180:183], v2, s[8:11], s48 offen offset:16
    s_mov_b64 exec, s[44:45]
    buffer_load_dwordx4 v[184:187], v2, s[8:11], s48 offen offset:2048
    buffer_load_dwordx4 v[188:191], v2, s[8:11], s48 offen offset:2064
    s_mov_b64 exec, -1
    s_add_u32 s48, s48, 294912

    buffer_load_dwordx4 v[192:195], v2, s[8:11], s48 offen
    buffer_load_dwordx4 v[196:199], v2, s[8:11], s48 offen offset:16
    s_mov_b64 exec, s[44:45]
    buffer_load_dwordx4 v[200:203], v2, s[8:11], s48 offen offset:2048
    buffer_load_dwordx4 v[204:207], v2, s[8:11], s48 offen offset:2064
    s_mov_b64 exec, -1
    s_add_u32 s48, s48, 294912

    buffer_load_dwordx4 v[208:211], v2, s[8:11], s48 offen
    buffer_load_dwordx4 v[212:215], v2, s[8:11], s48 offen offset:16
    s_mov_b64 exec, s[44:45]
    buffer_load_dwordx4 v[216:219], v2, s[8:11], s48 offen offset:2048
    buffer_load_dwordx4 v[220:223], v2, s[8:11], s48 offen offset:2064
    s_mov_b64 exec, -1
    s_add_u32 s48, s48, 294912

    v_mov_b32 v8, 0
    v_mov_b32 v9, 0
    v_mov_b32 v10, 0
    v_mov_b32 v11, 0
    buffer_load_dwordx4 v[4:7], v3, s[12:15], s49 offen
    s_mov_b64 exec, s[44:45]
    buffer_load_dwordx4 v[8:11], v3, s[12:15], s49 offen offset:1024
    s_mov_b64 exec, -1
    s_waitcnt vmcnt(0)

    v_add_f32 v96, v96, v112
    v_add_f32 v97, v97, v113
    v_add_f32 v98, v98, v114
    v_add_f32 v99, v99, v115
    v_add_f32 v100, v100, v116
    v_add_f32 v101, v101, v117
    v_add_f32 v102, v102, v118
    v_add_f32 v103, v103, v119
    v_add_f32 v104, v104, v120
    v_add_f32 v105, v105, v121
    v_add_f32 v106, v106, v122
    v_add_f32 v107, v107, v123
    v_add_f32 v108, v108, v124
    v_add_f32 v109, v109, v125
    v_add_f32 v110, v110, v126
    v_add_f32 v111, v111, v127
    v_add_f32 v96, v96, v128
    v_add_f32 v97, v97, v129
    v_add_f32 v98, v98, v130
    v_add_f32 v99, v99, v131
    v_add_f32 v100, v100, v132
    v_add_f32 v101, v101, v133
    v_add_f32 v102, v102, v134
    v_add_f32 v103, v103, v135
    v_add_f32 v104, v104, v136
    v_add_f32 v105, v105, v137
    v_add_f32 v106, v106, v138
    v_add_f32 v107, v107, v139
    v_add_f32 v108, v108, v140
    v_add_f32 v109, v109, v141
    v_add_f32 v110, v110, v142
    v_add_f32 v111, v111, v143
    v_add_f32 v96, v96, v144
    v_add_f32 v97, v97, v145
    v_add_f32 v98, v98, v146
    v_add_f32 v99, v99, v147
    v_add_f32 v100, v100, v148
    v_add_f32 v101, v101, v149
    v_add_f32 v102, v102, v150
    v_add_f32 v103, v103, v151
    v_add_f32 v104, v104, v152
    v_add_f32 v105, v105, v153
    v_add_f32 v106, v106, v154
    v_add_f32 v107, v107, v155
    v_add_f32 v108, v108, v156
    v_add_f32 v109, v109, v157
    v_add_f32 v110, v110, v158
    v_add_f32 v111, v111, v159
    v_add_f32 v96, v96, v160
    v_add_f32 v97, v97, v161
    v_add_f32 v98, v98, v162
    v_add_f32 v99, v99, v163
    v_add_f32 v100, v100, v164
    v_add_f32 v101, v101, v165
    v_add_f32 v102, v102, v166
    v_add_f32 v103, v103, v167
    v_add_f32 v104, v104, v168
    v_add_f32 v105, v105, v169
    v_add_f32 v106, v106, v170
    v_add_f32 v107, v107, v171
    v_add_f32 v108, v108, v172
    v_add_f32 v109, v109, v173
    v_add_f32 v110, v110, v174
    v_add_f32 v111, v111, v175
    v_add_f32 v96, v96, v176
    v_add_f32 v97, v97, v177
    v_add_f32 v98, v98, v178
    v_add_f32 v99, v99, v179
    v_add_f32 v100, v100, v180
    v_add_f32 v101, v101, v181
    v_add_f32 v102, v102, v182
    v_add_f32 v103, v103, v183
    v_add_f32 v104, v104, v184
    v_add_f32 v105, v105, v185
    v_add_f32 v106, v106, v186
    v_add_f32 v107, v107, v187
    v_add_f32 v108, v108, v188
    v_add_f32 v109, v109, v189
    v_add_f32 v110, v110, v190
    v_add_f32 v111, v111, v191
    v_add_f32 v96, v96, v192
    v_add_f32 v97, v97, v193
    v_add_f32 v98, v98, v194
    v_add_f32 v99, v99, v195
    v_add_f32 v100, v100, v196
    v_add_f32 v101, v101, v197
    v_add_f32 v102, v102, v198
    v_add_f32 v103, v103, v199
    v_add_f32 v104, v104, v200
    v_add_f32 v105, v105, v201
    v_add_f32 v106, v106, v202
    v_add_f32 v107, v107, v203
    v_add_f32 v108, v108, v204
    v_add_f32 v109, v109, v205
    v_add_f32 v110, v110, v206
    v_add_f32 v111, v111, v207
    v_add_f32 v96, v96, v208
    v_add_f32 v97, v97, v209
    v_add_f32 v98, v98, v210
    v_add_f32 v99, v99, v211
    v_add_f32 v100, v100, v212
    v_add_f32 v101, v101, v213
    v_add_f32 v102, v102, v214
    v_add_f32 v103, v103, v215
    v_add_f32 v104, v104, v216
    v_add_f32 v105, v105, v217
    v_add_f32 v106, v106, v218
    v_add_f32 v107, v107, v219
    v_add_f32 v108, v108, v220
    v_add_f32 v109, v109, v221
    v_add_f32 v110, v110, v222
    v_add_f32 v111, v111, v223
    v_cvt_pk_bf16_f32 v33, v96, v97
    v_lshlrev_b32 v96, 16, v33
    v_and_b32 v97, 0xffff0000, v33

    v_mul_f32 v96, v96, v72
    v_mul_f32 v97, v97, v73

    v_cvt_pk_bf16_f32 v33, v96, v97
    v_lshlrev_b32 v96, 16, v33
    v_and_b32 v97, 0xffff0000, v33

    v_lshlrev_b32 v16, 16, v4
    v_and_b32 v17, 0xffff0000, v4
    v_add_f32 v16, v16, v96
    v_add_f32 v17, v17, v97
    v_cvt_pk_bf16_f32 v4, v16, v17
    v_lshlrev_b32 v16, 16, v4
    v_and_b32 v17, 0xffff0000, v4

    v_cvt_pk_bf16_f32 v33, v98, v99
    v_lshlrev_b32 v98, 16, v33
    v_and_b32 v99, 0xffff0000, v33

    v_mul_f32 v98, v98, v74
    v_mul_f32 v99, v99, v75

    v_cvt_pk_bf16_f32 v33, v98, v99
    v_lshlrev_b32 v98, 16, v33
    v_and_b32 v99, 0xffff0000, v33

    v_lshlrev_b32 v18, 16, v5
    v_and_b32 v19, 0xffff0000, v5
    v_add_f32 v18, v18, v98
    v_add_f32 v19, v19, v99
    v_cvt_pk_bf16_f32 v5, v18, v19
    v_lshlrev_b32 v18, 16, v5
    v_and_b32 v19, 0xffff0000, v5

    v_cvt_pk_bf16_f32 v33, v100, v101
    v_lshlrev_b32 v100, 16, v33
    v_and_b32 v101, 0xffff0000, v33

    v_mul_f32 v100, v100, v76
    v_mul_f32 v101, v101, v77

    v_cvt_pk_bf16_f32 v33, v100, v101
    v_lshlrev_b32 v100, 16, v33
    v_and_b32 v101, 0xffff0000, v33

    v_lshlrev_b32 v20, 16, v6
    v_and_b32 v21, 0xffff0000, v6
    v_add_f32 v20, v20, v100
    v_add_f32 v21, v21, v101
    v_cvt_pk_bf16_f32 v6, v20, v21
    v_lshlrev_b32 v20, 16, v6
    v_and_b32 v21, 0xffff0000, v6

    v_cvt_pk_bf16_f32 v33, v102, v103
    v_lshlrev_b32 v102, 16, v33
    v_and_b32 v103, 0xffff0000, v33

    v_mul_f32 v102, v102, v78
    v_mul_f32 v103, v103, v79

    v_cvt_pk_bf16_f32 v33, v102, v103
    v_lshlrev_b32 v102, 16, v33
    v_and_b32 v103, 0xffff0000, v33

    v_lshlrev_b32 v22, 16, v7
    v_and_b32 v23, 0xffff0000, v7
    v_add_f32 v22, v22, v102
    v_add_f32 v23, v23, v103
    v_cvt_pk_bf16_f32 v7, v22, v23
    v_lshlrev_b32 v22, 16, v7
    v_and_b32 v23, 0xffff0000, v7

    v_cvt_pk_bf16_f32 v33, v104, v105
    v_lshlrev_b32 v104, 16, v33
    v_and_b32 v105, 0xffff0000, v33

    v_mul_f32 v104, v104, v80
    v_mul_f32 v105, v105, v81

    v_cvt_pk_bf16_f32 v33, v104, v105
    v_lshlrev_b32 v104, 16, v33
    v_and_b32 v105, 0xffff0000, v33

    v_lshlrev_b32 v24, 16, v8
    v_and_b32 v25, 0xffff0000, v8
    v_add_f32 v24, v24, v104
    v_add_f32 v25, v25, v105
    v_cvt_pk_bf16_f32 v8, v24, v25
    v_lshlrev_b32 v24, 16, v8
    v_and_b32 v25, 0xffff0000, v8

    v_cvt_pk_bf16_f32 v33, v106, v107
    v_lshlrev_b32 v106, 16, v33
    v_and_b32 v107, 0xffff0000, v33

    v_mul_f32 v106, v106, v82
    v_mul_f32 v107, v107, v83

    v_cvt_pk_bf16_f32 v33, v106, v107
    v_lshlrev_b32 v106, 16, v33
    v_and_b32 v107, 0xffff0000, v33

    v_lshlrev_b32 v26, 16, v9
    v_and_b32 v27, 0xffff0000, v9
    v_add_f32 v26, v26, v106
    v_add_f32 v27, v27, v107
    v_cvt_pk_bf16_f32 v9, v26, v27
    v_lshlrev_b32 v26, 16, v9
    v_and_b32 v27, 0xffff0000, v9

    v_cvt_pk_bf16_f32 v33, v108, v109
    v_lshlrev_b32 v108, 16, v33
    v_and_b32 v109, 0xffff0000, v33

    v_mul_f32 v108, v108, v84
    v_mul_f32 v109, v109, v85

    v_cvt_pk_bf16_f32 v33, v108, v109
    v_lshlrev_b32 v108, 16, v33
    v_and_b32 v109, 0xffff0000, v33

    v_lshlrev_b32 v28, 16, v10
    v_and_b32 v29, 0xffff0000, v10
    v_add_f32 v28, v28, v108
    v_add_f32 v29, v29, v109
    v_cvt_pk_bf16_f32 v10, v28, v29
    v_lshlrev_b32 v28, 16, v10
    v_and_b32 v29, 0xffff0000, v10

    v_cvt_pk_bf16_f32 v33, v110, v111
    v_lshlrev_b32 v110, 16, v33
    v_and_b32 v111, 0xffff0000, v33

    v_mul_f32 v110, v110, v86
    v_mul_f32 v111, v111, v87

    v_cvt_pk_bf16_f32 v33, v110, v111
    v_lshlrev_b32 v110, 16, v33
    v_and_b32 v111, 0xffff0000, v33

    v_lshlrev_b32 v30, 16, v11
    v_and_b32 v31, 0xffff0000, v11
    v_add_f32 v30, v30, v110
    v_add_f32 v31, v31, v111
    v_cvt_pk_bf16_f32 v11, v30, v31
    v_lshlrev_b32 v30, 16, v11
    v_and_b32 v31, 0xffff0000, v11

    buffer_store_dwordx4 v[4:7], v3, s[24:27], s49 offen sc1
    s_mov_b64 exec, s[44:45]
    buffer_store_dwordx4 v[8:11], v3, s[24:27], s49 offen offset:1024 sc1
    s_mov_b64 exec, -1

    s_not_b64 exec, s[44:45]
    v_mov_b32 v24, 0
    v_mov_b32 v25, 0
    v_mov_b32 v26, 0
    v_mov_b32 v27, 0
    v_mov_b32 v28, 0
    v_mov_b32 v29, 0
    v_mov_b32 v30, 0
    v_mov_b32 v31, 0
    s_mov_b64 exec, -1
    v_add_f32 v32, v16, v17
    v_add_f32 v32, v32, v18
    v_add_f32 v32, v32, v19
    v_add_f32 v32, v32, v20
    v_add_f32 v32, v32, v21
    v_add_f32 v32, v32, v22
    v_add_f32 v32, v32, v23
    v_add_f32 v32, v32, v24
    v_add_f32 v32, v32, v25
    v_add_f32 v32, v32, v26
    v_add_f32 v32, v32, v27
    v_add_f32 v32, v32, v28
    v_add_f32 v32, v32, v29
    v_add_f32 v32, v32, v30
    v_add_f32 v32, v32, v31
    ds_swizzle_b32 v33, v32 offset:1055
    s_waitcnt lgkmcnt(0)
    v_add_f32 v32, v32, v33

    ds_swizzle_b32 v33, v32 offset:2079
    s_waitcnt lgkmcnt(0)
    v_add_f32 v32, v32, v33

    ds_swizzle_b32 v33, v32 offset:4127
    s_waitcnt lgkmcnt(0)
    v_add_f32 v32, v32, v33

    ds_swizzle_b32 v33, v32 offset:8223
    s_waitcnt lgkmcnt(0)
    v_add_f32 v32, v32, v33

    ds_swizzle_b32 v33, v32 offset:16415
    s_waitcnt lgkmcnt(0)
    v_add_f32 v32, v32, v33

    s_nop 1
    v_readlane_b32 s26, v32, 32
    s_nop 3
    v_add_f32 v32, s26, v32
    s_nop 1
    v_readlane_b32 s26, v32, 0
    s_nop 3

    v_mov_b32 v33, 0x3ae38e39
    v_mul_f32 v34, s26, v33
    v_mov_b32 v32, 0

    v_sub_f32 v33, v16, v34
    v_fmac_f32 v32, v33, v33

    v_sub_f32 v33, v17, v34
    v_fmac_f32 v32, v33, v33

    v_sub_f32 v33, v18, v34
    v_fmac_f32 v32, v33, v33

    v_sub_f32 v33, v19, v34
    v_fmac_f32 v32, v33, v33

    v_sub_f32 v33, v20, v34
    v_fmac_f32 v32, v33, v33

    v_sub_f32 v33, v21, v34
    v_fmac_f32 v32, v33, v33

    v_sub_f32 v33, v22, v34
    v_fmac_f32 v32, v33, v33

    v_sub_f32 v33, v23, v34
    v_fmac_f32 v32, v33, v33

    s_mov_b64 exec, s[44:45]
    v_sub_f32 v33, v24, v34
    v_fmac_f32 v32, v33, v33

    v_sub_f32 v33, v25, v34
    v_fmac_f32 v32, v33, v33

    v_sub_f32 v33, v26, v34
    v_fmac_f32 v32, v33, v33

    v_sub_f32 v33, v27, v34
    v_fmac_f32 v32, v33, v33

    v_sub_f32 v33, v28, v34
    v_fmac_f32 v32, v33, v33

    v_sub_f32 v33, v29, v34
    v_fmac_f32 v32, v33, v33

    v_sub_f32 v33, v30, v34
    v_fmac_f32 v32, v33, v33

    v_sub_f32 v33, v31, v34
    v_fmac_f32 v32, v33, v33

    s_mov_b64 exec, -1
    ds_swizzle_b32 v33, v32 offset:1055
    s_waitcnt lgkmcnt(0)
    v_add_f32 v32, v32, v33

    ds_swizzle_b32 v33, v32 offset:2079
    s_waitcnt lgkmcnt(0)
    v_add_f32 v32, v32, v33

    ds_swizzle_b32 v33, v32 offset:4127
    s_waitcnt lgkmcnt(0)
    v_add_f32 v32, v32, v33

    ds_swizzle_b32 v33, v32 offset:8223
    s_waitcnt lgkmcnt(0)
    v_add_f32 v32, v32, v33

    ds_swizzle_b32 v33, v32 offset:16415
    s_waitcnt lgkmcnt(0)
    v_add_f32 v32, v32, v33

    s_nop 1
    v_readlane_b32 s26, v32, 32
    s_nop 3
    v_add_f32 v32, s26, v32
    s_nop 1
    v_readlane_b32 s26, v32, 0
    s_nop 3

    v_mov_b32 v33, 0x3ae38e39
    v_mul_f32 v35, s26, v33

    v_cvt_pk_bf16_f32 v33, v34, v35
    v_lshlrev_b32 v34, 16, v33
    v_and_b32 v35, 0xffff0000, v33

    v_add_f32 v35, 0x3727c5ac, v35
    v_cvt_pk_bf16_f32 v33, v35, v35
    v_lshlrev_b32 v35, 16, v33

    v_sqrt_f32 v35, v35
    s_nop 0
    v_cvt_pk_bf16_f32 v33, v35, v35
    v_lshlrev_b32 v35, 16, v33

    v_rcp_f32 v35, v35
    s_nop 0
    v_sub_f32 v16, v16, v34
    v_sub_f32 v17, v17, v34

    v_cvt_pk_bf16_f32 v33, v16, v17
    v_lshlrev_b32 v16, 16, v33
    v_and_b32 v17, 0xffff0000, v33

    v_mul_f32 v16, v16, v35
    v_mul_f32 v17, v17, v35

    v_cvt_pk_bf16_f32 v33, v16, v17
    v_lshlrev_b32 v16, 16, v33
    v_and_b32 v17, 0xffff0000, v33

    v_mul_f32 v16, v16, v40
    v_mul_f32 v17, v17, v41

    v_cvt_pk_bf16_f32 v33, v16, v17
    v_lshlrev_b32 v16, 16, v33
    v_and_b32 v17, 0xffff0000, v33

    v_add_f32 v16, v16, v48
    v_add_f32 v17, v17, v49
    v_cvt_pk_bf16_f32 v88, v16, v17

    v_sub_f32 v18, v18, v34
    v_sub_f32 v19, v19, v34

    v_cvt_pk_bf16_f32 v33, v18, v19
    v_lshlrev_b32 v18, 16, v33
    v_and_b32 v19, 0xffff0000, v33

    v_mul_f32 v18, v18, v35
    v_mul_f32 v19, v19, v35

    v_cvt_pk_bf16_f32 v33, v18, v19
    v_lshlrev_b32 v18, 16, v33
    v_and_b32 v19, 0xffff0000, v33

    v_mul_f32 v18, v18, v42
    v_mul_f32 v19, v19, v43

    v_cvt_pk_bf16_f32 v33, v18, v19
    v_lshlrev_b32 v18, 16, v33
    v_and_b32 v19, 0xffff0000, v33

    v_add_f32 v18, v18, v50
    v_add_f32 v19, v19, v51
    v_cvt_pk_bf16_f32 v89, v18, v19

    v_sub_f32 v20, v20, v34
    v_sub_f32 v21, v21, v34

    v_cvt_pk_bf16_f32 v33, v20, v21
    v_lshlrev_b32 v20, 16, v33
    v_and_b32 v21, 0xffff0000, v33

    v_mul_f32 v20, v20, v35
    v_mul_f32 v21, v21, v35

    v_cvt_pk_bf16_f32 v33, v20, v21
    v_lshlrev_b32 v20, 16, v33
    v_and_b32 v21, 0xffff0000, v33

    v_mul_f32 v20, v20, v44
    v_mul_f32 v21, v21, v45

    v_cvt_pk_bf16_f32 v33, v20, v21
    v_lshlrev_b32 v20, 16, v33
    v_and_b32 v21, 0xffff0000, v33

    v_add_f32 v20, v20, v52
    v_add_f32 v21, v21, v53
    v_cvt_pk_bf16_f32 v90, v20, v21

    v_sub_f32 v22, v22, v34
    v_sub_f32 v23, v23, v34

    v_cvt_pk_bf16_f32 v33, v22, v23
    v_lshlrev_b32 v22, 16, v33
    v_and_b32 v23, 0xffff0000, v33

    v_mul_f32 v22, v22, v35
    v_mul_f32 v23, v23, v35

    v_cvt_pk_bf16_f32 v33, v22, v23
    v_lshlrev_b32 v22, 16, v33
    v_and_b32 v23, 0xffff0000, v33

    v_mul_f32 v22, v22, v46
    v_mul_f32 v23, v23, v47

    v_cvt_pk_bf16_f32 v33, v22, v23
    v_lshlrev_b32 v22, 16, v33
    v_and_b32 v23, 0xffff0000, v33

    v_add_f32 v22, v22, v54
    v_add_f32 v23, v23, v55
    v_cvt_pk_bf16_f32 v91, v22, v23

    v_sub_f32 v24, v24, v34
    v_sub_f32 v25, v25, v34

    v_cvt_pk_bf16_f32 v33, v24, v25
    v_lshlrev_b32 v24, 16, v33
    v_and_b32 v25, 0xffff0000, v33

    v_mul_f32 v24, v24, v35
    v_mul_f32 v25, v25, v35

    v_cvt_pk_bf16_f32 v33, v24, v25
    v_lshlrev_b32 v24, 16, v33
    v_and_b32 v25, 0xffff0000, v33

    v_mul_f32 v24, v24, v56
    v_mul_f32 v25, v25, v57

    v_cvt_pk_bf16_f32 v33, v24, v25
    v_lshlrev_b32 v24, 16, v33
    v_and_b32 v25, 0xffff0000, v33

    v_add_f32 v24, v24, v64
    v_add_f32 v25, v25, v65
    v_cvt_pk_bf16_f32 v92, v24, v25

    v_sub_f32 v26, v26, v34
    v_sub_f32 v27, v27, v34

    v_cvt_pk_bf16_f32 v33, v26, v27
    v_lshlrev_b32 v26, 16, v33
    v_and_b32 v27, 0xffff0000, v33

    v_mul_f32 v26, v26, v35
    v_mul_f32 v27, v27, v35

    v_cvt_pk_bf16_f32 v33, v26, v27
    v_lshlrev_b32 v26, 16, v33
    v_and_b32 v27, 0xffff0000, v33

    v_mul_f32 v26, v26, v58
    v_mul_f32 v27, v27, v59

    v_cvt_pk_bf16_f32 v33, v26, v27
    v_lshlrev_b32 v26, 16, v33
    v_and_b32 v27, 0xffff0000, v33

    v_add_f32 v26, v26, v66
    v_add_f32 v27, v27, v67
    v_cvt_pk_bf16_f32 v93, v26, v27

    v_sub_f32 v28, v28, v34
    v_sub_f32 v29, v29, v34

    v_cvt_pk_bf16_f32 v33, v28, v29
    v_lshlrev_b32 v28, 16, v33
    v_and_b32 v29, 0xffff0000, v33

    v_mul_f32 v28, v28, v35
    v_mul_f32 v29, v29, v35

    v_cvt_pk_bf16_f32 v33, v28, v29
    v_lshlrev_b32 v28, 16, v33
    v_and_b32 v29, 0xffff0000, v33

    v_mul_f32 v28, v28, v60
    v_mul_f32 v29, v29, v61

    v_cvt_pk_bf16_f32 v33, v28, v29
    v_lshlrev_b32 v28, 16, v33
    v_and_b32 v29, 0xffff0000, v33

    v_add_f32 v28, v28, v68
    v_add_f32 v29, v29, v69
    v_cvt_pk_bf16_f32 v94, v28, v29

    v_sub_f32 v30, v30, v34
    v_sub_f32 v31, v31, v34

    v_cvt_pk_bf16_f32 v33, v30, v31
    v_lshlrev_b32 v30, 16, v33
    v_and_b32 v31, 0xffff0000, v33

    v_mul_f32 v30, v30, v35
    v_mul_f32 v31, v31, v35

    v_cvt_pk_bf16_f32 v33, v30, v31
    v_lshlrev_b32 v30, 16, v33
    v_and_b32 v31, 0xffff0000, v33

    v_mul_f32 v30, v30, v62
    v_mul_f32 v31, v31, v63

    v_cvt_pk_bf16_f32 v33, v30, v31
    v_lshlrev_b32 v30, 16, v33
    v_and_b32 v31, 0xffff0000, v33

    v_add_f32 v30, v30, v70
    v_add_f32 v31, v31, v71
    v_cvt_pk_bf16_f32 v95, v30, v31

    buffer_store_dwordx4 v[88:91], v3, s[28:31], s49 offen sc1
    s_mov_b64 exec, s[44:45]
    buffer_store_dwordx4 v[92:95], v3, s[28:31], s49 offen offset:1024 sc1
    s_mov_b64 exec, -1
    s_nop 1

    s_lshl_b32 s72, s65, 6
    v_accvgpr_read_b32 v168, a0
    s_nop 0
    v_and_b32 v169, 63, v168

    s_waitcnt vmcnt(0)
    s_barrier
    v_cmp_eq_u32 vcc, 0, v168
    s_and_saveexec_b64 s[76:77], vcc
    s_cbranch_execz L_sig_82
    v_mov_b32 v140, 14336
    v_mov_b32 v141, 1

    buffer_atomic_add v141, v140, s[68:71], s72 offen
L_sig_82:
    s_mov_b64 exec, s[76:77]
    s_add_u32 s65, s65, 1
    s_cmp_lt_u32 s65, 16
    s_cbranch_scc1 L_rloop_79
    s_branch L_end_1

L_rskip_78:
    s_sub_u32 s66, s64, 88
    s_cmp_ge_u32 s66, 72
    s_cbranch_scc1 L_rskip_83
    s_mov_b32 s65, 0

L_rloop_84:
    v_accvgpr_read_b32 v168, a0
    s_nop 0
    v_and_b32 v169, 63, v168

    s_load_dwordx4 s[44:47], s[80:81], 64
    s_lshl_b32 s30, s65, 7
    s_mov_b32 s32, s66
    v_lshrrev_b32 v1, 7, v168
    s_nop 0
    v_readfirstlane_b32 s33, v1
    s_waitcnt lgkmcnt(0)
    s_cmp_eq_u32 s33, 1
    s_cselect_b32 s6, s46, s44
    s_cselect_b32 s7, s47, s45

    s_add_u32 s8, s4, 88080384
    s_addc_u32 s9, s5, 0
    s_and_b32 s9, s9, 0xffff
    s_mov_b32 s10, 2359296
    s_mov_b32 s11, 0x00020000

    s_mov_b32 s12, s6
    s_and_b32 s13, s7, 0xffff
    s_mov_b32 s14, 5308416
    s_mov_b32 s15, 0x00020000

    s_mul_i32 s35, s30, 1152
    s_lshl_b32 s36, s32, 7

    s_add_u32 s20, s35, 0
    s_add_u32 s24, s36, 0
    s_add_u32 s21, s35, 36864
    s_add_u32 s25, s36, 147456
    s_add_u32 s22, s35, 73728
    s_add_u32 s26, s36, 294912
    s_add_u32 s23, s35, 110592
    s_add_u32 s27, s36, 442368
    v_mov_b32 v0, v168
    v_mov_b32 v168, v0
    v_and_b32 v169, 63, v0
    v_lshrrev_b32 v140, 3, v0
    v_and_b32 v141, 7, v0
    s_mov_b32 s40, 1152
    v_mul_lo_u32 v128, v140, s40
    v_lshl_add_u32 v128, v141, 4, v128
    v_lshrrev_b32 v142, 4, v0
    v_and_b32 v142, 7, v142
    v_xor_b32 v142, v142, v141
    v_lshlrev_b32 v142, 4, v142
    v_lshl_add_u32 v130, v140, 7, v142

    v_and_b32 v143, 127, v0
    v_lshrrev_b32 v140, 3, v143
    v_and_b32 v141, 7, v0
    s_mov_b32 s40, 9216
    v_mul_lo_u32 v129, v140, s40
    v_lshl_add_u32 v129, v141, 4, v129
    v_lshrrev_b32 v142, 2, v141
    v_lshlrev_b32 v142, 3, v142
    v_and_b32 v141, 3, v141
    v_add_u32 v141, v141, v142
    v_lshrrev_b32 v142, 7, v0
    v_lshl_add_u32 v141, v142, 2, v141

    v_lshrrev_b32 v142, 2, v141
    v_and_b32 v143, 3, v140
    v_xor_b32 v142, v142, v143
    v_lshlrev_b32 v142, 6, v142
    v_and_b32 v143, 3, v141
    v_lshl_add_u32 v142, v143, 4, v142
    v_lshl_add_u32 v131, v140, 8, v142
    v_add_u32 v131, 16384, v131
    v_lshrrev_b32 v140, 7, v0
    v_and_b32 v141, 31, v0
    v_lshl_add_u32 v140, v140, 6, v141
    v_lshrrev_b32 v141, 1, v140
    v_and_b32 v141, 7, v141
    v_lshrrev_b32 v142, 5, v169

    v_add_u32 v143, 0, v142
    v_xor_b32 v143, v143, v141
    v_lshlrev_b32 v143, 4, v143
    v_lshl_add_u32 v132, v140, 7, v143

    v_add_u32 v143, 2, v142
    v_xor_b32 v143, v143, v141
    v_lshlrev_b32 v143, 4, v143
    v_lshl_add_u32 v133, v140, 7, v143

    v_add_u32 v143, 4, v142
    v_xor_b32 v143, v143, v141
    v_lshlrev_b32 v143, 4, v143
    v_lshl_add_u32 v134, v140, 7, v143

    v_add_u32 v143, 6, v142
    v_xor_b32 v143, v143, v141
    v_lshlrev_b32 v143, 4, v143
    v_lshl_add_u32 v135, v140, 7, v143

    v_lshrrev_b32 v140, 4, v169
    v_and_b32 v141, 15, v169
    v_lshrrev_b32 v142, 1, v140
    v_lshlrev_b32 v142, 3, v142
    v_lshrrev_b32 v143, 2, v141
    v_add_u32 v142, v142, v143
    v_and_b32 v140, 1, v140
    v_lshlrev_b32 v140, 5, v140
    v_and_b32 v141, 3, v141
    v_lshl_add_u32 v140, v141, 3, v140
    v_lshl_add_u32 v140, v142, 8, v140
    v_add_u32 v140, 16384, v140
    v_lshrrev_b32 v141, 6, v0
    v_and_b32 v141, 1, v141
    v_lshlrev_b32 v141, 1, v141

    v_add_u32 v142, 0, v141
    v_xor_b32 v142, v142, v143
    v_lshl_add_u32 v136, v142, 6, v140

    v_add_u32 v142, 1, v141
    v_xor_b32 v142, v142, v143
    v_lshl_add_u32 v137, v142, 6, v140

    v_mov_b32 v0, 0
    v_mov_b32 v1, 0
    v_mov_b32 v2, 0
    v_mov_b32 v3, 0
    v_mov_b32 v4, 0
    v_mov_b32 v5, 0
    v_mov_b32 v6, 0
    v_mov_b32 v7, 0
    v_mov_b32 v8, 0
    v_mov_b32 v9, 0
    v_mov_b32 v10, 0
    v_mov_b32 v11, 0
    v_mov_b32 v12, 0
    v_mov_b32 v13, 0
    v_mov_b32 v14, 0
    v_mov_b32 v15, 0
    v_mov_b32 v16, 0
    v_mov_b32 v17, 0
    v_mov_b32 v18, 0
    v_mov_b32 v19, 0
    v_mov_b32 v20, 0
    v_mov_b32 v21, 0
    v_mov_b32 v22, 0
    v_mov_b32 v23, 0
    v_mov_b32 v24, 0
    v_mov_b32 v25, 0
    v_mov_b32 v26, 0
    v_mov_b32 v27, 0
    v_mov_b32 v28, 0
    v_mov_b32 v29, 0
    v_mov_b32 v30, 0
    v_mov_b32 v31, 0
    v_mov_b32 v32, 0
    v_mov_b32 v33, 0
    v_mov_b32 v34, 0
    v_mov_b32 v35, 0
    v_mov_b32 v36, 0
    v_mov_b32 v37, 0
    v_mov_b32 v38, 0
    v_mov_b32 v39, 0
    v_mov_b32 v40, 0
    v_mov_b32 v41, 0
    v_mov_b32 v42, 0
    v_mov_b32 v43, 0
    v_mov_b32 v44, 0
    v_mov_b32 v45, 0
    v_mov_b32 v46, 0
    v_mov_b32 v47, 0
    v_mov_b32 v48, 0
    v_mov_b32 v49, 0
    v_mov_b32 v50, 0
    v_mov_b32 v51, 0
    v_mov_b32 v52, 0
    v_mov_b32 v53, 0
    v_mov_b32 v54, 0
    v_mov_b32 v55, 0
    v_mov_b32 v56, 0
    v_mov_b32 v57, 0
    v_mov_b32 v58, 0
    v_mov_b32 v59, 0
    v_mov_b32 v60, 0
    v_mov_b32 v61, 0
    v_mov_b32 v62, 0
    v_mov_b32 v63, 0
    s_lshl_b32 s72, s65, 6
    v_accvgpr_read_b32 v168, a0
    s_nop 0
    v_and_b32 v169, 63, v168

    v_lshrrev_b32 v140, 6, v168
    s_nop 0
    v_readfirstlane_b32 s78, v140
    s_cmp_lg_u32 s78, 0
    s_cbranch_scc1 L_wpollx_86
    v_mov_b32 v140, 14336
    s_mov_b32 s79, 0

L_wpoll_85:
    buffer_load_dword v141, v140, s[68:71], s72 offen sc1
    s_add_u32 s79, s79, 1
    s_waitcnt vmcnt(0)
    v_readfirstlane_b32 s78, v141
    s_cmp_ge_u32 s78, 16
    s_cbranch_scc1 L_wpollx_86
    s_cmp_gt_u32 s79, 200000
    s_cbranch_scc1 L_wpollx_86
    s_sleep 24
    s_branch L_wpoll_85

L_wpollx_86:
    s_barrier
    buffer_load_dwordx4 v[96:99], v128, s[8:11], s20 offen
    buffer_load_dwordx4 v[100:103], v128, s[8:11], s21 offen
    buffer_load_dwordx4 v[104:107], v128, s[8:11], s22 offen
    buffer_load_dwordx4 v[108:111], v128, s[8:11], s23 offen
    buffer_load_dwordx4 v[112:115], v129, s[12:15], s24 offen
    buffer_load_dwordx4 v[116:119], v129, s[12:15], s25 offen
    buffer_load_dwordx4 v[120:123], v129, s[12:15], s26 offen
    buffer_load_dwordx4 v[124:127], v129, s[12:15], s27 offen
    s_add_u32 s20, s20, 128
    s_add_u32 s21, s21, 128
    s_add_u32 s22, s22, 128
    s_add_u32 s23, s23, 128
    s_add_u32 s24, s24, 589824
    s_add_u32 s25, s25, 589824
    s_add_u32 s26, s26, 589824
    s_add_u32 s27, s27, 589824
    buffer_load_dwordx4 v[176:179], v128, s[8:11], s20 offen
    buffer_load_dwordx4 v[180:183], v128, s[8:11], s21 offen
    buffer_load_dwordx4 v[184:187], v128, s[8:11], s22 offen
    buffer_load_dwordx4 v[188:191], v128, s[8:11], s23 offen
    buffer_load_dwordx4 v[192:195], v129, s[12:15], s24 offen
    buffer_load_dwordx4 v[196:199], v129, s[12:15], s25 offen
    buffer_load_dwordx4 v[200:203], v129, s[12:15], s26 offen
    buffer_load_dwordx4 v[204:207], v129, s[12:15], s27 offen
    s_add_u32 s20, s20, 128
    s_add_u32 s21, s21, 128
    s_add_u32 s22, s22, 128
    s_add_u32 s23, s23, 128
    s_add_u32 s24, s24, 589824
    s_add_u32 s25, s25, 589824
    s_add_u32 s26, s26, 589824
    s_add_u32 s27, s27, 589824
    buffer_load_dwordx4 v[208:211], v128, s[8:11], s20 offen
    buffer_load_dwordx4 v[212:215], v128, s[8:11], s21 offen
    buffer_load_dwordx4 v[216:219], v128, s[8:11], s22 offen
    buffer_load_dwordx4 v[220:223], v128, s[8:11], s23 offen
    buffer_load_dwordx4 v[224:227], v129, s[12:15], s24 offen
    buffer_load_dwordx4 v[228:231], v129, s[12:15], s25 offen
    buffer_load_dwordx4 v[232:235], v129, s[12:15], s26 offen
    buffer_load_dwordx4 v[236:239], v129, s[12:15], s27 offen
    s_add_u32 s20, s20, 128
    s_add_u32 s21, s21, 128
    s_add_u32 s22, s22, 128
    s_add_u32 s23, s23, 128
    s_add_u32 s24, s24, 589824
    s_add_u32 s25, s25, 589824
    s_add_u32 s26, s26, 589824
    s_add_u32 s27, s27, 589824
    s_waitcnt vmcnt(20)
    ds_write_b128 v130, v[96:99] offset:0
    ds_write_b128 v130, v[100:103] offset:4096
    ds_write_b128 v130, v[104:107] offset:8192
    ds_write_b128 v130, v[108:111] offset:12288
    s_waitcnt vmcnt(16)
    ds_write_b128 v131, v[112:115] offset:0
    ds_write_b128 v131, v[116:119] offset:4096
    ds_write_b128 v131, v[120:123] offset:8192
    ds_write_b128 v131, v[124:127] offset:12288
    s_waitcnt lgkmcnt(0)
    s_barrier
    buffer_load_dwordx4 v[96:99], v128, s[8:11], s20 offen
    buffer_load_dwordx4 v[100:103], v128, s[8:11], s21 offen
    buffer_load_dwordx4 v[104:107], v128, s[8:11], s22 offen
    buffer_load_dwordx4 v[108:111], v128, s[8:11], s23 offen
    buffer_load_dwordx4 v[112:115], v129, s[12:15], s24 offen
    buffer_load_dwordx4 v[116:119], v129, s[12:15], s25 offen
    buffer_load_dwordx4 v[120:123], v129, s[12:15], s26 offen
    buffer_load_dwordx4 v[124:127], v129, s[12:15], s27 offen
    s_add_u32 s20, s20, 128
    s_add_u32 s21, s21, 128
    s_add_u32 s22, s22, 128
    s_add_u32 s23, s23, 128
    s_add_u32 s24, s24, 589824
    s_add_u32 s25, s25, 589824
    s_add_u32 s26, s26, 589824
    s_add_u32 s27, s27, 589824
    ds_read_b128 v[64:67], v132 offset:0
    ds_read_b128 v[68:71], v132 offset:4096
    ds_read_b64_tr_b16 v[72:73], v136 offset:0
    ds_read_b64_tr_b16 v[74:75], v136 offset:1024
    ds_read_b64_tr_b16 v[76:77], v137 offset:0
    ds_read_b64_tr_b16 v[78:79], v137 offset:1024
    ds_read_b128 v[80:83], v133 offset:0
    ds_read_b128 v[84:87], v133 offset:4096
    ds_read_b64_tr_b16 v[88:89], v136 offset:4096
    ds_read_b64_tr_b16 v[90:91], v136 offset:5120
    ds_read_b64_tr_b16 v[92:93], v137 offset:4096
    ds_read_b64_tr_b16 v[94:95], v137 offset:5120
    s_waitcnt lgkmcnt(6)
    v_mfma_f32_32x32x16_bf16 v[0:15], v[72:75], v[64:67], v[0:15]
    v_mfma_f32_32x32x16_bf16 v[16:31], v[76:79], v[64:67], v[16:31]
    v_mfma_f32_32x32x16_bf16 v[32:47], v[72:75], v[68:71], v[32:47]
    v_mfma_f32_32x32x16_bf16 v[48:63], v[76:79], v[68:71], v[48:63]
    ds_read_b128 v[64:67], v134 offset:0
    ds_read_b128 v[68:71], v134 offset:4096
    ds_read_b64_tr_b16 v[72:73], v136 offset:8192
    ds_read_b64_tr_b16 v[74:75], v136 offset:9216
    ds_read_b64_tr_b16 v[76:77], v137 offset:8192
    ds_read_b64_tr_b16 v[78:79], v137 offset:9216
    s_waitcnt lgkmcnt(6)
    v_mfma_f32_32x32x16_bf16 v[0:15], v[88:91], v[80:83], v[0:15]
    v_mfma_f32_32x32x16_bf16 v[16:31], v[92:95], v[80:83], v[16:31]
    v_mfma_f32_32x32x16_bf16 v[32:47], v[88:91], v[84:87], v[32:47]
    v_mfma_f32_32x32x16_bf16 v[48:63], v[92:95], v[84:87], v[48:63]
    ds_read_b128 v[80:83], v135 offset:0
    ds_read_b128 v[84:87], v135 offset:4096
    ds_read_b64_tr_b16 v[88:89], v136 offset:12288
    ds_read_b64_tr_b16 v[90:91], v136 offset:13312
    ds_read_b64_tr_b16 v[92:93], v137 offset:12288
    ds_read_b64_tr_b16 v[94:95], v137 offset:13312
    s_waitcnt lgkmcnt(6)
    v_mfma_f32_32x32x16_bf16 v[0:15], v[72:75], v[64:67], v[0:15]
    v_mfma_f32_32x32x16_bf16 v[16:31], v[76:79], v[64:67], v[16:31]
    v_mfma_f32_32x32x16_bf16 v[32:47], v[72:75], v[68:71], v[32:47]
    v_mfma_f32_32x32x16_bf16 v[48:63], v[76:79], v[68:71], v[48:63]
    s_waitcnt lgkmcnt(0)
    v_mfma_f32_32x32x16_bf16 v[0:15], v[88:91], v[80:83], v[0:15]
    v_mfma_f32_32x32x16_bf16 v[16:31], v[92:95], v[80:83], v[16:31]
    v_mfma_f32_32x32x16_bf16 v[32:47], v[88:91], v[84:87], v[32:47]
    v_mfma_f32_32x32x16_bf16 v[48:63], v[92:95], v[84:87], v[48:63]
    s_waitcnt vmcnt(20)
    ds_write_b128 v130, v[176:179] offset:32768
    ds_write_b128 v130, v[180:183] offset:36864
    ds_write_b128 v130, v[184:187] offset:40960
    ds_write_b128 v130, v[188:191] offset:45056
    s_waitcnt vmcnt(16)
    ds_write_b128 v131, v[192:195] offset:32768
    ds_write_b128 v131, v[196:199] offset:36864
    ds_write_b128 v131, v[200:203] offset:40960
    ds_write_b128 v131, v[204:207] offset:45056
    s_waitcnt lgkmcnt(0)
    s_barrier
    buffer_load_dwordx4 v[176:179], v128, s[8:11], s20 offen
    buffer_load_dwordx4 v[180:183], v128, s[8:11], s21 offen
    buffer_load_dwordx4 v[184:187], v128, s[8:11], s22 offen
    buffer_load_dwordx4 v[188:191], v128, s[8:11], s23 offen
    buffer_load_dwordx4 v[192:195], v129, s[12:15], s24 offen
    buffer_load_dwordx4 v[196:199], v129, s[12:15], s25 offen
    buffer_load_dwordx4 v[200:203], v129, s[12:15], s26 offen
    buffer_load_dwordx4 v[204:207], v129, s[12:15], s27 offen
    s_add_u32 s20, s20, 128
    s_add_u32 s21, s21, 128
    s_add_u32 s22, s22, 128
    s_add_u32 s23, s23, 128
    s_add_u32 s24, s24, 589824
    s_add_u32 s25, s25, 589824
    s_add_u32 s26, s26, 589824
    s_add_u32 s27, s27, 589824
    ds_read_b128 v[64:67], v132 offset:32768
    ds_read_b128 v[68:71], v132 offset:36864
    ds_read_b64_tr_b16 v[72:73], v136 offset:32768
    ds_read_b64_tr_b16 v[74:75], v136 offset:33792
    ds_read_b64_tr_b16 v[76:77], v137 offset:32768
    ds_read_b64_tr_b16 v[78:79], v137 offset:33792
    ds_read_b128 v[80:83], v133 offset:32768
    ds_read_b128 v[84:87], v133 offset:36864
    ds_read_b64_tr_b16 v[88:89], v136 offset:36864
    ds_read_b64_tr_b16 v[90:91], v136 offset:37888
    ds_read_b64_tr_b16 v[92:93], v137 offset:36864
    ds_read_b64_tr_b16 v[94:95], v137 offset:37888
    s_waitcnt lgkmcnt(6)
    v_mfma_f32_32x32x16_bf16 v[0:15], v[72:75], v[64:67], v[0:15]
    v_mfma_f32_32x32x16_bf16 v[16:31], v[76:79], v[64:67], v[16:31]
    v_mfma_f32_32x32x16_bf16 v[32:47], v[72:75], v[68:71], v[32:47]
    v_mfma_f32_32x32x16_bf16 v[48:63], v[76:79], v[68:71], v[48:63]
    ds_read_b128 v[64:67], v134 offset:32768
    ds_read_b128 v[68:71], v134 offset:36864
    ds_read_b64_tr_b16 v[72:73], v136 offset:40960
    ds_read_b64_tr_b16 v[74:75], v136 offset:41984
    ds_read_b64_tr_b16 v[76:77], v137 offset:40960
    ds_read_b64_tr_b16 v[78:79], v137 offset:41984
    s_waitcnt lgkmcnt(6)
    v_mfma_f32_32x32x16_bf16 v[0:15], v[88:91], v[80:83], v[0:15]
    v_mfma_f32_32x32x16_bf16 v[16:31], v[92:95], v[80:83], v[16:31]
    v_mfma_f32_32x32x16_bf16 v[32:47], v[88:91], v[84:87], v[32:47]
    v_mfma_f32_32x32x16_bf16 v[48:63], v[92:95], v[84:87], v[48:63]
    ds_read_b128 v[80:83], v135 offset:32768
    ds_read_b128 v[84:87], v135 offset:36864
    ds_read_b64_tr_b16 v[88:89], v136 offset:45056
    ds_read_b64_tr_b16 v[90:91], v136 offset:46080
    ds_read_b64_tr_b16 v[92:93], v137 offset:45056
    ds_read_b64_tr_b16 v[94:95], v137 offset:46080
    s_waitcnt lgkmcnt(6)
    v_mfma_f32_32x32x16_bf16 v[0:15], v[72:75], v[64:67], v[0:15]
    v_mfma_f32_32x32x16_bf16 v[16:31], v[76:79], v[64:67], v[16:31]
    v_mfma_f32_32x32x16_bf16 v[32:47], v[72:75], v[68:71], v[32:47]
    v_mfma_f32_32x32x16_bf16 v[48:63], v[76:79], v[68:71], v[48:63]
    s_waitcnt lgkmcnt(0)
    v_mfma_f32_32x32x16_bf16 v[0:15], v[88:91], v[80:83], v[0:15]
    v_mfma_f32_32x32x16_bf16 v[16:31], v[92:95], v[80:83], v[16:31]
    v_mfma_f32_32x32x16_bf16 v[32:47], v[88:91], v[84:87], v[32:47]
    v_mfma_f32_32x32x16_bf16 v[48:63], v[92:95], v[84:87], v[48:63]
    s_waitcnt vmcnt(20)
    ds_write_b128 v130, v[208:211] offset:0
    ds_write_b128 v130, v[212:215] offset:4096
    ds_write_b128 v130, v[216:219] offset:8192
    ds_write_b128 v130, v[220:223] offset:12288
    s_waitcnt vmcnt(16)
    ds_write_b128 v131, v[224:227] offset:0
    ds_write_b128 v131, v[228:231] offset:4096
    ds_write_b128 v131, v[232:235] offset:8192
    ds_write_b128 v131, v[236:239] offset:12288
    s_waitcnt lgkmcnt(0)
    s_barrier
    buffer_load_dwordx4 v[208:211], v128, s[8:11], s20 offen
    buffer_load_dwordx4 v[212:215], v128, s[8:11], s21 offen
    buffer_load_dwordx4 v[216:219], v128, s[8:11], s22 offen
    buffer_load_dwordx4 v[220:223], v128, s[8:11], s23 offen
    buffer_load_dwordx4 v[224:227], v129, s[12:15], s24 offen
    buffer_load_dwordx4 v[228:231], v129, s[12:15], s25 offen
    buffer_load_dwordx4 v[232:235], v129, s[12:15], s26 offen
    buffer_load_dwordx4 v[236:239], v129, s[12:15], s27 offen
    s_add_u32 s20, s20, 128
    s_add_u32 s21, s21, 128
    s_add_u32 s22, s22, 128
    s_add_u32 s23, s23, 128
    s_add_u32 s24, s24, 589824
    s_add_u32 s25, s25, 589824
    s_add_u32 s26, s26, 589824
    s_add_u32 s27, s27, 589824
    ds_read_b128 v[64:67], v132 offset:0
    ds_read_b128 v[68:71], v132 offset:4096
    ds_read_b64_tr_b16 v[72:73], v136 offset:0
    ds_read_b64_tr_b16 v[74:75], v136 offset:1024
    ds_read_b64_tr_b16 v[76:77], v137 offset:0
    ds_read_b64_tr_b16 v[78:79], v137 offset:1024
    ds_read_b128 v[80:83], v133 offset:0
    ds_read_b128 v[84:87], v133 offset:4096
    ds_read_b64_tr_b16 v[88:89], v136 offset:4096
    ds_read_b64_tr_b16 v[90:91], v136 offset:5120
    ds_read_b64_tr_b16 v[92:93], v137 offset:4096
    ds_read_b64_tr_b16 v[94:95], v137 offset:5120
    s_waitcnt lgkmcnt(6)
    v_mfma_f32_32x32x16_bf16 v[0:15], v[72:75], v[64:67], v[0:15]
    v_mfma_f32_32x32x16_bf16 v[16:31], v[76:79], v[64:67], v[16:31]
    v_mfma_f32_32x32x16_bf16 v[32:47], v[72:75], v[68:71], v[32:47]
    v_mfma_f32_32x32x16_bf16 v[48:63], v[76:79], v[68:71], v[48:63]
    ds_read_b128 v[64:67], v134 offset:0
    ds_read_b128 v[68:71], v134 offset:4096
    ds_read_b64_tr_b16 v[72:73], v136 offset:8192
    ds_read_b64_tr_b16 v[74:75], v136 offset:9216
    ds_read_b64_tr_b16 v[76:77], v137 offset:8192
    ds_read_b64_tr_b16 v[78:79], v137 offset:9216
    s_waitcnt lgkmcnt(6)
    v_mfma_f32_32x32x16_bf16 v[0:15], v[88:91], v[80:83], v[0:15]
    v_mfma_f32_32x32x16_bf16 v[16:31], v[92:95], v[80:83], v[16:31]
    v_mfma_f32_32x32x16_bf16 v[32:47], v[88:91], v[84:87], v[32:47]
    v_mfma_f32_32x32x16_bf16 v[48:63], v[92:95], v[84:87], v[48:63]
    ds_read_b128 v[80:83], v135 offset:0
    ds_read_b128 v[84:87], v135 offset:4096
    ds_read_b64_tr_b16 v[88:89], v136 offset:12288
    ds_read_b64_tr_b16 v[90:91], v136 offset:13312
    ds_read_b64_tr_b16 v[92:93], v137 offset:12288
    ds_read_b64_tr_b16 v[94:95], v137 offset:13312
    s_waitcnt lgkmcnt(6)
    v_mfma_f32_32x32x16_bf16 v[0:15], v[72:75], v[64:67], v[0:15]
    v_mfma_f32_32x32x16_bf16 v[16:31], v[76:79], v[64:67], v[16:31]
    v_mfma_f32_32x32x16_bf16 v[32:47], v[72:75], v[68:71], v[32:47]
    v_mfma_f32_32x32x16_bf16 v[48:63], v[76:79], v[68:71], v[48:63]
    s_waitcnt lgkmcnt(0)
    v_mfma_f32_32x32x16_bf16 v[0:15], v[88:91], v[80:83], v[0:15]
    v_mfma_f32_32x32x16_bf16 v[16:31], v[92:95], v[80:83], v[16:31]
    v_mfma_f32_32x32x16_bf16 v[32:47], v[88:91], v[84:87], v[32:47]
    v_mfma_f32_32x32x16_bf16 v[48:63], v[92:95], v[84:87], v[48:63]
    s_waitcnt vmcnt(20)
    ds_write_b128 v130, v[96:99] offset:32768
    ds_write_b128 v130, v[100:103] offset:36864
    ds_write_b128 v130, v[104:107] offset:40960
    ds_write_b128 v130, v[108:111] offset:45056
    s_waitcnt vmcnt(16)
    ds_write_b128 v131, v[112:115] offset:32768
    ds_write_b128 v131, v[116:119] offset:36864
    ds_write_b128 v131, v[120:123] offset:40960
    ds_write_b128 v131, v[124:127] offset:45056
    s_waitcnt lgkmcnt(0)
    s_barrier
    buffer_load_dwordx4 v[96:99], v128, s[8:11], s20 offen
    buffer_load_dwordx4 v[100:103], v128, s[8:11], s21 offen
    buffer_load_dwordx4 v[104:107], v128, s[8:11], s22 offen
    buffer_load_dwordx4 v[108:111], v128, s[8:11], s23 offen
    buffer_load_dwordx4 v[112:115], v129, s[12:15], s24 offen
    buffer_load_dwordx4 v[116:119], v129, s[12:15], s25 offen
    buffer_load_dwordx4 v[120:123], v129, s[12:15], s26 offen
    buffer_load_dwordx4 v[124:127], v129, s[12:15], s27 offen
    s_add_u32 s20, s20, 128
    s_add_u32 s21, s21, 128
    s_add_u32 s22, s22, 128
    s_add_u32 s23, s23, 128
    s_add_u32 s24, s24, 589824
    s_add_u32 s25, s25, 589824
    s_add_u32 s26, s26, 589824
    s_add_u32 s27, s27, 589824
    ds_read_b128 v[64:67], v132 offset:32768
    ds_read_b128 v[68:71], v132 offset:36864
    ds_read_b64_tr_b16 v[72:73], v136 offset:32768
    ds_read_b64_tr_b16 v[74:75], v136 offset:33792
    ds_read_b64_tr_b16 v[76:77], v137 offset:32768
    ds_read_b64_tr_b16 v[78:79], v137 offset:33792
    ds_read_b128 v[80:83], v133 offset:32768
    ds_read_b128 v[84:87], v133 offset:36864
    ds_read_b64_tr_b16 v[88:89], v136 offset:36864
    ds_read_b64_tr_b16 v[90:91], v136 offset:37888
    ds_read_b64_tr_b16 v[92:93], v137 offset:36864
    ds_read_b64_tr_b16 v[94:95], v137 offset:37888
    s_waitcnt lgkmcnt(6)
    v_mfma_f32_32x32x16_bf16 v[0:15], v[72:75], v[64:67], v[0:15]
    v_mfma_f32_32x32x16_bf16 v[16:31], v[76:79], v[64:67], v[16:31]
    v_mfma_f32_32x32x16_bf16 v[32:47], v[72:75], v[68:71], v[32:47]
    v_mfma_f32_32x32x16_bf16 v[48:63], v[76:79], v[68:71], v[48:63]
    ds_read_b128 v[64:67], v134 offset:32768
    ds_read_b128 v[68:71], v134 offset:36864
    ds_read_b64_tr_b16 v[72:73], v136 offset:40960
    ds_read_b64_tr_b16 v[74:75], v136 offset:41984
    ds_read_b64_tr_b16 v[76:77], v137 offset:40960
    ds_read_b64_tr_b16 v[78:79], v137 offset:41984
    s_waitcnt lgkmcnt(6)
    v_mfma_f32_32x32x16_bf16 v[0:15], v[88:91], v[80:83], v[0:15]
    v_mfma_f32_32x32x16_bf16 v[16:31], v[92:95], v[80:83], v[16:31]
    v_mfma_f32_32x32x16_bf16 v[32:47], v[88:91], v[84:87], v[32:47]
    v_mfma_f32_32x32x16_bf16 v[48:63], v[92:95], v[84:87], v[48:63]
    ds_read_b128 v[80:83], v135 offset:32768
    ds_read_b128 v[84:87], v135 offset:36864
    ds_read_b64_tr_b16 v[88:89], v136 offset:45056
    ds_read_b64_tr_b16 v[90:91], v136 offset:46080
    ds_read_b64_tr_b16 v[92:93], v137 offset:45056
    ds_read_b64_tr_b16 v[94:95], v137 offset:46080
    s_waitcnt lgkmcnt(6)
    v_mfma_f32_32x32x16_bf16 v[0:15], v[72:75], v[64:67], v[0:15]
    v_mfma_f32_32x32x16_bf16 v[16:31], v[76:79], v[64:67], v[16:31]
    v_mfma_f32_32x32x16_bf16 v[32:47], v[72:75], v[68:71], v[32:47]
    v_mfma_f32_32x32x16_bf16 v[48:63], v[76:79], v[68:71], v[48:63]
    s_waitcnt lgkmcnt(0)
    v_mfma_f32_32x32x16_bf16 v[0:15], v[88:91], v[80:83], v[0:15]
    v_mfma_f32_32x32x16_bf16 v[16:31], v[92:95], v[80:83], v[16:31]
    v_mfma_f32_32x32x16_bf16 v[32:47], v[88:91], v[84:87], v[32:47]
    v_mfma_f32_32x32x16_bf16 v[48:63], v[92:95], v[84:87], v[48:63]
    s_waitcnt vmcnt(20)
    ds_write_b128 v130, v[176:179] offset:0
    ds_write_b128 v130, v[180:183] offset:4096
    ds_write_b128 v130, v[184:187] offset:8192
    ds_write_b128 v130, v[188:191] offset:12288
    s_waitcnt vmcnt(16)
    ds_write_b128 v131, v[192:195] offset:0
    ds_write_b128 v131, v[196:199] offset:4096
    ds_write_b128 v131, v[200:203] offset:8192
    ds_write_b128 v131, v[204:207] offset:12288
    s_waitcnt lgkmcnt(0)
    s_barrier
    buffer_load_dwordx4 v[176:179], v128, s[8:11], s20 offen
    buffer_load_dwordx4 v[180:183], v128, s[8:11], s21 offen
    buffer_load_dwordx4 v[184:187], v128, s[8:11], s22 offen
    buffer_load_dwordx4 v[188:191], v128, s[8:11], s23 offen
    buffer_load_dwordx4 v[192:195], v129, s[12:15], s24 offen
    buffer_load_dwordx4 v[196:199], v129, s[12:15], s25 offen
    buffer_load_dwordx4 v[200:203], v129, s[12:15], s26 offen
    buffer_load_dwordx4 v[204:207], v129, s[12:15], s27 offen
    s_add_u32 s20, s20, 128
    s_add_u32 s21, s21, 128
    s_add_u32 s22, s22, 128
    s_add_u32 s23, s23, 128
    s_add_u32 s24, s24, 589824
    s_add_u32 s25, s25, 589824
    s_add_u32 s26, s26, 589824
    s_add_u32 s27, s27, 589824
    ds_read_b128 v[64:67], v132 offset:0
    ds_read_b128 v[68:71], v132 offset:4096
    ds_read_b64_tr_b16 v[72:73], v136 offset:0
    ds_read_b64_tr_b16 v[74:75], v136 offset:1024
    ds_read_b64_tr_b16 v[76:77], v137 offset:0
    ds_read_b64_tr_b16 v[78:79], v137 offset:1024
    ds_read_b128 v[80:83], v133 offset:0
    ds_read_b128 v[84:87], v133 offset:4096
    ds_read_b64_tr_b16 v[88:89], v136 offset:4096
    ds_read_b64_tr_b16 v[90:91], v136 offset:5120
    ds_read_b64_tr_b16 v[92:93], v137 offset:4096
    ds_read_b64_tr_b16 v[94:95], v137 offset:5120
    s_waitcnt lgkmcnt(6)
    v_mfma_f32_32x32x16_bf16 v[0:15], v[72:75], v[64:67], v[0:15]
    v_mfma_f32_32x32x16_bf16 v[16:31], v[76:79], v[64:67], v[16:31]
    v_mfma_f32_32x32x16_bf16 v[32:47], v[72:75], v[68:71], v[32:47]
    v_mfma_f32_32x32x16_bf16 v[48:63], v[76:79], v[68:71], v[48:63]
    ds_read_b128 v[64:67], v134 offset:0
    ds_read_b128 v[68:71], v134 offset:4096
    ds_read_b64_tr_b16 v[72:73], v136 offset:8192
    ds_read_b64_tr_b16 v[74:75], v136 offset:9216
    ds_read_b64_tr_b16 v[76:77], v137 offset:8192
    ds_read_b64_tr_b16 v[78:79], v137 offset:9216
    s_waitcnt lgkmcnt(6)
    v_mfma_f32_32x32x16_bf16 v[0:15], v[88:91], v[80:83], v[0:15]
    v_mfma_f32_32x32x16_bf16 v[16:31], v[92:95], v[80:83], v[16:31]
    v_mfma_f32_32x32x16_bf16 v[32:47], v[88:91], v[84:87], v[32:47]
    v_mfma_f32_32x32x16_bf16 v[48:63], v[92:95], v[84:87], v[48:63]
    ds_read_b128 v[80:83], v135 offset:0
    ds_read_b128 v[84:87], v135 offset:4096
    ds_read_b64_tr_b16 v[88:89], v136 offset:12288
    ds_read_b64_tr_b16 v[90:91], v136 offset:13312
    ds_read_b64_tr_b16 v[92:93], v137 offset:12288
    ds_read_b64_tr_b16 v[94:95], v137 offset:13312
    s_waitcnt lgkmcnt(6)
    v_mfma_f32_32x32x16_bf16 v[0:15], v[72:75], v[64:67], v[0:15]
    v_mfma_f32_32x32x16_bf16 v[16:31], v[76:79], v[64:67], v[16:31]
    v_mfma_f32_32x32x16_bf16 v[32:47], v[72:75], v[68:71], v[32:47]
    v_mfma_f32_32x32x16_bf16 v[48:63], v[76:79], v[68:71], v[48:63]
    s_waitcnt lgkmcnt(0)
    v_mfma_f32_32x32x16_bf16 v[0:15], v[88:91], v[80:83], v[0:15]
    v_mfma_f32_32x32x16_bf16 v[16:31], v[92:95], v[80:83], v[16:31]
    v_mfma_f32_32x32x16_bf16 v[32:47], v[88:91], v[84:87], v[32:47]
    v_mfma_f32_32x32x16_bf16 v[48:63], v[92:95], v[84:87], v[48:63]
    s_waitcnt vmcnt(20)
    ds_write_b128 v130, v[208:211] offset:32768
    ds_write_b128 v130, v[212:215] offset:36864
    ds_write_b128 v130, v[216:219] offset:40960
    ds_write_b128 v130, v[220:223] offset:45056
    s_waitcnt vmcnt(16)
    ds_write_b128 v131, v[224:227] offset:32768
    ds_write_b128 v131, v[228:231] offset:36864
    ds_write_b128 v131, v[232:235] offset:40960
    ds_write_b128 v131, v[236:239] offset:45056
    s_waitcnt lgkmcnt(0)
    s_barrier
    buffer_load_dwordx4 v[208:211], v128, s[8:11], s20 offen
    buffer_load_dwordx4 v[212:215], v128, s[8:11], s21 offen
    buffer_load_dwordx4 v[216:219], v128, s[8:11], s22 offen
    buffer_load_dwordx4 v[220:223], v128, s[8:11], s23 offen
    buffer_load_dwordx4 v[224:227], v129, s[12:15], s24 offen
    buffer_load_dwordx4 v[228:231], v129, s[12:15], s25 offen
    buffer_load_dwordx4 v[232:235], v129, s[12:15], s26 offen
    buffer_load_dwordx4 v[236:239], v129, s[12:15], s27 offen
    s_add_u32 s20, s20, 128
    s_add_u32 s21, s21, 128
    s_add_u32 s22, s22, 128
    s_add_u32 s23, s23, 128
    s_add_u32 s24, s24, 589824
    s_add_u32 s25, s25, 589824
    s_add_u32 s26, s26, 589824
    s_add_u32 s27, s27, 589824
    ds_read_b128 v[64:67], v132 offset:32768
    ds_read_b128 v[68:71], v132 offset:36864
    ds_read_b64_tr_b16 v[72:73], v136 offset:32768
    ds_read_b64_tr_b16 v[74:75], v136 offset:33792
    ds_read_b64_tr_b16 v[76:77], v137 offset:32768
    ds_read_b64_tr_b16 v[78:79], v137 offset:33792
    ds_read_b128 v[80:83], v133 offset:32768
    ds_read_b128 v[84:87], v133 offset:36864
    ds_read_b64_tr_b16 v[88:89], v136 offset:36864
    ds_read_b64_tr_b16 v[90:91], v136 offset:37888
    ds_read_b64_tr_b16 v[92:93], v137 offset:36864
    ds_read_b64_tr_b16 v[94:95], v137 offset:37888
    s_waitcnt lgkmcnt(6)
    v_mfma_f32_32x32x16_bf16 v[0:15], v[72:75], v[64:67], v[0:15]
    v_mfma_f32_32x32x16_bf16 v[16:31], v[76:79], v[64:67], v[16:31]
    v_mfma_f32_32x32x16_bf16 v[32:47], v[72:75], v[68:71], v[32:47]
    v_mfma_f32_32x32x16_bf16 v[48:63], v[76:79], v[68:71], v[48:63]
    ds_read_b128 v[64:67], v134 offset:32768
    ds_read_b128 v[68:71], v134 offset:36864
    ds_read_b64_tr_b16 v[72:73], v136 offset:40960
    ds_read_b64_tr_b16 v[74:75], v136 offset:41984
    ds_read_b64_tr_b16 v[76:77], v137 offset:40960
    ds_read_b64_tr_b16 v[78:79], v137 offset:41984
    s_waitcnt lgkmcnt(6)
    v_mfma_f32_32x32x16_bf16 v[0:15], v[88:91], v[80:83], v[0:15]
    v_mfma_f32_32x32x16_bf16 v[16:31], v[92:95], v[80:83], v[16:31]
    v_mfma_f32_32x32x16_bf16 v[32:47], v[88:91], v[84:87], v[32:47]
    v_mfma_f32_32x32x16_bf16 v[48:63], v[92:95], v[84:87], v[48:63]
    ds_read_b128 v[80:83], v135 offset:32768
    ds_read_b128 v[84:87], v135 offset:36864
    ds_read_b64_tr_b16 v[88:89], v136 offset:45056
    ds_read_b64_tr_b16 v[90:91], v136 offset:46080
    ds_read_b64_tr_b16 v[92:93], v137 offset:45056
    ds_read_b64_tr_b16 v[94:95], v137 offset:46080
    s_waitcnt lgkmcnt(6)
    v_mfma_f32_32x32x16_bf16 v[0:15], v[72:75], v[64:67], v[0:15]
    v_mfma_f32_32x32x16_bf16 v[16:31], v[76:79], v[64:67], v[16:31]
    v_mfma_f32_32x32x16_bf16 v[32:47], v[72:75], v[68:71], v[32:47]
    v_mfma_f32_32x32x16_bf16 v[48:63], v[76:79], v[68:71], v[48:63]
    s_waitcnt lgkmcnt(0)
    v_mfma_f32_32x32x16_bf16 v[0:15], v[88:91], v[80:83], v[0:15]
    v_mfma_f32_32x32x16_bf16 v[16:31], v[92:95], v[80:83], v[16:31]
    v_mfma_f32_32x32x16_bf16 v[32:47], v[88:91], v[84:87], v[32:47]
    v_mfma_f32_32x32x16_bf16 v[48:63], v[92:95], v[84:87], v[48:63]
    s_waitcnt vmcnt(20)
    ds_write_b128 v130, v[96:99] offset:0
    ds_write_b128 v130, v[100:103] offset:4096
    ds_write_b128 v130, v[104:107] offset:8192
    ds_write_b128 v130, v[108:111] offset:12288
    s_waitcnt vmcnt(16)
    ds_write_b128 v131, v[112:115] offset:0
    ds_write_b128 v131, v[116:119] offset:4096
    ds_write_b128 v131, v[120:123] offset:8192
    ds_write_b128 v131, v[124:127] offset:12288
    s_waitcnt lgkmcnt(0)
    s_barrier
    ds_read_b128 v[64:67], v132 offset:0
    ds_read_b128 v[68:71], v132 offset:4096
    ds_read_b64_tr_b16 v[72:73], v136 offset:0
    ds_read_b64_tr_b16 v[74:75], v136 offset:1024
    ds_read_b64_tr_b16 v[76:77], v137 offset:0
    ds_read_b64_tr_b16 v[78:79], v137 offset:1024
    ds_read_b128 v[80:83], v133 offset:0
    ds_read_b128 v[84:87], v133 offset:4096
    ds_read_b64_tr_b16 v[88:89], v136 offset:4096
    ds_read_b64_tr_b16 v[90:91], v136 offset:5120
    ds_read_b64_tr_b16 v[92:93], v137 offset:4096
    ds_read_b64_tr_b16 v[94:95], v137 offset:5120
    s_waitcnt lgkmcnt(6)
    v_mfma_f32_32x32x16_bf16 v[0:15], v[72:75], v[64:67], v[0:15]
    v_mfma_f32_32x32x16_bf16 v[16:31], v[76:79], v[64:67], v[16:31]
    v_mfma_f32_32x32x16_bf16 v[32:47], v[72:75], v[68:71], v[32:47]
    v_mfma_f32_32x32x16_bf16 v[48:63], v[76:79], v[68:71], v[48:63]
    ds_read_b128 v[64:67], v134 offset:0
    ds_read_b128 v[68:71], v134 offset:4096
    ds_read_b64_tr_b16 v[72:73], v136 offset:8192
    ds_read_b64_tr_b16 v[74:75], v136 offset:9216
    ds_read_b64_tr_b16 v[76:77], v137 offset:8192
    ds_read_b64_tr_b16 v[78:79], v137 offset:9216
    s_waitcnt lgkmcnt(6)
    v_mfma_f32_32x32x16_bf16 v[0:15], v[88:91], v[80:83], v[0:15]
    v_mfma_f32_32x32x16_bf16 v[16:31], v[92:95], v[80:83], v[16:31]
    v_mfma_f32_32x32x16_bf16 v[32:47], v[88:91], v[84:87], v[32:47]
    v_mfma_f32_32x32x16_bf16 v[48:63], v[92:95], v[84:87], v[48:63]
    ds_read_b128 v[80:83], v135 offset:0
    ds_read_b128 v[84:87], v135 offset:4096
    ds_read_b64_tr_b16 v[88:89], v136 offset:12288
    ds_read_b64_tr_b16 v[90:91], v136 offset:13312
    ds_read_b64_tr_b16 v[92:93], v137 offset:12288
    ds_read_b64_tr_b16 v[94:95], v137 offset:13312
    s_waitcnt lgkmcnt(6)
    v_mfma_f32_32x32x16_bf16 v[0:15], v[72:75], v[64:67], v[0:15]
    v_mfma_f32_32x32x16_bf16 v[16:31], v[76:79], v[64:67], v[16:31]
    v_mfma_f32_32x32x16_bf16 v[32:47], v[72:75], v[68:71], v[32:47]
    v_mfma_f32_32x32x16_bf16 v[48:63], v[76:79], v[68:71], v[48:63]
    s_waitcnt lgkmcnt(0)
    v_mfma_f32_32x32x16_bf16 v[0:15], v[88:91], v[80:83], v[0:15]
    v_mfma_f32_32x32x16_bf16 v[16:31], v[92:95], v[80:83], v[16:31]
    v_mfma_f32_32x32x16_bf16 v[32:47], v[88:91], v[84:87], v[32:47]
    v_mfma_f32_32x32x16_bf16 v[48:63], v[92:95], v[84:87], v[48:63]
    s_waitcnt vmcnt(12)
    ds_write_b128 v130, v[176:179] offset:32768
    ds_write_b128 v130, v[180:183] offset:36864
    ds_write_b128 v130, v[184:187] offset:40960
    ds_write_b128 v130, v[188:191] offset:45056
    s_waitcnt vmcnt(8)
    ds_write_b128 v131, v[192:195] offset:32768
    ds_write_b128 v131, v[196:199] offset:36864
    ds_write_b128 v131, v[200:203] offset:40960
    ds_write_b128 v131, v[204:207] offset:45056
    s_waitcnt lgkmcnt(0)
    s_barrier
    ds_read_b128 v[64:67], v132 offset:32768
    ds_read_b128 v[68:71], v132 offset:36864
    ds_read_b64_tr_b16 v[72:73], v136 offset:32768
    ds_read_b64_tr_b16 v[74:75], v136 offset:33792
    ds_read_b64_tr_b16 v[76:77], v137 offset:32768
    ds_read_b64_tr_b16 v[78:79], v137 offset:33792
    ds_read_b128 v[80:83], v133 offset:32768
    ds_read_b128 v[84:87], v133 offset:36864
    ds_read_b64_tr_b16 v[88:89], v136 offset:36864
    ds_read_b64_tr_b16 v[90:91], v136 offset:37888
    ds_read_b64_tr_b16 v[92:93], v137 offset:36864
    ds_read_b64_tr_b16 v[94:95], v137 offset:37888
    s_waitcnt lgkmcnt(6)
    v_mfma_f32_32x32x16_bf16 v[0:15], v[72:75], v[64:67], v[0:15]
    v_mfma_f32_32x32x16_bf16 v[16:31], v[76:79], v[64:67], v[16:31]
    v_mfma_f32_32x32x16_bf16 v[32:47], v[72:75], v[68:71], v[32:47]
    v_mfma_f32_32x32x16_bf16 v[48:63], v[76:79], v[68:71], v[48:63]
    ds_read_b128 v[64:67], v134 offset:32768
    ds_read_b128 v[68:71], v134 offset:36864
    ds_read_b64_tr_b16 v[72:73], v136 offset:40960
    ds_read_b64_tr_b16 v[74:75], v136 offset:41984
    ds_read_b64_tr_b16 v[76:77], v137 offset:40960
    ds_read_b64_tr_b16 v[78:79], v137 offset:41984
    s_waitcnt lgkmcnt(6)
    v_mfma_f32_32x32x16_bf16 v[0:15], v[88:91], v[80:83], v[0:15]
    v_mfma_f32_32x32x16_bf16 v[16:31], v[92:95], v[80:83], v[16:31]
    v_mfma_f32_32x32x16_bf16 v[32:47], v[88:91], v[84:87], v[32:47]
    v_mfma_f32_32x32x16_bf16 v[48:63], v[92:95], v[84:87], v[48:63]
    ds_read_b128 v[80:83], v135 offset:32768
    ds_read_b128 v[84:87], v135 offset:36864
    ds_read_b64_tr_b16 v[88:89], v136 offset:45056
    ds_read_b64_tr_b16 v[90:91], v136 offset:46080
    ds_read_b64_tr_b16 v[92:93], v137 offset:45056
    ds_read_b64_tr_b16 v[94:95], v137 offset:46080
    s_waitcnt lgkmcnt(6)
    v_mfma_f32_32x32x16_bf16 v[0:15], v[72:75], v[64:67], v[0:15]
    v_mfma_f32_32x32x16_bf16 v[16:31], v[76:79], v[64:67], v[16:31]
    v_mfma_f32_32x32x16_bf16 v[32:47], v[72:75], v[68:71], v[32:47]
    v_mfma_f32_32x32x16_bf16 v[48:63], v[76:79], v[68:71], v[48:63]
    s_waitcnt lgkmcnt(0)
    v_mfma_f32_32x32x16_bf16 v[0:15], v[88:91], v[80:83], v[0:15]
    v_mfma_f32_32x32x16_bf16 v[16:31], v[92:95], v[80:83], v[16:31]
    v_mfma_f32_32x32x16_bf16 v[32:47], v[88:91], v[84:87], v[32:47]
    v_mfma_f32_32x32x16_bf16 v[48:63], v[92:95], v[84:87], v[48:63]
    s_waitcnt vmcnt(4)
    ds_write_b128 v130, v[208:211] offset:0
    ds_write_b128 v130, v[212:215] offset:4096
    ds_write_b128 v130, v[216:219] offset:8192
    ds_write_b128 v130, v[220:223] offset:12288
    s_waitcnt vmcnt(0)
    ds_write_b128 v131, v[224:227] offset:0
    ds_write_b128 v131, v[228:231] offset:4096
    ds_write_b128 v131, v[232:235] offset:8192
    ds_write_b128 v131, v[236:239] offset:12288
    s_waitcnt lgkmcnt(0)
    s_barrier
    ds_read_b128 v[64:67], v132 offset:0
    ds_read_b128 v[68:71], v132 offset:4096
    ds_read_b64_tr_b16 v[72:73], v136 offset:0
    ds_read_b64_tr_b16 v[74:75], v136 offset:1024
    ds_read_b64_tr_b16 v[76:77], v137 offset:0
    ds_read_b64_tr_b16 v[78:79], v137 offset:1024
    ds_read_b128 v[80:83], v133 offset:0
    ds_read_b128 v[84:87], v133 offset:4096
    ds_read_b64_tr_b16 v[88:89], v136 offset:4096
    ds_read_b64_tr_b16 v[90:91], v136 offset:5120
    ds_read_b64_tr_b16 v[92:93], v137 offset:4096
    ds_read_b64_tr_b16 v[94:95], v137 offset:5120
    s_waitcnt lgkmcnt(6)
    v_mfma_f32_32x32x16_bf16 v[0:15], v[72:75], v[64:67], v[0:15]
    v_mfma_f32_32x32x16_bf16 v[16:31], v[76:79], v[64:67], v[16:31]
    v_mfma_f32_32x32x16_bf16 v[32:47], v[72:75], v[68:71], v[32:47]
    v_mfma_f32_32x32x16_bf16 v[48:63], v[76:79], v[68:71], v[48:63]
    ds_read_b128 v[64:67], v134 offset:0
    ds_read_b128 v[68:71], v134 offset:4096
    ds_read_b64_tr_b16 v[72:73], v136 offset:8192
    ds_read_b64_tr_b16 v[74:75], v136 offset:9216
    ds_read_b64_tr_b16 v[76:77], v137 offset:8192
    ds_read_b64_tr_b16 v[78:79], v137 offset:9216
    s_waitcnt lgkmcnt(6)
    v_mfma_f32_32x32x16_bf16 v[0:15], v[88:91], v[80:83], v[0:15]
    v_mfma_f32_32x32x16_bf16 v[16:31], v[92:95], v[80:83], v[16:31]
    v_mfma_f32_32x32x16_bf16 v[32:47], v[88:91], v[84:87], v[32:47]
    v_mfma_f32_32x32x16_bf16 v[48:63], v[92:95], v[84:87], v[48:63]
    ds_read_b128 v[80:83], v135 offset:0
    ds_read_b128 v[84:87], v135 offset:4096
    ds_read_b64_tr_b16 v[88:89], v136 offset:12288
    ds_read_b64_tr_b16 v[90:91], v136 offset:13312
    ds_read_b64_tr_b16 v[92:93], v137 offset:12288
    ds_read_b64_tr_b16 v[94:95], v137 offset:13312
    s_waitcnt lgkmcnt(6)
    v_mfma_f32_32x32x16_bf16 v[0:15], v[72:75], v[64:67], v[0:15]
    v_mfma_f32_32x32x16_bf16 v[16:31], v[76:79], v[64:67], v[16:31]
    v_mfma_f32_32x32x16_bf16 v[32:47], v[72:75], v[68:71], v[32:47]
    v_mfma_f32_32x32x16_bf16 v[48:63], v[76:79], v[68:71], v[48:63]
    s_waitcnt lgkmcnt(0)
    v_mfma_f32_32x32x16_bf16 v[0:15], v[88:91], v[80:83], v[0:15]
    v_mfma_f32_32x32x16_bf16 v[16:31], v[92:95], v[80:83], v[16:31]
    v_mfma_f32_32x32x16_bf16 v[32:47], v[88:91], v[84:87], v[32:47]
    v_mfma_f32_32x32x16_bf16 v[48:63], v[92:95], v[84:87], v[48:63]
    s_barrier
    s_nop 7
    s_nop 7
    v_cvt_pk_bf16_f32 v140, v0, v1
    v_lshlrev_b32 v0, 16, v140
    v_and_b32 v1, 0xffff0000, v140

    v_cvt_pk_bf16_f32 v140, v16, v17
    v_lshlrev_b32 v16, 16, v140
    v_and_b32 v17, 0xffff0000, v140

    v_mul_f32 v141, v0, v0
    v_mov_b32 v144, 0x3d372713
    v_fma_f32 v141, v141, v144, 1.0
    v_mul_f32 v141, v141, v0
    v_mul_f32 v141, 0xc0135761, v141
    v_exp_f32 v141, v141
    s_nop 0
    v_add_f32 v141, 1.0, v141
    v_rcp_f32 v141, v141
    s_nop 0
    v_mul_f32 v0, v0, v141

    v_mul_f32 v142, v1, v1
    v_mov_b32 v144, 0x3d372713
    v_fma_f32 v142, v142, v144, 1.0
    v_mul_f32 v142, v142, v1
    v_mul_f32 v142, 0xc0135761, v142
    v_exp_f32 v142, v142
    s_nop 0
    v_add_f32 v142, 1.0, v142
    v_rcp_f32 v142, v142
    s_nop 0
    v_mul_f32 v1, v1, v142

    v_cvt_pk_bf16_f32 v140, v0, v1
    v_lshlrev_b32 v0, 16, v140
    v_and_b32 v1, 0xffff0000, v140

    v_mul_f32 v0, v0, v16
    v_mul_f32 v1, v1, v17

    v_cvt_pk_bf16_f32 v140, v2, v3
    v_lshlrev_b32 v2, 16, v140
    v_and_b32 v3, 0xffff0000, v140

    v_cvt_pk_bf16_f32 v140, v18, v19
    v_lshlrev_b32 v18, 16, v140
    v_and_b32 v19, 0xffff0000, v140

    v_mul_f32 v141, v2, v2
    v_mov_b32 v144, 0x3d372713
    v_fma_f32 v141, v141, v144, 1.0
    v_mul_f32 v141, v141, v2
    v_mul_f32 v141, 0xc0135761, v141
    v_exp_f32 v141, v141
    s_nop 0
    v_add_f32 v141, 1.0, v141
    v_rcp_f32 v141, v141
    s_nop 0
    v_mul_f32 v2, v2, v141

    v_mul_f32 v142, v3, v3
    v_mov_b32 v144, 0x3d372713
    v_fma_f32 v142, v142, v144, 1.0
    v_mul_f32 v142, v142, v3
    v_mul_f32 v142, 0xc0135761, v142
    v_exp_f32 v142, v142
    s_nop 0
    v_add_f32 v142, 1.0, v142
    v_rcp_f32 v142, v142
    s_nop 0
    v_mul_f32 v3, v3, v142

    v_cvt_pk_bf16_f32 v140, v2, v3
    v_lshlrev_b32 v2, 16, v140
    v_and_b32 v3, 0xffff0000, v140

    v_mul_f32 v2, v2, v18
    v_mul_f32 v3, v3, v19

    v_cvt_pk_bf16_f32 v140, v4, v5
    v_lshlrev_b32 v4, 16, v140
    v_and_b32 v5, 0xffff0000, v140

    v_cvt_pk_bf16_f32 v140, v20, v21
    v_lshlrev_b32 v20, 16, v140
    v_and_b32 v21, 0xffff0000, v140

    v_mul_f32 v141, v4, v4
    v_mov_b32 v144, 0x3d372713
    v_fma_f32 v141, v141, v144, 1.0
    v_mul_f32 v141, v141, v4
    v_mul_f32 v141, 0xc0135761, v141
    v_exp_f32 v141, v141
    s_nop 0
    v_add_f32 v141, 1.0, v141
    v_rcp_f32 v141, v141
    s_nop 0
    v_mul_f32 v4, v4, v141

    v_mul_f32 v142, v5, v5
    v_mov_b32 v144, 0x3d372713
    v_fma_f32 v142, v142, v144, 1.0
    v_mul_f32 v142, v142, v5
    v_mul_f32 v142, 0xc0135761, v142
    v_exp_f32 v142, v142
    s_nop 0
    v_add_f32 v142, 1.0, v142
    v_rcp_f32 v142, v142
    s_nop 0
    v_mul_f32 v5, v5, v142

    v_cvt_pk_bf16_f32 v140, v4, v5
    v_lshlrev_b32 v4, 16, v140
    v_and_b32 v5, 0xffff0000, v140

    v_mul_f32 v4, v4, v20
    v_mul_f32 v5, v5, v21

    v_cvt_pk_bf16_f32 v140, v6, v7
    v_lshlrev_b32 v6, 16, v140
    v_and_b32 v7, 0xffff0000, v140

    v_cvt_pk_bf16_f32 v140, v22, v23
    v_lshlrev_b32 v22, 16, v140
    v_and_b32 v23, 0xffff0000, v140

    v_mul_f32 v141, v6, v6
    v_mov_b32 v144, 0x3d372713
    v_fma_f32 v141, v141, v144, 1.0
    v_mul_f32 v141, v141, v6
    v_mul_f32 v141, 0xc0135761, v141
    v_exp_f32 v141, v141
    s_nop 0
    v_add_f32 v141, 1.0, v141
    v_rcp_f32 v141, v141
    s_nop 0
    v_mul_f32 v6, v6, v141

    v_mul_f32 v142, v7, v7
    v_mov_b32 v144, 0x3d372713
    v_fma_f32 v142, v142, v144, 1.0
    v_mul_f32 v142, v142, v7
    v_mul_f32 v142, 0xc0135761, v142
    v_exp_f32 v142, v142
    s_nop 0
    v_add_f32 v142, 1.0, v142
    v_rcp_f32 v142, v142
    s_nop 0
    v_mul_f32 v7, v7, v142

    v_cvt_pk_bf16_f32 v140, v6, v7
    v_lshlrev_b32 v6, 16, v140
    v_and_b32 v7, 0xffff0000, v140

    v_mul_f32 v6, v6, v22
    v_mul_f32 v7, v7, v23

    v_cvt_pk_bf16_f32 v140, v8, v9
    v_lshlrev_b32 v8, 16, v140
    v_and_b32 v9, 0xffff0000, v140

    v_cvt_pk_bf16_f32 v140, v24, v25
    v_lshlrev_b32 v24, 16, v140
    v_and_b32 v25, 0xffff0000, v140

    v_mul_f32 v141, v8, v8
    v_mov_b32 v144, 0x3d372713
    v_fma_f32 v141, v141, v144, 1.0
    v_mul_f32 v141, v141, v8
    v_mul_f32 v141, 0xc0135761, v141
    v_exp_f32 v141, v141
    s_nop 0
    v_add_f32 v141, 1.0, v141
    v_rcp_f32 v141, v141
    s_nop 0
    v_mul_f32 v8, v8, v141

    v_mul_f32 v142, v9, v9
    v_mov_b32 v144, 0x3d372713
    v_fma_f32 v142, v142, v144, 1.0
    v_mul_f32 v142, v142, v9
    v_mul_f32 v142, 0xc0135761, v142
    v_exp_f32 v142, v142
    s_nop 0
    v_add_f32 v142, 1.0, v142
    v_rcp_f32 v142, v142
    s_nop 0
    v_mul_f32 v9, v9, v142

    v_cvt_pk_bf16_f32 v140, v8, v9
    v_lshlrev_b32 v8, 16, v140
    v_and_b32 v9, 0xffff0000, v140

    v_mul_f32 v8, v8, v24
    v_mul_f32 v9, v9, v25

    v_cvt_pk_bf16_f32 v140, v10, v11
    v_lshlrev_b32 v10, 16, v140
    v_and_b32 v11, 0xffff0000, v140

    v_cvt_pk_bf16_f32 v140, v26, v27
    v_lshlrev_b32 v26, 16, v140
    v_and_b32 v27, 0xffff0000, v140

    v_mul_f32 v141, v10, v10
    v_mov_b32 v144, 0x3d372713
    v_fma_f32 v141, v141, v144, 1.0
    v_mul_f32 v141, v141, v10
    v_mul_f32 v141, 0xc0135761, v141
    v_exp_f32 v141, v141
    s_nop 0
    v_add_f32 v141, 1.0, v141
    v_rcp_f32 v141, v141
    s_nop 0
    v_mul_f32 v10, v10, v141

    v_mul_f32 v142, v11, v11
    v_mov_b32 v144, 0x3d372713
    v_fma_f32 v142, v142, v144, 1.0
    v_mul_f32 v142, v142, v11
    v_mul_f32 v142, 0xc0135761, v142
    v_exp_f32 v142, v142
    s_nop 0
    v_add_f32 v142, 1.0, v142
    v_rcp_f32 v142, v142
    s_nop 0
    v_mul_f32 v11, v11, v142

    v_cvt_pk_bf16_f32 v140, v10, v11
    v_lshlrev_b32 v10, 16, v140
    v_and_b32 v11, 0xffff0000, v140

    v_mul_f32 v10, v10, v26
    v_mul_f32 v11, v11, v27

    v_cvt_pk_bf16_f32 v140, v12, v13
    v_lshlrev_b32 v12, 16, v140
    v_and_b32 v13, 0xffff0000, v140

    v_cvt_pk_bf16_f32 v140, v28, v29
    v_lshlrev_b32 v28, 16, v140
    v_and_b32 v29, 0xffff0000, v140

    v_mul_f32 v141, v12, v12
    v_mov_b32 v144, 0x3d372713
    v_fma_f32 v141, v141, v144, 1.0
    v_mul_f32 v141, v141, v12
    v_mul_f32 v141, 0xc0135761, v141
    v_exp_f32 v141, v141
    s_nop 0
    v_add_f32 v141, 1.0, v141
    v_rcp_f32 v141, v141
    s_nop 0
    v_mul_f32 v12, v12, v141

    v_mul_f32 v142, v13, v13
    v_mov_b32 v144, 0x3d372713
    v_fma_f32 v142, v142, v144, 1.0
    v_mul_f32 v142, v142, v13
    v_mul_f32 v142, 0xc0135761, v142
    v_exp_f32 v142, v142
    s_nop 0
    v_add_f32 v142, 1.0, v142
    v_rcp_f32 v142, v142
    s_nop 0
    v_mul_f32 v13, v13, v142

    v_cvt_pk_bf16_f32 v140, v12, v13
    v_lshlrev_b32 v12, 16, v140
    v_and_b32 v13, 0xffff0000, v140

    v_mul_f32 v12, v12, v28
    v_mul_f32 v13, v13, v29

    v_cvt_pk_bf16_f32 v140, v14, v15
    v_lshlrev_b32 v14, 16, v140
    v_and_b32 v15, 0xffff0000, v140

    v_cvt_pk_bf16_f32 v140, v30, v31
    v_lshlrev_b32 v30, 16, v140
    v_and_b32 v31, 0xffff0000, v140

    v_mul_f32 v141, v14, v14
    v_mov_b32 v144, 0x3d372713
    v_fma_f32 v141, v141, v144, 1.0
    v_mul_f32 v141, v141, v14
    v_mul_f32 v141, 0xc0135761, v141
    v_exp_f32 v141, v141
    s_nop 0
    v_add_f32 v141, 1.0, v141
    v_rcp_f32 v141, v141
    s_nop 0
    v_mul_f32 v14, v14, v141

    v_mul_f32 v142, v15, v15
    v_mov_b32 v144, 0x3d372713
    v_fma_f32 v142, v142, v144, 1.0
    v_mul_f32 v142, v142, v15
    v_mul_f32 v142, 0xc0135761, v142
    v_exp_f32 v142, v142
    s_nop 0
    v_add_f32 v142, 1.0, v142
    v_rcp_f32 v142, v142
    s_nop 0
    v_mul_f32 v15, v15, v142

    v_cvt_pk_bf16_f32 v140, v14, v15
    v_lshlrev_b32 v14, 16, v140
    v_and_b32 v15, 0xffff0000, v140

    v_mul_f32 v14, v14, v30
    v_mul_f32 v15, v15, v31

    v_cvt_pk_bf16_f32 v140, v32, v33
    v_lshlrev_b32 v32, 16, v140
    v_and_b32 v33, 0xffff0000, v140

    v_cvt_pk_bf16_f32 v140, v48, v49
    v_lshlrev_b32 v48, 16, v140
    v_and_b32 v49, 0xffff0000, v140

    v_mul_f32 v141, v32, v32
    v_mov_b32 v144, 0x3d372713
    v_fma_f32 v141, v141, v144, 1.0
    v_mul_f32 v141, v141, v32
    v_mul_f32 v141, 0xc0135761, v141
    v_exp_f32 v141, v141
    s_nop 0
    v_add_f32 v141, 1.0, v141
    v_rcp_f32 v141, v141
    s_nop 0
    v_mul_f32 v32, v32, v141

    v_mul_f32 v142, v33, v33
    v_mov_b32 v144, 0x3d372713
    v_fma_f32 v142, v142, v144, 1.0
    v_mul_f32 v142, v142, v33
    v_mul_f32 v142, 0xc0135761, v142
    v_exp_f32 v142, v142
    s_nop 0
    v_add_f32 v142, 1.0, v142
    v_rcp_f32 v142, v142
    s_nop 0
    v_mul_f32 v33, v33, v142

    v_cvt_pk_bf16_f32 v140, v32, v33
    v_lshlrev_b32 v32, 16, v140
    v_and_b32 v33, 0xffff0000, v140

    v_mul_f32 v32, v32, v48
    v_mul_f32 v33, v33, v49

    v_cvt_pk_bf16_f32 v140, v34, v35
    v_lshlrev_b32 v34, 16, v140
    v_and_b32 v35, 0xffff0000, v140

    v_cvt_pk_bf16_f32 v140, v50, v51
    v_lshlrev_b32 v50, 16, v140
    v_and_b32 v51, 0xffff0000, v140

    v_mul_f32 v141, v34, v34
    v_mov_b32 v144, 0x3d372713
    v_fma_f32 v141, v141, v144, 1.0
    v_mul_f32 v141, v141, v34
    v_mul_f32 v141, 0xc0135761, v141
    v_exp_f32 v141, v141
    s_nop 0
    v_add_f32 v141, 1.0, v141
    v_rcp_f32 v141, v141
    s_nop 0
    v_mul_f32 v34, v34, v141

    v_mul_f32 v142, v35, v35
    v_mov_b32 v144, 0x3d372713
    v_fma_f32 v142, v142, v144, 1.0
    v_mul_f32 v142, v142, v35
    v_mul_f32 v142, 0xc0135761, v142
    v_exp_f32 v142, v142
    s_nop 0
    v_add_f32 v142, 1.0, v142
    v_rcp_f32 v142, v142
    s_nop 0
    v_mul_f32 v35, v35, v142

    v_cvt_pk_bf16_f32 v140, v34, v35
    v_lshlrev_b32 v34, 16, v140
    v_and_b32 v35, 0xffff0000, v140

    v_mul_f32 v34, v34, v50
    v_mul_f32 v35, v35, v51

    v_cvt_pk_bf16_f32 v140, v36, v37
    v_lshlrev_b32 v36, 16, v140
    v_and_b32 v37, 0xffff0000, v140

    v_cvt_pk_bf16_f32 v140, v52, v53
    v_lshlrev_b32 v52, 16, v140
    v_and_b32 v53, 0xffff0000, v140

    v_mul_f32 v141, v36, v36
    v_mov_b32 v144, 0x3d372713
    v_fma_f32 v141, v141, v144, 1.0
    v_mul_f32 v141, v141, v36
    v_mul_f32 v141, 0xc0135761, v141
    v_exp_f32 v141, v141
    s_nop 0
    v_add_f32 v141, 1.0, v141
    v_rcp_f32 v141, v141
    s_nop 0
    v_mul_f32 v36, v36, v141

    v_mul_f32 v142, v37, v37
    v_mov_b32 v144, 0x3d372713
    v_fma_f32 v142, v142, v144, 1.0
    v_mul_f32 v142, v142, v37
    v_mul_f32 v142, 0xc0135761, v142
    v_exp_f32 v142, v142
    s_nop 0
    v_add_f32 v142, 1.0, v142
    v_rcp_f32 v142, v142
    s_nop 0
    v_mul_f32 v37, v37, v142

    v_cvt_pk_bf16_f32 v140, v36, v37
    v_lshlrev_b32 v36, 16, v140
    v_and_b32 v37, 0xffff0000, v140

    v_mul_f32 v36, v36, v52
    v_mul_f32 v37, v37, v53

    v_cvt_pk_bf16_f32 v140, v38, v39
    v_lshlrev_b32 v38, 16, v140
    v_and_b32 v39, 0xffff0000, v140

    v_cvt_pk_bf16_f32 v140, v54, v55
    v_lshlrev_b32 v54, 16, v140
    v_and_b32 v55, 0xffff0000, v140

    v_mul_f32 v141, v38, v38
    v_mov_b32 v144, 0x3d372713
    v_fma_f32 v141, v141, v144, 1.0
    v_mul_f32 v141, v141, v38
    v_mul_f32 v141, 0xc0135761, v141
    v_exp_f32 v141, v141
    s_nop 0
    v_add_f32 v141, 1.0, v141
    v_rcp_f32 v141, v141
    s_nop 0
    v_mul_f32 v38, v38, v141

    v_mul_f32 v142, v39, v39
    v_mov_b32 v144, 0x3d372713
    v_fma_f32 v142, v142, v144, 1.0
    v_mul_f32 v142, v142, v39
    v_mul_f32 v142, 0xc0135761, v142
    v_exp_f32 v142, v142
    s_nop 0
    v_add_f32 v142, 1.0, v142
    v_rcp_f32 v142, v142
    s_nop 0
    v_mul_f32 v39, v39, v142

    v_cvt_pk_bf16_f32 v140, v38, v39
    v_lshlrev_b32 v38, 16, v140
    v_and_b32 v39, 0xffff0000, v140

    v_mul_f32 v38, v38, v54
    v_mul_f32 v39, v39, v55

    v_cvt_pk_bf16_f32 v140, v40, v41
    v_lshlrev_b32 v40, 16, v140
    v_and_b32 v41, 0xffff0000, v140

    v_cvt_pk_bf16_f32 v140, v56, v57
    v_lshlrev_b32 v56, 16, v140
    v_and_b32 v57, 0xffff0000, v140

    v_mul_f32 v141, v40, v40
    v_mov_b32 v144, 0x3d372713
    v_fma_f32 v141, v141, v144, 1.0
    v_mul_f32 v141, v141, v40
    v_mul_f32 v141, 0xc0135761, v141
    v_exp_f32 v141, v141
    s_nop 0
    v_add_f32 v141, 1.0, v141
    v_rcp_f32 v141, v141
    s_nop 0
    v_mul_f32 v40, v40, v141

    v_mul_f32 v142, v41, v41
    v_mov_b32 v144, 0x3d372713
    v_fma_f32 v142, v142, v144, 1.0
    v_mul_f32 v142, v142, v41
    v_mul_f32 v142, 0xc0135761, v142
    v_exp_f32 v142, v142
    s_nop 0
    v_add_f32 v142, 1.0, v142
    v_rcp_f32 v142, v142
    s_nop 0
    v_mul_f32 v41, v41, v142

    v_cvt_pk_bf16_f32 v140, v40, v41
    v_lshlrev_b32 v40, 16, v140
    v_and_b32 v41, 0xffff0000, v140

    v_mul_f32 v40, v40, v56
    v_mul_f32 v41, v41, v57

    v_cvt_pk_bf16_f32 v140, v42, v43
    v_lshlrev_b32 v42, 16, v140
    v_and_b32 v43, 0xffff0000, v140

    v_cvt_pk_bf16_f32 v140, v58, v59
    v_lshlrev_b32 v58, 16, v140
    v_and_b32 v59, 0xffff0000, v140

    v_mul_f32 v141, v42, v42
    v_mov_b32 v144, 0x3d372713
    v_fma_f32 v141, v141, v144, 1.0
    v_mul_f32 v141, v141, v42
    v_mul_f32 v141, 0xc0135761, v141
    v_exp_f32 v141, v141
    s_nop 0
    v_add_f32 v141, 1.0, v141
    v_rcp_f32 v141, v141
    s_nop 0
    v_mul_f32 v42, v42, v141

    v_mul_f32 v142, v43, v43
    v_mov_b32 v144, 0x3d372713
    v_fma_f32 v142, v142, v144, 1.0
    v_mul_f32 v142, v142, v43
    v_mul_f32 v142, 0xc0135761, v142
    v_exp_f32 v142, v142
    s_nop 0
    v_add_f32 v142, 1.0, v142
    v_rcp_f32 v142, v142
    s_nop 0
    v_mul_f32 v43, v43, v142

    v_cvt_pk_bf16_f32 v140, v42, v43
    v_lshlrev_b32 v42, 16, v140
    v_and_b32 v43, 0xffff0000, v140

    v_mul_f32 v42, v42, v58
    v_mul_f32 v43, v43, v59

    v_cvt_pk_bf16_f32 v140, v44, v45
    v_lshlrev_b32 v44, 16, v140
    v_and_b32 v45, 0xffff0000, v140

    v_cvt_pk_bf16_f32 v140, v60, v61
    v_lshlrev_b32 v60, 16, v140
    v_and_b32 v61, 0xffff0000, v140

    v_mul_f32 v141, v44, v44
    v_mov_b32 v144, 0x3d372713
    v_fma_f32 v141, v141, v144, 1.0
    v_mul_f32 v141, v141, v44
    v_mul_f32 v141, 0xc0135761, v141
    v_exp_f32 v141, v141
    s_nop 0
    v_add_f32 v141, 1.0, v141
    v_rcp_f32 v141, v141
    s_nop 0
    v_mul_f32 v44, v44, v141

    v_mul_f32 v142, v45, v45
    v_mov_b32 v144, 0x3d372713
    v_fma_f32 v142, v142, v144, 1.0
    v_mul_f32 v142, v142, v45
    v_mul_f32 v142, 0xc0135761, v142
    v_exp_f32 v142, v142
    s_nop 0
    v_add_f32 v142, 1.0, v142
    v_rcp_f32 v142, v142
    s_nop 0
    v_mul_f32 v45, v45, v142

    v_cvt_pk_bf16_f32 v140, v44, v45
    v_lshlrev_b32 v44, 16, v140
    v_and_b32 v45, 0xffff0000, v140

    v_mul_f32 v44, v44, v60
    v_mul_f32 v45, v45, v61

    v_cvt_pk_bf16_f32 v140, v46, v47
    v_lshlrev_b32 v46, 16, v140
    v_and_b32 v47, 0xffff0000, v140

    v_cvt_pk_bf16_f32 v140, v62, v63
    v_lshlrev_b32 v62, 16, v140
    v_and_b32 v63, 0xffff0000, v140

    v_mul_f32 v141, v46, v46
    v_mov_b32 v144, 0x3d372713
    v_fma_f32 v141, v141, v144, 1.0
    v_mul_f32 v141, v141, v46
    v_mul_f32 v141, 0xc0135761, v141
    v_exp_f32 v141, v141
    s_nop 0
    v_add_f32 v141, 1.0, v141
    v_rcp_f32 v141, v141
    s_nop 0
    v_mul_f32 v46, v46, v141

    v_mul_f32 v142, v47, v47
    v_mov_b32 v144, 0x3d372713
    v_fma_f32 v142, v142, v144, 1.0
    v_mul_f32 v142, v142, v47
    v_mul_f32 v142, 0xc0135761, v142
    v_exp_f32 v142, v142
    s_nop 0
    v_add_f32 v142, 1.0, v142
    v_rcp_f32 v142, v142
    s_nop 0
    v_mul_f32 v47, v47, v142

    v_cvt_pk_bf16_f32 v140, v46, v47
    v_lshlrev_b32 v46, 16, v140
    v_and_b32 v47, 0xffff0000, v140

    v_mul_f32 v46, v46, v62
    v_mul_f32 v47, v47, v63

    v_lshrrev_b32 v140, 7, v168
    v_lshrrev_b32 v141, 6, v168
    v_and_b32 v141, 1, v141
    v_and_b32 v142, 31, v169
    v_lshrrev_b32 v143, 5, v169
    v_lshl_add_u32 v142, v140, 6, v142
    v_mul_u32_u24 v142, 144, v142
    v_lshlrev_b32 v144, 6, v141
    v_lshl_add_u32 v144, v143, 3, v144
    v_add_u32 v142, v142, v144

    v_cvt_pk_bf16_f32 v146, v0, v1
    v_cvt_pk_bf16_f32 v147, v2, v3
    ds_write_b64 v142, v[146:147] offset:0

    v_cvt_pk_bf16_f32 v146, v4, v5
    v_cvt_pk_bf16_f32 v147, v6, v7
    ds_write_b64 v142, v[146:147] offset:16

    v_cvt_pk_bf16_f32 v146, v8, v9
    v_cvt_pk_bf16_f32 v147, v10, v11
    ds_write_b64 v142, v[146:147] offset:32

    v_cvt_pk_bf16_f32 v146, v12, v13
    v_cvt_pk_bf16_f32 v147, v14, v15
    ds_write_b64 v142, v[146:147] offset:48

    v_cvt_pk_bf16_f32 v146, v32, v33
    v_cvt_pk_bf16_f32 v147, v34, v35
    ds_write_b64 v142, v[146:147] offset:4608

    v_cvt_pk_bf16_f32 v146, v36, v37
    v_cvt_pk_bf16_f32 v147, v38, v39
    ds_write_b64 v142, v[146:147] offset:4624

    v_cvt_pk_bf16_f32 v146, v40, v41
    v_cvt_pk_bf16_f32 v147, v42, v43
    ds_write_b64 v142, v[146:147] offset:4640

    v_cvt_pk_bf16_f32 v146, v44, v45
    v_cvt_pk_bf16_f32 v147, v46, v47
    ds_write_b64 v142, v[146:147] offset:4656

    s_waitcnt lgkmcnt(0)
    s_barrier
    s_add_u32 s16, s4, 100663296
    s_addc_u32 s17, s5, 0
    s_and_b32 s17, s17, 0xffff
    s_mov_b32 s18, 18874368
    s_mov_b32 s19, 0x00020000

    v_lshrrev_b32 v141, 3, v168
    v_and_b32 v142, 7, v168
    v_mul_u32_u24 v140, 144, v141
    v_lshl_add_u32 v140, v142, 4, v140
    v_mul_u32_u24 v143, 9216, v141
    v_lshl_add_u32 v143, v142, 4, v143
    s_mul_i32 s36, s30, 9216
    s_lshl_b32 s37, s32, 7
    s_add_u32 s36, s36, s37

    ds_read_b128 v[64:67], v140 offset:0
    ds_read_b128 v[68:71], v140 offset:4608
    ds_read_b128 v[72:75], v140 offset:9216
    ds_read_b128 v[76:79], v140 offset:13824
    s_waitcnt lgkmcnt(3)
    buffer_store_dwordx4 v[64:67], v143, s[16:19], s36 offen sc1
    s_add_u32 s36, s36, 294912

    s_waitcnt lgkmcnt(2)
    buffer_store_dwordx4 v[68:71], v143, s[16:19], s36 offen sc1
    s_add_u32 s36, s36, 294912

    s_waitcnt lgkmcnt(1)
    buffer_store_dwordx4 v[72:75], v143, s[16:19], s36 offen sc1
    s_add_u32 s36, s36, 294912

    s_waitcnt lgkmcnt(0)
    buffer_store_dwordx4 v[76:79], v143, s[16:19], s36 offen sc1
    s_add_u32 s36, s36, 294912

    s_lshl_b32 s72, s65, 6
    v_accvgpr_read_b32 v168, a0
    s_nop 0
    v_and_b32 v169, 63, v168

    s_waitcnt vmcnt(0)
    s_barrier
    v_cmp_eq_u32 vcc, 0, v168
    s_and_saveexec_b64 s[76:77], vcc
    s_cbranch_execz L_sig_87
    v_mov_b32 v140, 15360
    v_mov_b32 v141, 1

    buffer_atomic_add v141, v140, s[68:71], s72 offen
L_sig_87:
    s_mov_b64 exec, s[76:77]
    s_add_u32 s65, s65, 1
    s_cmp_lt_u32 s65, 16
    s_cbranch_scc1 L_rloop_84
    s_branch L_end_1

L_rskip_83:
    s_sub_u32 s66, s64, 160
    s_cmp_ge_u32 s66, 45
    s_cbranch_scc1 L_rskip_88
    s_mov_b32 s65, 0

L_rloop_89:
    v_accvgpr_read_b32 v168, a0
    s_nop 0
    v_and_b32 v169, 63, v168

    s_load_dwordx2 s[6:7], s[80:81], 80
    s_mul_i32 s33, s66, 52429
    s_lshr_b32 s33, s33, 18
    s_mul_i32 s32, s33, 5
    s_sub_u32 s32, s66, s32
    s_lshl_b32 s30, s65, 7
    s_waitcnt lgkmcnt(0)

    s_add_u32 s8, s4, 100663296
    s_addc_u32 s9, s5, 0
    s_and_b32 s9, s9, 0xffff
    s_mov_b32 s10, 18874368
    s_mov_b32 s11, 0x00020000

    s_mov_b32 s12, s6
    s_and_b32 s13, s7, 0xffff
    s_mov_b32 s14, 5308416
    s_mov_b32 s15, 0x00020000

    s_mul_i32 s35, s30, 9216
    s_lshl_b32 s37, s33, 10
    s_add_u32 s35, s35, s37
    s_lshl_b32 s36, s32, 8
    s_mul_i32 s37, s33, 589824
    s_add_u32 s36, s36, s37

    s_add_u32 s20, s35, 0
    s_add_u32 s24, s36, 0
    s_add_u32 s21, s35, 294912
    s_add_u32 s25, s36, 18432
    s_add_u32 s22, s35, 589824
    s_add_u32 s26, s36, 36864
    s_add_u32 s23, s35, 884736
    s_add_u32 s27, s36, 55296
    v_mov_b32 v0, v168
    v_mov_b32 v168, v0
    v_and_b32 v169, 63, v0
    v_lshrrev_b32 v140, 3, v0
    v_and_b32 v141, 7, v0
    s_mov_b32 s40, 9216
    v_mul_lo_u32 v128, v140, s40
    v_lshl_add_u32 v128, v141, 4, v128
    v_lshrrev_b32 v142, 4, v0
    v_and_b32 v142, 7, v142
    v_xor_b32 v142, v142, v141
    v_lshlrev_b32 v142, 4, v142
    v_lshl_add_u32 v130, v140, 7, v142

    v_lshrrev_b32 v140, 4, v0
    v_and_b32 v141, 15, v0
    s_mov_b32 s40, 1152
    v_mul_lo_u32 v129, v140, s40
    v_lshl_add_u32 v129, v141, 4, v129

    v_lshrrev_b32 v142, 2, v141
    v_and_b32 v143, 3, v140
    v_xor_b32 v142, v142, v143
    v_lshlrev_b32 v142, 6, v142
    v_and_b32 v143, 3, v141
    v_lshl_add_u32 v142, v143, 4, v142
    v_lshl_add_u32 v131, v140, 8, v142
    v_add_u32 v131, 16384, v131
    v_lshrrev_b32 v140, 7, v0
    v_and_b32 v141, 31, v0
    v_lshl_add_u32 v140, v140, 6, v141
    v_lshrrev_b32 v141, 1, v140
    v_and_b32 v141, 7, v141
    v_lshrrev_b32 v142, 5, v169

    v_add_u32 v143, 0, v142
    v_xor_b32 v143, v143, v141
    v_lshlrev_b32 v143, 4, v143
    v_lshl_add_u32 v132, v140, 7, v143

    v_add_u32 v143, 2, v142
    v_xor_b32 v143, v143, v141
    v_lshlrev_b32 v143, 4, v143
    v_lshl_add_u32 v133, v140, 7, v143

    v_add_u32 v143, 4, v142
    v_xor_b32 v143, v143, v141
    v_lshlrev_b32 v143, 4, v143
    v_lshl_add_u32 v134, v140, 7, v143

    v_add_u32 v143, 6, v142
    v_xor_b32 v143, v143, v141
    v_lshlrev_b32 v143, 4, v143
    v_lshl_add_u32 v135, v140, 7, v143

    v_lshrrev_b32 v140, 4, v169
    v_and_b32 v141, 15, v169
    v_lshrrev_b32 v142, 1, v140
    v_lshlrev_b32 v142, 3, v142
    v_lshrrev_b32 v143, 2, v141
    v_add_u32 v142, v142, v143
    v_and_b32 v140, 1, v140
    v_lshlrev_b32 v140, 5, v140
    v_and_b32 v141, 3, v141
    v_lshl_add_u32 v140, v141, 3, v140
    v_lshl_add_u32 v140, v142, 8, v140
    v_add_u32 v140, 16384, v140
    v_lshrrev_b32 v141, 6, v0
    v_and_b32 v141, 1, v141
    v_lshlrev_b32 v141, 1, v141

    v_add_u32 v142, 0, v141
    v_xor_b32 v142, v142, v143
    v_lshl_add_u32 v136, v142, 6, v140

    v_add_u32 v142, 1, v141
    v_xor_b32 v142, v142, v143
    v_lshl_add_u32 v137, v142, 6, v140

    v_mov_b32 v0, 0
    v_mov_b32 v1, 0
    v_mov_b32 v2, 0
    v_mov_b32 v3, 0
    v_mov_b32 v4, 0
    v_mov_b32 v5, 0
    v_mov_b32 v6, 0
    v_mov_b32 v7, 0
    v_mov_b32 v8, 0
    v_mov_b32 v9, 0
    v_mov_b32 v10, 0
    v_mov_b32 v11, 0
    v_mov_b32 v12, 0
    v_mov_b32 v13, 0
    v_mov_b32 v14, 0
    v_mov_b32 v15, 0
    v_mov_b32 v16, 0
    v_mov_b32 v17, 0
    v_mov_b32 v18, 0
    v_mov_b32 v19, 0
    v_mov_b32 v20, 0
    v_mov_b32 v21, 0
    v_mov_b32 v22, 0
    v_mov_b32 v23, 0
    v_mov_b32 v24, 0
    v_mov_b32 v25, 0
    v_mov_b32 v26, 0
    v_mov_b32 v27, 0
    v_mov_b32 v28, 0
    v_mov_b32 v29, 0
    v_mov_b32 v30, 0
    v_mov_b32 v31, 0
    v_mov_b32 v32, 0
    v_mov_b32 v33, 0
    v_mov_b32 v34, 0
    v_mov_b32 v35, 0
    v_mov_b32 v36, 0
    v_mov_b32 v37, 0
    v_mov_b32 v38, 0
    v_mov_b32 v39, 0
    v_mov_b32 v40, 0
    v_mov_b32 v41, 0
    v_mov_b32 v42, 0
    v_mov_b32 v43, 0
    v_mov_b32 v44, 0
    v_mov_b32 v45, 0
    v_mov_b32 v46, 0
    v_mov_b32 v47, 0
    v_mov_b32 v48, 0
    v_mov_b32 v49, 0
    v_mov_b32 v50, 0
    v_mov_b32 v51, 0
    v_mov_b32 v52, 0
    v_mov_b32 v53, 0
    v_mov_b32 v54, 0
    v_mov_b32 v55, 0
    v_mov_b32 v56, 0
    v_mov_b32 v57, 0
    v_mov_b32 v58, 0
    v_mov_b32 v59, 0
    v_mov_b32 v60, 0
    v_mov_b32 v61, 0
    v_mov_b32 v62, 0
    v_mov_b32 v63, 0
    s_lshl_b32 s72, s65, 6
    v_accvgpr_read_b32 v168, a0
    s_nop 0
    v_and_b32 v169, 63, v168

    v_lshrrev_b32 v140, 6, v168
    s_nop 0
    v_readfirstlane_b32 s78, v140
    s_cmp_lg_u32 s78, 0
    s_cbranch_scc1 L_wpollx_91
    v_mov_b32 v140, 15360
    s_mov_b32 s79, 0

L_wpoll_90:
    buffer_load_dword v141, v140, s[68:71], s72 offen sc1
    s_add_u32 s79, s79, 1
    s_waitcnt vmcnt(0)
    v_readfirstlane_b32 s78, v141
    s_cmp_ge_u32 s78, 72
    s_cbranch_scc1 L_wpollx_91
    s_cmp_gt_u32 s79, 200000
    s_cbranch_scc1 L_wpollx_91
    s_sleep 24
    s_branch L_wpoll_90

L_wpollx_91:
    s_barrier
    buffer_load_dwordx4 v[96:99], v128, s[8:11], s20 offen
    buffer_load_dwordx4 v[100:103], v128, s[8:11], s21 offen
    buffer_load_dwordx4 v[104:107], v128, s[8:11], s22 offen
    buffer_load_dwordx4 v[108:111], v128, s[8:11], s23 offen
    buffer_load_dwordx4 v[112:115], v129, s[12:15], s24 offen
    buffer_load_dwordx4 v[116:119], v129, s[12:15], s25 offen
    buffer_load_dwordx4 v[120:123], v129, s[12:15], s26 offen
    buffer_load_dwordx4 v[124:127], v129, s[12:15], s27 offen
    s_add_u32 s20, s20, 128
    s_add_u32 s21, s21, 128
    s_add_u32 s22, s22, 128
    s_add_u32 s23, s23, 128
    s_add_u32 s24, s24, 73728
    s_add_u32 s25, s25, 73728
    s_add_u32 s26, s26, 73728
    s_add_u32 s27, s27, 73728
    buffer_load_dwordx4 v[176:179], v128, s[8:11], s20 offen
    buffer_load_dwordx4 v[180:183], v128, s[8:11], s21 offen
    buffer_load_dwordx4 v[184:187], v128, s[8:11], s22 offen
    buffer_load_dwordx4 v[188:191], v128, s[8:11], s23 offen
    buffer_load_dwordx4 v[192:195], v129, s[12:15], s24 offen
    buffer_load_dwordx4 v[196:199], v129, s[12:15], s25 offen
    buffer_load_dwordx4 v[200:203], v129, s[12:15], s26 offen
    buffer_load_dwordx4 v[204:207], v129, s[12:15], s27 offen
    s_add_u32 s20, s20, 128
    s_add_u32 s21, s21, 128
    s_add_u32 s22, s22, 128
    s_add_u32 s23, s23, 128
    s_add_u32 s24, s24, 73728
    s_add_u32 s25, s25, 73728
    s_add_u32 s26, s26, 73728
    s_add_u32 s27, s27, 73728
    buffer_load_dwordx4 v[208:211], v128, s[8:11], s20 offen
    buffer_load_dwordx4 v[212:215], v128, s[8:11], s21 offen
    buffer_load_dwordx4 v[216:219], v128, s[8:11], s22 offen
    buffer_load_dwordx4 v[220:223], v128, s[8:11], s23 offen
    buffer_load_dwordx4 v[224:227], v129, s[12:15], s24 offen
    buffer_load_dwordx4 v[228:231], v129, s[12:15], s25 offen
    buffer_load_dwordx4 v[232:235], v129, s[12:15], s26 offen
    buffer_load_dwordx4 v[236:239], v129, s[12:15], s27 offen
    s_add_u32 s20, s20, 128
    s_add_u32 s21, s21, 128
    s_add_u32 s22, s22, 128
    s_add_u32 s23, s23, 128
    s_add_u32 s24, s24, 73728
    s_add_u32 s25, s25, 73728
    s_add_u32 s26, s26, 73728
    s_add_u32 s27, s27, 73728
    s_waitcnt vmcnt(20)
    ds_write_b128 v130, v[96:99] offset:0
    ds_write_b128 v130, v[100:103] offset:4096
    ds_write_b128 v130, v[104:107] offset:8192
    ds_write_b128 v130, v[108:111] offset:12288
    s_waitcnt vmcnt(16)
    ds_write_b128 v131, v[112:115] offset:0
    ds_write_b128 v131, v[116:119] offset:4096
    ds_write_b128 v131, v[120:123] offset:8192
    ds_write_b128 v131, v[124:127] offset:12288
    s_waitcnt lgkmcnt(0)
    s_barrier
    buffer_load_dwordx4 v[96:99], v128, s[8:11], s20 offen
    buffer_load_dwordx4 v[100:103], v128, s[8:11], s21 offen
    buffer_load_dwordx4 v[104:107], v128, s[8:11], s22 offen
    buffer_load_dwordx4 v[108:111], v128, s[8:11], s23 offen
    buffer_load_dwordx4 v[112:115], v129, s[12:15], s24 offen
    buffer_load_dwordx4 v[116:119], v129, s[12:15], s25 offen
    buffer_load_dwordx4 v[120:123], v129, s[12:15], s26 offen
    buffer_load_dwordx4 v[124:127], v129, s[12:15], s27 offen
    s_add_u32 s20, s20, 128
    s_add_u32 s21, s21, 128
    s_add_u32 s22, s22, 128
    s_add_u32 s23, s23, 128
    s_add_u32 s24, s24, 73728
    s_add_u32 s25, s25, 73728
    s_add_u32 s26, s26, 73728
    s_add_u32 s27, s27, 73728
    ds_read_b128 v[64:67], v132 offset:0
    ds_read_b128 v[68:71], v132 offset:4096
    ds_read_b64_tr_b16 v[72:73], v136 offset:0
    ds_read_b64_tr_b16 v[74:75], v136 offset:1024
    ds_read_b64_tr_b16 v[76:77], v137 offset:0
    ds_read_b64_tr_b16 v[78:79], v137 offset:1024
    ds_read_b128 v[80:83], v133 offset:0
    ds_read_b128 v[84:87], v133 offset:4096
    ds_read_b64_tr_b16 v[88:89], v136 offset:4096
    ds_read_b64_tr_b16 v[90:91], v136 offset:5120
    ds_read_b64_tr_b16 v[92:93], v137 offset:4096
    ds_read_b64_tr_b16 v[94:95], v137 offset:5120
    s_waitcnt lgkmcnt(6)
    v_mfma_f32_32x32x16_bf16 v[0:15], v[72:75], v[64:67], v[0:15]
    v_mfma_f32_32x32x16_bf16 v[16:31], v[76:79], v[64:67], v[16:31]
    v_mfma_f32_32x32x16_bf16 v[32:47], v[72:75], v[68:71], v[32:47]
    v_mfma_f32_32x32x16_bf16 v[48:63], v[76:79], v[68:71], v[48:63]
    ds_read_b128 v[64:67], v134 offset:0
    ds_read_b128 v[68:71], v134 offset:4096
    ds_read_b64_tr_b16 v[72:73], v136 offset:8192
    ds_read_b64_tr_b16 v[74:75], v136 offset:9216
    ds_read_b64_tr_b16 v[76:77], v137 offset:8192
    ds_read_b64_tr_b16 v[78:79], v137 offset:9216
    s_waitcnt lgkmcnt(6)
    v_mfma_f32_32x32x16_bf16 v[0:15], v[88:91], v[80:83], v[0:15]
    v_mfma_f32_32x32x16_bf16 v[16:31], v[92:95], v[80:83], v[16:31]
    v_mfma_f32_32x32x16_bf16 v[32:47], v[88:91], v[84:87], v[32:47]
    v_mfma_f32_32x32x16_bf16 v[48:63], v[92:95], v[84:87], v[48:63]
    ds_read_b128 v[80:83], v135 offset:0
    ds_read_b128 v[84:87], v135 offset:4096
    ds_read_b64_tr_b16 v[88:89], v136 offset:12288
    ds_read_b64_tr_b16 v[90:91], v136 offset:13312
    ds_read_b64_tr_b16 v[92:93], v137 offset:12288
    ds_read_b64_tr_b16 v[94:95], v137 offset:13312
    s_waitcnt lgkmcnt(6)
    v_mfma_f32_32x32x16_bf16 v[0:15], v[72:75], v[64:67], v[0:15]
    v_mfma_f32_32x32x16_bf16 v[16:31], v[76:79], v[64:67], v[16:31]
    v_mfma_f32_32x32x16_bf16 v[32:47], v[72:75], v[68:71], v[32:47]
    v_mfma_f32_32x32x16_bf16 v[48:63], v[76:79], v[68:71], v[48:63]
    s_waitcnt lgkmcnt(0)
    v_mfma_f32_32x32x16_bf16 v[0:15], v[88:91], v[80:83], v[0:15]
    v_mfma_f32_32x32x16_bf16 v[16:31], v[92:95], v[80:83], v[16:31]
    v_mfma_f32_32x32x16_bf16 v[32:47], v[88:91], v[84:87], v[32:47]
    v_mfma_f32_32x32x16_bf16 v[48:63], v[92:95], v[84:87], v[48:63]
    s_waitcnt vmcnt(20)
    ds_write_b128 v130, v[176:179] offset:32768
    ds_write_b128 v130, v[180:183] offset:36864
    ds_write_b128 v130, v[184:187] offset:40960
    ds_write_b128 v130, v[188:191] offset:45056
    s_waitcnt vmcnt(16)
    ds_write_b128 v131, v[192:195] offset:32768
    ds_write_b128 v131, v[196:199] offset:36864
    ds_write_b128 v131, v[200:203] offset:40960
    ds_write_b128 v131, v[204:207] offset:45056
    s_waitcnt lgkmcnt(0)
    s_barrier
    buffer_load_dwordx4 v[176:179], v128, s[8:11], s20 offen
    buffer_load_dwordx4 v[180:183], v128, s[8:11], s21 offen
    buffer_load_dwordx4 v[184:187], v128, s[8:11], s22 offen
    buffer_load_dwordx4 v[188:191], v128, s[8:11], s23 offen
    buffer_load_dwordx4 v[192:195], v129, s[12:15], s24 offen
    buffer_load_dwordx4 v[196:199], v129, s[12:15], s25 offen
    buffer_load_dwordx4 v[200:203], v129, s[12:15], s26 offen
    buffer_load_dwordx4 v[204:207], v129, s[12:15], s27 offen
    s_add_u32 s20, s20, 128
    s_add_u32 s21, s21, 128
    s_add_u32 s22, s22, 128
    s_add_u32 s23, s23, 128
    s_add_u32 s24, s24, 73728
    s_add_u32 s25, s25, 73728
    s_add_u32 s26, s26, 73728
    s_add_u32 s27, s27, 73728
    ds_read_b128 v[64:67], v132 offset:32768
    ds_read_b128 v[68:71], v132 offset:36864
    ds_read_b64_tr_b16 v[72:73], v136 offset:32768
    ds_read_b64_tr_b16 v[74:75], v136 offset:33792
    ds_read_b64_tr_b16 v[76:77], v137 offset:32768
    ds_read_b64_tr_b16 v[78:79], v137 offset:33792
    ds_read_b128 v[80:83], v133 offset:32768
    ds_read_b128 v[84:87], v133 offset:36864
    ds_read_b64_tr_b16 v[88:89], v136 offset:36864
    ds_read_b64_tr_b16 v[90:91], v136 offset:37888
    ds_read_b64_tr_b16 v[92:93], v137 offset:36864
    ds_read_b64_tr_b16 v[94:95], v137 offset:37888
    s_waitcnt lgkmcnt(6)
    v_mfma_f32_32x32x16_bf16 v[0:15], v[72:75], v[64:67], v[0:15]
    v_mfma_f32_32x32x16_bf16 v[16:31], v[76:79], v[64:67], v[16:31]
    v_mfma_f32_32x32x16_bf16 v[32:47], v[72:75], v[68:71], v[32:47]
    v_mfma_f32_32x32x16_bf16 v[48:63], v[76:79], v[68:71], v[48:63]
    ds_read_b128 v[64:67], v134 offset:32768
    ds_read_b128 v[68:71], v134 offset:36864
    ds_read_b64_tr_b16 v[72:73], v136 offset:40960
    ds_read_b64_tr_b16 v[74:75], v136 offset:41984
    ds_read_b64_tr_b16 v[76:77], v137 offset:40960
    ds_read_b64_tr_b16 v[78:79], v137 offset:41984
    s_waitcnt lgkmcnt(6)
    v_mfma_f32_32x32x16_bf16 v[0:15], v[88:91], v[80:83], v[0:15]
    v_mfma_f32_32x32x16_bf16 v[16:31], v[92:95], v[80:83], v[16:31]
    v_mfma_f32_32x32x16_bf16 v[32:47], v[88:91], v[84:87], v[32:47]
    v_mfma_f32_32x32x16_bf16 v[48:63], v[92:95], v[84:87], v[48:63]
    ds_read_b128 v[80:83], v135 offset:32768
    ds_read_b128 v[84:87], v135 offset:36864
    ds_read_b64_tr_b16 v[88:89], v136 offset:45056
    ds_read_b64_tr_b16 v[90:91], v136 offset:46080
    ds_read_b64_tr_b16 v[92:93], v137 offset:45056
    ds_read_b64_tr_b16 v[94:95], v137 offset:46080
    s_waitcnt lgkmcnt(6)
    v_mfma_f32_32x32x16_bf16 v[0:15], v[72:75], v[64:67], v[0:15]
    v_mfma_f32_32x32x16_bf16 v[16:31], v[76:79], v[64:67], v[16:31]
    v_mfma_f32_32x32x16_bf16 v[32:47], v[72:75], v[68:71], v[32:47]
    v_mfma_f32_32x32x16_bf16 v[48:63], v[76:79], v[68:71], v[48:63]
    s_waitcnt lgkmcnt(0)
    v_mfma_f32_32x32x16_bf16 v[0:15], v[88:91], v[80:83], v[0:15]
    v_mfma_f32_32x32x16_bf16 v[16:31], v[92:95], v[80:83], v[16:31]
    v_mfma_f32_32x32x16_bf16 v[32:47], v[88:91], v[84:87], v[32:47]
    v_mfma_f32_32x32x16_bf16 v[48:63], v[92:95], v[84:87], v[48:63]
    s_waitcnt vmcnt(20)
    ds_write_b128 v130, v[208:211] offset:0
    ds_write_b128 v130, v[212:215] offset:4096
    ds_write_b128 v130, v[216:219] offset:8192
    ds_write_b128 v130, v[220:223] offset:12288
    s_waitcnt vmcnt(16)
    ds_write_b128 v131, v[224:227] offset:0
    ds_write_b128 v131, v[228:231] offset:4096
    ds_write_b128 v131, v[232:235] offset:8192
    ds_write_b128 v131, v[236:239] offset:12288
    s_waitcnt lgkmcnt(0)
    s_barrier
    buffer_load_dwordx4 v[208:211], v128, s[8:11], s20 offen
    buffer_load_dwordx4 v[212:215], v128, s[8:11], s21 offen
    buffer_load_dwordx4 v[216:219], v128, s[8:11], s22 offen
    buffer_load_dwordx4 v[220:223], v128, s[8:11], s23 offen
    buffer_load_dwordx4 v[224:227], v129, s[12:15], s24 offen
    buffer_load_dwordx4 v[228:231], v129, s[12:15], s25 offen
    buffer_load_dwordx4 v[232:235], v129, s[12:15], s26 offen
    buffer_load_dwordx4 v[236:239], v129, s[12:15], s27 offen
    s_add_u32 s20, s20, 128
    s_add_u32 s21, s21, 128
    s_add_u32 s22, s22, 128
    s_add_u32 s23, s23, 128
    s_add_u32 s24, s24, 73728
    s_add_u32 s25, s25, 73728
    s_add_u32 s26, s26, 73728
    s_add_u32 s27, s27, 73728
    ds_read_b128 v[64:67], v132 offset:0
    ds_read_b128 v[68:71], v132 offset:4096
    ds_read_b64_tr_b16 v[72:73], v136 offset:0
    ds_read_b64_tr_b16 v[74:75], v136 offset:1024
    ds_read_b64_tr_b16 v[76:77], v137 offset:0
    ds_read_b64_tr_b16 v[78:79], v137 offset:1024
    ds_read_b128 v[80:83], v133 offset:0
    ds_read_b128 v[84:87], v133 offset:4096
    ds_read_b64_tr_b16 v[88:89], v136 offset:4096
    ds_read_b64_tr_b16 v[90:91], v136 offset:5120
    ds_read_b64_tr_b16 v[92:93], v137 offset:4096
    ds_read_b64_tr_b16 v[94:95], v137 offset:5120
    s_waitcnt lgkmcnt(6)
    v_mfma_f32_32x32x16_bf16 v[0:15], v[72:75], v[64:67], v[0:15]
    v_mfma_f32_32x32x16_bf16 v[16:31], v[76:79], v[64:67], v[16:31]
    v_mfma_f32_32x32x16_bf16 v[32:47], v[72:75], v[68:71], v[32:47]
    v_mfma_f32_32x32x16_bf16 v[48:63], v[76:79], v[68:71], v[48:63]
    ds_read_b128 v[64:67], v134 offset:0
    ds_read_b128 v[68:71], v134 offset:4096
    ds_read_b64_tr_b16 v[72:73], v136 offset:8192
    ds_read_b64_tr_b16 v[74:75], v136 offset:9216
    ds_read_b64_tr_b16 v[76:77], v137 offset:8192
    ds_read_b64_tr_b16 v[78:79], v137 offset:9216
    s_waitcnt lgkmcnt(6)
    v_mfma_f32_32x32x16_bf16 v[0:15], v[88:91], v[80:83], v[0:15]
    v_mfma_f32_32x32x16_bf16 v[16:31], v[92:95], v[80:83], v[16:31]
    v_mfma_f32_32x32x16_bf16 v[32:47], v[88:91], v[84:87], v[32:47]
    v_mfma_f32_32x32x16_bf16 v[48:63], v[92:95], v[84:87], v[48:63]
    ds_read_b128 v[80:83], v135 offset:0
    ds_read_b128 v[84:87], v135 offset:4096
    ds_read_b64_tr_b16 v[88:89], v136 offset:12288
    ds_read_b64_tr_b16 v[90:91], v136 offset:13312
    ds_read_b64_tr_b16 v[92:93], v137 offset:12288
    ds_read_b64_tr_b16 v[94:95], v137 offset:13312
    s_waitcnt lgkmcnt(6)
    v_mfma_f32_32x32x16_bf16 v[0:15], v[72:75], v[64:67], v[0:15]
    v_mfma_f32_32x32x16_bf16 v[16:31], v[76:79], v[64:67], v[16:31]
    v_mfma_f32_32x32x16_bf16 v[32:47], v[72:75], v[68:71], v[32:47]
    v_mfma_f32_32x32x16_bf16 v[48:63], v[76:79], v[68:71], v[48:63]
    s_waitcnt lgkmcnt(0)
    v_mfma_f32_32x32x16_bf16 v[0:15], v[88:91], v[80:83], v[0:15]
    v_mfma_f32_32x32x16_bf16 v[16:31], v[92:95], v[80:83], v[16:31]
    v_mfma_f32_32x32x16_bf16 v[32:47], v[88:91], v[84:87], v[32:47]
    v_mfma_f32_32x32x16_bf16 v[48:63], v[92:95], v[84:87], v[48:63]
    s_waitcnt vmcnt(20)
    ds_write_b128 v130, v[96:99] offset:32768
    ds_write_b128 v130, v[100:103] offset:36864
    ds_write_b128 v130, v[104:107] offset:40960
    ds_write_b128 v130, v[108:111] offset:45056
    s_waitcnt vmcnt(16)
    ds_write_b128 v131, v[112:115] offset:32768
    ds_write_b128 v131, v[116:119] offset:36864
    ds_write_b128 v131, v[120:123] offset:40960
    ds_write_b128 v131, v[124:127] offset:45056
    s_waitcnt lgkmcnt(0)
    s_barrier
    buffer_load_dwordx4 v[96:99], v128, s[8:11], s20 offen
    buffer_load_dwordx4 v[100:103], v128, s[8:11], s21 offen
    buffer_load_dwordx4 v[104:107], v128, s[8:11], s22 offen
    buffer_load_dwordx4 v[108:111], v128, s[8:11], s23 offen
    buffer_load_dwordx4 v[112:115], v129, s[12:15], s24 offen
    buffer_load_dwordx4 v[116:119], v129, s[12:15], s25 offen
    buffer_load_dwordx4 v[120:123], v129, s[12:15], s26 offen
    buffer_load_dwordx4 v[124:127], v129, s[12:15], s27 offen
    s_add_u32 s20, s20, 128
    s_add_u32 s21, s21, 128
    s_add_u32 s22, s22, 128
    s_add_u32 s23, s23, 128
    s_add_u32 s24, s24, 73728
    s_add_u32 s25, s25, 73728
    s_add_u32 s26, s26, 73728
    s_add_u32 s27, s27, 73728
    ds_read_b128 v[64:67], v132 offset:32768
    ds_read_b128 v[68:71], v132 offset:36864
    ds_read_b64_tr_b16 v[72:73], v136 offset:32768
    ds_read_b64_tr_b16 v[74:75], v136 offset:33792
    ds_read_b64_tr_b16 v[76:77], v137 offset:32768
    ds_read_b64_tr_b16 v[78:79], v137 offset:33792
    ds_read_b128 v[80:83], v133 offset:32768
    ds_read_b128 v[84:87], v133 offset:36864
    ds_read_b64_tr_b16 v[88:89], v136 offset:36864
    ds_read_b64_tr_b16 v[90:91], v136 offset:37888
    ds_read_b64_tr_b16 v[92:93], v137 offset:36864
    ds_read_b64_tr_b16 v[94:95], v137 offset:37888
    s_waitcnt lgkmcnt(6)
    v_mfma_f32_32x32x16_bf16 v[0:15], v[72:75], v[64:67], v[0:15]
    v_mfma_f32_32x32x16_bf16 v[16:31], v[76:79], v[64:67], v[16:31]
    v_mfma_f32_32x32x16_bf16 v[32:47], v[72:75], v[68:71], v[32:47]
    v_mfma_f32_32x32x16_bf16 v[48:63], v[76:79], v[68:71], v[48:63]
    ds_read_b128 v[64:67], v134 offset:32768
    ds_read_b128 v[68:71], v134 offset:36864
    ds_read_b64_tr_b16 v[72:73], v136 offset:40960
    ds_read_b64_tr_b16 v[74:75], v136 offset:41984
    ds_read_b64_tr_b16 v[76:77], v137 offset:40960
    ds_read_b64_tr_b16 v[78:79], v137 offset:41984
    s_waitcnt lgkmcnt(6)
    v_mfma_f32_32x32x16_bf16 v[0:15], v[88:91], v[80:83], v[0:15]
    v_mfma_f32_32x32x16_bf16 v[16:31], v[92:95], v[80:83], v[16:31]
    v_mfma_f32_32x32x16_bf16 v[32:47], v[88:91], v[84:87], v[32:47]
    v_mfma_f32_32x32x16_bf16 v[48:63], v[92:95], v[84:87], v[48:63]
    ds_read_b128 v[80:83], v135 offset:32768
    ds_read_b128 v[84:87], v135 offset:36864
    ds_read_b64_tr_b16 v[88:89], v136 offset:45056
    ds_read_b64_tr_b16 v[90:91], v136 offset:46080
    ds_read_b64_tr_b16 v[92:93], v137 offset:45056
    ds_read_b64_tr_b16 v[94:95], v137 offset:46080
    s_waitcnt lgkmcnt(6)
    v_mfma_f32_32x32x16_bf16 v[0:15], v[72:75], v[64:67], v[0:15]
    v_mfma_f32_32x32x16_bf16 v[16:31], v[76:79], v[64:67], v[16:31]
    v_mfma_f32_32x32x16_bf16 v[32:47], v[72:75], v[68:71], v[32:47]
    v_mfma_f32_32x32x16_bf16 v[48:63], v[76:79], v[68:71], v[48:63]
    s_waitcnt lgkmcnt(0)
    v_mfma_f32_32x32x16_bf16 v[0:15], v[88:91], v[80:83], v[0:15]
    v_mfma_f32_32x32x16_bf16 v[16:31], v[92:95], v[80:83], v[16:31]
    v_mfma_f32_32x32x16_bf16 v[32:47], v[88:91], v[84:87], v[32:47]
    v_mfma_f32_32x32x16_bf16 v[48:63], v[92:95], v[84:87], v[48:63]
    s_waitcnt vmcnt(20)
    ds_write_b128 v130, v[176:179] offset:0
    ds_write_b128 v130, v[180:183] offset:4096
    ds_write_b128 v130, v[184:187] offset:8192
    ds_write_b128 v130, v[188:191] offset:12288
    s_waitcnt vmcnt(16)
    ds_write_b128 v131, v[192:195] offset:0
    ds_write_b128 v131, v[196:199] offset:4096
    ds_write_b128 v131, v[200:203] offset:8192
    ds_write_b128 v131, v[204:207] offset:12288
    s_waitcnt lgkmcnt(0)
    s_barrier
    buffer_load_dwordx4 v[176:179], v128, s[8:11], s20 offen
    buffer_load_dwordx4 v[180:183], v128, s[8:11], s21 offen
    buffer_load_dwordx4 v[184:187], v128, s[8:11], s22 offen
    buffer_load_dwordx4 v[188:191], v128, s[8:11], s23 offen
    buffer_load_dwordx4 v[192:195], v129, s[12:15], s24 offen
    buffer_load_dwordx4 v[196:199], v129, s[12:15], s25 offen
    buffer_load_dwordx4 v[200:203], v129, s[12:15], s26 offen
    buffer_load_dwordx4 v[204:207], v129, s[12:15], s27 offen
    s_add_u32 s20, s20, 128
    s_add_u32 s21, s21, 128
    s_add_u32 s22, s22, 128
    s_add_u32 s23, s23, 128
    s_add_u32 s24, s24, 73728
    s_add_u32 s25, s25, 73728
    s_add_u32 s26, s26, 73728
    s_add_u32 s27, s27, 73728
    ds_read_b128 v[64:67], v132 offset:0
    ds_read_b128 v[68:71], v132 offset:4096
    ds_read_b64_tr_b16 v[72:73], v136 offset:0
    ds_read_b64_tr_b16 v[74:75], v136 offset:1024
    ds_read_b64_tr_b16 v[76:77], v137 offset:0
    ds_read_b64_tr_b16 v[78:79], v137 offset:1024
    ds_read_b128 v[80:83], v133 offset:0
    ds_read_b128 v[84:87], v133 offset:4096
    ds_read_b64_tr_b16 v[88:89], v136 offset:4096
    ds_read_b64_tr_b16 v[90:91], v136 offset:5120
    ds_read_b64_tr_b16 v[92:93], v137 offset:4096
    ds_read_b64_tr_b16 v[94:95], v137 offset:5120
    s_waitcnt lgkmcnt(6)
    v_mfma_f32_32x32x16_bf16 v[0:15], v[72:75], v[64:67], v[0:15]
    v_mfma_f32_32x32x16_bf16 v[16:31], v[76:79], v[64:67], v[16:31]
    v_mfma_f32_32x32x16_bf16 v[32:47], v[72:75], v[68:71], v[32:47]
    v_mfma_f32_32x32x16_bf16 v[48:63], v[76:79], v[68:71], v[48:63]
    ds_read_b128 v[64:67], v134 offset:0
    ds_read_b128 v[68:71], v134 offset:4096
    ds_read_b64_tr_b16 v[72:73], v136 offset:8192
    ds_read_b64_tr_b16 v[74:75], v136 offset:9216
    ds_read_b64_tr_b16 v[76:77], v137 offset:8192
    ds_read_b64_tr_b16 v[78:79], v137 offset:9216
    s_waitcnt lgkmcnt(6)
    v_mfma_f32_32x32x16_bf16 v[0:15], v[88:91], v[80:83], v[0:15]
    v_mfma_f32_32x32x16_bf16 v[16:31], v[92:95], v[80:83], v[16:31]
    v_mfma_f32_32x32x16_bf16 v[32:47], v[88:91], v[84:87], v[32:47]
    v_mfma_f32_32x32x16_bf16 v[48:63], v[92:95], v[84:87], v[48:63]
    ds_read_b128 v[80:83], v135 offset:0
    ds_read_b128 v[84:87], v135 offset:4096
    ds_read_b64_tr_b16 v[88:89], v136 offset:12288
    ds_read_b64_tr_b16 v[90:91], v136 offset:13312
    ds_read_b64_tr_b16 v[92:93], v137 offset:12288
    ds_read_b64_tr_b16 v[94:95], v137 offset:13312
    s_waitcnt lgkmcnt(6)
    v_mfma_f32_32x32x16_bf16 v[0:15], v[72:75], v[64:67], v[0:15]
    v_mfma_f32_32x32x16_bf16 v[16:31], v[76:79], v[64:67], v[16:31]
    v_mfma_f32_32x32x16_bf16 v[32:47], v[72:75], v[68:71], v[32:47]
    v_mfma_f32_32x32x16_bf16 v[48:63], v[76:79], v[68:71], v[48:63]
    s_waitcnt lgkmcnt(0)
    v_mfma_f32_32x32x16_bf16 v[0:15], v[88:91], v[80:83], v[0:15]
    v_mfma_f32_32x32x16_bf16 v[16:31], v[92:95], v[80:83], v[16:31]
    v_mfma_f32_32x32x16_bf16 v[32:47], v[88:91], v[84:87], v[32:47]
    v_mfma_f32_32x32x16_bf16 v[48:63], v[92:95], v[84:87], v[48:63]
    s_waitcnt vmcnt(20)
    ds_write_b128 v130, v[208:211] offset:32768
    ds_write_b128 v130, v[212:215] offset:36864
    ds_write_b128 v130, v[216:219] offset:40960
    ds_write_b128 v130, v[220:223] offset:45056
    s_waitcnt vmcnt(16)
    ds_write_b128 v131, v[224:227] offset:32768
    ds_write_b128 v131, v[228:231] offset:36864
    ds_write_b128 v131, v[232:235] offset:40960
    ds_write_b128 v131, v[236:239] offset:45056
    s_waitcnt lgkmcnt(0)
    s_barrier
    ds_read_b128 v[64:67], v132 offset:32768
    ds_read_b128 v[68:71], v132 offset:36864
    ds_read_b64_tr_b16 v[72:73], v136 offset:32768
    ds_read_b64_tr_b16 v[74:75], v136 offset:33792
    ds_read_b64_tr_b16 v[76:77], v137 offset:32768
    ds_read_b64_tr_b16 v[78:79], v137 offset:33792
    ds_read_b128 v[80:83], v133 offset:32768
    ds_read_b128 v[84:87], v133 offset:36864
    ds_read_b64_tr_b16 v[88:89], v136 offset:36864
    ds_read_b64_tr_b16 v[90:91], v136 offset:37888
    ds_read_b64_tr_b16 v[92:93], v137 offset:36864
    ds_read_b64_tr_b16 v[94:95], v137 offset:37888
    s_waitcnt lgkmcnt(6)
    v_mfma_f32_32x32x16_bf16 v[0:15], v[72:75], v[64:67], v[0:15]
    v_mfma_f32_32x32x16_bf16 v[16:31], v[76:79], v[64:67], v[16:31]
    v_mfma_f32_32x32x16_bf16 v[32:47], v[72:75], v[68:71], v[32:47]
    v_mfma_f32_32x32x16_bf16 v[48:63], v[76:79], v[68:71], v[48:63]
    ds_read_b128 v[64:67], v134 offset:32768
    ds_read_b128 v[68:71], v134 offset:36864
    ds_read_b64_tr_b16 v[72:73], v136 offset:40960
    ds_read_b64_tr_b16 v[74:75], v136 offset:41984
    ds_read_b64_tr_b16 v[76:77], v137 offset:40960
    ds_read_b64_tr_b16 v[78:79], v137 offset:41984
    s_waitcnt lgkmcnt(6)
    v_mfma_f32_32x32x16_bf16 v[0:15], v[88:91], v[80:83], v[0:15]
    v_mfma_f32_32x32x16_bf16 v[16:31], v[92:95], v[80:83], v[16:31]
    v_mfma_f32_32x32x16_bf16 v[32:47], v[88:91], v[84:87], v[32:47]
    v_mfma_f32_32x32x16_bf16 v[48:63], v[92:95], v[84:87], v[48:63]
    ds_read_b128 v[80:83], v135 offset:32768
    ds_read_b128 v[84:87], v135 offset:36864
    ds_read_b64_tr_b16 v[88:89], v136 offset:45056
    ds_read_b64_tr_b16 v[90:91], v136 offset:46080
    ds_read_b64_tr_b16 v[92:93], v137 offset:45056
    ds_read_b64_tr_b16 v[94:95], v137 offset:46080
    s_waitcnt lgkmcnt(6)
    v_mfma_f32_32x32x16_bf16 v[0:15], v[72:75], v[64:67], v[0:15]
    v_mfma_f32_32x32x16_bf16 v[16:31], v[76:79], v[64:67], v[16:31]
    v_mfma_f32_32x32x16_bf16 v[32:47], v[72:75], v[68:71], v[32:47]
    v_mfma_f32_32x32x16_bf16 v[48:63], v[76:79], v[68:71], v[48:63]
    s_waitcnt lgkmcnt(0)
    v_mfma_f32_32x32x16_bf16 v[0:15], v[88:91], v[80:83], v[0:15]
    v_mfma_f32_32x32x16_bf16 v[16:31], v[92:95], v[80:83], v[16:31]
    v_mfma_f32_32x32x16_bf16 v[32:47], v[88:91], v[84:87], v[32:47]
    v_mfma_f32_32x32x16_bf16 v[48:63], v[92:95], v[84:87], v[48:63]
    s_waitcnt vmcnt(12)
    ds_write_b128 v130, v[96:99] offset:0
    ds_write_b128 v130, v[100:103] offset:4096
    ds_write_b128 v130, v[104:107] offset:8192
    ds_write_b128 v130, v[108:111] offset:12288
    s_waitcnt vmcnt(8)
    ds_write_b128 v131, v[112:115] offset:0
    ds_write_b128 v131, v[116:119] offset:4096
    ds_write_b128 v131, v[120:123] offset:8192
    ds_write_b128 v131, v[124:127] offset:12288
    s_waitcnt lgkmcnt(0)
    s_barrier
    ds_read_b128 v[64:67], v132 offset:0
    ds_read_b128 v[68:71], v132 offset:4096
    ds_read_b64_tr_b16 v[72:73], v136 offset:0
    ds_read_b64_tr_b16 v[74:75], v136 offset:1024
    ds_read_b64_tr_b16 v[76:77], v137 offset:0
    ds_read_b64_tr_b16 v[78:79], v137 offset:1024
    ds_read_b128 v[80:83], v133 offset:0
    ds_read_b128 v[84:87], v133 offset:4096
    ds_read_b64_tr_b16 v[88:89], v136 offset:4096
    ds_read_b64_tr_b16 v[90:91], v136 offset:5120
    ds_read_b64_tr_b16 v[92:93], v137 offset:4096
    ds_read_b64_tr_b16 v[94:95], v137 offset:5120
    s_waitcnt lgkmcnt(6)
    v_mfma_f32_32x32x16_bf16 v[0:15], v[72:75], v[64:67], v[0:15]
    v_mfma_f32_32x32x16_bf16 v[16:31], v[76:79], v[64:67], v[16:31]
    v_mfma_f32_32x32x16_bf16 v[32:47], v[72:75], v[68:71], v[32:47]
    v_mfma_f32_32x32x16_bf16 v[48:63], v[76:79], v[68:71], v[48:63]
    ds_read_b128 v[64:67], v134 offset:0
    ds_read_b128 v[68:71], v134 offset:4096
    ds_read_b64_tr_b16 v[72:73], v136 offset:8192
    ds_read_b64_tr_b16 v[74:75], v136 offset:9216
    ds_read_b64_tr_b16 v[76:77], v137 offset:8192
    ds_read_b64_tr_b16 v[78:79], v137 offset:9216
    s_waitcnt lgkmcnt(6)
    v_mfma_f32_32x32x16_bf16 v[0:15], v[88:91], v[80:83], v[0:15]
    v_mfma_f32_32x32x16_bf16 v[16:31], v[92:95], v[80:83], v[16:31]
    v_mfma_f32_32x32x16_bf16 v[32:47], v[88:91], v[84:87], v[32:47]
    v_mfma_f32_32x32x16_bf16 v[48:63], v[92:95], v[84:87], v[48:63]
    ds_read_b128 v[80:83], v135 offset:0
    ds_read_b128 v[84:87], v135 offset:4096
    ds_read_b64_tr_b16 v[88:89], v136 offset:12288
    ds_read_b64_tr_b16 v[90:91], v136 offset:13312
    ds_read_b64_tr_b16 v[92:93], v137 offset:12288
    ds_read_b64_tr_b16 v[94:95], v137 offset:13312
    s_waitcnt lgkmcnt(6)
    v_mfma_f32_32x32x16_bf16 v[0:15], v[72:75], v[64:67], v[0:15]
    v_mfma_f32_32x32x16_bf16 v[16:31], v[76:79], v[64:67], v[16:31]
    v_mfma_f32_32x32x16_bf16 v[32:47], v[72:75], v[68:71], v[32:47]
    v_mfma_f32_32x32x16_bf16 v[48:63], v[76:79], v[68:71], v[48:63]
    s_waitcnt lgkmcnt(0)
    v_mfma_f32_32x32x16_bf16 v[0:15], v[88:91], v[80:83], v[0:15]
    v_mfma_f32_32x32x16_bf16 v[16:31], v[92:95], v[80:83], v[16:31]
    v_mfma_f32_32x32x16_bf16 v[32:47], v[88:91], v[84:87], v[32:47]
    v_mfma_f32_32x32x16_bf16 v[48:63], v[92:95], v[84:87], v[48:63]
    s_waitcnt vmcnt(4)
    ds_write_b128 v130, v[176:179] offset:32768
    ds_write_b128 v130, v[180:183] offset:36864
    ds_write_b128 v130, v[184:187] offset:40960
    ds_write_b128 v130, v[188:191] offset:45056
    s_waitcnt vmcnt(0)
    ds_write_b128 v131, v[192:195] offset:32768
    ds_write_b128 v131, v[196:199] offset:36864
    ds_write_b128 v131, v[200:203] offset:40960
    ds_write_b128 v131, v[204:207] offset:45056
    s_waitcnt lgkmcnt(0)
    s_barrier
    ds_read_b128 v[64:67], v132 offset:32768
    ds_read_b128 v[68:71], v132 offset:36864
    ds_read_b64_tr_b16 v[72:73], v136 offset:32768
    ds_read_b64_tr_b16 v[74:75], v136 offset:33792
    ds_read_b64_tr_b16 v[76:77], v137 offset:32768
    ds_read_b64_tr_b16 v[78:79], v137 offset:33792
    ds_read_b128 v[80:83], v133 offset:32768
    ds_read_b128 v[84:87], v133 offset:36864
    ds_read_b64_tr_b16 v[88:89], v136 offset:36864
    ds_read_b64_tr_b16 v[90:91], v136 offset:37888
    ds_read_b64_tr_b16 v[92:93], v137 offset:36864
    ds_read_b64_tr_b16 v[94:95], v137 offset:37888
    s_waitcnt lgkmcnt(6)
    v_mfma_f32_32x32x16_bf16 v[0:15], v[72:75], v[64:67], v[0:15]
    v_mfma_f32_32x32x16_bf16 v[16:31], v[76:79], v[64:67], v[16:31]
    v_mfma_f32_32x32x16_bf16 v[32:47], v[72:75], v[68:71], v[32:47]
    v_mfma_f32_32x32x16_bf16 v[48:63], v[76:79], v[68:71], v[48:63]
    ds_read_b128 v[64:67], v134 offset:32768
    ds_read_b128 v[68:71], v134 offset:36864
    ds_read_b64_tr_b16 v[72:73], v136 offset:40960
    ds_read_b64_tr_b16 v[74:75], v136 offset:41984
    ds_read_b64_tr_b16 v[76:77], v137 offset:40960
    ds_read_b64_tr_b16 v[78:79], v137 offset:41984
    s_waitcnt lgkmcnt(6)
    v_mfma_f32_32x32x16_bf16 v[0:15], v[88:91], v[80:83], v[0:15]
    v_mfma_f32_32x32x16_bf16 v[16:31], v[92:95], v[80:83], v[16:31]
    v_mfma_f32_32x32x16_bf16 v[32:47], v[88:91], v[84:87], v[32:47]
    v_mfma_f32_32x32x16_bf16 v[48:63], v[92:95], v[84:87], v[48:63]
    ds_read_b128 v[80:83], v135 offset:32768
    ds_read_b128 v[84:87], v135 offset:36864
    ds_read_b64_tr_b16 v[88:89], v136 offset:45056
    ds_read_b64_tr_b16 v[90:91], v136 offset:46080
    ds_read_b64_tr_b16 v[92:93], v137 offset:45056
    ds_read_b64_tr_b16 v[94:95], v137 offset:46080
    s_waitcnt lgkmcnt(6)
    v_mfma_f32_32x32x16_bf16 v[0:15], v[72:75], v[64:67], v[0:15]
    v_mfma_f32_32x32x16_bf16 v[16:31], v[76:79], v[64:67], v[16:31]
    v_mfma_f32_32x32x16_bf16 v[32:47], v[72:75], v[68:71], v[32:47]
    v_mfma_f32_32x32x16_bf16 v[48:63], v[76:79], v[68:71], v[48:63]
    s_waitcnt lgkmcnt(0)
    v_mfma_f32_32x32x16_bf16 v[0:15], v[88:91], v[80:83], v[0:15]
    v_mfma_f32_32x32x16_bf16 v[16:31], v[92:95], v[80:83], v[16:31]
    v_mfma_f32_32x32x16_bf16 v[32:47], v[88:91], v[84:87], v[32:47]
    v_mfma_f32_32x32x16_bf16 v[48:63], v[92:95], v[84:87], v[48:63]
    s_barrier
    s_nop 7
    s_nop 7
    s_add_u32 s16, s4, 192937984
    s_addc_u32 s17, s5, 0
    s_and_b32 s17, s17, 0xffff
    s_mov_b32 s18, 42467328
    s_mov_b32 s19, 0x00020000

    v_lshrrev_b32 v140, 7, v168
    v_lshrrev_b32 v141, 6, v168
    v_and_b32 v141, 1, v141
    v_and_b32 v142, 31, v169
    v_lshrrev_b32 v143, 5, v169
    v_lshl_add_u32 v142, v140, 6, v142
    v_mul_u32_u24 v142, 528, v142
    v_lshlrev_b32 v144, 8, v141
    v_lshl_add_u32 v144, v143, 4, v144
    v_add_u32 v142, v142, v144

    ds_write_b128 v142, v[0:3] offset:0
    ds_write_b128 v142, v[4:7] offset:32
    ds_write_b128 v142, v[8:11] offset:64
    ds_write_b128 v142, v[12:15] offset:96
    ds_write_b128 v142, v[16:19] offset:128
    ds_write_b128 v142, v[20:23] offset:160
    ds_write_b128 v142, v[24:27] offset:192
    ds_write_b128 v142, v[28:31] offset:224
    ds_write_b128 v142, v[32:35] offset:16896
    ds_write_b128 v142, v[36:39] offset:16928
    ds_write_b128 v142, v[40:43] offset:16960
    ds_write_b128 v142, v[44:47] offset:16992
    ds_write_b128 v142, v[48:51] offset:17024
    ds_write_b128 v142, v[52:55] offset:17056
    ds_write_b128 v142, v[56:59] offset:17088
    ds_write_b128 v142, v[60:63] offset:17120
    s_waitcnt lgkmcnt(0)
    s_barrier
    v_lshrrev_b32 v141, 5, v168
    v_and_b32 v142, 31, v168
    v_mul_u32_u24 v140, 528, v141
    v_lshl_add_u32 v140, v142, 4, v140
    v_mul_u32_u24 v143, 2304, v141
    v_lshl_add_u32 v143, v142, 4, v143
    s_lshl_b32 s37, s32, 7
    v_lshl_add_u32 v144, v142, 2, s37
    s_mul_i32 s36, s65, 9
    s_add_u32 s36, s36, s33
    s_mul_i32 s36, s36, 294912
    s_lshl_b32 s37, s32, 9
    s_add_u32 s36, s36, s37
    v_add_u32 v145, 33792, v140

    ds_read_b128 v[0:3], v140 offset:0
    ds_read_b128 v[4:7], v140 offset:4224
    ds_read_b128 v[8:11], v140 offset:8448
    ds_read_b128 v[12:15], v140 offset:12672
    ds_read_b128 v[16:19], v140 offset:16896
    ds_read_b128 v[20:23], v140 offset:21120
    ds_read_b128 v[24:27], v140 offset:25344
    ds_read_b128 v[28:31], v140 offset:29568
    ds_read_b128 v[32:35], v145 offset:0
    ds_read_b128 v[36:39], v145 offset:4224
    ds_read_b128 v[40:43], v145 offset:8448
    ds_read_b128 v[44:47], v145 offset:12672
    ds_read_b128 v[48:51], v145 offset:16896
    ds_read_b128 v[52:55], v145 offset:21120
    ds_read_b128 v[56:59], v145 offset:25344
    ds_read_b128 v[60:63], v145 offset:29568
    v_cmp_gt_u32 vcc, 576, v144
    s_and_saveexec_b64 s[60:61], vcc

    s_waitcnt lgkmcnt(15)
    buffer_store_dwordx4 v[0:3], v143, s[16:19], s36 offen sc1
    s_add_u32 s36, s36, 18432

    s_waitcnt lgkmcnt(14)
    buffer_store_dwordx4 v[4:7], v143, s[16:19], s36 offen sc1
    s_add_u32 s36, s36, 18432

    s_waitcnt lgkmcnt(13)
    buffer_store_dwordx4 v[8:11], v143, s[16:19], s36 offen sc1
    s_add_u32 s36, s36, 18432

    s_waitcnt lgkmcnt(12)
    buffer_store_dwordx4 v[12:15], v143, s[16:19], s36 offen sc1
    s_add_u32 s36, s36, 18432

    s_waitcnt lgkmcnt(11)
    buffer_store_dwordx4 v[16:19], v143, s[16:19], s36 offen sc1
    s_add_u32 s36, s36, 18432

    s_waitcnt lgkmcnt(10)
    buffer_store_dwordx4 v[20:23], v143, s[16:19], s36 offen sc1
    s_add_u32 s36, s36, 18432

    s_waitcnt lgkmcnt(9)
    buffer_store_dwordx4 v[24:27], v143, s[16:19], s36 offen sc1
    s_add_u32 s36, s36, 18432

    s_waitcnt lgkmcnt(8)
    buffer_store_dwordx4 v[28:31], v143, s[16:19], s36 offen sc1
    s_add_u32 s36, s36, 18432

    s_waitcnt lgkmcnt(7)
    buffer_store_dwordx4 v[32:35], v143, s[16:19], s36 offen sc1
    s_add_u32 s36, s36, 18432

    s_waitcnt lgkmcnt(6)
    buffer_store_dwordx4 v[36:39], v143, s[16:19], s36 offen sc1
    s_add_u32 s36, s36, 18432

    s_waitcnt lgkmcnt(5)
    buffer_store_dwordx4 v[40:43], v143, s[16:19], s36 offen sc1
    s_add_u32 s36, s36, 18432

    s_waitcnt lgkmcnt(4)
    buffer_store_dwordx4 v[44:47], v143, s[16:19], s36 offen sc1
    s_add_u32 s36, s36, 18432

    s_waitcnt lgkmcnt(3)
    buffer_store_dwordx4 v[48:51], v143, s[16:19], s36 offen sc1
    s_add_u32 s36, s36, 18432

    s_waitcnt lgkmcnt(2)
    buffer_store_dwordx4 v[52:55], v143, s[16:19], s36 offen sc1
    s_add_u32 s36, s36, 18432

    s_waitcnt lgkmcnt(1)
    buffer_store_dwordx4 v[56:59], v143, s[16:19], s36 offen sc1
    s_add_u32 s36, s36, 18432

    s_waitcnt lgkmcnt(0)
    buffer_store_dwordx4 v[60:63], v143, s[16:19], s36 offen sc1
    s_add_u32 s36, s36, 18432

    s_mov_b64 exec, s[60:61]
    s_lshl_b32 s72, s65, 6
    v_accvgpr_read_b32 v168, a0
    s_nop 0
    v_and_b32 v169, 63, v168

    s_waitcnt vmcnt(0)
    s_barrier
    v_cmp_eq_u32 vcc, 0, v168
    s_and_saveexec_b64 s[76:77], vcc
    s_cbranch_execz L_sig_92
    v_mov_b32 v140, 16384
    v_mov_b32 v141, 1

    buffer_atomic_add v141, v140, s[68:71], s72 offen
L_sig_92:
    s_mov_b64 exec, s[76:77]
    s_add_u32 s65, s65, 1
    s_cmp_lt_u32 s65, 16
    s_cbranch_scc1 L_rloop_89
    s_branch L_end_1

L_rskip_88:
    s_sub_u32 s66, s64, 205
    s_cmp_ge_u32 s66, 16
    s_cbranch_scc1 L_rskip_93
    s_mov_b32 s65, 0

L_rloop_94:
    s_lshl_b32 s72, s65, 6
    v_accvgpr_read_b32 v168, a0
    s_nop 0
    v_and_b32 v169, 63, v168

    v_lshrrev_b32 v140, 6, v168
    s_nop 0
    v_readfirstlane_b32 s78, v140
    s_cmp_lg_u32 s78, 0
    s_cbranch_scc1 L_wpollx_96
    v_mov_b32 v140, 16384
    s_mov_b32 s79, 0

L_wpoll_95:
    buffer_load_dword v141, v140, s[68:71], s72 offen sc1
    s_add_u32 s79, s79, 1
    s_waitcnt vmcnt(0)
    v_readfirstlane_b32 s78, v141
    s_cmp_ge_u32 s78, 45
    s_cbranch_scc1 L_wpollx_96
    s_cmp_gt_u32 s79, 200000
    s_cbranch_scc1 L_wpollx_96
    s_sleep 24
    s_branch L_wpoll_95

L_wpollx_96:
    s_barrier
    s_load_dwordx2 s[6:7], s[80:81], 104
    s_add_u32 s8, s4, 192937984
    s_addc_u32 s9, s5, 0
    s_and_b32 s9, s9, 0xffff
    s_mov_b32 s10, 42467328
    s_mov_b32 s11, 0x00020000

    s_add_u32 s16, s4, 0
    s_addc_u32 s17, s5, 0
    s_and_b32 s17, s17, 0xffff
    s_mov_b32 s18, 13824
    s_mov_b32 s19, 0x00020000

    s_add_u32 s24, s4, 83886080
    s_addc_u32 s25, s5, 0
    s_and_b32 s25, s25, 0xffff
    s_mov_b32 s26, 2359296
    s_mov_b32 s27, 0x00020000

    s_add_u32 s28, s4, 88080384
    s_addc_u32 s29, s5, 0
    s_and_b32 s29, s29, 0xffff
    s_mov_b32 s30, 2359296
    s_mov_b32 s31, 0x00020000

    s_waitcnt lgkmcnt(0)
    s_mov_b32 s12, s6
    s_and_b32 s13, s7, 0xffff
    s_mov_b32 s14, 2359296
    s_mov_b32 s15, 0x00020000

    v_mov_b32 v0, v168
    v_and_b32 v1, 63, v0
    v_lshrrev_b32 v2, 6, v0
    s_nop 0
    v_readfirstlane_b32 s20, v2
    s_lshl_b32 s21, s66, 3
    s_lshl_b32 s22, s20, 1
    s_add_u32 s21, s21, s22
    v_lshlrev_b32 v3, 4, v1
    v_lshlrev_b32 v2, 5, v1
    v_cmp_gt_u32 vcc, 8, v1
    s_mov_b64 s[44:45], vcc
    s_mov_b32 s46, 11520
    buffer_load_dwordx4 v[72:75], v2, s[16:19], s46 offen
    buffer_load_dwordx4 v[76:79], v2, s[16:19], s46 offen offset:16
    s_mov_b64 exec, s[44:45]
    buffer_load_dwordx4 v[80:83], v2, s[16:19], s46 offen offset:2048
    buffer_load_dwordx4 v[84:87], v2, s[16:19], s46 offen offset:2064
    s_mov_b64 exec, -1

    s_add_u32 s47, s21, 0
    s_mul_i32 s48, s47, 2304
    s_mul_i32 s49, s65, 2654208
    s_add_u32 s48, s48, s49
    s_lshl_b32 s49, s65, 7
    s_add_u32 s49, s49, s47
    s_mul_i32 s49, s49, 1152

    buffer_load_dwordx4 v[96:99], v2, s[8:11], s48 offen
    buffer_load_dwordx4 v[100:103], v2, s[8:11], s48 offen offset:16
    s_mov_b64 exec, s[44:45]
    buffer_load_dwordx4 v[104:107], v2, s[8:11], s48 offen offset:2048
    buffer_load_dwordx4 v[108:111], v2, s[8:11], s48 offen offset:2064
    s_mov_b64 exec, -1
    s_add_u32 s48, s48, 294912

    buffer_load_dwordx4 v[112:115], v2, s[8:11], s48 offen
    buffer_load_dwordx4 v[116:119], v2, s[8:11], s48 offen offset:16
    s_mov_b64 exec, s[44:45]
    buffer_load_dwordx4 v[120:123], v2, s[8:11], s48 offen offset:2048
    buffer_load_dwordx4 v[124:127], v2, s[8:11], s48 offen offset:2064
    s_mov_b64 exec, -1
    s_add_u32 s48, s48, 294912

    buffer_load_dwordx4 v[128:131], v2, s[8:11], s48 offen
    buffer_load_dwordx4 v[132:135], v2, s[8:11], s48 offen offset:16
    s_mov_b64 exec, s[44:45]
    buffer_load_dwordx4 v[136:139], v2, s[8:11], s48 offen offset:2048
    buffer_load_dwordx4 v[140:143], v2, s[8:11], s48 offen offset:2064
    s_mov_b64 exec, -1
    s_add_u32 s48, s48, 294912

    buffer_load_dwordx4 v[144:147], v2, s[8:11], s48 offen
    buffer_load_dwordx4 v[148:151], v2, s[8:11], s48 offen offset:16
    s_mov_b64 exec, s[44:45]
    buffer_load_dwordx4 v[152:155], v2, s[8:11], s48 offen offset:2048
    buffer_load_dwordx4 v[156:159], v2, s[8:11], s48 offen offset:2064
    s_mov_b64 exec, -1
    s_add_u32 s48, s48, 294912

    buffer_load_dwordx4 v[160:163], v2, s[8:11], s48 offen
    buffer_load_dwordx4 v[164:167], v2, s[8:11], s48 offen offset:16
    s_mov_b64 exec, s[44:45]
    buffer_load_dwordx4 v[168:171], v2, s[8:11], s48 offen offset:2048
    buffer_load_dwordx4 v[172:175], v2, s[8:11], s48 offen offset:2064
    s_mov_b64 exec, -1
    s_add_u32 s48, s48, 294912

    buffer_load_dwordx4 v[176:179], v2, s[8:11], s48 offen
    buffer_load_dwordx4 v[180:183], v2, s[8:11], s48 offen offset:16
    s_mov_b64 exec, s[44:45]
    buffer_load_dwordx4 v[184:187], v2, s[8:11], s48 offen offset:2048
    buffer_load_dwordx4 v[188:191], v2, s[8:11], s48 offen offset:2064
    s_mov_b64 exec, -1
    s_add_u32 s48, s48, 294912

    buffer_load_dwordx4 v[192:195], v2, s[8:11], s48 offen
    buffer_load_dwordx4 v[196:199], v2, s[8:11], s48 offen offset:16
    s_mov_b64 exec, s[44:45]
    buffer_load_dwordx4 v[200:203], v2, s[8:11], s48 offen offset:2048
    buffer_load_dwordx4 v[204:207], v2, s[8:11], s48 offen offset:2064
    s_mov_b64 exec, -1
    s_add_u32 s48, s48, 294912

    buffer_load_dwordx4 v[208:211], v2, s[8:11], s48 offen
    buffer_load_dwordx4 v[212:215], v2, s[8:11], s48 offen offset:16
    s_mov_b64 exec, s[44:45]
    buffer_load_dwordx4 v[216:219], v2, s[8:11], s48 offen offset:2048
    buffer_load_dwordx4 v[220:223], v2, s[8:11], s48 offen offset:2064
    s_mov_b64 exec, -1
    s_add_u32 s48, s48, 294912

    buffer_load_dwordx4 v[224:227], v2, s[8:11], s48 offen
    buffer_load_dwordx4 v[228:231], v2, s[8:11], s48 offen offset:16
    s_mov_b64 exec, s[44:45]
    buffer_load_dwordx4 v[232:235], v2, s[8:11], s48 offen offset:2048
    buffer_load_dwordx4 v[236:239], v2, s[8:11], s48 offen offset:2064
    s_mov_b64 exec, -1
    s_add_u32 s48, s48, 294912

    v_mov_b32 v8, 0
    v_mov_b32 v9, 0
    v_mov_b32 v10, 0
    v_mov_b32 v11, 0
    buffer_load_dwordx4 v[4:7], v3, s[24:27], s49 offen
    s_mov_b64 exec, s[44:45]
    buffer_load_dwordx4 v[8:11], v3, s[24:27], s49 offen offset:1024
    s_mov_b64 exec, -1
    s_waitcnt vmcnt(0)

    v_add_f32 v96, v96, v112
    v_add_f32 v97, v97, v113
    v_add_f32 v98, v98, v114
    v_add_f32 v99, v99, v115
    v_add_f32 v100, v100, v116
    v_add_f32 v101, v101, v117
    v_add_f32 v102, v102, v118
    v_add_f32 v103, v103, v119
    v_add_f32 v104, v104, v120
    v_add_f32 v105, v105, v121
    v_add_f32 v106, v106, v122
    v_add_f32 v107, v107, v123
    v_add_f32 v108, v108, v124
    v_add_f32 v109, v109, v125
    v_add_f32 v110, v110, v126
    v_add_f32 v111, v111, v127
    v_add_f32 v96, v96, v128
    v_add_f32 v97, v97, v129
    v_add_f32 v98, v98, v130
    v_add_f32 v99, v99, v131
    v_add_f32 v100, v100, v132
    v_add_f32 v101, v101, v133
    v_add_f32 v102, v102, v134
    v_add_f32 v103, v103, v135
    v_add_f32 v104, v104, v136
    v_add_f32 v105, v105, v137
    v_add_f32 v106, v106, v138
    v_add_f32 v107, v107, v139
    v_add_f32 v108, v108, v140
    v_add_f32 v109, v109, v141
    v_add_f32 v110, v110, v142
    v_add_f32 v111, v111, v143
    v_add_f32 v96, v96, v144
    v_add_f32 v97, v97, v145
    v_add_f32 v98, v98, v146
    v_add_f32 v99, v99, v147
    v_add_f32 v100, v100, v148
    v_add_f32 v101, v101, v149
    v_add_f32 v102, v102, v150
    v_add_f32 v103, v103, v151
    v_add_f32 v104, v104, v152
    v_add_f32 v105, v105, v153
    v_add_f32 v106, v106, v154
    v_add_f32 v107, v107, v155
    v_add_f32 v108, v108, v156
    v_add_f32 v109, v109, v157
    v_add_f32 v110, v110, v158
    v_add_f32 v111, v111, v159
    v_add_f32 v96, v96, v160
    v_add_f32 v97, v97, v161
    v_add_f32 v98, v98, v162
    v_add_f32 v99, v99, v163
    v_add_f32 v100, v100, v164
    v_add_f32 v101, v101, v165
    v_add_f32 v102, v102, v166
    v_add_f32 v103, v103, v167
    v_add_f32 v104, v104, v168
    v_add_f32 v105, v105, v169
    v_add_f32 v106, v106, v170
    v_add_f32 v107, v107, v171
    v_add_f32 v108, v108, v172
    v_add_f32 v109, v109, v173
    v_add_f32 v110, v110, v174
    v_add_f32 v111, v111, v175
    v_add_f32 v96, v96, v176
    v_add_f32 v97, v97, v177
    v_add_f32 v98, v98, v178
    v_add_f32 v99, v99, v179
    v_add_f32 v100, v100, v180
    v_add_f32 v101, v101, v181
    v_add_f32 v102, v102, v182
    v_add_f32 v103, v103, v183
    v_add_f32 v104, v104, v184
    v_add_f32 v105, v105, v185
    v_add_f32 v106, v106, v186
    v_add_f32 v107, v107, v187
    v_add_f32 v108, v108, v188
    v_add_f32 v109, v109, v189
    v_add_f32 v110, v110, v190
    v_add_f32 v111, v111, v191
    v_add_f32 v96, v96, v192
    v_add_f32 v97, v97, v193
    v_add_f32 v98, v98, v194
    v_add_f32 v99, v99, v195
    v_add_f32 v100, v100, v196
    v_add_f32 v101, v101, v197
    v_add_f32 v102, v102, v198
    v_add_f32 v103, v103, v199
    v_add_f32 v104, v104, v200
    v_add_f32 v105, v105, v201
    v_add_f32 v106, v106, v202
    v_add_f32 v107, v107, v203
    v_add_f32 v108, v108, v204
    v_add_f32 v109, v109, v205
    v_add_f32 v110, v110, v206
    v_add_f32 v111, v111, v207
    v_add_f32 v96, v96, v208
    v_add_f32 v97, v97, v209
    v_add_f32 v98, v98, v210
    v_add_f32 v99, v99, v211
    v_add_f32 v100, v100, v212
    v_add_f32 v101, v101, v213
    v_add_f32 v102, v102, v214
    v_add_f32 v103, v103, v215
    v_add_f32 v104, v104, v216
    v_add_f32 v105, v105, v217
    v_add_f32 v106, v106, v218
    v_add_f32 v107, v107, v219
    v_add_f32 v108, v108, v220
    v_add_f32 v109, v109, v221
    v_add_f32 v110, v110, v222
    v_add_f32 v111, v111, v223
    v_add_f32 v96, v96, v224
    v_add_f32 v97, v97, v225
    v_add_f32 v98, v98, v226
    v_add_f32 v99, v99, v227
    v_add_f32 v100, v100, v228
    v_add_f32 v101, v101, v229
    v_add_f32 v102, v102, v230
    v_add_f32 v103, v103, v231
    v_add_f32 v104, v104, v232
    v_add_f32 v105, v105, v233
    v_add_f32 v106, v106, v234
    v_add_f32 v107, v107, v235
    v_add_f32 v108, v108, v236
    v_add_f32 v109, v109, v237
    v_add_f32 v110, v110, v238
    v_add_f32 v111, v111, v239
    v_cvt_pk_bf16_f32 v33, v96, v97
    v_lshlrev_b32 v96, 16, v33
    v_and_b32 v97, 0xffff0000, v33

    v_mul_f32 v96, v96, v72
    v_mul_f32 v97, v97, v73

    v_cvt_pk_bf16_f32 v33, v96, v97
    v_lshlrev_b32 v96, 16, v33
    v_and_b32 v97, 0xffff0000, v33

    v_lshlrev_b32 v16, 16, v4
    v_and_b32 v17, 0xffff0000, v4
    v_add_f32 v16, v16, v96
    v_add_f32 v17, v17, v97
    v_cvt_pk_bf16_f32 v4, v16, v17
    v_lshlrev_b32 v16, 16, v4
    v_and_b32 v17, 0xffff0000, v4

    v_cvt_pk_bf16_f32 v33, v98, v99
    v_lshlrev_b32 v98, 16, v33
    v_and_b32 v99, 0xffff0000, v33

    v_mul_f32 v98, v98, v74
    v_mul_f32 v99, v99, v75

    v_cvt_pk_bf16_f32 v33, v98, v99
    v_lshlrev_b32 v98, 16, v33
    v_and_b32 v99, 0xffff0000, v33

    v_lshlrev_b32 v18, 16, v5
    v_and_b32 v19, 0xffff0000, v5
    v_add_f32 v18, v18, v98
    v_add_f32 v19, v19, v99
    v_cvt_pk_bf16_f32 v5, v18, v19
    v_lshlrev_b32 v18, 16, v5
    v_and_b32 v19, 0xffff0000, v5

    v_cvt_pk_bf16_f32 v33, v100, v101
    v_lshlrev_b32 v100, 16, v33
    v_and_b32 v101, 0xffff0000, v33

    v_mul_f32 v100, v100, v76
    v_mul_f32 v101, v101, v77

    v_cvt_pk_bf16_f32 v33, v100, v101
    v_lshlrev_b32 v100, 16, v33
    v_and_b32 v101, 0xffff0000, v33

    v_lshlrev_b32 v20, 16, v6
    v_and_b32 v21, 0xffff0000, v6
    v_add_f32 v20, v20, v100
    v_add_f32 v21, v21, v101
    v_cvt_pk_bf16_f32 v6, v20, v21
    v_lshlrev_b32 v20, 16, v6
    v_and_b32 v21, 0xffff0000, v6

    v_cvt_pk_bf16_f32 v33, v102, v103
    v_lshlrev_b32 v102, 16, v33
    v_and_b32 v103, 0xffff0000, v33

    v_mul_f32 v102, v102, v78
    v_mul_f32 v103, v103, v79

    v_cvt_pk_bf16_f32 v33, v102, v103
    v_lshlrev_b32 v102, 16, v33
    v_and_b32 v103, 0xffff0000, v33

    v_lshlrev_b32 v22, 16, v7
    v_and_b32 v23, 0xffff0000, v7
    v_add_f32 v22, v22, v102
    v_add_f32 v23, v23, v103
    v_cvt_pk_bf16_f32 v7, v22, v23
    v_lshlrev_b32 v22, 16, v7
    v_and_b32 v23, 0xffff0000, v7

    v_cvt_pk_bf16_f32 v33, v104, v105
    v_lshlrev_b32 v104, 16, v33
    v_and_b32 v105, 0xffff0000, v33

    v_mul_f32 v104, v104, v80
    v_mul_f32 v105, v105, v81

    v_cvt_pk_bf16_f32 v33, v104, v105
    v_lshlrev_b32 v104, 16, v33
    v_and_b32 v105, 0xffff0000, v33

    v_lshlrev_b32 v24, 16, v8
    v_and_b32 v25, 0xffff0000, v8
    v_add_f32 v24, v24, v104
    v_add_f32 v25, v25, v105
    v_cvt_pk_bf16_f32 v8, v24, v25
    v_lshlrev_b32 v24, 16, v8
    v_and_b32 v25, 0xffff0000, v8

    v_cvt_pk_bf16_f32 v33, v106, v107
    v_lshlrev_b32 v106, 16, v33
    v_and_b32 v107, 0xffff0000, v33

    v_mul_f32 v106, v106, v82
    v_mul_f32 v107, v107, v83

    v_cvt_pk_bf16_f32 v33, v106, v107
    v_lshlrev_b32 v106, 16, v33
    v_and_b32 v107, 0xffff0000, v33

    v_lshlrev_b32 v26, 16, v9
    v_and_b32 v27, 0xffff0000, v9
    v_add_f32 v26, v26, v106
    v_add_f32 v27, v27, v107
    v_cvt_pk_bf16_f32 v9, v26, v27
    v_lshlrev_b32 v26, 16, v9
    v_and_b32 v27, 0xffff0000, v9

    v_cvt_pk_bf16_f32 v33, v108, v109
    v_lshlrev_b32 v108, 16, v33
    v_and_b32 v109, 0xffff0000, v33

    v_mul_f32 v108, v108, v84
    v_mul_f32 v109, v109, v85

    v_cvt_pk_bf16_f32 v33, v108, v109
    v_lshlrev_b32 v108, 16, v33
    v_and_b32 v109, 0xffff0000, v33

    v_lshlrev_b32 v28, 16, v10
    v_and_b32 v29, 0xffff0000, v10
    v_add_f32 v28, v28, v108
    v_add_f32 v29, v29, v109
    v_cvt_pk_bf16_f32 v10, v28, v29
    v_lshlrev_b32 v28, 16, v10
    v_and_b32 v29, 0xffff0000, v10

    v_cvt_pk_bf16_f32 v33, v110, v111
    v_lshlrev_b32 v110, 16, v33
    v_and_b32 v111, 0xffff0000, v33

    v_mul_f32 v110, v110, v86
    v_mul_f32 v111, v111, v87

    v_cvt_pk_bf16_f32 v33, v110, v111
    v_lshlrev_b32 v110, 16, v33
    v_and_b32 v111, 0xffff0000, v33

    v_lshlrev_b32 v30, 16, v11
    v_and_b32 v31, 0xffff0000, v11
    v_add_f32 v30, v30, v110
    v_add_f32 v31, v31, v111
    v_cvt_pk_bf16_f32 v11, v30, v31
    v_lshlrev_b32 v30, 16, v11
    v_and_b32 v31, 0xffff0000, v11

    buffer_store_dwordx4 v[4:7], v3, s[12:15], s49 offen
    s_mov_b64 exec, s[44:45]
    buffer_store_dwordx4 v[8:11], v3, s[12:15], s49 offen offset:1024
    s_mov_b64 exec, -1
    s_nop 1

    s_add_u32 s47, s21, 1
    s_mul_i32 s48, s47, 2304
    s_mul_i32 s49, s65, 2654208
    s_add_u32 s48, s48, s49
    s_lshl_b32 s49, s65, 7
    s_add_u32 s49, s49, s47
    s_mul_i32 s49, s49, 1152

    buffer_load_dwordx4 v[96:99], v2, s[8:11], s48 offen
    buffer_load_dwordx4 v[100:103], v2, s[8:11], s48 offen offset:16
    s_mov_b64 exec, s[44:45]
    buffer_load_dwordx4 v[104:107], v2, s[8:11], s48 offen offset:2048
    buffer_load_dwordx4 v[108:111], v2, s[8:11], s48 offen offset:2064
    s_mov_b64 exec, -1
    s_add_u32 s48, s48, 294912

    buffer_load_dwordx4 v[112:115], v2, s[8:11], s48 offen
    buffer_load_dwordx4 v[116:119], v2, s[8:11], s48 offen offset:16
    s_mov_b64 exec, s[44:45]
    buffer_load_dwordx4 v[120:123], v2, s[8:11], s48 offen offset:2048
    buffer_load_dwordx4 v[124:127], v2, s[8:11], s48 offen offset:2064
    s_mov_b64 exec, -1
    s_add_u32 s48, s48, 294912

    buffer_load_dwordx4 v[128:131], v2, s[8:11], s48 offen
    buffer_load_dwordx4 v[132:135], v2, s[8:11], s48 offen offset:16
    s_mov_b64 exec, s[44:45]
    buffer_load_dwordx4 v[136:139], v2, s[8:11], s48 offen offset:2048
    buffer_load_dwordx4 v[140:143], v2, s[8:11], s48 offen offset:2064
    s_mov_b64 exec, -1
    s_add_u32 s48, s48, 294912

    buffer_load_dwordx4 v[144:147], v2, s[8:11], s48 offen
    buffer_load_dwordx4 v[148:151], v2, s[8:11], s48 offen offset:16
    s_mov_b64 exec, s[44:45]
    buffer_load_dwordx4 v[152:155], v2, s[8:11], s48 offen offset:2048
    buffer_load_dwordx4 v[156:159], v2, s[8:11], s48 offen offset:2064
    s_mov_b64 exec, -1
    s_add_u32 s48, s48, 294912

    buffer_load_dwordx4 v[160:163], v2, s[8:11], s48 offen
    buffer_load_dwordx4 v[164:167], v2, s[8:11], s48 offen offset:16
    s_mov_b64 exec, s[44:45]
    buffer_load_dwordx4 v[168:171], v2, s[8:11], s48 offen offset:2048
    buffer_load_dwordx4 v[172:175], v2, s[8:11], s48 offen offset:2064
    s_mov_b64 exec, -1
    s_add_u32 s48, s48, 294912

    buffer_load_dwordx4 v[176:179], v2, s[8:11], s48 offen
    buffer_load_dwordx4 v[180:183], v2, s[8:11], s48 offen offset:16
    s_mov_b64 exec, s[44:45]
    buffer_load_dwordx4 v[184:187], v2, s[8:11], s48 offen offset:2048
    buffer_load_dwordx4 v[188:191], v2, s[8:11], s48 offen offset:2064
    s_mov_b64 exec, -1
    s_add_u32 s48, s48, 294912

    buffer_load_dwordx4 v[192:195], v2, s[8:11], s48 offen
    buffer_load_dwordx4 v[196:199], v2, s[8:11], s48 offen offset:16
    s_mov_b64 exec, s[44:45]
    buffer_load_dwordx4 v[200:203], v2, s[8:11], s48 offen offset:2048
    buffer_load_dwordx4 v[204:207], v2, s[8:11], s48 offen offset:2064
    s_mov_b64 exec, -1
    s_add_u32 s48, s48, 294912

    buffer_load_dwordx4 v[208:211], v2, s[8:11], s48 offen
    buffer_load_dwordx4 v[212:215], v2, s[8:11], s48 offen offset:16
    s_mov_b64 exec, s[44:45]
    buffer_load_dwordx4 v[216:219], v2, s[8:11], s48 offen offset:2048
    buffer_load_dwordx4 v[220:223], v2, s[8:11], s48 offen offset:2064
    s_mov_b64 exec, -1
    s_add_u32 s48, s48, 294912

    buffer_load_dwordx4 v[224:227], v2, s[8:11], s48 offen
    buffer_load_dwordx4 v[228:231], v2, s[8:11], s48 offen offset:16
    s_mov_b64 exec, s[44:45]
    buffer_load_dwordx4 v[232:235], v2, s[8:11], s48 offen offset:2048
    buffer_load_dwordx4 v[236:239], v2, s[8:11], s48 offen offset:2064
    s_mov_b64 exec, -1
    s_add_u32 s48, s48, 294912

    v_mov_b32 v8, 0
    v_mov_b32 v9, 0
    v_mov_b32 v10, 0
    v_mov_b32 v11, 0
    buffer_load_dwordx4 v[4:7], v3, s[24:27], s49 offen
    s_mov_b64 exec, s[44:45]
    buffer_load_dwordx4 v[8:11], v3, s[24:27], s49 offen offset:1024
    s_mov_b64 exec, -1
    s_waitcnt vmcnt(0)

    v_add_f32 v96, v96, v112
    v_add_f32 v97, v97, v113
    v_add_f32 v98, v98, v114
    v_add_f32 v99, v99, v115
    v_add_f32 v100, v100, v116
    v_add_f32 v101, v101, v117
    v_add_f32 v102, v102, v118
    v_add_f32 v103, v103, v119
    v_add_f32 v104, v104, v120
    v_add_f32 v105, v105, v121
    v_add_f32 v106, v106, v122
    v_add_f32 v107, v107, v123
    v_add_f32 v108, v108, v124
    v_add_f32 v109, v109, v125
    v_add_f32 v110, v110, v126
    v_add_f32 v111, v111, v127
    v_add_f32 v96, v96, v128
    v_add_f32 v97, v97, v129
    v_add_f32 v98, v98, v130
    v_add_f32 v99, v99, v131
    v_add_f32 v100, v100, v132
    v_add_f32 v101, v101, v133
    v_add_f32 v102, v102, v134
    v_add_f32 v103, v103, v135
    v_add_f32 v104, v104, v136
    v_add_f32 v105, v105, v137
    v_add_f32 v106, v106, v138
    v_add_f32 v107, v107, v139
    v_add_f32 v108, v108, v140
    v_add_f32 v109, v109, v141
    v_add_f32 v110, v110, v142
    v_add_f32 v111, v111, v143
    v_add_f32 v96, v96, v144
    v_add_f32 v97, v97, v145
    v_add_f32 v98, v98, v146
    v_add_f32 v99, v99, v147
    v_add_f32 v100, v100, v148
    v_add_f32 v101, v101, v149
    v_add_f32 v102, v102, v150
    v_add_f32 v103, v103, v151
    v_add_f32 v104, v104, v152
    v_add_f32 v105, v105, v153
    v_add_f32 v106, v106, v154
    v_add_f32 v107, v107, v155
    v_add_f32 v108, v108, v156
    v_add_f32 v109, v109, v157
    v_add_f32 v110, v110, v158
    v_add_f32 v111, v111, v159
    v_add_f32 v96, v96, v160
    v_add_f32 v97, v97, v161
    v_add_f32 v98, v98, v162
    v_add_f32 v99, v99, v163
    v_add_f32 v100, v100, v164
    v_add_f32 v101, v101, v165
    v_add_f32 v102, v102, v166
    v_add_f32 v103, v103, v167
    v_add_f32 v104, v104, v168
    v_add_f32 v105, v105, v169
    v_add_f32 v106, v106, v170
    v_add_f32 v107, v107, v171
    v_add_f32 v108, v108, v172
    v_add_f32 v109, v109, v173
    v_add_f32 v110, v110, v174
    v_add_f32 v111, v111, v175
    v_add_f32 v96, v96, v176
    v_add_f32 v97, v97, v177
    v_add_f32 v98, v98, v178
    v_add_f32 v99, v99, v179
    v_add_f32 v100, v100, v180
    v_add_f32 v101, v101, v181
    v_add_f32 v102, v102, v182
    v_add_f32 v103, v103, v183
    v_add_f32 v104, v104, v184
    v_add_f32 v105, v105, v185
    v_add_f32 v106, v106, v186
    v_add_f32 v107, v107, v187
    v_add_f32 v108, v108, v188
    v_add_f32 v109, v109, v189
    v_add_f32 v110, v110, v190
    v_add_f32 v111, v111, v191
    v_add_f32 v96, v96, v192
    v_add_f32 v97, v97, v193
    v_add_f32 v98, v98, v194
    v_add_f32 v99, v99, v195
    v_add_f32 v100, v100, v196
    v_add_f32 v101, v101, v197
    v_add_f32 v102, v102, v198
    v_add_f32 v103, v103, v199
    v_add_f32 v104, v104, v200
    v_add_f32 v105, v105, v201
    v_add_f32 v106, v106, v202
    v_add_f32 v107, v107, v203
    v_add_f32 v108, v108, v204
    v_add_f32 v109, v109, v205
    v_add_f32 v110, v110, v206
    v_add_f32 v111, v111, v207
    v_add_f32 v96, v96, v208
    v_add_f32 v97, v97, v209
    v_add_f32 v98, v98, v210
    v_add_f32 v99, v99, v211
    v_add_f32 v100, v100, v212
    v_add_f32 v101, v101, v213
    v_add_f32 v102, v102, v214
    v_add_f32 v103, v103, v215
    v_add_f32 v104, v104, v216
    v_add_f32 v105, v105, v217
    v_add_f32 v106, v106, v218
    v_add_f32 v107, v107, v219
    v_add_f32 v108, v108, v220
    v_add_f32 v109, v109, v221
    v_add_f32 v110, v110, v222
    v_add_f32 v111, v111, v223
    v_add_f32 v96, v96, v224
    v_add_f32 v97, v97, v225
    v_add_f32 v98, v98, v226
    v_add_f32 v99, v99, v227
    v_add_f32 v100, v100, v228
    v_add_f32 v101, v101, v229
    v_add_f32 v102, v102, v230
    v_add_f32 v103, v103, v231
    v_add_f32 v104, v104, v232
    v_add_f32 v105, v105, v233
    v_add_f32 v106, v106, v234
    v_add_f32 v107, v107, v235
    v_add_f32 v108, v108, v236
    v_add_f32 v109, v109, v237
    v_add_f32 v110, v110, v238
    v_add_f32 v111, v111, v239
    v_cvt_pk_bf16_f32 v33, v96, v97
    v_lshlrev_b32 v96, 16, v33
    v_and_b32 v97, 0xffff0000, v33

    v_mul_f32 v96, v96, v72
    v_mul_f32 v97, v97, v73

    v_cvt_pk_bf16_f32 v33, v96, v97
    v_lshlrev_b32 v96, 16, v33
    v_and_b32 v97, 0xffff0000, v33

    v_lshlrev_b32 v16, 16, v4
    v_and_b32 v17, 0xffff0000, v4
    v_add_f32 v16, v16, v96
    v_add_f32 v17, v17, v97
    v_cvt_pk_bf16_f32 v4, v16, v17
    v_lshlrev_b32 v16, 16, v4
    v_and_b32 v17, 0xffff0000, v4

    v_cvt_pk_bf16_f32 v33, v98, v99
    v_lshlrev_b32 v98, 16, v33
    v_and_b32 v99, 0xffff0000, v33

    v_mul_f32 v98, v98, v74
    v_mul_f32 v99, v99, v75

    v_cvt_pk_bf16_f32 v33, v98, v99
    v_lshlrev_b32 v98, 16, v33
    v_and_b32 v99, 0xffff0000, v33

    v_lshlrev_b32 v18, 16, v5
    v_and_b32 v19, 0xffff0000, v5
    v_add_f32 v18, v18, v98
    v_add_f32 v19, v19, v99
    v_cvt_pk_bf16_f32 v5, v18, v19
    v_lshlrev_b32 v18, 16, v5
    v_and_b32 v19, 0xffff0000, v5

    v_cvt_pk_bf16_f32 v33, v100, v101
    v_lshlrev_b32 v100, 16, v33
    v_and_b32 v101, 0xffff0000, v33

    v_mul_f32 v100, v100, v76
    v_mul_f32 v101, v101, v77

    v_cvt_pk_bf16_f32 v33, v100, v101
    v_lshlrev_b32 v100, 16, v33
    v_and_b32 v101, 0xffff0000, v33

    v_lshlrev_b32 v20, 16, v6
    v_and_b32 v21, 0xffff0000, v6
    v_add_f32 v20, v20, v100
    v_add_f32 v21, v21, v101
    v_cvt_pk_bf16_f32 v6, v20, v21
    v_lshlrev_b32 v20, 16, v6
    v_and_b32 v21, 0xffff0000, v6

    v_cvt_pk_bf16_f32 v33, v102, v103
    v_lshlrev_b32 v102, 16, v33
    v_and_b32 v103, 0xffff0000, v33

    v_mul_f32 v102, v102, v78
    v_mul_f32 v103, v103, v79

    v_cvt_pk_bf16_f32 v33, v102, v103
    v_lshlrev_b32 v102, 16, v33
    v_and_b32 v103, 0xffff0000, v33

    v_lshlrev_b32 v22, 16, v7
    v_and_b32 v23, 0xffff0000, v7
    v_add_f32 v22, v22, v102
    v_add_f32 v23, v23, v103
    v_cvt_pk_bf16_f32 v7, v22, v23
    v_lshlrev_b32 v22, 16, v7
    v_and_b32 v23, 0xffff0000, v7

    v_cvt_pk_bf16_f32 v33, v104, v105
    v_lshlrev_b32 v104, 16, v33
    v_and_b32 v105, 0xffff0000, v33

    v_mul_f32 v104, v104, v80
    v_mul_f32 v105, v105, v81

    v_cvt_pk_bf16_f32 v33, v104, v105
    v_lshlrev_b32 v104, 16, v33
    v_and_b32 v105, 0xffff0000, v33

    v_lshlrev_b32 v24, 16, v8
    v_and_b32 v25, 0xffff0000, v8
    v_add_f32 v24, v24, v104
    v_add_f32 v25, v25, v105
    v_cvt_pk_bf16_f32 v8, v24, v25
    v_lshlrev_b32 v24, 16, v8
    v_and_b32 v25, 0xffff0000, v8

    v_cvt_pk_bf16_f32 v33, v106, v107
    v_lshlrev_b32 v106, 16, v33
    v_and_b32 v107, 0xffff0000, v33

    v_mul_f32 v106, v106, v82
    v_mul_f32 v107, v107, v83

    v_cvt_pk_bf16_f32 v33, v106, v107
    v_lshlrev_b32 v106, 16, v33
    v_and_b32 v107, 0xffff0000, v33

    v_lshlrev_b32 v26, 16, v9
    v_and_b32 v27, 0xffff0000, v9
    v_add_f32 v26, v26, v106
    v_add_f32 v27, v27, v107
    v_cvt_pk_bf16_f32 v9, v26, v27
    v_lshlrev_b32 v26, 16, v9
    v_and_b32 v27, 0xffff0000, v9

    v_cvt_pk_bf16_f32 v33, v108, v109
    v_lshlrev_b32 v108, 16, v33
    v_and_b32 v109, 0xffff0000, v33

    v_mul_f32 v108, v108, v84
    v_mul_f32 v109, v109, v85

    v_cvt_pk_bf16_f32 v33, v108, v109
    v_lshlrev_b32 v108, 16, v33
    v_and_b32 v109, 0xffff0000, v33

    v_lshlrev_b32 v28, 16, v10
    v_and_b32 v29, 0xffff0000, v10
    v_add_f32 v28, v28, v108
    v_add_f32 v29, v29, v109
    v_cvt_pk_bf16_f32 v10, v28, v29
    v_lshlrev_b32 v28, 16, v10
    v_and_b32 v29, 0xffff0000, v10

    v_cvt_pk_bf16_f32 v33, v110, v111
    v_lshlrev_b32 v110, 16, v33
    v_and_b32 v111, 0xffff0000, v33

    v_mul_f32 v110, v110, v86
    v_mul_f32 v111, v111, v87

    v_cvt_pk_bf16_f32 v33, v110, v111
    v_lshlrev_b32 v110, 16, v33
    v_and_b32 v111, 0xffff0000, v33

    v_lshlrev_b32 v30, 16, v11
    v_and_b32 v31, 0xffff0000, v11
    v_add_f32 v30, v30, v110
    v_add_f32 v31, v31, v111
    v_cvt_pk_bf16_f32 v11, v30, v31
    v_lshlrev_b32 v30, 16, v11
    v_and_b32 v31, 0xffff0000, v11

    buffer_store_dwordx4 v[4:7], v3, s[12:15], s49 offen
    s_mov_b64 exec, s[44:45]
    buffer_store_dwordx4 v[8:11], v3, s[12:15], s49 offen offset:1024
    s_mov_b64 exec, -1
    s_nop 1

    s_add_u32 s65, s65, 1
    s_cmp_lt_u32 s65, 16
    s_cbranch_scc1 L_rloop_94
    s_branch L_end_1

L_rskip_93:
L_end_1:
    s_endpgm
.section .rodata,"a"
.p2align 6
.amdhsa_kernel mega_kernel
  .amdhsa_next_free_vgpr 512
  .amdhsa_next_free_sgpr 100
  .amdhsa_accum_offset 256
  .amdhsa_group_segment_fixed_size 0
  .amdhsa_kernarg_size 128
  .amdhsa_user_sgpr_count 2
  .amdhsa_user_sgpr_kernarg_segment_ptr 1
  .amdhsa_system_sgpr_workgroup_id_x 1
.end_amdhsa_kernel
```
